```python
import torch

def _softmax(x, axis=-1):
    return torch.softmax(x, dim=axis)
def _gelu(x):
    return torch.nn.functional.gelu(x, approximate="tanh")
def _silu(x):
    return torch.nn.functional.silu(x)
def _sigmoid(x):
    return torch.sigmoid(x)
def _layernorm(x, axis=-1, eps=1e-5):
    m = x.mean(dim=axis, keepdim=True)
    v = x.var(dim=axis, keepdim=True, unbiased=False)
    return (x - m) / torch.sqrt(v + eps)
def _scatter_add(tgt, idx, src, axis=0):
    return tgt.clone().index_add_(axis, idx, src)
def _segment_sum(src, seg, n):
    out = torch.zeros((n,) + src.shape[1:], dtype=src.dtype)
    return out.index_add_(0, seg, src)
def _pad(x, pw):
    flat = tuple(v for pair in reversed(pw) for v in pair)
    return torch.nn.functional.pad(x, flat)

kernel_name = 'interleave_layers__linear_attn_block__dense_activation_silu__prompt'

def setup_inputs():

    _w = (lambda a: (lambda t: t.to(torch.bfloat16) if t.is_floating_point() else t)(torch.as_tensor(a)))
    def _A_setup():
        B, S, D = 1, 2048, 512
        return {
            "x": _w((lambda *s: torch.randn(*s, dtype=torch.bfloat16) * 0.05)(B, S, D)),
            "wqkv": _w((lambda *s: torch.randn(*s, dtype=torch.bfloat16) * 0.05)(D, 3 * D)),
            "wo": _w((lambda *s: torch.randn(*s, dtype=torch.bfloat16) * 0.05)(D, D)),
        }
    _A_in = _A_setup()

    def _B_setup():
        B, S, D, F = 1, 2048, 512, 1792
        return {
            "x": _w((lambda *s: torch.randn(*s, dtype=torch.bfloat16) * 0.05)(B, S, D)),
            "w1": _w((lambda *s: torch.randn(*s, dtype=torch.bfloat16) * 0.8)(D, F) * (D ** -0.5)),
            "w2": _w((lambda *s: torch.randn(*s, dtype=torch.bfloat16) * 0.8)(F, D) * (F ** -0.5)),
        }
    _B_in = _B_setup()

    return {
        "A_x": _A_in["x"],
        "A_wqkv": _A_in["wqkv"],
        "A_wo": _A_in["wo"],
        "B_x": _B_in["x"],
        "B_w1": _B_in["w1"],
        "B_w2": _B_in["w2"],
    }

def reference(A_x, A_wqkv, A_wo, B_x, B_w1, B_w2):
    def _A_ref(x, wqkv, wo):
        B, S, D = x.shape
        H = 32; Dh = D // H
        qkv = (lambda x, *d: x.permute(*d))((x @ wqkv).reshape(B, S, 3, H, Dh), 2, 0, 3, 1, 4)
        q, k, v = qkv[0], qkv[1], qkv[2]
        phi = lambda t: torch.where(t > 0, t + 1, torch.exp(t)) + 1e-6
        pq, pk = phi(q), phi(k)
        kv = torch.einsum("bhsd,bhse->bhde", pk, v)
        z = torch.einsum("bhsd->bhd", pk)
        num = torch.einsum("bhqd,bhde->bhqe", pq, kv)
        den = torch.einsum("bhqd,bhd->bhq", pq, z)[..., None] + 1e-6
        o = num / den
        return (lambda x, *d: x.permute(*d))(o, 0, 2, 1, 3).reshape(B, S, D) @ wo

    def _B_ref(x, w1, w2):
        h = torch.einsum("bsd,df->bsf", x, w1)
        h = _silu(h)
        out = torch.einsum("bsf,fd->bsd", h, w2)
        return out

    x = A_x
    x = x + _A_ref(_layernorm(x, axis=-1), A_wqkv, A_wo)
    x = x + _B_ref(_layernorm(x, axis=-1), B_w1, B_w2)
    x = x + _A_ref(_layernorm(x, axis=-1), A_wqkv, A_wo)
    x = x + _B_ref(_layernorm(x, axis=-1), B_w1, B_w2)
    return x
```

```asm
; @launch kernel=kA_kernel grid=(256,1,1) block=(512,1,1) lds=163840
; @launch kernel=kB_kernel grid=(256,1,1) block=(512,1,1) lds=163840
; @launch kernel=kC_kernel grid=(256,1,1) block=(512,1,1) lds=163840
.amdgcn_target "amdgcn-amd-amdhsa--gfx950"
.text
.globl kA_kernel
.p2align 8
.type kA_kernel,@function
kA_kernel:
    s_cmp_ge_u32 s2, 256
    s_cbranch_scc1 kA_kernel_end
    s_load_dwordx16 s[4:19], s[0:1], 0
    s_load_dwordx2 s[20:21], s[0:1], 64
    v_lshrrev_b32 v4, 6, v0
    v_and_b32 v1, 63, v0
    v_readfirstlane_b32 s3, v4
    v_and_b32 v2, 15, v0
    v_bfe_u32 v3, v0, 4, 2
    s_sub_u32 s59, s3, 4
    s_and_b32 s48, s2, 7
    s_lshl_b32 s48, s48, 1
    s_lshr_b32 s49, s2, 7
    s_add_u32 s96, s48, s49
    s_bfe_u32 s97, s2, 0x40003
    s_cmp_lt_u32 s3, 4
    s_cbranch_scc1 kA_kernel_compute
    s_cmp_lt_u32 s3, 6
    s_cbranch_scc1 kA_kernel_aload
    s_sub_u32 s59, s3, 6
    v_lshlrev_b32 v15, 4, v1
    s_mul_i32 s53, s59, 384
    s_lshl_b32 s54, s97, 6
    v_add_u32 v10, s53, v1
    v_mul_u32_u24 v11, 0xaaab, v10
    v_lshrrev_b32 v11, 19, v11
    v_mul_u32_u24 v12, 12, v11
    v_sub_u32 v12, v10, v12
    v_lshrrev_b32 v13, 1, v12
    v_bfe_u32 v14, v11, 3, 1
    v_sub_u32 v13, v13, v14
    v_add_u32 v14, 6, v13
    v_min_u32 v13, v13, v14
    v_lshrrev_b32 v14, 1, v13
    v_lshlrev_b32 v14, 10, v14
    v_and_b32 v13, 1, v13
    v_lshl_add_u32 v14, v13, 5, v14
    v_and_b32 v12, 1, v12
    v_lshl_add_u32 v14, v12, 4, v14
    v_mul_u32_u24 v11, 3072, v11
    v_add3_u32 v16, v11, v14, s54
    v_add_u32 v10, s53, v1
    v_add_u32 v10, 64, v10
    v_mul_u32_u24 v11, 0xaaab, v10
    v_lshrrev_b32 v11, 19, v11
    v_mul_u32_u24 v12, 12, v11
    v_sub_u32 v12, v10, v12
    v_lshrrev_b32 v13, 1, v12
    v_bfe_u32 v14, v11, 3, 1
    v_sub_u32 v13, v13, v14
    v_add_u32 v14, 6, v13
    v_min_u32 v13, v13, v14
    v_lshrrev_b32 v14, 1, v13
    v_lshlrev_b32 v14, 10, v14
    v_and_b32 v13, 1, v13
    v_lshl_add_u32 v14, v13, 5, v14
    v_and_b32 v12, 1, v12
    v_lshl_add_u32 v14, v12, 4, v14
    v_mul_u32_u24 v11, 3072, v11
    v_add3_u32 v17, v11, v14, s54
    v_add_u32 v10, s53, v1
    v_add_u32 v10, 128, v10
    v_mul_u32_u24 v11, 0xaaab, v10
    v_lshrrev_b32 v11, 19, v11
    v_mul_u32_u24 v12, 12, v11
    v_sub_u32 v12, v10, v12
    v_lshrrev_b32 v13, 1, v12
    v_bfe_u32 v14, v11, 3, 1
    v_sub_u32 v13, v13, v14
    v_add_u32 v14, 6, v13
    v_min_u32 v13, v13, v14
    v_lshrrev_b32 v14, 1, v13
    v_lshlrev_b32 v14, 10, v14
    v_and_b32 v13, 1, v13
    v_lshl_add_u32 v14, v13, 5, v14
    v_and_b32 v12, 1, v12
    v_lshl_add_u32 v14, v12, 4, v14
    v_mul_u32_u24 v11, 3072, v11
    v_add3_u32 v18, v11, v14, s54
    v_add_u32 v10, s53, v1
    v_add_u32 v10, 192, v10
    v_mul_u32_u24 v11, 0xaaab, v10
    v_lshrrev_b32 v11, 19, v11
    v_mul_u32_u24 v12, 12, v11
    v_sub_u32 v12, v10, v12
    v_lshrrev_b32 v13, 1, v12
    v_bfe_u32 v14, v11, 3, 1
    v_sub_u32 v13, v13, v14
    v_add_u32 v14, 6, v13
    v_min_u32 v13, v13, v14
    v_lshrrev_b32 v14, 1, v13
    v_lshlrev_b32 v14, 10, v14
    v_and_b32 v13, 1, v13
    v_lshl_add_u32 v14, v13, 5, v14
    v_and_b32 v12, 1, v12
    v_lshl_add_u32 v14, v12, 4, v14
    v_mul_u32_u24 v11, 3072, v11
    v_add3_u32 v19, v11, v14, s54
    v_add_u32 v10, s53, v1
    v_add_u32 v10, 256, v10
    v_mul_u32_u24 v11, 0xaaab, v10
    v_lshrrev_b32 v11, 19, v11
    v_mul_u32_u24 v12, 12, v11
    v_sub_u32 v12, v10, v12
    v_lshrrev_b32 v13, 1, v12
    v_bfe_u32 v14, v11, 3, 1
    v_sub_u32 v13, v13, v14
    v_add_u32 v14, 6, v13
    v_min_u32 v13, v13, v14
    v_lshrrev_b32 v14, 1, v13
    v_lshlrev_b32 v14, 10, v14
    v_and_b32 v13, 1, v13
    v_lshl_add_u32 v14, v13, 5, v14
    v_and_b32 v12, 1, v12
    v_lshl_add_u32 v14, v12, 4, v14
    v_mul_u32_u24 v11, 3072, v11
    v_add3_u32 v20, v11, v14, s54
    v_add_u32 v10, s53, v1
    v_add_u32 v10, 320, v10
    v_mul_u32_u24 v11, 0xaaab, v10
    v_lshrrev_b32 v11, 19, v11
    v_mul_u32_u24 v12, 12, v11
    v_sub_u32 v12, v10, v12
    v_lshrrev_b32 v13, 1, v12
    v_bfe_u32 v14, v11, 3, 1
    v_sub_u32 v13, v13, v14
    v_add_u32 v14, 6, v13
    v_min_u32 v13, v13, v14
    v_lshrrev_b32 v14, 1, v13
    v_lshlrev_b32 v14, 10, v14
    v_and_b32 v13, 1, v13
    v_lshl_add_u32 v14, v13, 5, v14
    v_and_b32 v12, 1, v12
    v_lshl_add_u32 v14, v12, 4, v14
    v_mul_u32_u24 v11, 3072, v11
    v_add3_u32 v21, v11, v14, s54
    s_mul_i32 s44, s59, 6144
    s_waitcnt lgkmcnt(0)
    s_mov_b32 s24, s6
    s_and_b32 s25, s7, 0xffff
    s_mov_b32 s26, 1572864
    s_mov_b32 s27, 0x20000
    s_mov_b32 s57, 0
    s_add_u32 m0, s44, 65536
    s_nop 0
    buffer_load_dwordx4 v16, s[24:27], s57 offen lds
    s_add_u32 m0, s44, 66560
    s_nop 0
    buffer_load_dwordx4 v17, s[24:27], s57 offen lds
    s_add_u32 m0, s44, 67584
    s_nop 0
    buffer_load_dwordx4 v18, s[24:27], s57 offen lds
    s_add_u32 m0, s44, 68608
    s_nop 0
    buffer_load_dwordx4 v19, s[24:27], s57 offen lds
    s_add_u32 m0, s44, 69632
    s_nop 0
    buffer_load_dwordx4 v20, s[24:27], s57 offen lds
    s_add_u32 m0, s44, 70656
    s_nop 0
    buffer_load_dwordx4 v21, s[24:27], s57 offen lds
    s_mov_b32 s57, 196608
    s_add_u32 m0, s44, 81920
    s_nop 0
    buffer_load_dwordx4 v16, s[24:27], s57 offen lds
    s_add_u32 m0, s44, 82944
    s_nop 0
    buffer_load_dwordx4 v17, s[24:27], s57 offen lds
    s_add_u32 m0, s44, 83968
    s_nop 0
    buffer_load_dwordx4 v18, s[24:27], s57 offen lds
    s_add_u32 m0, s44, 84992
    s_nop 0
    buffer_load_dwordx4 v19, s[24:27], s57 offen lds
    s_add_u32 m0, s44, 86016
    s_nop 0
    buffer_load_dwordx4 v20, s[24:27], s57 offen lds
    s_add_u32 m0, s44, 87040
    s_nop 0
    buffer_load_dwordx4 v21, s[24:27], s57 offen lds
    s_getpc_b64 s[40:41]
kA_kernel_pc:
    s_mov_b32 s42, all_code_end-kA_kernel_pc-16
    s_bfe_u32 s43, s2, 0x50003
    s_lshl_b32 s43, s43, 1
    s_add_u32 s43, s43, s59
    s_lshl_b32 s43, s43, 10
    v_add_u32 v5, s43, v15
    v_min_u32 v5, s42, v5
    v_and_b32 v5, -4, v5
    global_load_dwordx4 v[24:27], v5, s[40:41]
    v_add_u32 v5, s43, v15
    v_add_u32 v5, 65536, v5
    v_min_u32 v5, s42, v5
    v_and_b32 v5, -4, v5
    s_waitcnt vmcnt(0)
    global_load_dwordx4 v[24:27], v5, s[40:41]
    s_barrier
    s_mov_b32 s57, 393216
    s_add_u32 m0, s44, 98304
    s_nop 0
    buffer_load_dwordx4 v16, s[24:27], s57 offen lds
    s_add_u32 m0, s44, 99328
    s_nop 0
    buffer_load_dwordx4 v17, s[24:27], s57 offen lds
    s_add_u32 m0, s44, 100352
    s_nop 0
    buffer_load_dwordx4 v18, s[24:27], s57 offen lds
    s_add_u32 m0, s44, 101376
    s_nop 0
    buffer_load_dwordx4 v19, s[24:27], s57 offen lds
    s_add_u32 m0, s44, 102400
    s_nop 0
    buffer_load_dwordx4 v20, s[24:27], s57 offen lds
    s_add_u32 m0, s44, 103424
    s_nop 0
    buffer_load_dwordx4 v21, s[24:27], s57 offen lds
    s_mov_b32 s57, 589824
    s_add_u32 m0, s44, 114688
    s_nop 0
    buffer_load_dwordx4 v16, s[24:27], s57 offen lds
    s_add_u32 m0, s44, 115712
    s_nop 0
    buffer_load_dwordx4 v17, s[24:27], s57 offen lds
    s_add_u32 m0, s44, 116736
    s_nop 0
    buffer_load_dwordx4 v18, s[24:27], s57 offen lds
    s_add_u32 m0, s44, 117760
    s_nop 0
    buffer_load_dwordx4 v19, s[24:27], s57 offen lds
    s_add_u32 m0, s44, 118784
    s_nop 0
    buffer_load_dwordx4 v20, s[24:27], s57 offen lds
    s_add_u32 m0, s44, 119808
    s_nop 0
    buffer_load_dwordx4 v21, s[24:27], s57 offen lds
    s_barrier
    s_mov_b32 s57, 786432
    s_add_u32 m0, s44, 131072
    s_nop 0
    buffer_load_dwordx4 v16, s[24:27], s57 offen lds
    s_add_u32 m0, s44, 132096
    s_nop 0
    buffer_load_dwordx4 v17, s[24:27], s57 offen lds
    s_add_u32 m0, s44, 133120
    s_nop 0
    buffer_load_dwordx4 v18, s[24:27], s57 offen lds
    s_add_u32 m0, s44, 134144
    s_nop 0
    buffer_load_dwordx4 v19, s[24:27], s57 offen lds
    s_add_u32 m0, s44, 135168
    s_nop 0
    buffer_load_dwordx4 v20, s[24:27], s57 offen lds
    s_add_u32 m0, s44, 136192
    s_nop 0
    buffer_load_dwordx4 v21, s[24:27], s57 offen lds
    s_mov_b32 s57, 983040
    s_add_u32 m0, s44, 65536
    s_nop 0
    buffer_load_dwordx4 v16, s[24:27], s57 offen lds
    s_add_u32 m0, s44, 66560
    s_nop 0
    buffer_load_dwordx4 v17, s[24:27], s57 offen lds
    s_add_u32 m0, s44, 67584
    s_nop 0
    buffer_load_dwordx4 v18, s[24:27], s57 offen lds
    s_add_u32 m0, s44, 68608
    s_nop 0
    buffer_load_dwordx4 v19, s[24:27], s57 offen lds
    s_add_u32 m0, s44, 69632
    s_nop 0
    buffer_load_dwordx4 v20, s[24:27], s57 offen lds
    s_add_u32 m0, s44, 70656
    s_nop 0
    buffer_load_dwordx4 v21, s[24:27], s57 offen lds
    s_waitcnt vmcnt(18)
    s_barrier
    s_mov_b32 s28, s12
    s_and_b32 s29, s13, 0xffff
    s_mov_b32 s30, 1835008
    s_mov_b32 s31, 0x20000
    s_min_u32 s40, s2, 223
    s_mul_i32 s41, s40, 2341
    s_lshr_b32 s41, s41, 16
    s_mul_i32 s48, s41, 28
    s_sub_u32 s40, s40, s48
    s_lshl_b32 s48, s41, 6
    s_lshl_b32 s49, s59, 5
    s_add_u32 s48, s48, s49
    v_lshrrev_b32 v52, 3, v1
    v_add_u32 v52, s48, v52
    v_mul_u32_u24 v52, 3584, v52
    v_and_b32 v5, 7, v1
    v_lshl_add_u32 v52, v5, 4, v52
    s_lshl_b32 s48, s40, 7
    v_add_u32 v52, s48, v52
    s_mov_b32 s49, 0
    buffer_load_dwordx4 v[28:31], v52, s[28:31], s49 offen
    s_mov_b32 s49, 28672
    buffer_load_dwordx4 v[32:35], v52, s[28:31], s49 offen
    s_mov_b32 s49, 57344
    buffer_load_dwordx4 v[36:39], v52, s[28:31], s49 offen
    s_mov_b32 s49, 86016
    buffer_load_dwordx4 v[40:43], v52, s[28:31], s49 offen
    s_mov_b32 s57, 1179648
    s_add_u32 m0, s44, 81920
    s_nop 0
    buffer_load_dwordx4 v16, s[24:27], s57 offen lds
    s_add_u32 m0, s44, 82944
    s_nop 0
    buffer_load_dwordx4 v17, s[24:27], s57 offen lds
    s_add_u32 m0, s44, 83968
    s_nop 0
    buffer_load_dwordx4 v18, s[24:27], s57 offen lds
    s_add_u32 m0, s44, 84992
    s_nop 0
    buffer_load_dwordx4 v19, s[24:27], s57 offen lds
    s_add_u32 m0, s44, 86016
    s_nop 0
    buffer_load_dwordx4 v20, s[24:27], s57 offen lds
    s_add_u32 m0, s44, 87040
    s_nop 0
    buffer_load_dwordx4 v21, s[24:27], s57 offen lds
    s_waitcnt vmcnt(22)
    s_barrier
    s_mov_b32 s57, 1376256
    s_add_u32 m0, s44, 98304
    s_nop 0
    buffer_load_dwordx4 v16, s[24:27], s57 offen lds
    s_add_u32 m0, s44, 99328
    s_nop 0
    buffer_load_dwordx4 v17, s[24:27], s57 offen lds
    s_add_u32 m0, s44, 100352
    s_nop 0
    buffer_load_dwordx4 v18, s[24:27], s57 offen lds
    s_add_u32 m0, s44, 101376
    s_nop 0
    buffer_load_dwordx4 v19, s[24:27], s57 offen lds
    s_add_u32 m0, s44, 102400
    s_nop 0
    buffer_load_dwordx4 v20, s[24:27], s57 offen lds
    s_add_u32 m0, s44, 103424
    s_nop 0
    buffer_load_dwordx4 v21, s[24:27], s57 offen lds
    s_waitcnt vmcnt(22)
    s_barrier
    s_mov_b32 s32, s14
    s_and_b32 s33, s15, 0xffff
    s_mov_b32 s34, 1835008
    s_mov_b32 s35, 0x20000
    s_mov_b32 s36, s8
    s_and_b32 s37, s9, 0xffff
    s_mov_b32 s38, 524288
    s_mov_b32 s39, 0x20000
    s_mul_i32 s48, s2, 7168
    s_mul_i32 s49, s59, 3584
    s_add_u32 s48, s48, s49
    v_add_u32 v5, s48, v15
    buffer_load_dwordx4 v[56:59], v5, s[32:35], 0 offen offset:0
    buffer_load_dwordx4 v[60:63], v5, s[32:35], 0 offen offset:1024
    buffer_load_dwordx4 v[64:67], v5, s[32:35], 0 offen offset:2048
    buffer_load_dwordx4 v[68:71], v5, s[32:35], 0 offen offset:2560
    s_lshl_b32 s48, s2, 11
    s_lshl_b32 s49, s59, 10
    s_add_u32 s48, s48, s49
    v_add_u32 v5, s48, v15
    buffer_load_dwordx4 v[72:75], v5, s[36:39], 0 offen
    s_waitcnt vmcnt(21)
    s_barrier
    s_mov_b32 s60, 0x00003f80
    s_mov_b32 s61, 0x3f800000
    v_mov_b32 v44, 0
    v_mov_b32 v45, 0
    v_mov_b32 v46, 0
    v_mov_b32 v47, 0
    v_mov_b32 v48, 0
    v_mov_b32 v49, 0
    v_mov_b32 v50, 0
    v_mov_b32 v51, 0
    s_waitcnt vmcnt(20)
    v_dot2_f32_bf16 v44, v28, s60, v44
    v_dot2_f32_bf16 v45, v28, s61, v45
    v_dot2_f32_bf16 v46, v29, s60, v46
    v_dot2_f32_bf16 v47, v29, s61, v47
    v_dot2_f32_bf16 v48, v30, s60, v48
    v_dot2_f32_bf16 v49, v30, s61, v49
    v_dot2_f32_bf16 v50, v31, s60, v50
    v_dot2_f32_bf16 v51, v31, s61, v51
    s_waitcnt vmcnt(19)
    v_dot2_f32_bf16 v44, v32, s60, v44
    v_dot2_f32_bf16 v45, v32, s61, v45
    v_dot2_f32_bf16 v46, v33, s60, v46
    v_dot2_f32_bf16 v47, v33, s61, v47
    v_dot2_f32_bf16 v48, v34, s60, v48
    v_dot2_f32_bf16 v49, v34, s61, v49
    v_dot2_f32_bf16 v50, v35, s60, v50
    v_dot2_f32_bf16 v51, v35, s61, v51
    s_waitcnt vmcnt(18)
    v_dot2_f32_bf16 v44, v36, s60, v44
    v_dot2_f32_bf16 v45, v36, s61, v45
    v_dot2_f32_bf16 v46, v37, s60, v46
    v_dot2_f32_bf16 v47, v37, s61, v47
    v_dot2_f32_bf16 v48, v38, s60, v48
    v_dot2_f32_bf16 v49, v38, s61, v49
    v_dot2_f32_bf16 v50, v39, s60, v50
    v_dot2_f32_bf16 v51, v39, s61, v51
    s_waitcnt vmcnt(17)
    v_dot2_f32_bf16 v44, v40, s60, v44
    v_dot2_f32_bf16 v45, v40, s61, v45
    v_dot2_f32_bf16 v46, v41, s60, v46
    v_dot2_f32_bf16 v47, v41, s61, v47
    v_dot2_f32_bf16 v48, v42, s60, v48
    v_dot2_f32_bf16 v49, v42, s61, v49
    v_dot2_f32_bf16 v50, v43, s60, v50
    v_dot2_f32_bf16 v51, v43, s61, v51
    s_waitcnt vmcnt(11)
    s_barrier
    v_add_f32_dpp v28, v44, v44 row_ror:8 row_mask:0xf bank_mask:0xf
    v_add_f32_dpp v29, v45, v45 row_ror:8 row_mask:0xf bank_mask:0xf
    v_add_f32_dpp v30, v46, v46 row_ror:8 row_mask:0xf bank_mask:0xf
    v_add_f32_dpp v31, v47, v47 row_ror:8 row_mask:0xf bank_mask:0xf
    v_add_f32_dpp v32, v48, v48 row_ror:8 row_mask:0xf bank_mask:0xf
    v_add_f32_dpp v33, v49, v49 row_ror:8 row_mask:0xf bank_mask:0xf
    v_add_f32_dpp v34, v50, v50 row_ror:8 row_mask:0xf bank_mask:0xf
    v_add_f32_dpp v35, v51, v51 row_ror:8 row_mask:0xf bank_mask:0xf
    v_mov_b32 v44, v28
    s_nop 1
    v_permlane16_swap_b32 v28, v44
    v_add_f32 v28, v28, v44
    v_mov_b32 v44, v28
    s_nop 1
    v_permlane32_swap_b32 v28, v44
    v_add_f32 v28, v28, v44
    v_mov_b32 v45, v29
    s_nop 1
    v_permlane16_swap_b32 v29, v45
    v_add_f32 v29, v29, v45
    v_mov_b32 v45, v29
    s_nop 1
    v_permlane32_swap_b32 v29, v45
    v_add_f32 v29, v29, v45
    v_mov_b32 v46, v30
    s_nop 1
    v_permlane16_swap_b32 v30, v46
    v_add_f32 v30, v30, v46
    v_mov_b32 v46, v30
    s_nop 1
    v_permlane32_swap_b32 v30, v46
    v_add_f32 v30, v30, v46
    v_mov_b32 v47, v31
    s_nop 1
    v_permlane16_swap_b32 v31, v47
    v_add_f32 v31, v31, v47
    v_mov_b32 v47, v31
    s_nop 1
    v_permlane32_swap_b32 v31, v47
    v_add_f32 v31, v31, v47
    v_mov_b32 v48, v32
    s_nop 1
    v_permlane16_swap_b32 v32, v48
    v_add_f32 v32, v32, v48
    v_mov_b32 v48, v32
    s_nop 1
    v_permlane32_swap_b32 v32, v48
    v_add_f32 v32, v32, v48
    v_mov_b32 v49, v33
    s_nop 1
    v_permlane16_swap_b32 v33, v49
    v_add_f32 v33, v33, v49
    v_mov_b32 v49, v33
    s_nop 1
    v_permlane32_swap_b32 v33, v49
    v_add_f32 v33, v33, v49
    v_mov_b32 v50, v34
    s_nop 1
    v_permlane16_swap_b32 v34, v50
    v_add_f32 v34, v34, v50
    v_mov_b32 v50, v34
    s_nop 1
    v_permlane32_swap_b32 v34, v50
    v_add_f32 v34, v34, v50
    v_mov_b32 v51, v35
    s_nop 1
    v_permlane16_swap_b32 v35, v51
    v_add_f32 v35, v35, v51
    v_mov_b32 v51, v35
    s_nop 1
    v_permlane32_swap_b32 v35, v51
    v_add_f32 v35, v35, v51
    s_lshl_b32 s48, s59, 8
    s_add_u32 s48, s48, 155648
    v_and_b32 v5, 7, v1
    v_lshlrev_b32 v52, 5, v5
    v_add_u32 v5, s48, v52
    ds_write_b128 v5, v[28:31]
    ds_write_b128 v5, v[32:35] offset:16
    s_waitcnt lgkmcnt(0)
    s_waitcnt vmcnt(5)
    s_barrier
    v_add_u32 v5, 155648, v52
    ds_read_b128 v[28:31], v5 offset:0
    ds_read_b128 v[36:39], v5 offset:256
    ds_read_b128 v[32:35], v5 offset:16
    ds_read_b128 v[40:43], v5 offset:272
    s_waitcnt lgkmcnt(2)
    v_add_f32 v28, v28, v36
    v_add_f32 v29, v29, v37
    v_add_f32 v30, v30, v38
    v_add_f32 v31, v31, v39
    s_waitcnt lgkmcnt(0)
    v_add_f32 v32, v32, v40
    v_add_f32 v33, v33, v41
    v_add_f32 v34, v34, v42
    v_add_f32 v35, v35, v43
    s_add_u32 s28, s20, 14819328
    s_addc_u32 s29, s21, 0
    s_and_b32 s29, s29, 0xffff
    s_mov_b32 s30, 57344
    s_mov_b32 s31, 0x20000
    s_mul_i32 s48, s41, 7168
    s_lshl_b32 s49, s40, 8
    s_add_u32 s48, s48, s49
    v_add_u32 v5, s48, v52
    s_mov_b64 exec, 0xff
    buffer_store_dwordx4 v[28:31], v5, s[28:31], 0 offen
    buffer_store_dwordx4 v[32:35], v5, s[28:31], 0 offen offset:16
    s_mov_b64 exec, -1
    s_barrier
    s_barrier
    s_endpgm
kA_kernel_aload:
    s_nop 7
    s_nop 7
    s_lshl_b32 s55, s59, 13
    s_mov_b32 s22, s96
    s_mov_b32 s23, s97
    s_lshl_b32 s50, s22, 7
    s_lshl_b32 s54, s23, 6
    s_mul_i32 s58, s59, 64
    s_add_u32 s58, s58, s50
    v_lshrrev_b32 v5, 3, v1
    v_bfe_u32 v6, v5, 1, 3
    v_and_b32 v10, 7, v1
    v_xor_b32 v6, v6, v10
    v_add_u32 v5, s58, v5
    v_mul_u32_u24 v5, 1024, v5
    v_lshl_add_u32 v10, v6, 4, v5
    v_lshrrev_b32 v5, 3, v1
    v_add_u32 v5, 8, v5
    v_bfe_u32 v6, v5, 1, 3
    v_and_b32 v11, 7, v1
    v_xor_b32 v6, v6, v11
    v_add_u32 v5, s58, v5
    v_mul_u32_u24 v5, 1024, v5
    v_lshl_add_u32 v11, v6, 4, v5
    v_lshrrev_b32 v5, 3, v1
    v_add_u32 v5, 16, v5
    v_bfe_u32 v6, v5, 1, 3
    v_and_b32 v12, 7, v1
    v_xor_b32 v6, v6, v12
    v_add_u32 v5, s58, v5
    v_mul_u32_u24 v5, 1024, v5
    v_lshl_add_u32 v12, v6, 4, v5
    v_lshrrev_b32 v5, 3, v1
    v_add_u32 v5, 24, v5
    v_bfe_u32 v6, v5, 1, 3
    v_and_b32 v13, 7, v1
    v_xor_b32 v6, v6, v13
    v_add_u32 v5, s58, v5
    v_mul_u32_u24 v5, 1024, v5
    v_lshl_add_u32 v13, v6, 4, v5
    v_lshrrev_b32 v5, 3, v1
    v_add_u32 v5, 32, v5
    v_bfe_u32 v6, v5, 1, 3
    v_and_b32 v14, 7, v1
    v_xor_b32 v6, v6, v14
    v_add_u32 v5, s58, v5
    v_mul_u32_u24 v5, 1024, v5
    v_lshl_add_u32 v14, v6, 4, v5
    v_lshrrev_b32 v5, 3, v1
    v_add_u32 v5, 40, v5
    v_bfe_u32 v6, v5, 1, 3
    v_and_b32 v15, 7, v1
    v_xor_b32 v6, v6, v15
    v_add_u32 v5, s58, v5
    v_mul_u32_u24 v5, 1024, v5
    v_lshl_add_u32 v15, v6, 4, v5
    v_lshrrev_b32 v5, 3, v1
    v_add_u32 v5, 48, v5
    v_bfe_u32 v6, v5, 1, 3
    v_and_b32 v16, 7, v1
    v_xor_b32 v6, v6, v16
    v_add_u32 v5, s58, v5
    v_mul_u32_u24 v5, 1024, v5
    v_lshl_add_u32 v16, v6, 4, v5
    v_lshrrev_b32 v5, 3, v1
    v_add_u32 v5, 56, v5
    v_bfe_u32 v6, v5, 1, 3
    v_and_b32 v17, 7, v1
    v_xor_b32 v6, v6, v17
    v_add_u32 v5, s58, v5
    v_mul_u32_u24 v5, 1024, v5
    v_lshl_add_u32 v17, v6, 4, v5
    s_waitcnt lgkmcnt(0)
    s_mov_b32 s24, s4
    s_and_b32 s25, s5, 0xffff
    s_mov_b32 s26, 2097152
    s_mov_b32 s27, 0x20000
    v_mov_b32 v20, 0
    v_mov_b32 v21, 0
    v_mov_b32 v22, 0
    v_mov_b32 v23, 0
    s_add_u32 s28, s20, 14680064
    s_addc_u32 s29, s21, 0
    s_and_b32 s29, s29, 0xffff
    s_mov_b32 s30, 131072
    s_mov_b32 s31, 0x20000
    s_mov_b32 s32, s18
    s_and_b32 s33, s19, 0xffff
    s_mov_b32 s34, 256
    s_mov_b32 s35, 0x20000
    s_cmp_eq_u32 s59, 0
    s_cbranch_scc1 kA_kernel_tk
    s_lshl_b32 s48, s2, 8
    s_add_u32 s48, s48, 0x10000
    v_lshlrev_b32 v8, 4, v1
    v_add_u32 v8, s48, v8
    s_mov_b64 exec, 0xffff
    buffer_store_dwordx4 v[20:23], v8, s[28:31], 0 offen
    s_mov_b64 exec, -1
    s_branch kA_kernel_tkd
kA_kernel_tk:
    s_lshl_b32 s48, s97, 2
    v_mov_b32 v8, s48
    v_mov_b32 v9, 1
    s_mov_b64 exec, 1
    buffer_atomic_add v9, v8, s[32:35], 0 offen sc0
    s_mov_b64 exec, -1
kA_kernel_tkd:
    s_mov_b32 s56, 0
    s_add_u32 m0, s55, 0
    s_nop 0
    buffer_load_dwordx4 v10, s[24:27], s56 offen lds
    s_add_u32 m0, s55, 1024
    s_nop 0
    buffer_load_dwordx4 v11, s[24:27], s56 offen lds
    s_add_u32 m0, s55, 2048
    s_nop 0
    buffer_load_dwordx4 v12, s[24:27], s56 offen lds
    s_add_u32 m0, s55, 3072
    s_nop 0
    buffer_load_dwordx4 v13, s[24:27], s56 offen lds
    s_add_u32 m0, s55, 4096
    s_nop 0
    buffer_load_dwordx4 v14, s[24:27], s56 offen lds
    s_add_u32 m0, s55, 5120
    s_nop 0
    buffer_load_dwordx4 v15, s[24:27], s56 offen lds
    s_add_u32 m0, s55, 6144
    s_nop 0
    buffer_load_dwordx4 v16, s[24:27], s56 offen lds
    s_add_u32 m0, s55, 7168
    s_nop 0
    buffer_load_dwordx4 v17, s[24:27], s56 offen lds
    s_mov_b32 s56, 128
    s_add_u32 m0, s55, 16384
    s_nop 0
    buffer_load_dwordx4 v10, s[24:27], s56 offen lds
    s_add_u32 m0, s55, 17408
    s_nop 0
    buffer_load_dwordx4 v11, s[24:27], s56 offen lds
    s_add_u32 m0, s55, 18432
    s_nop 0
    buffer_load_dwordx4 v12, s[24:27], s56 offen lds
    s_add_u32 m0, s55, 19456
    s_nop 0
    buffer_load_dwordx4 v13, s[24:27], s56 offen lds
    s_add_u32 m0, s55, 20480
    s_nop 0
    buffer_load_dwordx4 v14, s[24:27], s56 offen lds
    s_add_u32 m0, s55, 21504
    s_nop 0
    buffer_load_dwordx4 v15, s[24:27], s56 offen lds
    s_add_u32 m0, s55, 22528
    s_nop 0
    buffer_load_dwordx4 v16, s[24:27], s56 offen lds
    s_add_u32 m0, s55, 23552
    s_nop 0
    buffer_load_dwordx4 v17, s[24:27], s56 offen lds
    s_mov_b32 s56, 256
    s_add_u32 m0, s55, 32768
    s_nop 0
    buffer_load_dwordx4 v10, s[24:27], s56 offen lds
    s_add_u32 m0, s55, 33792
    s_nop 0
    buffer_load_dwordx4 v11, s[24:27], s56 offen lds
    s_add_u32 m0, s55, 34816
    s_nop 0
    buffer_load_dwordx4 v12, s[24:27], s56 offen lds
    s_add_u32 m0, s55, 35840
    s_nop 0
    buffer_load_dwordx4 v13, s[24:27], s56 offen lds
    s_add_u32 m0, s55, 36864
    s_nop 0
    buffer_load_dwordx4 v14, s[24:27], s56 offen lds
    s_add_u32 m0, s55, 37888
    s_nop 0
    buffer_load_dwordx4 v15, s[24:27], s56 offen lds
    s_add_u32 m0, s55, 38912
    s_nop 0
    buffer_load_dwordx4 v16, s[24:27], s56 offen lds
    s_add_u32 m0, s55, 39936
    s_nop 0
    buffer_load_dwordx4 v17, s[24:27], s56 offen lds
    s_waitcnt vmcnt(16)
    s_barrier
    s_mov_b32 s56, 384
    s_add_u32 m0, s55, 49152
    s_nop 0
    buffer_load_dwordx4 v10, s[24:27], s56 offen lds
    s_add_u32 m0, s55, 50176
    s_nop 0
    buffer_load_dwordx4 v11, s[24:27], s56 offen lds
    s_add_u32 m0, s55, 51200
    s_nop 0
    buffer_load_dwordx4 v12, s[24:27], s56 offen lds
    s_add_u32 m0, s55, 52224
    s_nop 0
    buffer_load_dwordx4 v13, s[24:27], s56 offen lds
    s_add_u32 m0, s55, 53248
    s_nop 0
    buffer_load_dwordx4 v14, s[24:27], s56 offen lds
    s_add_u32 m0, s55, 54272
    s_nop 0
    buffer_load_dwordx4 v15, s[24:27], s56 offen lds
    s_add_u32 m0, s55, 55296
    s_nop 0
    buffer_load_dwordx4 v16, s[24:27], s56 offen lds
    s_add_u32 m0, s55, 56320
    s_nop 0
    buffer_load_dwordx4 v17, s[24:27], s56 offen lds
    s_cmp_lg_u32 s59, 0
    s_cbranch_scc1 kA_kernel_zk
    v_readfirstlane_b32 s48, v9
    s_nop 3
    s_cmp_lg_u32 s48, 0
    s_cbranch_scc1 kA_kernel_zk
    s_lshl_b32 s48, s97, 11
    v_lshlrev_b32 v8, 4, v1
    v_add_u32 v5, s48, v8
    buffer_store_dwordx4 v[20:23], v5, s[28:31], 0 offen sc0 sc1
    buffer_store_dwordx4 v[20:23], v5, s[28:31], 0 offen offset:1024 sc0 sc1
    s_lshl_b32 s48, s97, 7
    s_add_u32 s48, s48, 32768
    v_add_u32 v5, s48, v8
    s_mov_b64 exec, 0xff
    buffer_store_dwordx4 v[20:23], v5, s[28:31], 0 offen sc0 sc1
    s_waitcnt vmcnt(0)
    s_lshl_b32 s48, s97, 2
    s_add_u32 s48, s48, 64
    v_mov_b32 v8, s48
    v_mov_b32 v9, 1
    s_mov_b64 exec, 1
    buffer_store_dword v9, v8, s[32:35], 0 offen sc0 sc1
    s_mov_b64 exec, -1
kA_kernel_zk:
    s_waitcnt vmcnt(16)
    s_barrier
    s_mov_b32 s56, 512
    s_add_u32 m0, s55, 0
    s_nop 0
    buffer_load_dwordx4 v10, s[24:27], s56 offen lds
    s_add_u32 m0, s55, 1024
    s_nop 0
    buffer_load_dwordx4 v11, s[24:27], s56 offen lds
    s_add_u32 m0, s55, 2048
    s_nop 0
    buffer_load_dwordx4 v12, s[24:27], s56 offen lds
    s_add_u32 m0, s55, 3072
    s_nop 0
    buffer_load_dwordx4 v13, s[24:27], s56 offen lds
    s_add_u32 m0, s55, 4096
    s_nop 0
    buffer_load_dwordx4 v14, s[24:27], s56 offen lds
    s_add_u32 m0, s55, 5120
    s_nop 0
    buffer_load_dwordx4 v15, s[24:27], s56 offen lds
    s_add_u32 m0, s55, 6144
    s_nop 0
    buffer_load_dwordx4 v16, s[24:27], s56 offen lds
    s_add_u32 m0, s55, 7168
    s_nop 0
    buffer_load_dwordx4 v17, s[24:27], s56 offen lds
    s_waitcnt vmcnt(16)
    s_barrier
    s_mov_b32 s56, 640
    s_add_u32 m0, s55, 16384
    s_nop 0
    buffer_load_dwordx4 v10, s[24:27], s56 offen lds
    s_add_u32 m0, s55, 17408
    s_nop 0
    buffer_load_dwordx4 v11, s[24:27], s56 offen lds
    s_add_u32 m0, s55, 18432
    s_nop 0
    buffer_load_dwordx4 v12, s[24:27], s56 offen lds
    s_add_u32 m0, s55, 19456
    s_nop 0
    buffer_load_dwordx4 v13, s[24:27], s56 offen lds
    s_add_u32 m0, s55, 20480
    s_nop 0
    buffer_load_dwordx4 v14, s[24:27], s56 offen lds
    s_add_u32 m0, s55, 21504
    s_nop 0
    buffer_load_dwordx4 v15, s[24:27], s56 offen lds
    s_add_u32 m0, s55, 22528
    s_nop 0
    buffer_load_dwordx4 v16, s[24:27], s56 offen lds
    s_add_u32 m0, s55, 23552
    s_nop 0
    buffer_load_dwordx4 v17, s[24:27], s56 offen lds
    s_waitcnt vmcnt(16)
    s_barrier
    s_mov_b32 s56, 768
    s_add_u32 m0, s55, 32768
    s_nop 0
    buffer_load_dwordx4 v10, s[24:27], s56 offen lds
    s_add_u32 m0, s55, 33792
    s_nop 0
    buffer_load_dwordx4 v11, s[24:27], s56 offen lds
    s_add_u32 m0, s55, 34816
    s_nop 0
    buffer_load_dwordx4 v12, s[24:27], s56 offen lds
    s_add_u32 m0, s55, 35840
    s_nop 0
    buffer_load_dwordx4 v13, s[24:27], s56 offen lds
    s_add_u32 m0, s55, 36864
    s_nop 0
    buffer_load_dwordx4 v14, s[24:27], s56 offen lds
    s_add_u32 m0, s55, 37888
    s_nop 0
    buffer_load_dwordx4 v15, s[24:27], s56 offen lds
    s_add_u32 m0, s55, 38912
    s_nop 0
    buffer_load_dwordx4 v16, s[24:27], s56 offen lds
    s_add_u32 m0, s55, 39936
    s_nop 0
    buffer_load_dwordx4 v17, s[24:27], s56 offen lds
    s_waitcnt vmcnt(16)
    s_barrier
    s_mov_b32 s56, 896
    s_add_u32 m0, s55, 49152
    s_nop 0
    buffer_load_dwordx4 v10, s[24:27], s56 offen lds
    s_add_u32 m0, s55, 50176
    s_nop 0
    buffer_load_dwordx4 v11, s[24:27], s56 offen lds
    s_add_u32 m0, s55, 51200
    s_nop 0
    buffer_load_dwordx4 v12, s[24:27], s56 offen lds
    s_add_u32 m0, s55, 52224
    s_nop 0
    buffer_load_dwordx4 v13, s[24:27], s56 offen lds
    s_add_u32 m0, s55, 53248
    s_nop 0
    buffer_load_dwordx4 v14, s[24:27], s56 offen lds
    s_add_u32 m0, s55, 54272
    s_nop 0
    buffer_load_dwordx4 v15, s[24:27], s56 offen lds
    s_add_u32 m0, s55, 55296
    s_nop 0
    buffer_load_dwordx4 v16, s[24:27], s56 offen lds
    s_add_u32 m0, s55, 56320
    s_nop 0
    buffer_load_dwordx4 v17, s[24:27], s56 offen lds
    s_waitcnt vmcnt(16)
    s_barrier
    s_waitcnt vmcnt(8)
    s_barrier
    s_waitcnt vmcnt(0)
    s_barrier
    s_lshl_b32 s48, s97, 2
    s_add_u32 s48, s48, 64
    v_mov_b32 v8, s48
    s_mov_b64 exec, 1
    s_mov_b32 s49, 0
kA_kernel_rp:
    buffer_load_dword v9, v8, s[32:35], 0 offen sc0 sc1
    s_add_u32 s49, s49, 1
    s_waitcnt vmcnt(0)
    v_cmp_ne_u32 vcc, 1, v9
    s_cmp_gt_u32 s49, 200000
    s_cbranch_scc1 kA_kernel_rpd
    s_cbranch_vccnz kA_kernel_rp
kA_kernel_rpd:
    s_mov_b64 exec, -1
    s_barrier
    s_barrier
    s_endpgm
kA_kernel_compute:
    s_nop 7
    s_nop 7
    s_mov_b32 s22, s96
    s_mov_b32 s23, s97
    s_lshl_b32 s50, s22, 7
    s_lshl_b32 s54, s23, 6
    s_lshr_b32 s52, s3, 1
    s_lshl_b32 s52, s52, 6
    s_and_b32 s53, s3, 1
    s_lshl_b32 s56, s23, 7
    s_lshl_b32 s57, s53, 6
    s_add_u32 s56, s56, s57
    v_lshlrev_b32 v24, 4, v3
    v_add_u32 v24, s56, v24
    v_lshlrev_b32 v25, 2, v2
    v_add_u32 v25, s56, v25
    v_add_u32 v25, 2048, v25
    v_mov_b32 v12, 0
    v_mov_b32 v13, 0
    v_mov_b32 v14, 0
    v_mov_b32 v15, 0
    v_mov_b32 v16, 0
    v_mov_b32 v17, 0
    v_mov_b32 v18, 0
    v_mov_b32 v19, 0
    v_mov_b32 v20, 0
    v_mov_b32 v21, 0
    v_mov_b32 v22, 0
    v_mov_b32 v23, 0
    s_waitcnt lgkmcnt(0)
    s_mov_b32 s24, s6
    s_and_b32 s25, s7, 0xffff
    s_mov_b32 s26, 1572864
    s_mov_b32 s27, 0x20000
    s_mov_b32 s28, s4
    s_and_b32 s29, s5, 0xffff
    s_mov_b32 s30, 2097152
    s_mov_b32 s31, 0x20000
    v_lshlrev_b32 v5, 4, v0
    s_mul_i32 s57, s2, 6144
    buffer_load_dword v28, v5, s[24:27], s57 offen
    buffer_load_dword v29, v5, s[24:27], s57 offen offset:2048
    s_lshl_b32 s57, s2, 13
    buffer_load_dword v30, v5, s[28:31], s57 offen
    s_add_u32 s57, s57, 4096
    buffer_load_dword v31, v5, s[28:31], s57 offen
    v_mov_b32 v32, 0x3f803f80
    v_mov_b32 v33, 0x3f803f80
    v_mov_b32 v34, 0x3f803f80
    v_mov_b32 v35, 0x3f803f80
    s_lshl_b32 s57, s53, 5
    s_add_u32 s66, s52, s57
    s_xor_b32 s57, s57, 32
    s_add_u32 s67, s52, s57
    v_add_u32 v5, s66, v2
    v_mul_u32_u24 v5, 128, v5
    v_bfe_u32 v6, v2, 1, 3
    v_xor_b32 v6, v6, v3
    v_xor_b32 v36, 0, v6
    v_lshl_add_u32 v36, v36, 4, v5
    v_add_u32 v37, 65536, v36
    v_xor_b32 v38, 4, v6
    v_lshl_add_u32 v38, v38, 4, v5
    v_add_u32 v39, 65536, v38
    v_add_u32 v5, s67, v2
    v_mul_u32_u24 v5, 128, v5
    v_bfe_u32 v6, v2, 1, 3
    v_xor_b32 v6, v6, v3
    v_xor_b32 v40, 0, v6
    v_lshl_add_u32 v40, v40, 4, v5
    v_add_u32 v41, 65536, v40
    v_xor_b32 v42, 4, v6
    v_lshl_add_u32 v42, v42, 4, v5
    v_add_u32 v43, 65536, v42
    v_bfe_u32 v5, v1, 2, 2
    v_lshl_add_u32 v5, v3, 3, v5
    v_mul_u32_u24 v5, 192, v5
    v_and_b32 v6, 3, v1
    v_lshl_add_u32 v5, v6, 3, v5
    v_and_b32 v6, 1, v3
    v_add_u32 v6, s53, v6
    v_add_u32 v7, 0, v6
    v_lshl_add_u32 v44, v7, 5, v5
    v_add_u32 v45, 65536, v44
    v_add_u32 v46, 131072, v44
    v_add_u32 v7, 2, v6
    v_lshl_add_u32 v47, v7, 5, v5
    v_add_u32 v48, 65536, v47
    v_add_u32 v49, 131072, v47
    v_add_u32 v7, 4, v6
    v_subrev_u32 v50, 6, v7
    v_min_u32 v7, v7, v50
    v_lshl_add_u32 v50, v7, 5, v5
    v_add_u32 v51, 65536, v50
    v_add_u32 v52, 131072, v50
    v_mov_b32 v56, 0
    v_mov_b32 v57, 0
    v_mov_b32 v58, 0
    v_mov_b32 v59, 0
    v_mov_b32 v60, 0
    v_mov_b32 v61, 0
    v_mov_b32 v62, 0
    v_mov_b32 v63, 0
    v_mov_b32 v64, 0
    v_mov_b32 v65, 0
    v_mov_b32 v66, 0
    v_mov_b32 v67, 0
    v_mov_b32 v68, 0
    v_mov_b32 v69, 0
    v_mov_b32 v70, 0
    v_mov_b32 v71, 0
    v_mov_b32 v72, 0
    v_mov_b32 v73, 0
    v_mov_b32 v74, 0
    v_mov_b32 v75, 0
    v_mov_b32 v76, 0
    v_mov_b32 v77, 0
    v_mov_b32 v78, 0
    v_mov_b32 v79, 0
    v_mov_b32 v80, 0
    v_mov_b32 v81, 0
    v_mov_b32 v82, 0
    v_mov_b32 v83, 0
    v_mov_b32 v84, 0
    v_mov_b32 v85, 0
    v_mov_b32 v86, 0
    v_mov_b32 v87, 0
    v_mov_b32 v88, 0
    v_mov_b32 v89, 0
    v_mov_b32 v90, 0
    v_mov_b32 v91, 0
    v_mov_b32 v92, 0
    v_mov_b32 v93, 0
    v_mov_b32 v94, 0
    v_mov_b32 v95, 0
    v_mov_b32 v96, 0
    v_mov_b32 v97, 0
    v_mov_b32 v98, 0
    v_mov_b32 v99, 0
    v_mov_b32 v100, 0
    v_mov_b32 v101, 0
    v_mov_b32 v102, 0
    v_mov_b32 v103, 0
    v_add_u32 v200, s66, v2
    v_lshlrev_b32 v200, 3, v200
    v_add_u32 v200, 147456, v200
    v_lshlrev_b32 v202, 2, v3
    v_add_u32 v202, s66, v202
    v_lshlrev_b32 v202, 3, v202
    v_add_u32 v202, 147456, v202
    v_add_u32 v201, s67, v2
    v_lshlrev_b32 v201, 3, v201
    v_add_u32 v201, 147456, v201
    v_lshlrev_b32 v203, 2, v3
    v_add_u32 v203, s67, v203
    v_lshlrev_b32 v203, 3, v203
    v_add_u32 v203, 147456, v203
    v_mov_b32 v204, 0
    v_mov_b32 v205, 0
    v_mov_b32 v206, 0
    v_mov_b32 v207, 0
    v_mov_b32 v208, 0
    v_mov_b32 v209, 0
    v_mov_b32 v210, 0
    v_mov_b32 v211, 0
    v_mov_b32 v212, 0
    v_mov_b32 v213, 0
    v_mov_b32 v214, 0
    v_mov_b32 v215, 0
    v_mov_b32 v216, 0
    v_mov_b32 v217, 0
    v_mov_b32 v218, 0
    v_mov_b32 v219, 0
    s_barrier
    ds_read_b128 v[104:107], v36 offset:0
    ds_read_b64_tr_b16 v[136:137], v45 offset:0
    ds_read_b64_tr_b16 v[138:139], v45 offset:768
    ds_read_b64_tr_b16 v[140:141], v48 offset:0
    ds_read_b64_tr_b16 v[142:143], v48 offset:768
    ds_read_b64_tr_b16 v[144:145], v51 offset:0
    ds_read_b64_tr_b16 v[146:147], v51 offset:768
    ds_read_b128 v[108:111], v36 offset:2048
    ds_read_b128 v[112:115], v40 offset:0
    ds_read_b128 v[116:119], v40 offset:2048
    s_waitcnt lgkmcnt(7)
    v_mfma_f32_16x16x32_bf16 v[56:59], v[136:139], v[104:107], v[56:59]
    ds_read_b128 v[120:123], v38 offset:0
    s_waitcnt lgkmcnt(6)
    v_mfma_f32_16x16x32_bf16 v[60:63], v[104:107], v[140:143], v[60:63]
    ds_read_b64_tr_b16 v[148:149], v45 offset:6144
    s_waitcnt lgkmcnt(5)
    v_mfma_f32_16x16x32_bf16 v[64:67], v[104:107], v[144:147], v[64:67]
    ds_read_b64_tr_b16 v[150:151], v45 offset:6912
    s_waitcnt lgkmcnt(5)
    v_mfma_f32_16x16x32_bf16 v[68:71], v[136:139], v[108:111], v[68:71]
    ds_read_b64_tr_b16 v[152:153], v48 offset:6144
    v_mfma_f32_16x16x32_bf16 v[72:75], v[108:111], v[140:143], v[72:75]
    ds_read_b64_tr_b16 v[154:155], v48 offset:6912
    v_mfma_f32_16x16x32_bf16 v[76:79], v[108:111], v[144:147], v[76:79]
    ds_read_b64_tr_b16 v[156:157], v51 offset:6144
    s_waitcnt lgkmcnt(7)
    v_mfma_f32_16x16x32_bf16 v[80:83], v[136:139], v[112:115], v[80:83]
    ds_read_b64_tr_b16 v[158:159], v51 offset:6912
    v_mfma_f32_16x16x32_bf16 v[84:87], v[112:115], v[140:143], v[84:87]
    ds_read_b128 v[124:127], v38 offset:2048
    v_mfma_f32_16x16x32_bf16 v[88:91], v[112:115], v[144:147], v[88:91]
    ds_read_b128 v[128:131], v42 offset:0
    s_waitcnt lgkmcnt(9)
    v_mfma_f32_16x16x32_bf16 v[92:95], v[136:139], v[116:119], v[92:95]
    ds_read_b128 v[132:135], v42 offset:2048
    v_mfma_f32_16x16x32_bf16 v[96:99], v[116:119], v[140:143], v[96:99]
    v_mfma_f32_16x16x32_bf16 v[100:103], v[116:119], v[144:147], v[100:103]
    v_mfma_f32_16x16x32_bf16 v[12:15], v[136:139], v[32:35], v[12:15]
    v_mfma_f32_16x16x32_bf16 v[16:19], v[32:35], v[140:143], v[16:19]
    v_mfma_f32_16x16x32_bf16 v[20:23], v[32:35], v[144:147], v[20:23]
    v_mfma_f32_16x16x32_bf16 v[204:207], v[32:35], v[104:107], v[204:207]
    v_mfma_f32_16x16x32_bf16 v[208:211], v[104:107], v[104:107], v[208:211]
    v_mfma_f32_16x16x32_bf16 v[212:215], v[32:35], v[108:111], v[212:215]
    v_mfma_f32_16x16x32_bf16 v[216:219], v[108:111], v[108:111], v[216:219]
    s_waitcnt lgkmcnt(0)
    s_barrier
    v_mfma_f32_16x16x32_bf16 v[56:59], v[148:151], v[120:123], v[56:59]
    ds_read_b128 v[104:107], v36 offset:16384
    v_mfma_f32_16x16x32_bf16 v[60:63], v[120:123], v[152:155], v[60:63]
    ds_read_b64_tr_b16 v[136:137], v45 offset:16384
    v_mfma_f32_16x16x32_bf16 v[64:67], v[120:123], v[156:159], v[64:67]
    ds_read_b64_tr_b16 v[138:139], v45 offset:17152
    v_mfma_f32_16x16x32_bf16 v[68:71], v[148:151], v[124:127], v[68:71]
    ds_read_b64_tr_b16 v[140:141], v48 offset:16384
    v_mfma_f32_16x16x32_bf16 v[72:75], v[124:127], v[152:155], v[72:75]
    ds_read_b64_tr_b16 v[142:143], v48 offset:17152
    v_mfma_f32_16x16x32_bf16 v[76:79], v[124:127], v[156:159], v[76:79]
    ds_read_b64_tr_b16 v[144:145], v51 offset:16384
    v_mfma_f32_16x16x32_bf16 v[80:83], v[148:151], v[128:131], v[80:83]
    ds_read_b64_tr_b16 v[146:147], v51 offset:17152
    v_mfma_f32_16x16x32_bf16 v[84:87], v[128:131], v[152:155], v[84:87]
    ds_read_b128 v[108:111], v36 offset:18432
    v_mfma_f32_16x16x32_bf16 v[88:91], v[128:131], v[156:159], v[88:91]
    ds_read_b128 v[112:115], v40 offset:16384
    v_mfma_f32_16x16x32_bf16 v[92:95], v[148:151], v[132:135], v[92:95]
    ds_read_b128 v[116:119], v40 offset:18432
    v_mfma_f32_16x16x32_bf16 v[96:99], v[132:135], v[152:155], v[96:99]
    v_mfma_f32_16x16x32_bf16 v[100:103], v[132:135], v[156:159], v[100:103]
    v_mfma_f32_16x16x32_bf16 v[12:15], v[148:151], v[32:35], v[12:15]
    v_mfma_f32_16x16x32_bf16 v[16:19], v[32:35], v[152:155], v[16:19]
    v_mfma_f32_16x16x32_bf16 v[20:23], v[32:35], v[156:159], v[20:23]
    v_mfma_f32_16x16x32_bf16 v[204:207], v[32:35], v[120:123], v[204:207]
    v_mfma_f32_16x16x32_bf16 v[208:211], v[120:123], v[120:123], v[208:211]
    v_mfma_f32_16x16x32_bf16 v[212:215], v[32:35], v[124:127], v[212:215]
    v_mfma_f32_16x16x32_bf16 v[216:219], v[124:127], v[124:127], v[216:219]
    s_waitcnt lgkmcnt(7)
    v_mfma_f32_16x16x32_bf16 v[56:59], v[136:139], v[104:107], v[56:59]
    ds_read_b128 v[120:123], v38 offset:16384
    s_waitcnt lgkmcnt(6)
    v_mfma_f32_16x16x32_bf16 v[60:63], v[104:107], v[140:143], v[60:63]
    ds_read_b64_tr_b16 v[148:149], v45 offset:22528
    s_waitcnt lgkmcnt(5)
    v_mfma_f32_16x16x32_bf16 v[64:67], v[104:107], v[144:147], v[64:67]
    ds_read_b64_tr_b16 v[150:151], v45 offset:23296
    s_waitcnt lgkmcnt(5)
    v_mfma_f32_16x16x32_bf16 v[68:71], v[136:139], v[108:111], v[68:71]
    ds_read_b64_tr_b16 v[152:153], v48 offset:22528
    v_mfma_f32_16x16x32_bf16 v[72:75], v[108:111], v[140:143], v[72:75]
    ds_read_b64_tr_b16 v[154:155], v48 offset:23296
    v_mfma_f32_16x16x32_bf16 v[76:79], v[108:111], v[144:147], v[76:79]
    ds_read_b64_tr_b16 v[156:157], v51 offset:22528
    s_waitcnt lgkmcnt(7)
    v_mfma_f32_16x16x32_bf16 v[80:83], v[136:139], v[112:115], v[80:83]
    ds_read_b64_tr_b16 v[158:159], v51 offset:23296
    v_mfma_f32_16x16x32_bf16 v[84:87], v[112:115], v[140:143], v[84:87]
    ds_read_b128 v[124:127], v38 offset:18432
    v_mfma_f32_16x16x32_bf16 v[88:91], v[112:115], v[144:147], v[88:91]
    ds_read_b128 v[128:131], v42 offset:16384
    s_waitcnt lgkmcnt(9)
    v_mfma_f32_16x16x32_bf16 v[92:95], v[136:139], v[116:119], v[92:95]
    ds_read_b128 v[132:135], v42 offset:18432
    v_mfma_f32_16x16x32_bf16 v[96:99], v[116:119], v[140:143], v[96:99]
    v_mfma_f32_16x16x32_bf16 v[100:103], v[116:119], v[144:147], v[100:103]
    v_mfma_f32_16x16x32_bf16 v[12:15], v[136:139], v[32:35], v[12:15]
    v_mfma_f32_16x16x32_bf16 v[16:19], v[32:35], v[140:143], v[16:19]
    v_mfma_f32_16x16x32_bf16 v[20:23], v[32:35], v[144:147], v[20:23]
    v_mfma_f32_16x16x32_bf16 v[204:207], v[32:35], v[104:107], v[204:207]
    v_mfma_f32_16x16x32_bf16 v[208:211], v[104:107], v[104:107], v[208:211]
    v_mfma_f32_16x16x32_bf16 v[212:215], v[32:35], v[108:111], v[212:215]
    v_mfma_f32_16x16x32_bf16 v[216:219], v[108:111], v[108:111], v[216:219]
    s_waitcnt lgkmcnt(0)
    s_barrier
    v_mfma_f32_16x16x32_bf16 v[56:59], v[148:151], v[120:123], v[56:59]
    ds_read_b128 v[104:107], v36 offset:32768
    v_mfma_f32_16x16x32_bf16 v[60:63], v[120:123], v[152:155], v[60:63]
    ds_read_b64_tr_b16 v[136:137], v45 offset:32768
    v_mfma_f32_16x16x32_bf16 v[64:67], v[120:123], v[156:159], v[64:67]
    ds_read_b64_tr_b16 v[138:139], v45 offset:33536
    v_mfma_f32_16x16x32_bf16 v[68:71], v[148:151], v[124:127], v[68:71]
    ds_read_b64_tr_b16 v[140:141], v48 offset:32768
    v_mfma_f32_16x16x32_bf16 v[72:75], v[124:127], v[152:155], v[72:75]
    ds_read_b64_tr_b16 v[142:143], v48 offset:33536
    v_mfma_f32_16x16x32_bf16 v[76:79], v[124:127], v[156:159], v[76:79]
    ds_read_b64_tr_b16 v[144:145], v51 offset:32768
    v_mfma_f32_16x16x32_bf16 v[80:83], v[148:151], v[128:131], v[80:83]
    ds_read_b64_tr_b16 v[146:147], v51 offset:33536
    v_mfma_f32_16x16x32_bf16 v[84:87], v[128:131], v[152:155], v[84:87]
    ds_read_b128 v[108:111], v36 offset:34816
    v_mfma_f32_16x16x32_bf16 v[88:91], v[128:131], v[156:159], v[88:91]
    ds_read_b128 v[112:115], v40 offset:32768
    v_mfma_f32_16x16x32_bf16 v[92:95], v[148:151], v[132:135], v[92:95]
    ds_read_b128 v[116:119], v40 offset:34816
    v_mfma_f32_16x16x32_bf16 v[96:99], v[132:135], v[152:155], v[96:99]
    v_mfma_f32_16x16x32_bf16 v[100:103], v[132:135], v[156:159], v[100:103]
    v_mfma_f32_16x16x32_bf16 v[12:15], v[148:151], v[32:35], v[12:15]
    v_mfma_f32_16x16x32_bf16 v[16:19], v[32:35], v[152:155], v[16:19]
    v_mfma_f32_16x16x32_bf16 v[20:23], v[32:35], v[156:159], v[20:23]
    v_mfma_f32_16x16x32_bf16 v[204:207], v[32:35], v[120:123], v[204:207]
    v_mfma_f32_16x16x32_bf16 v[208:211], v[120:123], v[120:123], v[208:211]
    v_mfma_f32_16x16x32_bf16 v[212:215], v[32:35], v[124:127], v[212:215]
    v_mfma_f32_16x16x32_bf16 v[216:219], v[124:127], v[124:127], v[216:219]
    s_waitcnt lgkmcnt(7)
    v_mfma_f32_16x16x32_bf16 v[56:59], v[136:139], v[104:107], v[56:59]
    ds_read_b128 v[120:123], v38 offset:32768
    s_waitcnt lgkmcnt(6)
    v_mfma_f32_16x16x32_bf16 v[60:63], v[104:107], v[140:143], v[60:63]
    ds_read_b64_tr_b16 v[148:149], v45 offset:38912
    s_waitcnt lgkmcnt(5)
    v_mfma_f32_16x16x32_bf16 v[64:67], v[104:107], v[144:147], v[64:67]
    ds_read_b64_tr_b16 v[150:151], v45 offset:39680
    s_waitcnt lgkmcnt(5)
    v_mfma_f32_16x16x32_bf16 v[68:71], v[136:139], v[108:111], v[68:71]
    ds_read_b64_tr_b16 v[152:153], v48 offset:38912
    v_mfma_f32_16x16x32_bf16 v[72:75], v[108:111], v[140:143], v[72:75]
    ds_read_b64_tr_b16 v[154:155], v48 offset:39680
    v_mfma_f32_16x16x32_bf16 v[76:79], v[108:111], v[144:147], v[76:79]
    ds_read_b64_tr_b16 v[156:157], v51 offset:38912
    s_waitcnt lgkmcnt(7)
    v_mfma_f32_16x16x32_bf16 v[80:83], v[136:139], v[112:115], v[80:83]
    ds_read_b64_tr_b16 v[158:159], v51 offset:39680
    v_mfma_f32_16x16x32_bf16 v[84:87], v[112:115], v[140:143], v[84:87]
    ds_read_b128 v[124:127], v38 offset:34816
    v_mfma_f32_16x16x32_bf16 v[88:91], v[112:115], v[144:147], v[88:91]
    ds_read_b128 v[128:131], v42 offset:32768
    s_waitcnt lgkmcnt(9)
    v_mfma_f32_16x16x32_bf16 v[92:95], v[136:139], v[116:119], v[92:95]
    ds_read_b128 v[132:135], v42 offset:34816
    v_mfma_f32_16x16x32_bf16 v[96:99], v[116:119], v[140:143], v[96:99]
    v_mfma_f32_16x16x32_bf16 v[100:103], v[116:119], v[144:147], v[100:103]
    v_mfma_f32_16x16x32_bf16 v[12:15], v[136:139], v[32:35], v[12:15]
    v_mfma_f32_16x16x32_bf16 v[16:19], v[32:35], v[140:143], v[16:19]
    v_mfma_f32_16x16x32_bf16 v[20:23], v[32:35], v[144:147], v[20:23]
    v_mfma_f32_16x16x32_bf16 v[204:207], v[32:35], v[104:107], v[204:207]
    v_mfma_f32_16x16x32_bf16 v[208:211], v[104:107], v[104:107], v[208:211]
    v_mfma_f32_16x16x32_bf16 v[212:215], v[32:35], v[108:111], v[212:215]
    v_mfma_f32_16x16x32_bf16 v[216:219], v[108:111], v[108:111], v[216:219]
    s_waitcnt lgkmcnt(0)
    s_barrier
    v_mfma_f32_16x16x32_bf16 v[56:59], v[148:151], v[120:123], v[56:59]
    ds_read_b128 v[104:107], v36 offset:49152
    v_mfma_f32_16x16x32_bf16 v[60:63], v[120:123], v[152:155], v[60:63]
    ds_read_b64_tr_b16 v[136:137], v45 offset:49152
    v_mfma_f32_16x16x32_bf16 v[64:67], v[120:123], v[156:159], v[64:67]
    ds_read_b64_tr_b16 v[138:139], v45 offset:49920
    v_mfma_f32_16x16x32_bf16 v[68:71], v[148:151], v[124:127], v[68:71]
    ds_read_b64_tr_b16 v[140:141], v48 offset:49152
    v_mfma_f32_16x16x32_bf16 v[72:75], v[124:127], v[152:155], v[72:75]
    ds_read_b64_tr_b16 v[142:143], v48 offset:49920
    v_mfma_f32_16x16x32_bf16 v[76:79], v[124:127], v[156:159], v[76:79]
    ds_read_b64_tr_b16 v[144:145], v51 offset:49152
    v_mfma_f32_16x16x32_bf16 v[80:83], v[148:151], v[128:131], v[80:83]
    ds_read_b64_tr_b16 v[146:147], v51 offset:49920
    v_mfma_f32_16x16x32_bf16 v[84:87], v[128:131], v[152:155], v[84:87]
    ds_read_b128 v[108:111], v36 offset:51200
    v_mfma_f32_16x16x32_bf16 v[88:91], v[128:131], v[156:159], v[88:91]
    ds_read_b128 v[112:115], v40 offset:49152
    v_mfma_f32_16x16x32_bf16 v[92:95], v[148:151], v[132:135], v[92:95]
    ds_read_b128 v[116:119], v40 offset:51200
    v_mfma_f32_16x16x32_bf16 v[96:99], v[132:135], v[152:155], v[96:99]
    v_mfma_f32_16x16x32_bf16 v[100:103], v[132:135], v[156:159], v[100:103]
    v_mfma_f32_16x16x32_bf16 v[12:15], v[148:151], v[32:35], v[12:15]
    v_mfma_f32_16x16x32_bf16 v[16:19], v[32:35], v[152:155], v[16:19]
    v_mfma_f32_16x16x32_bf16 v[20:23], v[32:35], v[156:159], v[20:23]
    v_mfma_f32_16x16x32_bf16 v[204:207], v[32:35], v[120:123], v[204:207]
    v_mfma_f32_16x16x32_bf16 v[208:211], v[120:123], v[120:123], v[208:211]
    v_mfma_f32_16x16x32_bf16 v[212:215], v[32:35], v[124:127], v[212:215]
    v_mfma_f32_16x16x32_bf16 v[216:219], v[124:127], v[124:127], v[216:219]
    s_waitcnt lgkmcnt(7)
    v_mfma_f32_16x16x32_bf16 v[56:59], v[136:139], v[104:107], v[56:59]
    ds_read_b128 v[120:123], v38 offset:49152
    s_waitcnt lgkmcnt(6)
    v_mfma_f32_16x16x32_bf16 v[60:63], v[104:107], v[140:143], v[60:63]
    ds_read_b64_tr_b16 v[148:149], v45 offset:55296
    s_waitcnt lgkmcnt(5)
    v_mfma_f32_16x16x32_bf16 v[64:67], v[104:107], v[144:147], v[64:67]
    ds_read_b64_tr_b16 v[150:151], v45 offset:56064
    s_waitcnt lgkmcnt(5)
    v_mfma_f32_16x16x32_bf16 v[68:71], v[136:139], v[108:111], v[68:71]
    ds_read_b64_tr_b16 v[152:153], v48 offset:55296
    v_mfma_f32_16x16x32_bf16 v[72:75], v[108:111], v[140:143], v[72:75]
    ds_read_b64_tr_b16 v[154:155], v48 offset:56064
    v_mfma_f32_16x16x32_bf16 v[76:79], v[108:111], v[144:147], v[76:79]
    ds_read_b64_tr_b16 v[156:157], v51 offset:55296
    s_waitcnt lgkmcnt(7)
    v_mfma_f32_16x16x32_bf16 v[80:83], v[136:139], v[112:115], v[80:83]
    ds_read_b64_tr_b16 v[158:159], v51 offset:56064
    v_mfma_f32_16x16x32_bf16 v[84:87], v[112:115], v[140:143], v[84:87]
    ds_read_b128 v[124:127], v38 offset:51200
    v_mfma_f32_16x16x32_bf16 v[88:91], v[112:115], v[144:147], v[88:91]
    ds_read_b128 v[128:131], v42 offset:49152
    s_waitcnt lgkmcnt(9)
    v_mfma_f32_16x16x32_bf16 v[92:95], v[136:139], v[116:119], v[92:95]
    ds_read_b128 v[132:135], v42 offset:51200
    v_mfma_f32_16x16x32_bf16 v[96:99], v[116:119], v[140:143], v[96:99]
    v_mfma_f32_16x16x32_bf16 v[100:103], v[116:119], v[144:147], v[100:103]
    v_mfma_f32_16x16x32_bf16 v[12:15], v[136:139], v[32:35], v[12:15]
    v_mfma_f32_16x16x32_bf16 v[16:19], v[32:35], v[140:143], v[16:19]
    v_mfma_f32_16x16x32_bf16 v[20:23], v[32:35], v[144:147], v[20:23]
    v_mfma_f32_16x16x32_bf16 v[204:207], v[32:35], v[104:107], v[204:207]
    v_mfma_f32_16x16x32_bf16 v[208:211], v[104:107], v[104:107], v[208:211]
    v_mfma_f32_16x16x32_bf16 v[212:215], v[32:35], v[108:111], v[212:215]
    v_mfma_f32_16x16x32_bf16 v[216:219], v[108:111], v[108:111], v[216:219]
    s_waitcnt lgkmcnt(0)
    s_barrier
    v_mfma_f32_16x16x32_bf16 v[56:59], v[148:151], v[120:123], v[56:59]
    ds_read_b128 v[104:107], v36 offset:0
    v_mfma_f32_16x16x32_bf16 v[60:63], v[120:123], v[152:155], v[60:63]
    ds_read_b64_tr_b16 v[136:137], v46 offset:0
    v_mfma_f32_16x16x32_bf16 v[64:67], v[120:123], v[156:159], v[64:67]
    ds_read_b64_tr_b16 v[138:139], v46 offset:768
    v_mfma_f32_16x16x32_bf16 v[68:71], v[148:151], v[124:127], v[68:71]
    ds_read_b64_tr_b16 v[140:141], v49 offset:0
    v_mfma_f32_16x16x32_bf16 v[72:75], v[124:127], v[152:155], v[72:75]
    ds_read_b64_tr_b16 v[142:143], v49 offset:768
    v_mfma_f32_16x16x32_bf16 v[76:79], v[124:127], v[156:159], v[76:79]
    ds_read_b64_tr_b16 v[144:145], v52 offset:0
    v_mfma_f32_16x16x32_bf16 v[80:83], v[148:151], v[128:131], v[80:83]
    ds_read_b64_tr_b16 v[146:147], v52 offset:768
    v_mfma_f32_16x16x32_bf16 v[84:87], v[128:131], v[152:155], v[84:87]
    ds_read_b128 v[108:111], v36 offset:2048
    v_mfma_f32_16x16x32_bf16 v[88:91], v[128:131], v[156:159], v[88:91]
    ds_read_b128 v[112:115], v40 offset:0
    v_mfma_f32_16x16x32_bf16 v[92:95], v[148:151], v[132:135], v[92:95]
    ds_read_b128 v[116:119], v40 offset:2048
    v_mfma_f32_16x16x32_bf16 v[96:99], v[132:135], v[152:155], v[96:99]
    v_mfma_f32_16x16x32_bf16 v[100:103], v[132:135], v[156:159], v[100:103]
    v_mfma_f32_16x16x32_bf16 v[12:15], v[148:151], v[32:35], v[12:15]
    v_mfma_f32_16x16x32_bf16 v[16:19], v[32:35], v[152:155], v[16:19]
    v_mfma_f32_16x16x32_bf16 v[20:23], v[32:35], v[156:159], v[20:23]
    v_mfma_f32_16x16x32_bf16 v[204:207], v[32:35], v[120:123], v[204:207]
    v_mfma_f32_16x16x32_bf16 v[208:211], v[120:123], v[120:123], v[208:211]
    v_mfma_f32_16x16x32_bf16 v[212:215], v[32:35], v[124:127], v[212:215]
    v_mfma_f32_16x16x32_bf16 v[216:219], v[124:127], v[124:127], v[216:219]
    s_waitcnt lgkmcnt(7)
    v_mfma_f32_16x16x32_bf16 v[56:59], v[136:139], v[104:107], v[56:59]
    ds_read_b128 v[120:123], v38 offset:0
    s_waitcnt lgkmcnt(6)
    v_mfma_f32_16x16x32_bf16 v[60:63], v[104:107], v[140:143], v[60:63]
    ds_read_b64_tr_b16 v[148:149], v46 offset:6144
    s_waitcnt lgkmcnt(5)
    v_mfma_f32_16x16x32_bf16 v[64:67], v[104:107], v[144:147], v[64:67]
    ds_read_b64_tr_b16 v[150:151], v46 offset:6912
    s_waitcnt lgkmcnt(5)
    v_mfma_f32_16x16x32_bf16 v[68:71], v[136:139], v[108:111], v[68:71]
    ds_read_b64_tr_b16 v[152:153], v49 offset:6144
    v_mfma_f32_16x16x32_bf16 v[72:75], v[108:111], v[140:143], v[72:75]
    ds_read_b64_tr_b16 v[154:155], v49 offset:6912
    v_mfma_f32_16x16x32_bf16 v[76:79], v[108:111], v[144:147], v[76:79]
    ds_read_b64_tr_b16 v[156:157], v52 offset:6144
    s_waitcnt lgkmcnt(7)
    v_mfma_f32_16x16x32_bf16 v[80:83], v[136:139], v[112:115], v[80:83]
    ds_read_b64_tr_b16 v[158:159], v52 offset:6912
    v_mfma_f32_16x16x32_bf16 v[84:87], v[112:115], v[140:143], v[84:87]
    ds_read_b128 v[124:127], v38 offset:2048
    v_mfma_f32_16x16x32_bf16 v[88:91], v[112:115], v[144:147], v[88:91]
    ds_read_b128 v[128:131], v42 offset:0
    s_waitcnt lgkmcnt(9)
    v_mfma_f32_16x16x32_bf16 v[92:95], v[136:139], v[116:119], v[92:95]
    ds_read_b128 v[132:135], v42 offset:2048
    v_mfma_f32_16x16x32_bf16 v[96:99], v[116:119], v[140:143], v[96:99]
    v_mfma_f32_16x16x32_bf16 v[100:103], v[116:119], v[144:147], v[100:103]
    v_mfma_f32_16x16x32_bf16 v[12:15], v[136:139], v[32:35], v[12:15]
    v_mfma_f32_16x16x32_bf16 v[16:19], v[32:35], v[140:143], v[16:19]
    v_mfma_f32_16x16x32_bf16 v[20:23], v[32:35], v[144:147], v[20:23]
    v_mfma_f32_16x16x32_bf16 v[204:207], v[32:35], v[104:107], v[204:207]
    v_mfma_f32_16x16x32_bf16 v[208:211], v[104:107], v[104:107], v[208:211]
    v_mfma_f32_16x16x32_bf16 v[212:215], v[32:35], v[108:111], v[212:215]
    v_mfma_f32_16x16x32_bf16 v[216:219], v[108:111], v[108:111], v[216:219]
    s_waitcnt lgkmcnt(0)
    s_barrier
    v_mfma_f32_16x16x32_bf16 v[56:59], v[148:151], v[120:123], v[56:59]
    ds_read_b128 v[104:107], v36 offset:16384
    v_mfma_f32_16x16x32_bf16 v[60:63], v[120:123], v[152:155], v[60:63]
    ds_read_b64_tr_b16 v[136:137], v45 offset:0
    v_mfma_f32_16x16x32_bf16 v[64:67], v[120:123], v[156:159], v[64:67]
    ds_read_b64_tr_b16 v[138:139], v45 offset:768
    v_mfma_f32_16x16x32_bf16 v[68:71], v[148:151], v[124:127], v[68:71]
    ds_read_b64_tr_b16 v[140:141], v48 offset:0
    v_mfma_f32_16x16x32_bf16 v[72:75], v[124:127], v[152:155], v[72:75]
    ds_read_b64_tr_b16 v[142:143], v48 offset:768
    v_mfma_f32_16x16x32_bf16 v[76:79], v[124:127], v[156:159], v[76:79]
    ds_read_b64_tr_b16 v[144:145], v51 offset:0
    v_mfma_f32_16x16x32_bf16 v[80:83], v[148:151], v[128:131], v[80:83]
    ds_read_b64_tr_b16 v[146:147], v51 offset:768
    v_mfma_f32_16x16x32_bf16 v[84:87], v[128:131], v[152:155], v[84:87]
    ds_read_b128 v[108:111], v36 offset:18432
    v_mfma_f32_16x16x32_bf16 v[88:91], v[128:131], v[156:159], v[88:91]
    ds_read_b128 v[112:115], v40 offset:16384
    v_mfma_f32_16x16x32_bf16 v[92:95], v[148:151], v[132:135], v[92:95]
    ds_read_b128 v[116:119], v40 offset:18432
    v_mfma_f32_16x16x32_bf16 v[96:99], v[132:135], v[152:155], v[96:99]
    v_mfma_f32_16x16x32_bf16 v[100:103], v[132:135], v[156:159], v[100:103]
    v_mfma_f32_16x16x32_bf16 v[12:15], v[148:151], v[32:35], v[12:15]
    v_mfma_f32_16x16x32_bf16 v[16:19], v[32:35], v[152:155], v[16:19]
    v_mfma_f32_16x16x32_bf16 v[20:23], v[32:35], v[156:159], v[20:23]
    v_mfma_f32_16x16x32_bf16 v[204:207], v[32:35], v[120:123], v[204:207]
    v_mfma_f32_16x16x32_bf16 v[208:211], v[120:123], v[120:123], v[208:211]
    v_mfma_f32_16x16x32_bf16 v[212:215], v[32:35], v[124:127], v[212:215]
    v_mfma_f32_16x16x32_bf16 v[216:219], v[124:127], v[124:127], v[216:219]
    s_waitcnt lgkmcnt(7)
    v_mfma_f32_16x16x32_bf16 v[56:59], v[136:139], v[104:107], v[56:59]
    ds_read_b128 v[120:123], v38 offset:16384
    s_waitcnt lgkmcnt(6)
    v_mfma_f32_16x16x32_bf16 v[60:63], v[104:107], v[140:143], v[60:63]
    ds_read_b64_tr_b16 v[148:149], v45 offset:6144
    s_waitcnt lgkmcnt(5)
    v_mfma_f32_16x16x32_bf16 v[64:67], v[104:107], v[144:147], v[64:67]
    ds_read_b64_tr_b16 v[150:151], v45 offset:6912
    s_waitcnt lgkmcnt(5)
    v_mfma_f32_16x16x32_bf16 v[68:71], v[136:139], v[108:111], v[68:71]
    ds_read_b64_tr_b16 v[152:153], v48 offset:6144
    v_mfma_f32_16x16x32_bf16 v[72:75], v[108:111], v[140:143], v[72:75]
    ds_read_b64_tr_b16 v[154:155], v48 offset:6912
    v_mfma_f32_16x16x32_bf16 v[76:79], v[108:111], v[144:147], v[76:79]
    ds_read_b64_tr_b16 v[156:157], v51 offset:6144
    s_waitcnt lgkmcnt(7)
    v_mfma_f32_16x16x32_bf16 v[80:83], v[136:139], v[112:115], v[80:83]
    ds_read_b64_tr_b16 v[158:159], v51 offset:6912
    v_mfma_f32_16x16x32_bf16 v[84:87], v[112:115], v[140:143], v[84:87]
    ds_read_b128 v[124:127], v38 offset:18432
    v_mfma_f32_16x16x32_bf16 v[88:91], v[112:115], v[144:147], v[88:91]
    ds_read_b128 v[128:131], v42 offset:16384
    s_waitcnt lgkmcnt(9)
    v_mfma_f32_16x16x32_bf16 v[92:95], v[136:139], v[116:119], v[92:95]
    ds_read_b128 v[132:135], v42 offset:18432
    v_mfma_f32_16x16x32_bf16 v[96:99], v[116:119], v[140:143], v[96:99]
    v_mfma_f32_16x16x32_bf16 v[100:103], v[116:119], v[144:147], v[100:103]
    v_mfma_f32_16x16x32_bf16 v[12:15], v[136:139], v[32:35], v[12:15]
    v_mfma_f32_16x16x32_bf16 v[16:19], v[32:35], v[140:143], v[16:19]
    v_mfma_f32_16x16x32_bf16 v[20:23], v[32:35], v[144:147], v[20:23]
    v_mfma_f32_16x16x32_bf16 v[204:207], v[32:35], v[104:107], v[204:207]
    v_mfma_f32_16x16x32_bf16 v[208:211], v[104:107], v[104:107], v[208:211]
    v_mfma_f32_16x16x32_bf16 v[212:215], v[32:35], v[108:111], v[212:215]
    v_mfma_f32_16x16x32_bf16 v[216:219], v[108:111], v[108:111], v[216:219]
    s_waitcnt lgkmcnt(0)
    s_barrier
    v_mfma_f32_16x16x32_bf16 v[56:59], v[148:151], v[120:123], v[56:59]
    ds_read_b128 v[104:107], v36 offset:32768
    v_mfma_f32_16x16x32_bf16 v[60:63], v[120:123], v[152:155], v[60:63]
    ds_read_b64_tr_b16 v[136:137], v45 offset:16384
    v_mfma_f32_16x16x32_bf16 v[64:67], v[120:123], v[156:159], v[64:67]
    ds_read_b64_tr_b16 v[138:139], v45 offset:17152
    v_mfma_f32_16x16x32_bf16 v[68:71], v[148:151], v[124:127], v[68:71]
    ds_read_b64_tr_b16 v[140:141], v48 offset:16384
    v_mfma_f32_16x16x32_bf16 v[72:75], v[124:127], v[152:155], v[72:75]
    ds_read_b64_tr_b16 v[142:143], v48 offset:17152
    v_mfma_f32_16x16x32_bf16 v[76:79], v[124:127], v[156:159], v[76:79]
    ds_read_b64_tr_b16 v[144:145], v51 offset:16384
    v_mfma_f32_16x16x32_bf16 v[80:83], v[148:151], v[128:131], v[80:83]
    ds_read_b64_tr_b16 v[146:147], v51 offset:17152
    v_mfma_f32_16x16x32_bf16 v[84:87], v[128:131], v[152:155], v[84:87]
    ds_read_b128 v[108:111], v36 offset:34816
    v_mfma_f32_16x16x32_bf16 v[88:91], v[128:131], v[156:159], v[88:91]
    ds_read_b128 v[112:115], v40 offset:32768
    v_mfma_f32_16x16x32_bf16 v[92:95], v[148:151], v[132:135], v[92:95]
    ds_read_b128 v[116:119], v40 offset:34816
    v_mfma_f32_16x16x32_bf16 v[96:99], v[132:135], v[152:155], v[96:99]
    v_mfma_f32_16x16x32_bf16 v[100:103], v[132:135], v[156:159], v[100:103]
    v_mfma_f32_16x16x32_bf16 v[12:15], v[148:151], v[32:35], v[12:15]
    v_mfma_f32_16x16x32_bf16 v[16:19], v[32:35], v[152:155], v[16:19]
    v_mfma_f32_16x16x32_bf16 v[20:23], v[32:35], v[156:159], v[20:23]
    v_mfma_f32_16x16x32_bf16 v[204:207], v[32:35], v[120:123], v[204:207]
    v_mfma_f32_16x16x32_bf16 v[208:211], v[120:123], v[120:123], v[208:211]
    v_mfma_f32_16x16x32_bf16 v[212:215], v[32:35], v[124:127], v[212:215]
    v_mfma_f32_16x16x32_bf16 v[216:219], v[124:127], v[124:127], v[216:219]
    s_waitcnt lgkmcnt(7)
    v_mfma_f32_16x16x32_bf16 v[56:59], v[136:139], v[104:107], v[56:59]
    ds_read_b128 v[120:123], v38 offset:32768
    s_waitcnt lgkmcnt(6)
    v_mfma_f32_16x16x32_bf16 v[60:63], v[104:107], v[140:143], v[60:63]
    ds_read_b64_tr_b16 v[148:149], v45 offset:22528
    s_waitcnt lgkmcnt(5)
    v_mfma_f32_16x16x32_bf16 v[64:67], v[104:107], v[144:147], v[64:67]
    ds_read_b64_tr_b16 v[150:151], v45 offset:23296
    s_waitcnt lgkmcnt(5)
    v_mfma_f32_16x16x32_bf16 v[68:71], v[136:139], v[108:111], v[68:71]
    ds_read_b64_tr_b16 v[152:153], v48 offset:22528
    v_mfma_f32_16x16x32_bf16 v[72:75], v[108:111], v[140:143], v[72:75]
    ds_read_b64_tr_b16 v[154:155], v48 offset:23296
    v_mfma_f32_16x16x32_bf16 v[76:79], v[108:111], v[144:147], v[76:79]
    ds_read_b64_tr_b16 v[156:157], v51 offset:22528
    s_waitcnt lgkmcnt(7)
    v_mfma_f32_16x16x32_bf16 v[80:83], v[136:139], v[112:115], v[80:83]
    ds_read_b64_tr_b16 v[158:159], v51 offset:23296
    v_mfma_f32_16x16x32_bf16 v[84:87], v[112:115], v[140:143], v[84:87]
    ds_read_b128 v[124:127], v38 offset:34816
    v_mfma_f32_16x16x32_bf16 v[88:91], v[112:115], v[144:147], v[88:91]
    ds_read_b128 v[128:131], v42 offset:32768
    s_waitcnt lgkmcnt(9)
    v_mfma_f32_16x16x32_bf16 v[92:95], v[136:139], v[116:119], v[92:95]
    ds_read_b128 v[132:135], v42 offset:34816
    v_mfma_f32_16x16x32_bf16 v[96:99], v[116:119], v[140:143], v[96:99]
    v_mfma_f32_16x16x32_bf16 v[100:103], v[116:119], v[144:147], v[100:103]
    v_mfma_f32_16x16x32_bf16 v[12:15], v[136:139], v[32:35], v[12:15]
    v_mfma_f32_16x16x32_bf16 v[16:19], v[32:35], v[140:143], v[16:19]
    v_mfma_f32_16x16x32_bf16 v[20:23], v[32:35], v[144:147], v[20:23]
    v_mfma_f32_16x16x32_bf16 v[204:207], v[32:35], v[104:107], v[204:207]
    v_mfma_f32_16x16x32_bf16 v[208:211], v[104:107], v[104:107], v[208:211]
    v_mfma_f32_16x16x32_bf16 v[212:215], v[32:35], v[108:111], v[212:215]
    v_mfma_f32_16x16x32_bf16 v[216:219], v[108:111], v[108:111], v[216:219]
    s_waitcnt lgkmcnt(0)
    s_barrier
    v_mfma_f32_16x16x32_bf16 v[56:59], v[148:151], v[120:123], v[56:59]
    ds_read_b128 v[104:107], v36 offset:49152
    v_mfma_f32_16x16x32_bf16 v[60:63], v[120:123], v[152:155], v[60:63]
    ds_read_b64_tr_b16 v[136:137], v45 offset:32768
    v_mfma_f32_16x16x32_bf16 v[64:67], v[120:123], v[156:159], v[64:67]
    ds_read_b64_tr_b16 v[138:139], v45 offset:33536
    v_mfma_f32_16x16x32_bf16 v[68:71], v[148:151], v[124:127], v[68:71]
    ds_read_b64_tr_b16 v[140:141], v48 offset:32768
    v_mfma_f32_16x16x32_bf16 v[72:75], v[124:127], v[152:155], v[72:75]
    ds_read_b64_tr_b16 v[142:143], v48 offset:33536
    v_mfma_f32_16x16x32_bf16 v[76:79], v[124:127], v[156:159], v[76:79]
    ds_read_b64_tr_b16 v[144:145], v51 offset:32768
    v_mfma_f32_16x16x32_bf16 v[80:83], v[148:151], v[128:131], v[80:83]
    ds_read_b64_tr_b16 v[146:147], v51 offset:33536
    v_mfma_f32_16x16x32_bf16 v[84:87], v[128:131], v[152:155], v[84:87]
    ds_read_b128 v[108:111], v36 offset:51200
    v_mfma_f32_16x16x32_bf16 v[88:91], v[128:131], v[156:159], v[88:91]
    ds_read_b128 v[112:115], v40 offset:49152
    v_mfma_f32_16x16x32_bf16 v[92:95], v[148:151], v[132:135], v[92:95]
    ds_read_b128 v[116:119], v40 offset:51200
    v_mfma_f32_16x16x32_bf16 v[96:99], v[132:135], v[152:155], v[96:99]
    v_mfma_f32_16x16x32_bf16 v[100:103], v[132:135], v[156:159], v[100:103]
    v_mfma_f32_16x16x32_bf16 v[12:15], v[148:151], v[32:35], v[12:15]
    v_mfma_f32_16x16x32_bf16 v[16:19], v[32:35], v[152:155], v[16:19]
    v_mfma_f32_16x16x32_bf16 v[20:23], v[32:35], v[156:159], v[20:23]
    v_mfma_f32_16x16x32_bf16 v[204:207], v[32:35], v[120:123], v[204:207]
    v_mfma_f32_16x16x32_bf16 v[208:211], v[120:123], v[120:123], v[208:211]
    v_mfma_f32_16x16x32_bf16 v[212:215], v[32:35], v[124:127], v[212:215]
    v_mfma_f32_16x16x32_bf16 v[216:219], v[124:127], v[124:127], v[216:219]
    s_waitcnt lgkmcnt(7)
    v_mfma_f32_16x16x32_bf16 v[56:59], v[136:139], v[104:107], v[56:59]
    ds_read_b128 v[120:123], v38 offset:49152
    s_waitcnt lgkmcnt(6)
    v_mfma_f32_16x16x32_bf16 v[60:63], v[104:107], v[140:143], v[60:63]
    ds_read_b64_tr_b16 v[148:149], v45 offset:38912
    s_waitcnt lgkmcnt(5)
    v_mfma_f32_16x16x32_bf16 v[64:67], v[104:107], v[144:147], v[64:67]
    ds_read_b64_tr_b16 v[150:151], v45 offset:39680
    s_waitcnt lgkmcnt(5)
    v_mfma_f32_16x16x32_bf16 v[68:71], v[136:139], v[108:111], v[68:71]
    ds_read_b64_tr_b16 v[152:153], v48 offset:38912
    v_mfma_f32_16x16x32_bf16 v[72:75], v[108:111], v[140:143], v[72:75]
    ds_read_b64_tr_b16 v[154:155], v48 offset:39680
    v_mfma_f32_16x16x32_bf16 v[76:79], v[108:111], v[144:147], v[76:79]
    ds_read_b64_tr_b16 v[156:157], v51 offset:38912
    s_waitcnt lgkmcnt(7)
    v_mfma_f32_16x16x32_bf16 v[80:83], v[136:139], v[112:115], v[80:83]
    ds_read_b64_tr_b16 v[158:159], v51 offset:39680
    v_mfma_f32_16x16x32_bf16 v[84:87], v[112:115], v[140:143], v[84:87]
    ds_read_b128 v[124:127], v38 offset:51200
    v_mfma_f32_16x16x32_bf16 v[88:91], v[112:115], v[144:147], v[88:91]
    ds_read_b128 v[128:131], v42 offset:49152
    s_waitcnt lgkmcnt(9)
    v_mfma_f32_16x16x32_bf16 v[92:95], v[136:139], v[116:119], v[92:95]
    ds_read_b128 v[132:135], v42 offset:51200
    v_mfma_f32_16x16x32_bf16 v[96:99], v[116:119], v[140:143], v[96:99]
    v_mfma_f32_16x16x32_bf16 v[100:103], v[116:119], v[144:147], v[100:103]
    v_mfma_f32_16x16x32_bf16 v[12:15], v[136:139], v[32:35], v[12:15]
    v_mfma_f32_16x16x32_bf16 v[16:19], v[32:35], v[140:143], v[16:19]
    v_mfma_f32_16x16x32_bf16 v[20:23], v[32:35], v[144:147], v[20:23]
    v_mfma_f32_16x16x32_bf16 v[204:207], v[32:35], v[104:107], v[204:207]
    v_mfma_f32_16x16x32_bf16 v[208:211], v[104:107], v[104:107], v[208:211]
    v_mfma_f32_16x16x32_bf16 v[212:215], v[32:35], v[108:111], v[212:215]
    v_mfma_f32_16x16x32_bf16 v[216:219], v[108:111], v[108:111], v[216:219]
    s_waitcnt lgkmcnt(7)
    v_mfma_f32_16x16x32_bf16 v[56:59], v[148:151], v[120:123], v[56:59]
    s_waitcnt lgkmcnt(5)
    v_mfma_f32_16x16x32_bf16 v[60:63], v[120:123], v[152:155], v[60:63]
    s_waitcnt lgkmcnt(3)
    v_mfma_f32_16x16x32_bf16 v[64:67], v[120:123], v[156:159], v[64:67]
    s_waitcnt lgkmcnt(2)
    v_mfma_f32_16x16x32_bf16 v[68:71], v[148:151], v[124:127], v[68:71]
    v_mfma_f32_16x16x32_bf16 v[72:75], v[124:127], v[152:155], v[72:75]
    v_mfma_f32_16x16x32_bf16 v[76:79], v[124:127], v[156:159], v[76:79]
    s_waitcnt lgkmcnt(1)
    v_mfma_f32_16x16x32_bf16 v[80:83], v[148:151], v[128:131], v[80:83]
    v_mfma_f32_16x16x32_bf16 v[84:87], v[128:131], v[152:155], v[84:87]
    v_mfma_f32_16x16x32_bf16 v[88:91], v[128:131], v[156:159], v[88:91]
    s_waitcnt lgkmcnt(0)
    v_mfma_f32_16x16x32_bf16 v[92:95], v[148:151], v[132:135], v[92:95]
    v_mfma_f32_16x16x32_bf16 v[96:99], v[132:135], v[152:155], v[96:99]
    v_mfma_f32_16x16x32_bf16 v[100:103], v[132:135], v[156:159], v[100:103]
    v_mfma_f32_16x16x32_bf16 v[12:15], v[148:151], v[32:35], v[12:15]
    v_mfma_f32_16x16x32_bf16 v[16:19], v[32:35], v[152:155], v[16:19]
    v_mfma_f32_16x16x32_bf16 v[20:23], v[32:35], v[156:159], v[20:23]
    v_mfma_f32_16x16x32_bf16 v[204:207], v[32:35], v[120:123], v[204:207]
    v_mfma_f32_16x16x32_bf16 v[208:211], v[120:123], v[120:123], v[208:211]
    v_mfma_f32_16x16x32_bf16 v[212:215], v[32:35], v[124:127], v[212:215]
    v_mfma_f32_16x16x32_bf16 v[216:219], v[124:127], v[124:127], v[216:219]
    v_and_b32 v5, 3, v1
    v_lshrrev_b32 v6, 2, v2
    v_cmp_eq_u32 s[60:61], v6, v3
    v_cmp_eq_u32 vcc, 1, v5
    s_nop 1
    v_cndmask_b32 v208, v208, v209, vcc
    v_cmp_eq_u32 vcc, 2, v5
    s_nop 1
    v_cndmask_b32 v208, v208, v210, vcc
    v_cmp_eq_u32 vcc, 3, v5
    s_nop 1
    v_cndmask_b32 v208, v208, v211, vcc
    v_cndmask_b32 v205, 0, v208, s[60:61]
    v_mov_b32 v7, v205
    s_nop 1
    v_permlane16_swap_b32 v205, v7
    v_add_f32 v205, v205, v7
    v_mov_b32 v7, v205
    s_nop 1
    v_permlane32_swap_b32 v205, v7
    v_add_f32 v205, v205, v7
    v_mul_f32 v204, 0x3b000000, v204
    v_mul_f32 v205, 0x3b000000, v205
    v_fma_f32 v205, -v204, v204, v205
    v_max_f32 v205, 0, v205
    v_cvt_pk_bf16_f32 v204, v204, v204
    v_lshlrev_b32 v204, 16, v204
    v_cvt_pk_bf16_f32 v205, v205, v205
    v_lshlrev_b32 v205, 16, v205
    v_add_f32 v205, 0x3727c5ac, v205
    v_cvt_pk_bf16_f32 v205, v205, v205
    v_lshlrev_b32 v205, 16, v205
    v_sqrt_f32 v205, v205
    s_nop 0
    v_cvt_pk_bf16_f32 v205, v205, v205
    v_lshlrev_b32 v205, 16, v205
    v_rcp_f32 v160, v205
    s_nop 0
    v_mul_f32 v161, v204, v160
    v_sub_f32 v161, 0, v161
    ds_write_b64 v200, v[160:161] offset:0
    v_cmp_eq_u32 vcc, 1, v5
    s_nop 1
    v_cndmask_b32 v216, v216, v217, vcc
    v_cmp_eq_u32 vcc, 2, v5
    s_nop 1
    v_cndmask_b32 v216, v216, v218, vcc
    v_cmp_eq_u32 vcc, 3, v5
    s_nop 1
    v_cndmask_b32 v216, v216, v219, vcc
    v_cndmask_b32 v213, 0, v216, s[60:61]
    v_mov_b32 v7, v213
    s_nop 1
    v_permlane16_swap_b32 v213, v7
    v_add_f32 v213, v213, v7
    v_mov_b32 v7, v213
    s_nop 1
    v_permlane32_swap_b32 v213, v7
    v_add_f32 v213, v213, v7
    v_mul_f32 v212, 0x3b000000, v212
    v_mul_f32 v213, 0x3b000000, v213
    v_fma_f32 v213, -v212, v212, v213
    v_max_f32 v213, 0, v213
    v_cvt_pk_bf16_f32 v212, v212, v212
    v_lshlrev_b32 v212, 16, v212
    v_cvt_pk_bf16_f32 v213, v213, v213
    v_lshlrev_b32 v213, 16, v213
    v_add_f32 v213, 0x3727c5ac, v213
    v_cvt_pk_bf16_f32 v213, v213, v213
    v_lshlrev_b32 v213, 16, v213
    v_sqrt_f32 v213, v213
    s_nop 0
    v_cvt_pk_bf16_f32 v213, v213, v213
    v_lshlrev_b32 v213, 16, v213
    v_rcp_f32 v162, v213
    s_nop 0
    v_mul_f32 v163, v212, v162
    v_sub_f32 v163, 0, v163
    ds_write_b64 v200, v[162:163] offset:128
    s_waitcnt lgkmcnt(0)
    s_barrier
    ds_read_b128 v[168:171], v202 offset:0
    ds_read_b128 v[172:175], v202 offset:16
    ds_read_b64 v[160:161], v200 offset:0
    ds_read_b128 v[176:179], v202 offset:128
    ds_read_b128 v[180:183], v202 offset:144
    ds_read_b64 v[162:163], v200 offset:128
    ds_read_b128 v[184:187], v203 offset:0
    ds_read_b128 v[188:191], v203 offset:16
    ds_read_b64 v[164:165], v201 offset:0
    ds_read_b128 v[192:195], v203 offset:128
    ds_read_b128 v[196:199], v203 offset:144
    ds_read_b64 v[166:167], v201 offset:128
    s_add_u32 s40, s20, 14811136
    s_addc_u32 s41, s21, 0
    s_and_b32 s41, s41, 0xffff
    s_mov_b32 s42, 6144
    s_mov_b32 s43, 0x20000
    s_or_b32 s57, s96, s52
    s_cmp_eq_u32 s57, 0
    s_cselect_b32 s42, s42, 0
    buffer_store_dwordx4 v[12:15], v24, s[40:43], 0 offen
    buffer_store_dword v16, v25, s[40:43], 0 offen offset:0
    buffer_store_dword v20, v25, s[40:43], 0 offen offset:2048
    s_mov_b32 s62, 0x3fb8aa3b
    s_mov_b32 s63, 0x3fb8aa3b
    s_mov_b32 s64, 0x358637bd
    s_mov_b32 s65, 0x358637bd
    s_waitcnt lgkmcnt(11)
    v_mul_f32 v220, v169, v16
    v_mul_f32 v221, v171, v16
    s_waitcnt lgkmcnt(10)
    v_mul_f32 v222, v173, v16
    v_mul_f32 v223, v175, v16
    v_fma_f32 v60, v168, v60, v220
    v_fma_f32 v61, v170, v61, v221
    v_fma_f32 v62, v172, v62, v222
    v_fma_f32 v63, v174, v63, v223
    v_pk_mul_f32 v[220:221], v[60:61], s[62:63]
    v_pk_mul_f32 v[222:223], v[62:63], s[62:63]
    v_min_f32 v220, 0, v220
    v_min_f32 v221, 0, v221
    v_min_f32 v222, 0, v222
    v_min_f32 v223, 0, v223
    v_exp_f32 v220, v220
    v_exp_f32 v221, v221
    v_exp_f32 v222, v222
    v_exp_f32 v223, v223
    v_max_f32 v60, 0, v60
    v_max_f32 v61, 0, v61
    v_max_f32 v62, 0, v62
    v_max_f32 v63, 0, v63
    v_pk_add_f32 v[60:61], v[60:61], s[64:65]
    v_pk_add_f32 v[62:63], v[62:63], s[64:65]
    v_pk_add_f32 v[60:61], v[60:61], v[220:221]
    v_pk_add_f32 v[62:63], v[62:63], v[222:223]
    v_cvt_pk_bf16_f32 v224, v60, v61
    v_cvt_pk_bf16_f32 v225, v62, v63
    v_mul_f32 v220, v169, v20
    v_mul_f32 v221, v171, v20
    v_mul_f32 v222, v173, v20
    v_mul_f32 v223, v175, v20
    v_fma_f32 v64, v168, v64, v220
    v_fma_f32 v65, v170, v65, v221
    v_fma_f32 v66, v172, v66, v222
    v_fma_f32 v67, v174, v67, v223
    v_cvt_pk_bf16_f32 v232, v64, v65
    v_cvt_pk_bf16_f32 v233, v66, v67
    s_waitcnt lgkmcnt(8)
    v_mul_f32 v220, v177, v16
    v_mul_f32 v221, v179, v16
    s_waitcnt lgkmcnt(7)
    v_mul_f32 v222, v181, v16
    v_mul_f32 v223, v183, v16
    v_fma_f32 v72, v176, v72, v220
    v_fma_f32 v73, v178, v73, v221
    v_fma_f32 v74, v180, v74, v222
    v_fma_f32 v75, v182, v75, v223
    v_pk_mul_f32 v[220:221], v[72:73], s[62:63]
    v_pk_mul_f32 v[222:223], v[74:75], s[62:63]
    v_min_f32 v220, 0, v220
    v_min_f32 v221, 0, v221
    v_min_f32 v222, 0, v222
    v_min_f32 v223, 0, v223
    v_exp_f32 v220, v220
    v_exp_f32 v221, v221
    v_exp_f32 v222, v222
    v_exp_f32 v223, v223
    v_max_f32 v72, 0, v72
    v_max_f32 v73, 0, v73
    v_max_f32 v74, 0, v74
    v_max_f32 v75, 0, v75
    v_pk_add_f32 v[72:73], v[72:73], s[64:65]
    v_pk_add_f32 v[74:75], v[74:75], s[64:65]
    v_pk_add_f32 v[72:73], v[72:73], v[220:221]
    v_pk_add_f32 v[74:75], v[74:75], v[222:223]
    v_cvt_pk_bf16_f32 v226, v72, v73
    v_cvt_pk_bf16_f32 v227, v74, v75
    v_mul_f32 v220, v177, v20
    v_mul_f32 v221, v179, v20
    v_mul_f32 v222, v181, v20
    v_mul_f32 v223, v183, v20
    v_fma_f32 v76, v176, v76, v220
    v_fma_f32 v77, v178, v77, v221
    v_fma_f32 v78, v180, v78, v222
    v_fma_f32 v79, v182, v79, v223
    v_cvt_pk_bf16_f32 v234, v76, v77
    v_cvt_pk_bf16_f32 v235, v78, v79
    s_waitcnt lgkmcnt(5)
    v_mul_f32 v220, v185, v16
    v_mul_f32 v221, v187, v16
    s_waitcnt lgkmcnt(4)
    v_mul_f32 v222, v189, v16
    v_mul_f32 v223, v191, v16
    v_fma_f32 v84, v184, v84, v220
    v_fma_f32 v85, v186, v85, v221
    v_fma_f32 v86, v188, v86, v222
    v_fma_f32 v87, v190, v87, v223
    v_pk_mul_f32 v[220:221], v[84:85], s[62:63]
    v_pk_mul_f32 v[222:223], v[86:87], s[62:63]
    v_min_f32 v220, 0, v220
    v_min_f32 v221, 0, v221
    v_min_f32 v222, 0, v222
    v_min_f32 v223, 0, v223
    v_exp_f32 v220, v220
    v_exp_f32 v221, v221
    v_exp_f32 v222, v222
    v_exp_f32 v223, v223
    v_max_f32 v84, 0, v84
    v_max_f32 v85, 0, v85
    v_max_f32 v86, 0, v86
    v_max_f32 v87, 0, v87
    v_pk_add_f32 v[84:85], v[84:85], s[64:65]
    v_pk_add_f32 v[86:87], v[86:87], s[64:65]
    v_pk_add_f32 v[84:85], v[84:85], v[220:221]
    v_pk_add_f32 v[86:87], v[86:87], v[222:223]
    v_cvt_pk_bf16_f32 v228, v84, v85
    v_cvt_pk_bf16_f32 v229, v86, v87
    v_mul_f32 v220, v185, v20
    v_mul_f32 v221, v187, v20
    v_mul_f32 v222, v189, v20
    v_mul_f32 v223, v191, v20
    v_fma_f32 v88, v184, v88, v220
    v_fma_f32 v89, v186, v89, v221
    v_fma_f32 v90, v188, v90, v222
    v_fma_f32 v91, v190, v91, v223
    v_cvt_pk_bf16_f32 v236, v88, v89
    v_cvt_pk_bf16_f32 v237, v90, v91
    s_waitcnt lgkmcnt(2)
    v_mul_f32 v220, v193, v16
    v_mul_f32 v221, v195, v16
    s_waitcnt lgkmcnt(1)
    v_mul_f32 v222, v197, v16
    v_mul_f32 v223, v199, v16
    v_fma_f32 v96, v192, v96, v220
    v_fma_f32 v97, v194, v97, v221
    v_fma_f32 v98, v196, v98, v222
    v_fma_f32 v99, v198, v99, v223
    v_pk_mul_f32 v[220:221], v[96:97], s[62:63]
    v_pk_mul_f32 v[222:223], v[98:99], s[62:63]
    v_min_f32 v220, 0, v220
    v_min_f32 v221, 0, v221
    v_min_f32 v222, 0, v222
    v_min_f32 v223, 0, v223
    v_exp_f32 v220, v220
    v_exp_f32 v221, v221
    v_exp_f32 v222, v222
    v_exp_f32 v223, v223
    v_max_f32 v96, 0, v96
    v_max_f32 v97, 0, v97
    v_max_f32 v98, 0, v98
    v_max_f32 v99, 0, v99
    v_pk_add_f32 v[96:97], v[96:97], s[64:65]
    v_pk_add_f32 v[98:99], v[98:99], s[64:65]
    v_pk_add_f32 v[96:97], v[96:97], v[220:221]
    v_pk_add_f32 v[98:99], v[98:99], v[222:223]
    v_cvt_pk_bf16_f32 v230, v96, v97
    v_cvt_pk_bf16_f32 v231, v98, v99
    v_mul_f32 v220, v193, v20
    v_mul_f32 v221, v195, v20
    v_mul_f32 v222, v197, v20
    v_mul_f32 v223, v199, v20
    v_fma_f32 v100, v192, v100, v220
    v_fma_f32 v101, v194, v101, v221
    v_fma_f32 v102, v196, v102, v222
    v_fma_f32 v103, v198, v103, v223
    v_cvt_pk_bf16_f32 v238, v100, v101
    v_cvt_pk_bf16_f32 v239, v102, v103
    v_mfma_f32_16x16x32_bf16 v[240:243], v[224:227], v[232:235], 0
    v_mfma_f32_16x16x32_bf16 v[244:247], v[224:227], v[32:35], 0
    v_mfma_f32_16x16x32_bf16 v[240:243], v[228:231], v[236:239], v[240:243]
    v_mfma_f32_16x16x32_bf16 v[244:247], v[228:231], v[32:35], v[244:247]
    s_lshl_b32 s57, s53, 5
    v_add_u32 v248, s66, v2
    v_mul_u32_u24 v248, 80, v248
    v_lshl_add_u32 v248, v3, 3, v248
    v_add_u32 v248, s57, v248
    v_add_u32 v249, s67, v2
    v_mul_u32_u24 v249, 80, v249
    v_lshl_add_u32 v249, v3, 3, v249
    v_add_u32 v249, s57, v249
    v_pk_mul_f32 v[220:221], v[12:13], v[160:161] op_sel:[0,1] op_sel_hi:[1,1]
    v_pk_mul_f32 v[222:223], v[14:15], v[160:161] op_sel:[0,1] op_sel_hi:[1,1]
    v_pk_fma_f32 v[56:57], v[56:57], v[160:161], v[220:221] op_sel:[0,0,0] op_sel_hi:[1,0,1]
    v_pk_fma_f32 v[58:59], v[58:59], v[160:161], v[222:223] op_sel:[0,0,0] op_sel_hi:[1,0,1]
    v_pk_mul_f32 v[220:221], v[56:57], s[62:63]
    v_pk_mul_f32 v[222:223], v[58:59], s[62:63]
    v_min_f32 v220, 0, v220
    v_min_f32 v221, 0, v221
    v_min_f32 v222, 0, v222
    v_min_f32 v223, 0, v223
    v_exp_f32 v220, v220
    v_exp_f32 v221, v221
    v_exp_f32 v222, v222
    v_exp_f32 v223, v223
    v_max_f32 v56, 0, v56
    v_max_f32 v57, 0, v57
    v_max_f32 v58, 0, v58
    v_max_f32 v59, 0, v59
    v_pk_add_f32 v[56:57], v[56:57], s[64:65]
    v_pk_add_f32 v[58:59], v[58:59], s[64:65]
    v_pk_add_f32 v[56:57], v[56:57], v[220:221]
    v_pk_add_f32 v[58:59], v[58:59], v[222:223]
    v_cvt_pk_bf16_f32 v56, v56, v57
    v_cvt_pk_bf16_f32 v57, v58, v59
    ds_write_b64 v248, v[56:57] offset:0
    v_pk_mul_f32 v[220:221], v[12:13], v[162:163] op_sel:[0,1] op_sel_hi:[1,1]
    v_pk_mul_f32 v[222:223], v[14:15], v[162:163] op_sel:[0,1] op_sel_hi:[1,1]
    v_pk_fma_f32 v[68:69], v[68:69], v[162:163], v[220:221] op_sel:[0,0,0] op_sel_hi:[1,0,1]
    v_pk_fma_f32 v[70:71], v[70:71], v[162:163], v[222:223] op_sel:[0,0,0] op_sel_hi:[1,0,1]
    v_pk_mul_f32 v[220:221], v[68:69], s[62:63]
    v_pk_mul_f32 v[222:223], v[70:71], s[62:63]
    v_min_f32 v220, 0, v220
    v_min_f32 v221, 0, v221
    v_min_f32 v222, 0, v222
    v_min_f32 v223, 0, v223
    v_exp_f32 v220, v220
    v_exp_f32 v221, v221
    v_exp_f32 v222, v222
    v_exp_f32 v223, v223
    v_max_f32 v68, 0, v68
    v_max_f32 v69, 0, v69
    v_max_f32 v70, 0, v70
    v_max_f32 v71, 0, v71
    v_pk_add_f32 v[68:69], v[68:69], s[64:65]
    v_pk_add_f32 v[70:71], v[70:71], s[64:65]
    v_pk_add_f32 v[68:69], v[68:69], v[220:221]
    v_pk_add_f32 v[70:71], v[70:71], v[222:223]
    v_cvt_pk_bf16_f32 v68, v68, v69
    v_cvt_pk_bf16_f32 v69, v70, v71
    ds_write_b64 v248, v[68:69] offset:1280
    v_pk_mul_f32 v[220:221], v[12:13], v[164:165] op_sel:[0,1] op_sel_hi:[1,1]
    v_pk_mul_f32 v[222:223], v[14:15], v[164:165] op_sel:[0,1] op_sel_hi:[1,1]
    v_pk_fma_f32 v[80:81], v[80:81], v[164:165], v[220:221] op_sel:[0,0,0] op_sel_hi:[1,0,1]
    v_pk_fma_f32 v[82:83], v[82:83], v[164:165], v[222:223] op_sel:[0,0,0] op_sel_hi:[1,0,1]
    v_pk_mul_f32 v[220:221], v[80:81], s[62:63]
    v_pk_mul_f32 v[222:223], v[82:83], s[62:63]
    v_min_f32 v220, 0, v220
    v_min_f32 v221, 0, v221
    v_min_f32 v222, 0, v222
    v_min_f32 v223, 0, v223
    v_exp_f32 v220, v220
    v_exp_f32 v221, v221
    v_exp_f32 v222, v222
    v_exp_f32 v223, v223
    v_max_f32 v80, 0, v80
    v_max_f32 v81, 0, v81
    v_max_f32 v82, 0, v82
    v_max_f32 v83, 0, v83
    v_pk_add_f32 v[80:81], v[80:81], s[64:65]
    v_pk_add_f32 v[82:83], v[82:83], s[64:65]
    v_pk_add_f32 v[80:81], v[80:81], v[220:221]
    v_pk_add_f32 v[82:83], v[82:83], v[222:223]
    v_cvt_pk_bf16_f32 v80, v80, v81
    v_cvt_pk_bf16_f32 v81, v82, v83
    ds_write_b64 v249, v[80:81] offset:0
    s_waitcnt lgkmcnt(3)
    v_pk_mul_f32 v[220:221], v[12:13], v[166:167] op_sel:[0,1] op_sel_hi:[1,1]
    v_pk_mul_f32 v[222:223], v[14:15], v[166:167] op_sel:[0,1] op_sel_hi:[1,1]
    v_pk_fma_f32 v[92:93], v[92:93], v[166:167], v[220:221] op_sel:[0,0,0] op_sel_hi:[1,0,1]
    v_pk_fma_f32 v[94:95], v[94:95], v[166:167], v[222:223] op_sel:[0,0,0] op_sel_hi:[1,0,1]
    v_pk_mul_f32 v[220:221], v[92:93], s[62:63]
    v_pk_mul_f32 v[222:223], v[94:95], s[62:63]
    v_min_f32 v220, 0, v220
    v_min_f32 v221, 0, v221
    v_min_f32 v222, 0, v222
    v_min_f32 v223, 0, v223
    v_exp_f32 v220, v220
    v_exp_f32 v221, v221
    v_exp_f32 v222, v222
    v_exp_f32 v223, v223
    v_max_f32 v92, 0, v92
    v_max_f32 v93, 0, v93
    v_max_f32 v94, 0, v94
    v_max_f32 v95, 0, v95
    v_pk_add_f32 v[92:93], v[92:93], s[64:65]
    v_pk_add_f32 v[94:95], v[94:95], s[64:65]
    v_pk_add_f32 v[92:93], v[92:93], v[220:221]
    v_pk_add_f32 v[94:95], v[94:95], v[222:223]
    v_cvt_pk_bf16_f32 v92, v92, v93
    v_cvt_pk_bf16_f32 v93, v94, v95
    ds_write_b64 v249, v[92:93] offset:1280
    s_lshl_b32 s57, s3, 10
    s_add_u32 s57, s57, 149504
    v_lshlrev_b32 v5, 4, v1
    v_add_u32 v5, s57, v5
    s_lshl_b32 s58, s3, 6
    s_add_u32 s58, s58, 153600
    v_lshlrev_b32 v6, 4, v3
    v_add_u32 v6, s58, v6
    ds_write_b128 v5, v[240:243]
    ds_write_b128 v6, v[244:247]
    s_waitcnt lgkmcnt(0)
    s_mov_b32 s32, s20
    s_and_b32 s33, s21, 0xffff
    s_mov_b32 s34, 2097152
    s_mov_b32 s35, 0x20000
    s_add_u32 s36, s20, 14680064
    s_addc_u32 s37, s21, 0
    s_and_b32 s37, s37, 0xffff
    s_mov_b32 s38, 34816
    s_mov_b32 s39, 0x20000
    s_barrier
    v_lshrrev_b32 v5, 2, v0
    v_and_b32 v6, 3, v0
    v_mul_u32_u24 v32, 80, v5
    v_lshl_add_u32 v32, v6, 4, v32
    ds_read_b128 v[24:27], v32
    s_waitcnt vmcnt(3)
    ds_read_b128 v[28:31], v32 offset:5120
    v_add_u32 v5, s50, v5
    v_lshlrev_b32 v33, 10, v5
    v_lshl_add_u32 v33, v6, 4, v33
    v_add_u32 v33, s54, v33
    v_bfe_u32 v5, v0, 3, 4
    v_lshlrev_b32 v5, 4, v5
    v_bfe_u32 v6, v0, 7, 1
    v_lshl_add_u32 v5, v6, 9, v5
    v_bfe_u32 v6, v0, 2, 1
    v_lshl_add_u32 v5, v6, 8, v5
    v_and_b32 v6, 3, v0
    v_lshl_add_u32 v5, v6, 2, v5
    v_add_u32 v5, 149504, v5
    ds_read_b32 v36, v5 offset:0
    ds_read_b32 v37, v5 offset:2048
    ds_read_b32 v38, v5 offset:1024
    ds_read_b32 v39, v5 offset:3072
    v_and_b32 v7, 31, v0
    v_lshlrev_b32 v7, 2, v7
    v_add_u32 v6, 153600, v7
    ds_read_b32 v40, v6
    ds_read_b32 v41, v6 offset:128
    s_mov_b32 s60, 65536
    s_waitcnt lgkmcnt(7)
    buffer_store_dwordx4 v[24:27], v33, s[32:35], 0 offen
    s_waitcnt lgkmcnt(6)
    buffer_store_dwordx4 v[28:31], v33, s[32:35], s60 offen
    s_lshl_b32 s57, s23, 11
    v_lshlrev_b32 v6, 2, v0
    v_add_u32 v6, s57, v6
    s_waitcnt lgkmcnt(4)
    v_add_f32 v36, v36, v37
    buffer_atomic_add_f32 v36, v6, s[36:39], 0 offen offset:0
    s_waitcnt lgkmcnt(2)
    v_add_f32 v38, v38, v39
    buffer_atomic_add_f32 v38, v6, s[36:39], 0 offen offset:1024
    s_lshl_b32 s57, s23, 7
    s_add_u32 s57, s57, 32768
    v_add_u32 v7, s57, v7
    v_mov_b32 v6, 0x7ffffff0
    v_cmp_gt_u32 vcc, 32, v0
    s_nop 1
    v_cndmask_b32 v7, v6, v7, vcc
    s_waitcnt lgkmcnt(0)
    v_add_f32 v40, v40, v41
    buffer_atomic_add_f32 v40, v7, s[36:39], 0 offen
kA_kernel_end:
    s_endpgm
.globl kB_kernel
.p2align 8
.type kB_kernel,@function
kB_kernel:
    s_cmp_ge_u32 s2, 256
    s_cbranch_scc1 kB_kernel_end
    s_load_dwordx16 s[4:19], s[0:1], 0
    s_load_dwordx2 s[20:21], s[0:1], 64
    v_lshrrev_b32 v4, 6, v0
    v_and_b32 v1, 63, v0
    v_readfirstlane_b32 s3, v4
    v_and_b32 v2, 15, v0
    v_bfe_u32 v3, v0, 4, 2
    s_sub_u32 s59, s3, 4
    s_and_b32 s48, s2, 7
    s_lshl_b32 s48, s48, 1
    s_lshr_b32 s49, s2, 7
    s_add_u32 s96, s48, s49
    s_bfe_u32 s97, s2, 0x40003
    s_cmp_lt_u32 s3, 4
    s_cbranch_scc1 kB_kernel_compute
    s_cmp_lt_u32 s3, 6
    s_cbranch_scc1 kB_kernel_aload
    s_sub_u32 s59, s3, 6
    v_lshlrev_b32 v15, 4, v1
    v_lshrrev_b32 v5, 3, v1
    v_bfe_u32 v6, v1, 4, 2
    v_lshlrev_b32 v6, 1, v6
    v_and_b32 v7, 7, v1
    v_xor_b32 v6, v6, v7
    v_lshlrev_b32 v6, 4, v6
    v_lshl_add_u32 v5, v5, 10, v6
    s_lshl_b32 s52, s59, 16
    s_and_b32 s54, s97, 7
    s_lshl_b32 s54, s54, 7
    s_add_u32 s52, s52, s54
    v_add_u32 v16, s52, v5
    v_add_u32 v17, 8192, v16
    v_add_u32 v18, 16384, v16
    v_add_u32 v19, 24576, v16
    v_add_u32 v20, 32768, v16
    v_add_u32 v21, 40960, v16
    v_add_u32 v22, 49152, v16
    v_add_u32 v23, 57344, v16
    s_lshl_b32 s44, s59, 13
    s_waitcnt lgkmcnt(0)
    s_mov_b32 s24, s8
    s_and_b32 s25, s9, 0xffff
    s_mov_b32 s26, 524288
    s_mov_b32 s27, 0x20000
    s_mov_b32 s57, 0
    s_add_u32 m0, s44, 65536
    s_nop 0
    buffer_load_dwordx4 v16, s[24:27], s57 offen lds
    s_add_u32 m0, s44, 66560
    s_nop 0
    buffer_load_dwordx4 v17, s[24:27], s57 offen lds
    s_add_u32 m0, s44, 67584
    s_nop 0
    buffer_load_dwordx4 v18, s[24:27], s57 offen lds
    s_add_u32 m0, s44, 68608
    s_nop 0
    buffer_load_dwordx4 v19, s[24:27], s57 offen lds
    s_add_u32 m0, s44, 69632
    s_nop 0
    buffer_load_dwordx4 v20, s[24:27], s57 offen lds
    s_add_u32 m0, s44, 70656
    s_nop 0
    buffer_load_dwordx4 v21, s[24:27], s57 offen lds
    s_add_u32 m0, s44, 71680
    s_nop 0
    buffer_load_dwordx4 v22, s[24:27], s57 offen lds
    s_add_u32 m0, s44, 72704
    s_nop 0
    buffer_load_dwordx4 v23, s[24:27], s57 offen lds
    s_mov_b32 s57, 131072
    s_add_u32 m0, s44, 81920
    s_nop 0
    buffer_load_dwordx4 v16, s[24:27], s57 offen lds
    s_add_u32 m0, s44, 82944
    s_nop 0
    buffer_load_dwordx4 v17, s[24:27], s57 offen lds
    s_add_u32 m0, s44, 83968
    s_nop 0
    buffer_load_dwordx4 v18, s[24:27], s57 offen lds
    s_add_u32 m0, s44, 84992
    s_nop 0
    buffer_load_dwordx4 v19, s[24:27], s57 offen lds
    s_add_u32 m0, s44, 86016
    s_nop 0
    buffer_load_dwordx4 v20, s[24:27], s57 offen lds
    s_add_u32 m0, s44, 87040
    s_nop 0
    buffer_load_dwordx4 v21, s[24:27], s57 offen lds
    s_add_u32 m0, s44, 88064
    s_nop 0
    buffer_load_dwordx4 v22, s[24:27], s57 offen lds
    s_add_u32 m0, s44, 89088
    s_nop 0
    buffer_load_dwordx4 v23, s[24:27], s57 offen lds
    s_getpc_b64 s[40:41]
kB_kernel_pc:
    s_mov_b32 s42, kB_kernel_end-kB_kernel_pc-16
    s_bfe_u32 s43, s2, 0x50003
    s_lshl_b32 s43, s43, 1
    s_add_u32 s43, s43, s59
    s_lshl_b32 s43, s43, 10
    v_add_u32 v5, s43, v15
    v_min_u32 v5, s42, v5
    v_and_b32 v5, -4, v5
    global_load_dwordx4 v[28:31], v5, s[40:41]
    s_waitcnt vmcnt(9)
    s_barrier
    s_mov_b32 s57, 262144
    s_add_u32 m0, s44, 98304
    s_nop 0
    buffer_load_dwordx4 v16, s[24:27], s57 offen lds
    s_add_u32 m0, s44, 99328
    s_nop 0
    buffer_load_dwordx4 v17, s[24:27], s57 offen lds
    s_add_u32 m0, s44, 100352
    s_nop 0
    buffer_load_dwordx4 v18, s[24:27], s57 offen lds
    s_add_u32 m0, s44, 101376
    s_nop 0
    buffer_load_dwordx4 v19, s[24:27], s57 offen lds
    s_add_u32 m0, s44, 102400
    s_nop 0
    buffer_load_dwordx4 v20, s[24:27], s57 offen lds
    s_add_u32 m0, s44, 103424
    s_nop 0
    buffer_load_dwordx4 v21, s[24:27], s57 offen lds
    s_add_u32 m0, s44, 104448
    s_nop 0
    buffer_load_dwordx4 v22, s[24:27], s57 offen lds
    s_add_u32 m0, s44, 105472
    s_nop 0
    buffer_load_dwordx4 v23, s[24:27], s57 offen lds
    s_mov_b32 s57, 393216
    s_add_u32 m0, s44, 114688
    s_nop 0
    buffer_load_dwordx4 v16, s[24:27], s57 offen lds
    s_add_u32 m0, s44, 115712
    s_nop 0
    buffer_load_dwordx4 v17, s[24:27], s57 offen lds
    s_add_u32 m0, s44, 116736
    s_nop 0
    buffer_load_dwordx4 v18, s[24:27], s57 offen lds
    s_add_u32 m0, s44, 117760
    s_nop 0
    buffer_load_dwordx4 v19, s[24:27], s57 offen lds
    s_add_u32 m0, s44, 118784
    s_nop 0
    buffer_load_dwordx4 v20, s[24:27], s57 offen lds
    s_add_u32 m0, s44, 119808
    s_nop 0
    buffer_load_dwordx4 v21, s[24:27], s57 offen lds
    s_add_u32 m0, s44, 120832
    s_nop 0
    buffer_load_dwordx4 v22, s[24:27], s57 offen lds
    s_add_u32 m0, s44, 121856
    s_nop 0
    buffer_load_dwordx4 v23, s[24:27], s57 offen lds
    s_waitcnt vmcnt(17)
    s_barrier
    s_lshl_b32 s52, s59, 5
    s_mul_i32 s54, s97, 224
    v_lshlrev_b32 v5, 1, v3
    v_xor_b32 v5, v5, v2
    v_cmp_gt_u32 s[62:63], 14, v5
    v_lshlrev_b32 v5, 4, v5
    v_add3_u32 v6, v3, s52, 0
    v_mul_u32_u24 v6, 3584, v6
    v_add3_u32 v32, v6, v5, s54
    v_lshlrev_b32 v5, 1, v3
    v_xor_b32 v5, v5, v2
    v_lshlrev_b32 v5, 4, v5
    v_add3_u32 v6, v3, s52, 4
    v_mul_u32_u24 v6, 3584, v6
    v_add3_u32 v33, v6, v5, s54
    v_lshlrev_b32 v5, 1, v3
    v_or_b32 v5, 8, v5
    v_xor_b32 v5, v5, v2
    v_cmp_gt_u32 s[64:65], 14, v5
    v_lshlrev_b32 v5, 4, v5
    v_add3_u32 v6, v3, s52, 8
    v_mul_u32_u24 v6, 3584, v6
    v_add3_u32 v34, v6, v5, s54
    v_lshlrev_b32 v5, 1, v3
    v_or_b32 v5, 8, v5
    v_xor_b32 v5, v5, v2
    v_lshlrev_b32 v5, 4, v5
    v_add3_u32 v6, v3, s52, 12
    v_mul_u32_u24 v6, 3584, v6
    v_add3_u32 v35, v6, v5, s54
    v_lshlrev_b32 v5, 1, v3
    v_xor_b32 v5, v5, v2
    v_lshlrev_b32 v5, 4, v5
    v_add3_u32 v6, v3, s52, 16
    v_mul_u32_u24 v6, 3584, v6
    v_add3_u32 v36, v6, v5, s54
    v_lshlrev_b32 v5, 1, v3
    v_xor_b32 v5, v5, v2
    v_lshlrev_b32 v5, 4, v5
    v_add3_u32 v6, v3, s52, 20
    v_mul_u32_u24 v6, 3584, v6
    v_add3_u32 v37, v6, v5, s54
    v_lshlrev_b32 v5, 1, v3
    v_or_b32 v5, 8, v5
    v_xor_b32 v5, v5, v2
    v_lshlrev_b32 v5, 4, v5
    v_add3_u32 v6, v3, s52, 24
    v_mul_u32_u24 v6, 3584, v6
    v_add3_u32 v38, v6, v5, s54
    v_lshlrev_b32 v5, 1, v3
    v_or_b32 v5, 8, v5
    v_xor_b32 v5, v5, v2
    v_lshlrev_b32 v5, 4, v5
    v_add3_u32 v6, v3, s52, 28
    v_mul_u32_u24 v6, 3584, v6
    v_add3_u32 v39, v6, v5, s54
    s_lshl_b32 s45, s59, 13
    s_waitcnt lgkmcnt(0)
    s_mov_b32 s28, s12
    s_and_b32 s29, s13, 0xffff
    s_mov_b32 s30, 1835008
    s_mov_b32 s31, 0x20000
    s_mov_b32 s57, 0
    s_mov_b64 exec, s[62:63]
    s_add_u32 m0, s45, 65536
    s_nop 0
    buffer_load_dwordx4 v32, s[28:31], s57 offen lds
    s_add_u32 m0, s45, 66560
    s_nop 0
    buffer_load_dwordx4 v33, s[28:31], s57 offen lds
    s_mov_b64 exec, s[64:65]
    s_add_u32 m0, s45, 67584
    s_nop 0
    buffer_load_dwordx4 v34, s[28:31], s57 offen lds
    s_add_u32 m0, s45, 68608
    s_nop 0
    buffer_load_dwordx4 v35, s[28:31], s57 offen lds
    s_mov_b64 exec, s[62:63]
    s_add_u32 m0, s45, 69632
    s_nop 0
    buffer_load_dwordx4 v36, s[28:31], s57 offen lds
    s_add_u32 m0, s45, 70656
    s_nop 0
    buffer_load_dwordx4 v37, s[28:31], s57 offen lds
    s_mov_b64 exec, s[64:65]
    s_add_u32 m0, s45, 71680
    s_nop 0
    buffer_load_dwordx4 v38, s[28:31], s57 offen lds
    s_add_u32 m0, s45, 72704
    s_nop 0
    buffer_load_dwordx4 v39, s[28:31], s57 offen lds
    s_mov_b64 exec, -1
    s_waitcnt vmcnt(16)
    s_barrier
    s_mov_b32 s57, 229376
    s_mov_b64 exec, s[62:63]
    s_add_u32 m0, s45, 81920
    s_nop 0
    buffer_load_dwordx4 v32, s[28:31], s57 offen lds
    s_add_u32 m0, s45, 82944
    s_nop 0
    buffer_load_dwordx4 v33, s[28:31], s57 offen lds
    s_mov_b64 exec, s[64:65]
    s_add_u32 m0, s45, 83968
    s_nop 0
    buffer_load_dwordx4 v34, s[28:31], s57 offen lds
    s_add_u32 m0, s45, 84992
    s_nop 0
    buffer_load_dwordx4 v35, s[28:31], s57 offen lds
    s_mov_b64 exec, s[62:63]
    s_add_u32 m0, s45, 86016
    s_nop 0
    buffer_load_dwordx4 v36, s[28:31], s57 offen lds
    s_add_u32 m0, s45, 87040
    s_nop 0
    buffer_load_dwordx4 v37, s[28:31], s57 offen lds
    s_mov_b64 exec, s[64:65]
    s_add_u32 m0, s45, 88064
    s_nop 0
    buffer_load_dwordx4 v38, s[28:31], s57 offen lds
    s_add_u32 m0, s45, 89088
    s_nop 0
    buffer_load_dwordx4 v39, s[28:31], s57 offen lds
    s_mov_b64 exec, -1
    s_waitcnt vmcnt(16)
    s_barrier
    s_mov_b32 s57, 458752
    s_mov_b64 exec, s[62:63]
    s_add_u32 m0, s45, 98304
    s_nop 0
    buffer_load_dwordx4 v32, s[28:31], s57 offen lds
    s_add_u32 m0, s45, 99328
    s_nop 0
    buffer_load_dwordx4 v33, s[28:31], s57 offen lds
    s_mov_b64 exec, s[64:65]
    s_add_u32 m0, s45, 100352
    s_nop 0
    buffer_load_dwordx4 v34, s[28:31], s57 offen lds
    s_add_u32 m0, s45, 101376
    s_nop 0
    buffer_load_dwordx4 v35, s[28:31], s57 offen lds
    s_mov_b64 exec, s[62:63]
    s_add_u32 m0, s45, 102400
    s_nop 0
    buffer_load_dwordx4 v36, s[28:31], s57 offen lds
    s_add_u32 m0, s45, 103424
    s_nop 0
    buffer_load_dwordx4 v37, s[28:31], s57 offen lds
    s_mov_b64 exec, s[64:65]
    s_add_u32 m0, s45, 104448
    s_nop 0
    buffer_load_dwordx4 v38, s[28:31], s57 offen lds
    s_add_u32 m0, s45, 105472
    s_nop 0
    buffer_load_dwordx4 v39, s[28:31], s57 offen lds
    s_mov_b64 exec, -1
    s_barrier
    s_mov_b32 s57, 688128
    s_mov_b64 exec, s[62:63]
    s_add_u32 m0, s45, 114688
    s_nop 0
    buffer_load_dwordx4 v32, s[28:31], s57 offen lds
    s_add_u32 m0, s45, 115712
    s_nop 0
    buffer_load_dwordx4 v33, s[28:31], s57 offen lds
    s_mov_b64 exec, s[64:65]
    s_add_u32 m0, s45, 116736
    s_nop 0
    buffer_load_dwordx4 v34, s[28:31], s57 offen lds
    s_add_u32 m0, s45, 117760
    s_nop 0
    buffer_load_dwordx4 v35, s[28:31], s57 offen lds
    s_mov_b64 exec, s[62:63]
    s_add_u32 m0, s45, 118784
    s_nop 0
    buffer_load_dwordx4 v36, s[28:31], s57 offen lds
    s_add_u32 m0, s45, 119808
    s_nop 0
    buffer_load_dwordx4 v37, s[28:31], s57 offen lds
    s_mov_b64 exec, s[64:65]
    s_add_u32 m0, s45, 120832
    s_nop 0
    buffer_load_dwordx4 v38, s[28:31], s57 offen lds
    s_add_u32 m0, s45, 121856
    s_nop 0
    buffer_load_dwordx4 v39, s[28:31], s57 offen lds
    s_mov_b64 exec, -1
    s_barrier
    s_waitcnt vmcnt(24)
    s_mov_b32 s57, 917504
    s_mov_b64 exec, s[62:63]
    s_add_u32 m0, s45, 131072
    s_nop 0
    buffer_load_dwordx4 v32, s[28:31], s57 offen lds
    s_add_u32 m0, s45, 132096
    s_nop 0
    buffer_load_dwordx4 v33, s[28:31], s57 offen lds
    s_mov_b64 exec, s[64:65]
    s_add_u32 m0, s45, 133120
    s_nop 0
    buffer_load_dwordx4 v34, s[28:31], s57 offen lds
    s_add_u32 m0, s45, 134144
    s_nop 0
    buffer_load_dwordx4 v35, s[28:31], s57 offen lds
    s_mov_b64 exec, s[62:63]
    s_add_u32 m0, s45, 135168
    s_nop 0
    buffer_load_dwordx4 v36, s[28:31], s57 offen lds
    s_add_u32 m0, s45, 136192
    s_nop 0
    buffer_load_dwordx4 v37, s[28:31], s57 offen lds
    s_mov_b64 exec, s[64:65]
    s_add_u32 m0, s45, 137216
    s_nop 0
    buffer_load_dwordx4 v38, s[28:31], s57 offen lds
    s_add_u32 m0, s45, 138240
    s_nop 0
    buffer_load_dwordx4 v39, s[28:31], s57 offen lds
    s_mov_b64 exec, -1
    s_barrier
    s_barrier
    s_waitcnt vmcnt(24)
    s_barrier
    s_mov_b32 s57, 1146880
    s_mov_b64 exec, s[62:63]
    s_add_u32 m0, s45, 65536
    s_nop 0
    buffer_load_dwordx4 v32, s[28:31], s57 offen lds
    s_add_u32 m0, s45, 66560
    s_nop 0
    buffer_load_dwordx4 v33, s[28:31], s57 offen lds
    s_mov_b64 exec, s[64:65]
    s_add_u32 m0, s45, 67584
    s_nop 0
    buffer_load_dwordx4 v34, s[28:31], s57 offen lds
    s_add_u32 m0, s45, 68608
    s_nop 0
    buffer_load_dwordx4 v35, s[28:31], s57 offen lds
    s_mov_b64 exec, s[62:63]
    s_add_u32 m0, s45, 69632
    s_nop 0
    buffer_load_dwordx4 v36, s[28:31], s57 offen lds
    s_add_u32 m0, s45, 70656
    s_nop 0
    buffer_load_dwordx4 v37, s[28:31], s57 offen lds
    s_mov_b64 exec, s[64:65]
    s_add_u32 m0, s45, 71680
    s_nop 0
    buffer_load_dwordx4 v38, s[28:31], s57 offen lds
    s_add_u32 m0, s45, 72704
    s_nop 0
    buffer_load_dwordx4 v39, s[28:31], s57 offen lds
    s_mov_b64 exec, -1
    s_waitcnt vmcnt(24)
    s_barrier
    s_mov_b32 s57, 1376256
    s_mov_b64 exec, s[62:63]
    s_add_u32 m0, s45, 81920
    s_nop 0
    buffer_load_dwordx4 v32, s[28:31], s57 offen lds
    s_add_u32 m0, s45, 82944
    s_nop 0
    buffer_load_dwordx4 v33, s[28:31], s57 offen lds
    s_mov_b64 exec, s[64:65]
    s_add_u32 m0, s45, 83968
    s_nop 0
    buffer_load_dwordx4 v34, s[28:31], s57 offen lds
    s_add_u32 m0, s45, 84992
    s_nop 0
    buffer_load_dwordx4 v35, s[28:31], s57 offen lds
    s_mov_b64 exec, s[62:63]
    s_add_u32 m0, s45, 86016
    s_nop 0
    buffer_load_dwordx4 v36, s[28:31], s57 offen lds
    s_add_u32 m0, s45, 87040
    s_nop 0
    buffer_load_dwordx4 v37, s[28:31], s57 offen lds
    s_mov_b64 exec, s[64:65]
    s_add_u32 m0, s45, 88064
    s_nop 0
    buffer_load_dwordx4 v38, s[28:31], s57 offen lds
    s_add_u32 m0, s45, 89088
    s_nop 0
    buffer_load_dwordx4 v39, s[28:31], s57 offen lds
    s_mov_b64 exec, -1
    s_waitcnt vmcnt(24)
    s_barrier
    s_mov_b32 s57, 1605632
    s_mov_b64 exec, s[62:63]
    s_add_u32 m0, s45, 98304
    s_nop 0
    buffer_load_dwordx4 v32, s[28:31], s57 offen lds
    s_add_u32 m0, s45, 99328
    s_nop 0
    buffer_load_dwordx4 v33, s[28:31], s57 offen lds
    s_mov_b64 exec, s[64:65]
    s_add_u32 m0, s45, 100352
    s_nop 0
    buffer_load_dwordx4 v34, s[28:31], s57 offen lds
    s_add_u32 m0, s45, 101376
    s_nop 0
    buffer_load_dwordx4 v35, s[28:31], s57 offen lds
    s_mov_b64 exec, s[62:63]
    s_add_u32 m0, s45, 102400
    s_nop 0
    buffer_load_dwordx4 v36, s[28:31], s57 offen lds
    s_add_u32 m0, s45, 103424
    s_nop 0
    buffer_load_dwordx4 v37, s[28:31], s57 offen lds
    s_mov_b64 exec, s[64:65]
    s_add_u32 m0, s45, 104448
    s_nop 0
    buffer_load_dwordx4 v38, s[28:31], s57 offen lds
    s_add_u32 m0, s45, 105472
    s_nop 0
    buffer_load_dwordx4 v39, s[28:31], s57 offen lds
    s_mov_b64 exec, -1
    s_waitcnt vmcnt(24)
    s_barrier
    s_waitcnt vmcnt(16)
    s_barrier
    s_lshl_b32 s52, s59, 16
    s_and_b32 s54, s97, 7
    s_lshl_b32 s54, s54, 7
    s_add_u32 s52, s52, s54
    v_bfe_u32 v5, v1, 4, 1
    v_lshlrev_b32 v5, 1, v5
    v_and_b32 v6, 7, v1
    v_xor_b32 v5, v5, v6
    v_lshlrev_b32 v5, 4, v5
    v_lshrrev_b32 v6, 3, v1
    v_add_u32 v6, 0, v6
    v_lshl_add_u32 v5, v6, 10, v5
    v_add_u32 v40, s52, v5
    v_bfe_u32 v5, v1, 4, 1
    v_lshlrev_b32 v5, 1, v5
    v_or_b32 v5, 4, v5
    v_and_b32 v6, 7, v1
    v_xor_b32 v5, v5, v6
    v_lshlrev_b32 v5, 4, v5
    v_lshrrev_b32 v6, 3, v1
    v_add_u32 v6, 8, v6
    v_lshl_add_u32 v5, v6, 10, v5
    v_add_u32 v41, s52, v5
    v_bfe_u32 v5, v1, 4, 1
    v_lshlrev_b32 v5, 1, v5
    v_and_b32 v6, 7, v1
    v_xor_b32 v5, v5, v6
    v_lshlrev_b32 v5, 4, v5
    v_lshrrev_b32 v6, 3, v1
    v_add_u32 v6, 16, v6
    v_lshl_add_u32 v5, v6, 10, v5
    v_add_u32 v42, s52, v5
    v_bfe_u32 v5, v1, 4, 1
    v_lshlrev_b32 v5, 1, v5
    v_or_b32 v5, 4, v5
    v_and_b32 v6, 7, v1
    v_xor_b32 v5, v5, v6
    v_lshlrev_b32 v5, 4, v5
    v_lshrrev_b32 v6, 3, v1
    v_add_u32 v6, 24, v6
    v_lshl_add_u32 v5, v6, 10, v5
    v_add_u32 v43, s52, v5
    v_bfe_u32 v5, v1, 4, 1
    v_lshlrev_b32 v5, 1, v5
    v_and_b32 v6, 7, v1
    v_xor_b32 v5, v5, v6
    v_lshlrev_b32 v5, 4, v5
    v_lshrrev_b32 v6, 3, v1
    v_add_u32 v6, 32, v6
    v_lshl_add_u32 v5, v6, 10, v5
    v_add_u32 v44, s52, v5
    v_bfe_u32 v5, v1, 4, 1
    v_lshlrev_b32 v5, 1, v5
    v_or_b32 v5, 4, v5
    v_and_b32 v6, 7, v1
    v_xor_b32 v5, v5, v6
    v_lshlrev_b32 v5, 4, v5
    v_lshrrev_b32 v6, 3, v1
    v_add_u32 v6, 40, v6
    v_lshl_add_u32 v5, v6, 10, v5
    v_add_u32 v45, s52, v5
    v_bfe_u32 v5, v1, 4, 1
    v_lshlrev_b32 v5, 1, v5
    v_and_b32 v6, 7, v1
    v_xor_b32 v5, v5, v6
    v_lshlrev_b32 v5, 4, v5
    v_lshrrev_b32 v6, 3, v1
    v_add_u32 v6, 48, v6
    v_lshl_add_u32 v5, v6, 10, v5
    v_add_u32 v46, s52, v5
    v_bfe_u32 v5, v1, 4, 1
    v_lshlrev_b32 v5, 1, v5
    v_or_b32 v5, 4, v5
    v_and_b32 v6, 7, v1
    v_xor_b32 v5, v5, v6
    v_lshlrev_b32 v5, 4, v5
    v_lshrrev_b32 v6, 3, v1
    v_add_u32 v6, 56, v6
    v_lshl_add_u32 v5, v6, 10, v5
    v_add_u32 v47, s52, v5
    s_lshl_b32 s46, s59, 13
    s_waitcnt lgkmcnt(0)
    s_mov_b32 s32, s14
    s_and_b32 s33, s15, 0xffff
    s_mov_b32 s34, 1835008
    s_mov_b32 s35, 0x20000
    s_mov_b32 s57, 0
    s_add_u32 m0, s46, 114688
    s_nop 0
    buffer_load_dwordx4 v40, s[32:35], s57 offen lds
    s_add_u32 m0, s46, 115712
    s_nop 0
    buffer_load_dwordx4 v41, s[32:35], s57 offen lds
    s_add_u32 m0, s46, 116736
    s_nop 0
    buffer_load_dwordx4 v42, s[32:35], s57 offen lds
    s_add_u32 m0, s46, 117760
    s_nop 0
    buffer_load_dwordx4 v43, s[32:35], s57 offen lds
    s_add_u32 m0, s46, 118784
    s_nop 0
    buffer_load_dwordx4 v44, s[32:35], s57 offen lds
    s_add_u32 m0, s46, 119808
    s_nop 0
    buffer_load_dwordx4 v45, s[32:35], s57 offen lds
    s_add_u32 m0, s46, 120832
    s_nop 0
    buffer_load_dwordx4 v46, s[32:35], s57 offen lds
    s_add_u32 m0, s46, 121856
    s_nop 0
    buffer_load_dwordx4 v47, s[32:35], s57 offen lds
    s_waitcnt vmcnt(16)
    s_barrier
    s_mov_b32 s57, 131072
    s_add_u32 m0, s46, 131072
    s_nop 0
    buffer_load_dwordx4 v40, s[32:35], s57 offen lds
    s_add_u32 m0, s46, 132096
    s_nop 0
    buffer_load_dwordx4 v41, s[32:35], s57 offen lds
    s_add_u32 m0, s46, 133120
    s_nop 0
    buffer_load_dwordx4 v42, s[32:35], s57 offen lds
    s_add_u32 m0, s46, 134144
    s_nop 0
    buffer_load_dwordx4 v43, s[32:35], s57 offen lds
    s_add_u32 m0, s46, 135168
    s_nop 0
    buffer_load_dwordx4 v44, s[32:35], s57 offen lds
    s_add_u32 m0, s46, 136192
    s_nop 0
    buffer_load_dwordx4 v45, s[32:35], s57 offen lds
    s_add_u32 m0, s46, 137216
    s_nop 0
    buffer_load_dwordx4 v46, s[32:35], s57 offen lds
    s_add_u32 m0, s46, 138240
    s_nop 0
    buffer_load_dwordx4 v47, s[32:35], s57 offen lds
    s_waitcnt vmcnt(16)
    s_barrier
    s_mov_b32 s57, 262144
    s_add_u32 m0, s46, 65536
    s_nop 0
    buffer_load_dwordx4 v40, s[32:35], s57 offen lds
    s_add_u32 m0, s46, 66560
    s_nop 0
    buffer_load_dwordx4 v41, s[32:35], s57 offen lds
    s_add_u32 m0, s46, 67584
    s_nop 0
    buffer_load_dwordx4 v42, s[32:35], s57 offen lds
    s_add_u32 m0, s46, 68608
    s_nop 0
    buffer_load_dwordx4 v43, s[32:35], s57 offen lds
    s_add_u32 m0, s46, 69632
    s_nop 0
    buffer_load_dwordx4 v44, s[32:35], s57 offen lds
    s_add_u32 m0, s46, 70656
    s_nop 0
    buffer_load_dwordx4 v45, s[32:35], s57 offen lds
    s_add_u32 m0, s46, 71680
    s_nop 0
    buffer_load_dwordx4 v46, s[32:35], s57 offen lds
    s_add_u32 m0, s46, 72704
    s_nop 0
    buffer_load_dwordx4 v47, s[32:35], s57 offen lds
    s_barrier
    s_mov_b32 s57, 393216
    s_add_u32 m0, s46, 81920
    s_nop 0
    buffer_load_dwordx4 v40, s[32:35], s57 offen lds
    s_add_u32 m0, s46, 82944
    s_nop 0
    buffer_load_dwordx4 v41, s[32:35], s57 offen lds
    s_add_u32 m0, s46, 83968
    s_nop 0
    buffer_load_dwordx4 v42, s[32:35], s57 offen lds
    s_add_u32 m0, s46, 84992
    s_nop 0
    buffer_load_dwordx4 v43, s[32:35], s57 offen lds
    s_add_u32 m0, s46, 86016
    s_nop 0
    buffer_load_dwordx4 v44, s[32:35], s57 offen lds
    s_add_u32 m0, s46, 87040
    s_nop 0
    buffer_load_dwordx4 v45, s[32:35], s57 offen lds
    s_add_u32 m0, s46, 88064
    s_nop 0
    buffer_load_dwordx4 v46, s[32:35], s57 offen lds
    s_add_u32 m0, s46, 89088
    s_nop 0
    buffer_load_dwordx4 v47, s[32:35], s57 offen lds
    s_waitcnt vmcnt(24)
    s_mov_b32 s57, 524288
    s_add_u32 m0, s46, 98304
    s_nop 0
    buffer_load_dwordx4 v40, s[32:35], s57 offen lds
    s_add_u32 m0, s46, 99328
    s_nop 0
    buffer_load_dwordx4 v41, s[32:35], s57 offen lds
    s_add_u32 m0, s46, 100352
    s_nop 0
    buffer_load_dwordx4 v42, s[32:35], s57 offen lds
    s_add_u32 m0, s46, 101376
    s_nop 0
    buffer_load_dwordx4 v43, s[32:35], s57 offen lds
    s_add_u32 m0, s46, 102400
    s_nop 0
    buffer_load_dwordx4 v44, s[32:35], s57 offen lds
    s_add_u32 m0, s46, 103424
    s_nop 0
    buffer_load_dwordx4 v45, s[32:35], s57 offen lds
    s_add_u32 m0, s46, 104448
    s_nop 0
    buffer_load_dwordx4 v46, s[32:35], s57 offen lds
    s_add_u32 m0, s46, 105472
    s_nop 0
    buffer_load_dwordx4 v47, s[32:35], s57 offen lds
    s_barrier
    s_barrier
    s_barrier
    s_waitcnt vmcnt(24)
    s_barrier
    s_mov_b32 s57, 655360
    s_add_u32 m0, s46, 114688
    s_nop 0
    buffer_load_dwordx4 v40, s[32:35], s57 offen lds
    s_add_u32 m0, s46, 115712
    s_nop 0
    buffer_load_dwordx4 v41, s[32:35], s57 offen lds
    s_add_u32 m0, s46, 116736
    s_nop 0
    buffer_load_dwordx4 v42, s[32:35], s57 offen lds
    s_add_u32 m0, s46, 117760
    s_nop 0
    buffer_load_dwordx4 v43, s[32:35], s57 offen lds
    s_add_u32 m0, s46, 118784
    s_nop 0
    buffer_load_dwordx4 v44, s[32:35], s57 offen lds
    s_add_u32 m0, s46, 119808
    s_nop 0
    buffer_load_dwordx4 v45, s[32:35], s57 offen lds
    s_add_u32 m0, s46, 120832
    s_nop 0
    buffer_load_dwordx4 v46, s[32:35], s57 offen lds
    s_add_u32 m0, s46, 121856
    s_nop 0
    buffer_load_dwordx4 v47, s[32:35], s57 offen lds
    s_waitcnt vmcnt(24)
    s_barrier
    s_mov_b32 s57, 786432
    s_add_u32 m0, s46, 131072
    s_nop 0
    buffer_load_dwordx4 v40, s[32:35], s57 offen lds
    s_add_u32 m0, s46, 132096
    s_nop 0
    buffer_load_dwordx4 v41, s[32:35], s57 offen lds
    s_add_u32 m0, s46, 133120
    s_nop 0
    buffer_load_dwordx4 v42, s[32:35], s57 offen lds
    s_add_u32 m0, s46, 134144
    s_nop 0
    buffer_load_dwordx4 v43, s[32:35], s57 offen lds
    s_add_u32 m0, s46, 135168
    s_nop 0
    buffer_load_dwordx4 v44, s[32:35], s57 offen lds
    s_add_u32 m0, s46, 136192
    s_nop 0
    buffer_load_dwordx4 v45, s[32:35], s57 offen lds
    s_add_u32 m0, s46, 137216
    s_nop 0
    buffer_load_dwordx4 v46, s[32:35], s57 offen lds
    s_add_u32 m0, s46, 138240
    s_nop 0
    buffer_load_dwordx4 v47, s[32:35], s57 offen lds
    s_waitcnt vmcnt(24)
    s_barrier
    s_mov_b32 s57, 917504
    s_add_u32 m0, s46, 65536
    s_nop 0
    buffer_load_dwordx4 v40, s[32:35], s57 offen lds
    s_add_u32 m0, s46, 66560
    s_nop 0
    buffer_load_dwordx4 v41, s[32:35], s57 offen lds
    s_add_u32 m0, s46, 67584
    s_nop 0
    buffer_load_dwordx4 v42, s[32:35], s57 offen lds
    s_add_u32 m0, s46, 68608
    s_nop 0
    buffer_load_dwordx4 v43, s[32:35], s57 offen lds
    s_add_u32 m0, s46, 69632
    s_nop 0
    buffer_load_dwordx4 v44, s[32:35], s57 offen lds
    s_add_u32 m0, s46, 70656
    s_nop 0
    buffer_load_dwordx4 v45, s[32:35], s57 offen lds
    s_add_u32 m0, s46, 71680
    s_nop 0
    buffer_load_dwordx4 v46, s[32:35], s57 offen lds
    s_add_u32 m0, s46, 72704
    s_nop 0
    buffer_load_dwordx4 v47, s[32:35], s57 offen lds
    s_waitcnt vmcnt(24)
    s_barrier
    s_mov_b32 s57, 1048576
    s_add_u32 m0, s46, 81920
    s_nop 0
    buffer_load_dwordx4 v40, s[32:35], s57 offen lds
    s_add_u32 m0, s46, 82944
    s_nop 0
    buffer_load_dwordx4 v41, s[32:35], s57 offen lds
    s_add_u32 m0, s46, 83968
    s_nop 0
    buffer_load_dwordx4 v42, s[32:35], s57 offen lds
    s_add_u32 m0, s46, 84992
    s_nop 0
    buffer_load_dwordx4 v43, s[32:35], s57 offen lds
    s_add_u32 m0, s46, 86016
    s_nop 0
    buffer_load_dwordx4 v44, s[32:35], s57 offen lds
    s_add_u32 m0, s46, 87040
    s_nop 0
    buffer_load_dwordx4 v45, s[32:35], s57 offen lds
    s_add_u32 m0, s46, 88064
    s_nop 0
    buffer_load_dwordx4 v46, s[32:35], s57 offen lds
    s_add_u32 m0, s46, 89088
    s_nop 0
    buffer_load_dwordx4 v47, s[32:35], s57 offen lds
    s_waitcnt vmcnt(24)
    s_barrier
    s_mov_b32 s57, 1179648
    s_add_u32 m0, s46, 98304
    s_nop 0
    buffer_load_dwordx4 v40, s[32:35], s57 offen lds
    s_add_u32 m0, s46, 99328
    s_nop 0
    buffer_load_dwordx4 v41, s[32:35], s57 offen lds
    s_add_u32 m0, s46, 100352
    s_nop 0
    buffer_load_dwordx4 v42, s[32:35], s57 offen lds
    s_add_u32 m0, s46, 101376
    s_nop 0
    buffer_load_dwordx4 v43, s[32:35], s57 offen lds
    s_add_u32 m0, s46, 102400
    s_nop 0
    buffer_load_dwordx4 v44, s[32:35], s57 offen lds
    s_add_u32 m0, s46, 103424
    s_nop 0
    buffer_load_dwordx4 v45, s[32:35], s57 offen lds
    s_add_u32 m0, s46, 104448
    s_nop 0
    buffer_load_dwordx4 v46, s[32:35], s57 offen lds
    s_add_u32 m0, s46, 105472
    s_nop 0
    buffer_load_dwordx4 v47, s[32:35], s57 offen lds
    s_waitcnt vmcnt(24)
    s_barrier
    s_mov_b32 s57, 1310720
    s_add_u32 m0, s46, 114688
    s_nop 0
    buffer_load_dwordx4 v40, s[32:35], s57 offen lds
    s_add_u32 m0, s46, 115712
    s_nop 0
    buffer_load_dwordx4 v41, s[32:35], s57 offen lds
    s_add_u32 m0, s46, 116736
    s_nop 0
    buffer_load_dwordx4 v42, s[32:35], s57 offen lds
    s_add_u32 m0, s46, 117760
    s_nop 0
    buffer_load_dwordx4 v43, s[32:35], s57 offen lds
    s_add_u32 m0, s46, 118784
    s_nop 0
    buffer_load_dwordx4 v44, s[32:35], s57 offen lds
    s_add_u32 m0, s46, 119808
    s_nop 0
    buffer_load_dwordx4 v45, s[32:35], s57 offen lds
    s_add_u32 m0, s46, 120832
    s_nop 0
    buffer_load_dwordx4 v46, s[32:35], s57 offen lds
    s_add_u32 m0, s46, 121856
    s_nop 0
    buffer_load_dwordx4 v47, s[32:35], s57 offen lds
    s_waitcnt vmcnt(24)
    s_barrier
    s_mov_b32 s57, 1441792
    s_add_u32 m0, s46, 131072
    s_nop 0
    buffer_load_dwordx4 v40, s[32:35], s57 offen lds
    s_add_u32 m0, s46, 132096
    s_nop 0
    buffer_load_dwordx4 v41, s[32:35], s57 offen lds
    s_add_u32 m0, s46, 133120
    s_nop 0
    buffer_load_dwordx4 v42, s[32:35], s57 offen lds
    s_add_u32 m0, s46, 134144
    s_nop 0
    buffer_load_dwordx4 v43, s[32:35], s57 offen lds
    s_add_u32 m0, s46, 135168
    s_nop 0
    buffer_load_dwordx4 v44, s[32:35], s57 offen lds
    s_add_u32 m0, s46, 136192
    s_nop 0
    buffer_load_dwordx4 v45, s[32:35], s57 offen lds
    s_add_u32 m0, s46, 137216
    s_nop 0
    buffer_load_dwordx4 v46, s[32:35], s57 offen lds
    s_add_u32 m0, s46, 138240
    s_nop 0
    buffer_load_dwordx4 v47, s[32:35], s57 offen lds
    s_waitcnt vmcnt(24)
    s_barrier
    s_mov_b32 s57, 1572864
    s_add_u32 m0, s46, 65536
    s_nop 0
    buffer_load_dwordx4 v40, s[32:35], s57 offen lds
    s_add_u32 m0, s46, 66560
    s_nop 0
    buffer_load_dwordx4 v41, s[32:35], s57 offen lds
    s_add_u32 m0, s46, 67584
    s_nop 0
    buffer_load_dwordx4 v42, s[32:35], s57 offen lds
    s_add_u32 m0, s46, 68608
    s_nop 0
    buffer_load_dwordx4 v43, s[32:35], s57 offen lds
    s_add_u32 m0, s46, 69632
    s_nop 0
    buffer_load_dwordx4 v44, s[32:35], s57 offen lds
    s_add_u32 m0, s46, 70656
    s_nop 0
    buffer_load_dwordx4 v45, s[32:35], s57 offen lds
    s_add_u32 m0, s46, 71680
    s_nop 0
    buffer_load_dwordx4 v46, s[32:35], s57 offen lds
    s_add_u32 m0, s46, 72704
    s_nop 0
    buffer_load_dwordx4 v47, s[32:35], s57 offen lds
    s_waitcnt vmcnt(24)
    s_barrier
    s_mov_b32 s57, 1703936
    s_add_u32 m0, s46, 81920
    s_nop 0
    buffer_load_dwordx4 v40, s[32:35], s57 offen lds
    s_add_u32 m0, s46, 82944
    s_nop 0
    buffer_load_dwordx4 v41, s[32:35], s57 offen lds
    s_add_u32 m0, s46, 83968
    s_nop 0
    buffer_load_dwordx4 v42, s[32:35], s57 offen lds
    s_add_u32 m0, s46, 84992
    s_nop 0
    buffer_load_dwordx4 v43, s[32:35], s57 offen lds
    s_add_u32 m0, s46, 86016
    s_nop 0
    buffer_load_dwordx4 v44, s[32:35], s57 offen lds
    s_add_u32 m0, s46, 87040
    s_nop 0
    buffer_load_dwordx4 v45, s[32:35], s57 offen lds
    s_add_u32 m0, s46, 88064
    s_nop 0
    buffer_load_dwordx4 v46, s[32:35], s57 offen lds
    s_add_u32 m0, s46, 89088
    s_nop 0
    buffer_load_dwordx4 v47, s[32:35], s57 offen lds
    s_waitcnt vmcnt(24)
    s_barrier
    s_waitcnt vmcnt(16)
    s_barrier
    s_mul_i32 s53, s59, 384
    s_lshl_b32 s54, s97, 6
    v_add_u32 v10, s53, v1
    v_mul_u32_u24 v11, 0xaaab, v10
    v_lshrrev_b32 v11, 19, v11
    v_mul_u32_u24 v12, 12, v11
    v_sub_u32 v12, v10, v12
    v_lshrrev_b32 v13, 1, v12
    v_bfe_u32 v14, v11, 3, 1
    v_sub_u32 v13, v13, v14
    v_add_u32 v14, 6, v13
    v_min_u32 v13, v13, v14
    v_lshrrev_b32 v14, 1, v13
    v_lshlrev_b32 v14, 10, v14
    v_and_b32 v13, 1, v13
    v_lshl_add_u32 v14, v13, 5, v14
    v_and_b32 v12, 1, v12
    v_lshl_add_u32 v14, v12, 4, v14
    v_mul_u32_u24 v11, 3072, v11
    v_add3_u32 v48, v11, v14, s54
    v_add_u32 v10, s53, v1
    v_add_u32 v10, 64, v10
    v_mul_u32_u24 v11, 0xaaab, v10
    v_lshrrev_b32 v11, 19, v11
    v_mul_u32_u24 v12, 12, v11
    v_sub_u32 v12, v10, v12
    v_lshrrev_b32 v13, 1, v12
    v_bfe_u32 v14, v11, 3, 1
    v_sub_u32 v13, v13, v14
    v_add_u32 v14, 6, v13
    v_min_u32 v13, v13, v14
    v_lshrrev_b32 v14, 1, v13
    v_lshlrev_b32 v14, 10, v14
    v_and_b32 v13, 1, v13
    v_lshl_add_u32 v14, v13, 5, v14
    v_and_b32 v12, 1, v12
    v_lshl_add_u32 v14, v12, 4, v14
    v_mul_u32_u24 v11, 3072, v11
    v_add3_u32 v49, v11, v14, s54
    v_add_u32 v10, s53, v1
    v_add_u32 v10, 128, v10
    v_mul_u32_u24 v11, 0xaaab, v10
    v_lshrrev_b32 v11, 19, v11
    v_mul_u32_u24 v12, 12, v11
    v_sub_u32 v12, v10, v12
    v_lshrrev_b32 v13, 1, v12
    v_bfe_u32 v14, v11, 3, 1
    v_sub_u32 v13, v13, v14
    v_add_u32 v14, 6, v13
    v_min_u32 v13, v13, v14
    v_lshrrev_b32 v14, 1, v13
    v_lshlrev_b32 v14, 10, v14
    v_and_b32 v13, 1, v13
    v_lshl_add_u32 v14, v13, 5, v14
    v_and_b32 v12, 1, v12
    v_lshl_add_u32 v14, v12, 4, v14
    v_mul_u32_u24 v11, 3072, v11
    v_add3_u32 v50, v11, v14, s54
    v_add_u32 v10, s53, v1
    v_add_u32 v10, 192, v10
    v_mul_u32_u24 v11, 0xaaab, v10
    v_lshrrev_b32 v11, 19, v11
    v_mul_u32_u24 v12, 12, v11
    v_sub_u32 v12, v10, v12
    v_lshrrev_b32 v13, 1, v12
    v_bfe_u32 v14, v11, 3, 1
    v_sub_u32 v13, v13, v14
    v_add_u32 v14, 6, v13
    v_min_u32 v13, v13, v14
    v_lshrrev_b32 v14, 1, v13
    v_lshlrev_b32 v14, 10, v14
    v_and_b32 v13, 1, v13
    v_lshl_add_u32 v14, v13, 5, v14
    v_and_b32 v12, 1, v12
    v_lshl_add_u32 v14, v12, 4, v14
    v_mul_u32_u24 v11, 3072, v11
    v_add3_u32 v51, v11, v14, s54
    v_add_u32 v10, s53, v1
    v_add_u32 v10, 256, v10
    v_mul_u32_u24 v11, 0xaaab, v10
    v_lshrrev_b32 v11, 19, v11
    v_mul_u32_u24 v12, 12, v11
    v_sub_u32 v12, v10, v12
    v_lshrrev_b32 v13, 1, v12
    v_bfe_u32 v14, v11, 3, 1
    v_sub_u32 v13, v13, v14
    v_add_u32 v14, 6, v13
    v_min_u32 v13, v13, v14
    v_lshrrev_b32 v14, 1, v13
    v_lshlrev_b32 v14, 10, v14
    v_and_b32 v13, 1, v13
    v_lshl_add_u32 v14, v13, 5, v14
    v_and_b32 v12, 1, v12
    v_lshl_add_u32 v14, v12, 4, v14
    v_mul_u32_u24 v11, 3072, v11
    v_add3_u32 v52, v11, v14, s54
    v_add_u32 v10, s53, v1
    v_add_u32 v10, 320, v10
    v_mul_u32_u24 v11, 0xaaab, v10
    v_lshrrev_b32 v11, 19, v11
    v_mul_u32_u24 v12, 12, v11
    v_sub_u32 v12, v10, v12
    v_lshrrev_b32 v13, 1, v12
    v_bfe_u32 v14, v11, 3, 1
    v_sub_u32 v13, v13, v14
    v_add_u32 v14, 6, v13
    v_min_u32 v13, v13, v14
    v_lshrrev_b32 v14, 1, v13
    v_lshlrev_b32 v14, 10, v14
    v_and_b32 v13, 1, v13
    v_lshl_add_u32 v14, v13, 5, v14
    v_and_b32 v12, 1, v12
    v_lshl_add_u32 v14, v12, 4, v14
    v_mul_u32_u24 v11, 3072, v11
    v_add3_u32 v53, v11, v14, s54
    s_mul_i32 s47, s59, 6144
    s_waitcnt lgkmcnt(0)
    s_mov_b32 s36, s6
    s_and_b32 s37, s7, 0xffff
    s_mov_b32 s38, 1572864
    s_mov_b32 s39, 0x20000
    s_mov_b32 s57, 0
    s_add_u32 m0, s47, 98304
    s_nop 0
    buffer_load_dwordx4 v48, s[36:39], s57 offen lds
    s_add_u32 m0, s47, 99328
    s_nop 0
    buffer_load_dwordx4 v49, s[36:39], s57 offen lds
    s_add_u32 m0, s47, 100352
    s_nop 0
    buffer_load_dwordx4 v50, s[36:39], s57 offen lds
    s_add_u32 m0, s47, 101376
    s_nop 0
    buffer_load_dwordx4 v51, s[36:39], s57 offen lds
    s_add_u32 m0, s47, 102400
    s_nop 0
    buffer_load_dwordx4 v52, s[36:39], s57 offen lds
    s_add_u32 m0, s47, 103424
    s_nop 0
    buffer_load_dwordx4 v53, s[36:39], s57 offen lds
    s_waitcnt vmcnt(14)
    s_barrier
    s_mov_b32 s57, 196608
    s_add_u32 m0, s47, 114688
    s_nop 0
    buffer_load_dwordx4 v48, s[36:39], s57 offen lds
    s_add_u32 m0, s47, 115712
    s_nop 0
    buffer_load_dwordx4 v49, s[36:39], s57 offen lds
    s_add_u32 m0, s47, 116736
    s_nop 0
    buffer_load_dwordx4 v50, s[36:39], s57 offen lds
    s_add_u32 m0, s47, 117760
    s_nop 0
    buffer_load_dwordx4 v51, s[36:39], s57 offen lds
    s_add_u32 m0, s47, 118784
    s_nop 0
    buffer_load_dwordx4 v52, s[36:39], s57 offen lds
    s_add_u32 m0, s47, 119808
    s_nop 0
    buffer_load_dwordx4 v53, s[36:39], s57 offen lds
    s_waitcnt vmcnt(12)
    s_barrier
    s_mov_b32 s57, 393216
    s_add_u32 m0, s47, 131072
    s_nop 0
    buffer_load_dwordx4 v48, s[36:39], s57 offen lds
    s_add_u32 m0, s47, 132096
    s_nop 0
    buffer_load_dwordx4 v49, s[36:39], s57 offen lds
    s_add_u32 m0, s47, 133120
    s_nop 0
    buffer_load_dwordx4 v50, s[36:39], s57 offen lds
    s_add_u32 m0, s47, 134144
    s_nop 0
    buffer_load_dwordx4 v51, s[36:39], s57 offen lds
    s_add_u32 m0, s47, 135168
    s_nop 0
    buffer_load_dwordx4 v52, s[36:39], s57 offen lds
    s_add_u32 m0, s47, 136192
    s_nop 0
    buffer_load_dwordx4 v53, s[36:39], s57 offen lds
    s_barrier
    s_mov_b32 s57, 589824
    s_add_u32 m0, s47, 65536
    s_nop 0
    buffer_load_dwordx4 v48, s[36:39], s57 offen lds
    s_add_u32 m0, s47, 66560
    s_nop 0
    buffer_load_dwordx4 v49, s[36:39], s57 offen lds
    s_add_u32 m0, s47, 67584
    s_nop 0
    buffer_load_dwordx4 v50, s[36:39], s57 offen lds
    s_add_u32 m0, s47, 68608
    s_nop 0
    buffer_load_dwordx4 v51, s[36:39], s57 offen lds
    s_add_u32 m0, s47, 69632
    s_nop 0
    buffer_load_dwordx4 v52, s[36:39], s57 offen lds
    s_add_u32 m0, s47, 70656
    s_nop 0
    buffer_load_dwordx4 v53, s[36:39], s57 offen lds
    s_barrier
    s_mov_b32 s57, 786432
    s_add_u32 m0, s47, 81920
    s_nop 0
    buffer_load_dwordx4 v48, s[36:39], s57 offen lds
    s_add_u32 m0, s47, 82944
    s_nop 0
    buffer_load_dwordx4 v49, s[36:39], s57 offen lds
    s_add_u32 m0, s47, 83968
    s_nop 0
    buffer_load_dwordx4 v50, s[36:39], s57 offen lds
    s_add_u32 m0, s47, 84992
    s_nop 0
    buffer_load_dwordx4 v51, s[36:39], s57 offen lds
    s_add_u32 m0, s47, 86016
    s_nop 0
    buffer_load_dwordx4 v52, s[36:39], s57 offen lds
    s_add_u32 m0, s47, 87040
    s_nop 0
    buffer_load_dwordx4 v53, s[36:39], s57 offen lds
    s_barrier
    s_waitcnt vmcnt(24)
    s_barrier
    s_waitcnt vmcnt(18)
    s_barrier
    s_mov_b32 s57, 983040
    s_add_u32 m0, s47, 98304
    s_nop 0
    buffer_load_dwordx4 v48, s[36:39], s57 offen lds
    s_add_u32 m0, s47, 99328
    s_nop 0
    buffer_load_dwordx4 v49, s[36:39], s57 offen lds
    s_add_u32 m0, s47, 100352
    s_nop 0
    buffer_load_dwordx4 v50, s[36:39], s57 offen lds
    s_add_u32 m0, s47, 101376
    s_nop 0
    buffer_load_dwordx4 v51, s[36:39], s57 offen lds
    s_add_u32 m0, s47, 102400
    s_nop 0
    buffer_load_dwordx4 v52, s[36:39], s57 offen lds
    s_add_u32 m0, s47, 103424
    s_nop 0
    buffer_load_dwordx4 v53, s[36:39], s57 offen lds
    s_waitcnt vmcnt(18)
    s_barrier
    s_mov_b32 s57, 1179648
    s_add_u32 m0, s47, 114688
    s_nop 0
    buffer_load_dwordx4 v48, s[36:39], s57 offen lds
    s_add_u32 m0, s47, 115712
    s_nop 0
    buffer_load_dwordx4 v49, s[36:39], s57 offen lds
    s_add_u32 m0, s47, 116736
    s_nop 0
    buffer_load_dwordx4 v50, s[36:39], s57 offen lds
    s_add_u32 m0, s47, 117760
    s_nop 0
    buffer_load_dwordx4 v51, s[36:39], s57 offen lds
    s_add_u32 m0, s47, 118784
    s_nop 0
    buffer_load_dwordx4 v52, s[36:39], s57 offen lds
    s_add_u32 m0, s47, 119808
    s_nop 0
    buffer_load_dwordx4 v53, s[36:39], s57 offen lds
    s_waitcnt vmcnt(18)
    s_barrier
    s_mov_b32 s57, 1376256
    s_add_u32 m0, s47, 131072
    s_nop 0
    buffer_load_dwordx4 v48, s[36:39], s57 offen lds
    s_add_u32 m0, s47, 132096
    s_nop 0
    buffer_load_dwordx4 v49, s[36:39], s57 offen lds
    s_add_u32 m0, s47, 133120
    s_nop 0
    buffer_load_dwordx4 v50, s[36:39], s57 offen lds
    s_add_u32 m0, s47, 134144
    s_nop 0
    buffer_load_dwordx4 v51, s[36:39], s57 offen lds
    s_add_u32 m0, s47, 135168
    s_nop 0
    buffer_load_dwordx4 v52, s[36:39], s57 offen lds
    s_add_u32 m0, s47, 136192
    s_nop 0
    buffer_load_dwordx4 v53, s[36:39], s57 offen lds
    s_waitcnt vmcnt(18)
    s_barrier
    s_waitcnt vmcnt(12)
    s_barrier
    s_waitcnt vmcnt(6)
    s_barrier
    s_waitcnt vmcnt(0)
    s_barrier
    s_barrier
    s_barrier
    s_endpgm
kB_kernel_aload:
    s_nop 7
    s_nop 7
    s_lshl_b32 s55, s59, 13
    s_lshr_b32 s48, s97, 3
    s_lshl_b32 s22, s96, 1
    s_add_u32 s22, s22, s48
    s_and_b32 s23, s97, 7
    s_lshl_b32 s50, s22, 6
    s_lshl_b32 s54, s23, 7
    s_mul_i32 s58, s59, 32
    s_add_u32 s58, s58, s50
    v_lshrrev_b32 v5, 4, v1
    v_and_b32 v6, 15, v5
    v_and_b32 v10, 15, v1
    v_xor_b32 v6, v6, v10
    v_add_u32 v5, s58, v5
    v_mul_u32_u24 v5, 1024, v5
    v_lshl_add_u32 v10, v6, 4, v5
    v_lshrrev_b32 v5, 4, v1
    v_add_u32 v5, 4, v5
    v_and_b32 v6, 15, v5
    v_and_b32 v11, 15, v1
    v_xor_b32 v6, v6, v11
    v_add_u32 v5, s58, v5
    v_mul_u32_u24 v5, 1024, v5
    v_lshl_add_u32 v11, v6, 4, v5
    v_lshrrev_b32 v5, 4, v1
    v_add_u32 v5, 8, v5
    v_and_b32 v6, 15, v5
    v_and_b32 v12, 15, v1
    v_xor_b32 v6, v6, v12
    v_add_u32 v5, s58, v5
    v_mul_u32_u24 v5, 1024, v5
    v_lshl_add_u32 v12, v6, 4, v5
    v_lshrrev_b32 v5, 4, v1
    v_add_u32 v5, 12, v5
    v_and_b32 v6, 15, v5
    v_and_b32 v13, 15, v1
    v_xor_b32 v6, v6, v13
    v_add_u32 v5, s58, v5
    v_mul_u32_u24 v5, 1024, v5
    v_lshl_add_u32 v13, v6, 4, v5
    v_lshrrev_b32 v5, 4, v1
    v_add_u32 v5, 16, v5
    v_and_b32 v6, 15, v5
    v_and_b32 v14, 15, v1
    v_xor_b32 v6, v6, v14
    v_add_u32 v5, s58, v5
    v_mul_u32_u24 v5, 1024, v5
    v_lshl_add_u32 v14, v6, 4, v5
    v_lshrrev_b32 v5, 4, v1
    v_add_u32 v5, 20, v5
    v_and_b32 v6, 15, v5
    v_and_b32 v15, 15, v1
    v_xor_b32 v6, v6, v15
    v_add_u32 v5, s58, v5
    v_mul_u32_u24 v5, 1024, v5
    v_lshl_add_u32 v15, v6, 4, v5
    v_lshrrev_b32 v5, 4, v1
    v_add_u32 v5, 24, v5
    v_and_b32 v6, 15, v5
    v_and_b32 v16, 15, v1
    v_xor_b32 v6, v6, v16
    v_add_u32 v5, s58, v5
    v_mul_u32_u24 v5, 1024, v5
    v_lshl_add_u32 v16, v6, 4, v5
    v_lshrrev_b32 v5, 4, v1
    v_add_u32 v5, 28, v5
    v_and_b32 v6, 15, v5
    v_and_b32 v17, 15, v1
    v_xor_b32 v6, v6, v17
    v_add_u32 v5, s58, v5
    v_mul_u32_u24 v5, 1024, v5
    v_lshl_add_u32 v17, v6, 4, v5
    s_waitcnt lgkmcnt(0)
    s_mov_b32 s24, s20
    s_and_b32 s25, s21, 0xffff
    s_mov_b32 s26, 2097152
    s_mov_b32 s27, 0x20000
    s_add_u32 s92, s20, 14780416
    s_addc_u32 s93, s21, 0
    s_and_b32 s93, s93, 0xffff
    s_mov_b32 s94, 28672
    s_mov_b32 s95, 0x20000
    s_getreg_b32 s98, hwreg(HW_REG_XCC_ID)
    s_and_b32 s98, s98, 15
    s_add_u32 s98, s98, 1
    s_lshl_b32 s48, s96, 6
    s_lshl_b32 s49, s97, 2
    s_add_u32 s48, s48, s49
    s_add_u32 s48, s48, 24576
    v_mov_b32 v8, s48
    v_mov_b32 v9, s98
    s_mov_b64 exec, 1
    buffer_store_dword v9, v8, s[92:95], 0 offen sc0 sc1
    s_mov_b64 exec, -1
    s_mov_b32 s56, 0
    s_add_u32 m0, s55, 0
    s_nop 0
    buffer_load_dwordx4 v10, s[24:27], s56 offen lds
    s_add_u32 m0, s55, 1024
    s_nop 0
    buffer_load_dwordx4 v11, s[24:27], s56 offen lds
    s_add_u32 m0, s55, 2048
    s_nop 0
    buffer_load_dwordx4 v12, s[24:27], s56 offen lds
    s_add_u32 m0, s55, 3072
    s_nop 0
    buffer_load_dwordx4 v13, s[24:27], s56 offen lds
    s_add_u32 m0, s55, 4096
    s_nop 0
    buffer_load_dwordx4 v14, s[24:27], s56 offen lds
    s_add_u32 m0, s55, 5120
    s_nop 0
    buffer_load_dwordx4 v15, s[24:27], s56 offen lds
    s_add_u32 m0, s55, 6144
    s_nop 0
    buffer_load_dwordx4 v16, s[24:27], s56 offen lds
    s_add_u32 m0, s55, 7168
    s_nop 0
    buffer_load_dwordx4 v17, s[24:27], s56 offen lds
    s_mov_b32 s56, 256
    s_add_u32 m0, s55, 16384
    s_nop 0
    buffer_load_dwordx4 v10, s[24:27], s56 offen lds
    s_add_u32 m0, s55, 17408
    s_nop 0
    buffer_load_dwordx4 v11, s[24:27], s56 offen lds
    s_add_u32 m0, s55, 18432
    s_nop 0
    buffer_load_dwordx4 v12, s[24:27], s56 offen lds
    s_add_u32 m0, s55, 19456
    s_nop 0
    buffer_load_dwordx4 v13, s[24:27], s56 offen lds
    s_add_u32 m0, s55, 20480
    s_nop 0
    buffer_load_dwordx4 v14, s[24:27], s56 offen lds
    s_add_u32 m0, s55, 21504
    s_nop 0
    buffer_load_dwordx4 v15, s[24:27], s56 offen lds
    s_add_u32 m0, s55, 22528
    s_nop 0
    buffer_load_dwordx4 v16, s[24:27], s56 offen lds
    s_add_u32 m0, s55, 23552
    s_nop 0
    buffer_load_dwordx4 v17, s[24:27], s56 offen lds
    s_mov_b32 s56, 512
    s_add_u32 m0, s55, 32768
    s_nop 0
    buffer_load_dwordx4 v10, s[24:27], s56 offen lds
    s_add_u32 m0, s55, 33792
    s_nop 0
    buffer_load_dwordx4 v11, s[24:27], s56 offen lds
    s_add_u32 m0, s55, 34816
    s_nop 0
    buffer_load_dwordx4 v12, s[24:27], s56 offen lds
    s_add_u32 m0, s55, 35840
    s_nop 0
    buffer_load_dwordx4 v13, s[24:27], s56 offen lds
    s_add_u32 m0, s55, 36864
    s_nop 0
    buffer_load_dwordx4 v14, s[24:27], s56 offen lds
    s_add_u32 m0, s55, 37888
    s_nop 0
    buffer_load_dwordx4 v15, s[24:27], s56 offen lds
    s_add_u32 m0, s55, 38912
    s_nop 0
    buffer_load_dwordx4 v16, s[24:27], s56 offen lds
    s_add_u32 m0, s55, 39936
    s_nop 0
    buffer_load_dwordx4 v17, s[24:27], s56 offen lds
    s_waitcnt vmcnt(16)
    s_barrier
    s_mov_b32 s56, 768
    s_add_u32 m0, s55, 49152
    s_nop 0
    buffer_load_dwordx4 v10, s[24:27], s56 offen lds
    s_add_u32 m0, s55, 50176
    s_nop 0
    buffer_load_dwordx4 v11, s[24:27], s56 offen lds
    s_add_u32 m0, s55, 51200
    s_nop 0
    buffer_load_dwordx4 v12, s[24:27], s56 offen lds
    s_add_u32 m0, s55, 52224
    s_nop 0
    buffer_load_dwordx4 v13, s[24:27], s56 offen lds
    s_add_u32 m0, s55, 53248
    s_nop 0
    buffer_load_dwordx4 v14, s[24:27], s56 offen lds
    s_add_u32 m0, s55, 54272
    s_nop 0
    buffer_load_dwordx4 v15, s[24:27], s56 offen lds
    s_add_u32 m0, s55, 55296
    s_nop 0
    buffer_load_dwordx4 v16, s[24:27], s56 offen lds
    s_add_u32 m0, s55, 56320
    s_nop 0
    buffer_load_dwordx4 v17, s[24:27], s56 offen lds
    s_add_u32 s28, s20, 14819328
    s_addc_u32 s29, s21, 0
    s_and_b32 s29, s29, 0xffff
    s_mov_b32 s30, 57344
    s_mov_b32 s31, 0x20000
    s_mul_i32 s48, s97, 448
    v_lshlrev_b32 v5, 3, v1
    v_add_u32 v5, s48, v5
    s_mov_b32 s49, 0
    buffer_load_dwordx2 v[20:21], v5, s[28:31], s49 offen
    s_mov_b32 s49, 7168
    buffer_load_dwordx2 v[22:23], v5, s[28:31], s49 offen
    s_mov_b32 s49, 14336
    buffer_load_dwordx2 v[24:25], v5, s[28:31], s49 offen
    s_mov_b32 s49, 21504
    buffer_load_dwordx2 v[26:27], v5, s[28:31], s49 offen
    s_mov_b32 s49, 28672
    buffer_load_dwordx2 v[28:29], v5, s[28:31], s49 offen
    s_mov_b32 s49, 35840
    buffer_load_dwordx2 v[30:31], v5, s[28:31], s49 offen
    s_mov_b32 s49, 43008
    buffer_load_dwordx2 v[32:33], v5, s[28:31], s49 offen
    s_mov_b32 s49, 50176
    buffer_load_dwordx2 v[34:35], v5, s[28:31], s49 offen
    s_waitcnt vmcnt(24)
    s_barrier
    s_waitcnt vmcnt(16)
    s_barrier
    s_waitcnt vmcnt(6)
    v_pk_add_f32 v[20:21], v[20:21], v[22:23]
    s_waitcnt vmcnt(5)
    v_pk_add_f32 v[20:21], v[20:21], v[24:25]
    s_waitcnt vmcnt(4)
    v_pk_add_f32 v[20:21], v[20:21], v[26:27]
    s_waitcnt vmcnt(3)
    v_pk_add_f32 v[20:21], v[20:21], v[28:29]
    s_waitcnt vmcnt(2)
    v_pk_add_f32 v[20:21], v[20:21], v[30:31]
    s_waitcnt vmcnt(1)
    v_pk_add_f32 v[20:21], v[20:21], v[32:33]
    s_waitcnt vmcnt(0)
    v_pk_add_f32 v[20:21], v[20:21], v[34:35]
    v_lshlrev_b32 v5, 3, v1
    v_add_u32 v5, 154624, v5
    ds_write_b64 v5, v[20:21]
    s_waitcnt lgkmcnt(0)
    s_barrier
    s_lshl_b32 s48, s96, 6
    s_add_u32 s48, s48, 24576
    v_and_b32 v8, 15, v1
    v_lshlrev_b32 v8, 2, v8
    v_add_u32 v8, s48, v8
    buffer_load_dword v9, v8, s[92:95], 0 offen sc0 sc1
    s_waitcnt vmcnt(0)
    v_cmp_ne_u32 vcc, s98, v9
    s_nop 0
    s_cmp_eq_u64 vcc, 0
    s_cselect_b32 s99, 1, 0
    v_mov_b32 v9, s99
    v_mov_b32 v8, 148480
    s_lshl_b32 s48, s59, 2
    v_add_u32 v8, s48, v8
    ds_write_b32 v8, v9
    s_waitcnt lgkmcnt(0)
    s_barrier
    s_barrier
    s_barrier
    s_cmp_lg_u32 s59, 0
    s_cbranch_scc1 kB_kernel_pub0
    s_lshl_b32 s48, s96, 8
    s_lshl_b32 s49, s97, 2
    s_add_u32 s48, s48, s49
    s_add_u32 s48, s48, 0
    v_mov_b32 v8, s48
    v_mov_b32 v9, 1
    s_mov_b64 exec, 1
    s_cmp_eq_u32 s99, 1
    s_cbranch_scc0 kB_kernel_pubs0
    buffer_store_dword v9, v8, s[92:95], 0 offen
    s_branch kB_kernel_pub0
kB_kernel_pubs0:
    buffer_store_dword v9, v8, s[92:95], 0 offen sc0 sc1
kB_kernel_pub0:
    s_mov_b64 exec, -1
    s_mov_b32 s22, s96
    s_mov_b32 s23, s97
    s_lshl_b32 s50, s22, 7
    s_mul_i32 s54, s23, 224
    s_mul_i32 s58, s59, 64
    s_add_u32 s58, s58, s50
    v_lshrrev_b32 v5, 3, v1
    v_bfe_u32 v6, v5, 1, 3
    v_and_b32 v10, 7, v1
    v_xor_b32 v6, v6, v10
    v_add_u32 v5, s58, v5
    v_mul_u32_u24 v5, 1024, v5
    v_lshl_add_u32 v10, v6, 4, v5
    v_lshrrev_b32 v5, 3, v1
    v_add_u32 v5, 8, v5
    v_bfe_u32 v6, v5, 1, 3
    v_and_b32 v11, 7, v1
    v_xor_b32 v6, v6, v11
    v_add_u32 v5, s58, v5
    v_mul_u32_u24 v5, 1024, v5
    v_lshl_add_u32 v11, v6, 4, v5
    v_lshrrev_b32 v5, 3, v1
    v_add_u32 v5, 16, v5
    v_bfe_u32 v6, v5, 1, 3
    v_and_b32 v12, 7, v1
    v_xor_b32 v6, v6, v12
    v_add_u32 v5, s58, v5
    v_mul_u32_u24 v5, 1024, v5
    v_lshl_add_u32 v12, v6, 4, v5
    v_lshrrev_b32 v5, 3, v1
    v_add_u32 v5, 24, v5
    v_bfe_u32 v6, v5, 1, 3
    v_and_b32 v13, 7, v1
    v_xor_b32 v6, v6, v13
    v_add_u32 v5, s58, v5
    v_mul_u32_u24 v5, 1024, v5
    v_lshl_add_u32 v13, v6, 4, v5
    v_lshrrev_b32 v5, 3, v1
    v_add_u32 v5, 32, v5
    v_bfe_u32 v6, v5, 1, 3
    v_and_b32 v14, 7, v1
    v_xor_b32 v6, v6, v14
    v_add_u32 v5, s58, v5
    v_mul_u32_u24 v5, 1024, v5
    v_lshl_add_u32 v14, v6, 4, v5
    v_lshrrev_b32 v5, 3, v1
    v_add_u32 v5, 40, v5
    v_bfe_u32 v6, v5, 1, 3
    v_and_b32 v15, 7, v1
    v_xor_b32 v6, v6, v15
    v_add_u32 v5, s58, v5
    v_mul_u32_u24 v5, 1024, v5
    v_lshl_add_u32 v15, v6, 4, v5
    v_lshrrev_b32 v5, 3, v1
    v_add_u32 v5, 48, v5
    v_bfe_u32 v6, v5, 1, 3
    v_and_b32 v16, 7, v1
    v_xor_b32 v6, v6, v16
    v_add_u32 v5, s58, v5
    v_mul_u32_u24 v5, 1024, v5
    v_lshl_add_u32 v16, v6, 4, v5
    v_lshrrev_b32 v5, 3, v1
    v_add_u32 v5, 56, v5
    v_bfe_u32 v6, v5, 1, 3
    v_and_b32 v17, 7, v1
    v_xor_b32 v6, v6, v17
    v_add_u32 v5, s58, v5
    v_mul_u32_u24 v5, 1024, v5
    v_lshl_add_u32 v17, v6, 4, v5
    s_waitcnt lgkmcnt(0)
    s_add_u32 s24, s20, 2097152
    s_addc_u32 s25, s21, 0
    s_and_b32 s25, s25, 0xffff
    s_mov_b32 s26, 2097152
    s_mov_b32 s27, 0x20000
    s_lshl_b32 s48, s96, 8
    s_add_u32 s48, s48, 0
    v_lshlrev_b32 v8, 2, v1
    v_add_u32 v8, s48, v8
    s_mov_b64 exec, 0xffff
    s_mov_b32 s49, 0
kB_kernel_poll1:
    buffer_load_dword v9, v8, s[92:95], 0 offen sc1
    s_add_u32 s49, s49, 1
    s_waitcnt vmcnt(0)
    v_cmp_ne_u32 vcc, 1, v9
    s_cmp_gt_u32 s49, 200000
    s_cbranch_scc1 kB_kernel_polld1
    s_cbranch_vccnz kB_kernel_poll1
kB_kernel_polld1:
    s_mov_b64 exec, -1
    s_mov_b32 s56, 0
    s_add_u32 m0, s55, 0
    s_nop 0
    buffer_load_dwordx4 v10, s[24:27], s56 offen lds
    s_add_u32 m0, s55, 1024
    s_nop 0
    buffer_load_dwordx4 v11, s[24:27], s56 offen lds
    s_add_u32 m0, s55, 2048
    s_nop 0
    buffer_load_dwordx4 v12, s[24:27], s56 offen lds
    s_add_u32 m0, s55, 3072
    s_nop 0
    buffer_load_dwordx4 v13, s[24:27], s56 offen lds
    s_add_u32 m0, s55, 4096
    s_nop 0
    buffer_load_dwordx4 v14, s[24:27], s56 offen lds
    s_add_u32 m0, s55, 5120
    s_nop 0
    buffer_load_dwordx4 v15, s[24:27], s56 offen lds
    s_add_u32 m0, s55, 6144
    s_nop 0
    buffer_load_dwordx4 v16, s[24:27], s56 offen lds
    s_add_u32 m0, s55, 7168
    s_nop 0
    buffer_load_dwordx4 v17, s[24:27], s56 offen lds
    s_mov_b32 s56, 128
    s_add_u32 m0, s55, 16384
    s_nop 0
    buffer_load_dwordx4 v10, s[24:27], s56 offen lds
    s_add_u32 m0, s55, 17408
    s_nop 0
    buffer_load_dwordx4 v11, s[24:27], s56 offen lds
    s_add_u32 m0, s55, 18432
    s_nop 0
    buffer_load_dwordx4 v12, s[24:27], s56 offen lds
    s_add_u32 m0, s55, 19456
    s_nop 0
    buffer_load_dwordx4 v13, s[24:27], s56 offen lds
    s_add_u32 m0, s55, 20480
    s_nop 0
    buffer_load_dwordx4 v14, s[24:27], s56 offen lds
    s_add_u32 m0, s55, 21504
    s_nop 0
    buffer_load_dwordx4 v15, s[24:27], s56 offen lds
    s_add_u32 m0, s55, 22528
    s_nop 0
    buffer_load_dwordx4 v16, s[24:27], s56 offen lds
    s_add_u32 m0, s55, 23552
    s_nop 0
    buffer_load_dwordx4 v17, s[24:27], s56 offen lds
    s_mov_b32 s56, 256
    s_add_u32 m0, s55, 32768
    s_nop 0
    buffer_load_dwordx4 v10, s[24:27], s56 offen lds
    s_add_u32 m0, s55, 33792
    s_nop 0
    buffer_load_dwordx4 v11, s[24:27], s56 offen lds
    s_add_u32 m0, s55, 34816
    s_nop 0
    buffer_load_dwordx4 v12, s[24:27], s56 offen lds
    s_add_u32 m0, s55, 35840
    s_nop 0
    buffer_load_dwordx4 v13, s[24:27], s56 offen lds
    s_add_u32 m0, s55, 36864
    s_nop 0
    buffer_load_dwordx4 v14, s[24:27], s56 offen lds
    s_add_u32 m0, s55, 37888
    s_nop 0
    buffer_load_dwordx4 v15, s[24:27], s56 offen lds
    s_add_u32 m0, s55, 38912
    s_nop 0
    buffer_load_dwordx4 v16, s[24:27], s56 offen lds
    s_add_u32 m0, s55, 39936
    s_nop 0
    buffer_load_dwordx4 v17, s[24:27], s56 offen lds
    s_waitcnt vmcnt(16)
    s_barrier
    s_mov_b32 s56, 384
    s_add_u32 m0, s55, 49152
    s_nop 0
    buffer_load_dwordx4 v10, s[24:27], s56 offen lds
    s_add_u32 m0, s55, 50176
    s_nop 0
    buffer_load_dwordx4 v11, s[24:27], s56 offen lds
    s_add_u32 m0, s55, 51200
    s_nop 0
    buffer_load_dwordx4 v12, s[24:27], s56 offen lds
    s_add_u32 m0, s55, 52224
    s_nop 0
    buffer_load_dwordx4 v13, s[24:27], s56 offen lds
    s_add_u32 m0, s55, 53248
    s_nop 0
    buffer_load_dwordx4 v14, s[24:27], s56 offen lds
    s_add_u32 m0, s55, 54272
    s_nop 0
    buffer_load_dwordx4 v15, s[24:27], s56 offen lds
    s_add_u32 m0, s55, 55296
    s_nop 0
    buffer_load_dwordx4 v16, s[24:27], s56 offen lds
    s_add_u32 m0, s55, 56320
    s_nop 0
    buffer_load_dwordx4 v17, s[24:27], s56 offen lds
    s_add_u32 s28, s20, 15073280
    s_addc_u32 s29, s21, 0
    s_and_b32 s29, s29, 0xffff
    s_mov_b32 s30, 131072
    s_mov_b32 s31, 0x20000
    s_lshl_b32 s48, s59, 6
    s_add_u32 s48, s48, s50
    v_add_u32 v5, s48, v1
    v_lshlrev_b32 v5, 6, v5
    buffer_load_dwordx4 v[20:23], v5, s[28:31], 0 offen offset:0
    buffer_load_dwordx4 v[24:27], v5, s[28:31], 0 offen offset:16
    buffer_load_dwordx4 v[28:31], v5, s[28:31], 0 offen offset:32
    buffer_load_dwordx4 v[32:35], v5, s[28:31], 0 offen offset:48
    s_waitcnt vmcnt(20)
    s_barrier
    s_mov_b32 s56, 512
    s_add_u32 m0, s55, 0
    s_nop 0
    buffer_load_dwordx4 v10, s[24:27], s56 offen lds
    s_add_u32 m0, s55, 1024
    s_nop 0
    buffer_load_dwordx4 v11, s[24:27], s56 offen lds
    s_add_u32 m0, s55, 2048
    s_nop 0
    buffer_load_dwordx4 v12, s[24:27], s56 offen lds
    s_add_u32 m0, s55, 3072
    s_nop 0
    buffer_load_dwordx4 v13, s[24:27], s56 offen lds
    s_add_u32 m0, s55, 4096
    s_nop 0
    buffer_load_dwordx4 v14, s[24:27], s56 offen lds
    s_add_u32 m0, s55, 5120
    s_nop 0
    buffer_load_dwordx4 v15, s[24:27], s56 offen lds
    s_add_u32 m0, s55, 6144
    s_nop 0
    buffer_load_dwordx4 v16, s[24:27], s56 offen lds
    s_add_u32 m0, s55, 7168
    s_nop 0
    buffer_load_dwordx4 v17, s[24:27], s56 offen lds
    s_waitcnt vmcnt(20)
    s_barrier
    s_mov_b32 s56, 640
    s_add_u32 m0, s55, 16384
    s_nop 0
    buffer_load_dwordx4 v10, s[24:27], s56 offen lds
    s_add_u32 m0, s55, 17408
    s_nop 0
    buffer_load_dwordx4 v11, s[24:27], s56 offen lds
    s_add_u32 m0, s55, 18432
    s_nop 0
    buffer_load_dwordx4 v12, s[24:27], s56 offen lds
    s_add_u32 m0, s55, 19456
    s_nop 0
    buffer_load_dwordx4 v13, s[24:27], s56 offen lds
    s_add_u32 m0, s55, 20480
    s_nop 0
    buffer_load_dwordx4 v14, s[24:27], s56 offen lds
    s_add_u32 m0, s55, 21504
    s_nop 0
    buffer_load_dwordx4 v15, s[24:27], s56 offen lds
    s_add_u32 m0, s55, 22528
    s_nop 0
    buffer_load_dwordx4 v16, s[24:27], s56 offen lds
    s_add_u32 m0, s55, 23552
    s_nop 0
    buffer_load_dwordx4 v17, s[24:27], s56 offen lds
    s_waitcnt vmcnt(20)
    s_barrier
    s_mov_b32 s56, 768
    s_add_u32 m0, s55, 32768
    s_nop 0
    buffer_load_dwordx4 v10, s[24:27], s56 offen lds
    s_add_u32 m0, s55, 33792
    s_nop 0
    buffer_load_dwordx4 v11, s[24:27], s56 offen lds
    s_add_u32 m0, s55, 34816
    s_nop 0
    buffer_load_dwordx4 v12, s[24:27], s56 offen lds
    s_add_u32 m0, s55, 35840
    s_nop 0
    buffer_load_dwordx4 v13, s[24:27], s56 offen lds
    s_add_u32 m0, s55, 36864
    s_nop 0
    buffer_load_dwordx4 v14, s[24:27], s56 offen lds
    s_add_u32 m0, s55, 37888
    s_nop 0
    buffer_load_dwordx4 v15, s[24:27], s56 offen lds
    s_add_u32 m0, s55, 38912
    s_nop 0
    buffer_load_dwordx4 v16, s[24:27], s56 offen lds
    s_add_u32 m0, s55, 39936
    s_nop 0
    buffer_load_dwordx4 v17, s[24:27], s56 offen lds
    s_waitcnt vmcnt(16)
    s_barrier
    s_mov_b32 s56, 896
    s_add_u32 m0, s55, 49152
    s_nop 0
    buffer_load_dwordx4 v10, s[24:27], s56 offen lds
    s_add_u32 m0, s55, 50176
    s_nop 0
    buffer_load_dwordx4 v11, s[24:27], s56 offen lds
    s_add_u32 m0, s55, 51200
    s_nop 0
    buffer_load_dwordx4 v12, s[24:27], s56 offen lds
    s_add_u32 m0, s55, 52224
    s_nop 0
    buffer_load_dwordx4 v13, s[24:27], s56 offen lds
    s_add_u32 m0, s55, 53248
    s_nop 0
    buffer_load_dwordx4 v14, s[24:27], s56 offen lds
    s_add_u32 m0, s55, 54272
    s_nop 0
    buffer_load_dwordx4 v15, s[24:27], s56 offen lds
    s_add_u32 m0, s55, 55296
    s_nop 0
    buffer_load_dwordx4 v16, s[24:27], s56 offen lds
    s_add_u32 m0, s55, 56320
    s_nop 0
    buffer_load_dwordx4 v17, s[24:27], s56 offen lds
    v_add_f32 v5, v20, v22
    v_add_f32 v6, v21, v23
    v_add_f32 v5, v5, v24
    v_add_f32 v6, v6, v25
    v_add_f32 v5, v5, v26
    v_add_f32 v6, v6, v27
    v_add_f32 v5, v5, v28
    v_add_f32 v6, v6, v29
    v_add_f32 v5, v5, v30
    v_add_f32 v6, v6, v31
    v_add_f32 v5, v5, v32
    v_add_f32 v6, v6, v33
    v_add_f32 v5, v5, v34
    v_add_f32 v6, v6, v35
    v_mul_f32 v5, 0x3b000000, v5
    v_mul_f32 v6, 0x3b000000, v6
    v_fma_f32 v6, -v5, v5, v6
    v_max_f32 v6, 0, v6
    v_cvt_pk_bf16_f32 v5, v5, v5
    v_lshlrev_b32 v5, 16, v5
    v_cvt_pk_bf16_f32 v6, v6, v6
    v_lshlrev_b32 v6, 16, v6
    v_add_f32 v6, 0x3727c5ac, v6
    v_cvt_pk_bf16_f32 v6, v6, v6
    v_lshlrev_b32 v6, 16, v6
    v_sqrt_f32 v6, v6
    s_nop 0
    v_cvt_pk_bf16_f32 v6, v6, v6
    v_lshlrev_b32 v6, 16, v6
    v_rcp_f32 v36, v6
    s_nop 0
    v_mul_f32 v37, v5, v36
    v_sub_f32 v37, 0, v37
    s_lshl_b32 s48, s59, 9
    s_add_u32 s48, s48, 147456
    v_lshlrev_b32 v5, 3, v1
    v_add_u32 v5, s48, v5
    ds_write_b64 v5, v[36:37]
    s_waitcnt lgkmcnt(0)
    s_waitcnt vmcnt(16)
    s_barrier
    s_waitcnt vmcnt(8)
    s_barrier
    s_waitcnt vmcnt(0)
    s_barrier
    s_barrier
    s_barrier
    s_barrier
    s_cmp_lg_u32 s59, 0
    s_cbranch_scc1 kB_kernel_pub1
    s_lshl_b32 s48, s96, 8
    s_lshl_b32 s49, s97, 2
    s_add_u32 s48, s48, s49
    s_add_u32 s48, s48, 4096
    v_mov_b32 v8, s48
    v_mov_b32 v9, 1
    s_mov_b64 exec, 1
    s_cmp_eq_u32 s99, 1
    s_cbranch_scc0 kB_kernel_pubs1
    buffer_store_dword v9, v8, s[92:95], 0 offen
    s_branch kB_kernel_pub1
kB_kernel_pubs1:
    buffer_store_dword v9, v8, s[92:95], 0 offen sc0 sc1
kB_kernel_pub1:
    s_mov_b64 exec, -1
    s_lshr_b32 s48, s97, 3
    s_lshl_b32 s22, s96, 1
    s_add_u32 s22, s22, s48
    s_and_b32 s23, s97, 7
    s_lshl_b32 s50, s22, 6
    s_lshl_b32 s54, s23, 7
    s_mul_i32 s58, s59, 32
    s_add_u32 s58, s58, s50
    v_lshrrev_b32 v5, 4, v1
    v_and_b32 v6, 15, v5
    v_and_b32 v10, 15, v1
    v_xor_b32 v6, v6, v10
    v_add_u32 v5, s58, v5
    v_mul_u32_u24 v5, 3584, v5
    v_lshl_add_u32 v10, v6, 4, v5
    v_lshrrev_b32 v5, 4, v1
    v_add_u32 v5, 4, v5
    v_and_b32 v6, 15, v5
    v_and_b32 v11, 15, v1
    v_xor_b32 v6, v6, v11
    v_add_u32 v5, s58, v5
    v_mul_u32_u24 v5, 3584, v5
    v_lshl_add_u32 v11, v6, 4, v5
    v_lshrrev_b32 v5, 4, v1
    v_add_u32 v5, 8, v5
    v_and_b32 v6, 15, v5
    v_and_b32 v12, 15, v1
    v_xor_b32 v6, v6, v12
    v_add_u32 v5, s58, v5
    v_mul_u32_u24 v5, 3584, v5
    v_lshl_add_u32 v12, v6, 4, v5
    v_lshrrev_b32 v5, 4, v1
    v_add_u32 v5, 12, v5
    v_and_b32 v6, 15, v5
    v_and_b32 v13, 15, v1
    v_xor_b32 v6, v6, v13
    v_add_u32 v5, s58, v5
    v_mul_u32_u24 v5, 3584, v5
    v_lshl_add_u32 v13, v6, 4, v5
    v_lshrrev_b32 v5, 4, v1
    v_add_u32 v5, 16, v5
    v_and_b32 v6, 15, v5
    v_and_b32 v14, 15, v1
    v_xor_b32 v6, v6, v14
    v_add_u32 v5, s58, v5
    v_mul_u32_u24 v5, 3584, v5
    v_lshl_add_u32 v14, v6, 4, v5
    v_lshrrev_b32 v5, 4, v1
    v_add_u32 v5, 20, v5
    v_and_b32 v6, 15, v5
    v_and_b32 v15, 15, v1
    v_xor_b32 v6, v6, v15
    v_add_u32 v5, s58, v5
    v_mul_u32_u24 v5, 3584, v5
    v_lshl_add_u32 v15, v6, 4, v5
    v_lshrrev_b32 v5, 4, v1
    v_add_u32 v5, 24, v5
    v_and_b32 v6, 15, v5
    v_and_b32 v16, 15, v1
    v_xor_b32 v6, v6, v16
    v_add_u32 v5, s58, v5
    v_mul_u32_u24 v5, 3584, v5
    v_lshl_add_u32 v16, v6, 4, v5
    v_lshrrev_b32 v5, 4, v1
    v_add_u32 v5, 28, v5
    v_and_b32 v6, 15, v5
    v_and_b32 v17, 15, v1
    v_xor_b32 v6, v6, v17
    v_add_u32 v5, s58, v5
    v_mul_u32_u24 v5, 3584, v5
    v_lshl_add_u32 v17, v6, 4, v5
    s_waitcnt lgkmcnt(0)
    s_add_u32 s24, s20, 6291456
    s_addc_u32 s25, s21, 0
    s_and_b32 s25, s25, 0xffff
    s_mov_b32 s26, 7340032
    s_mov_b32 s27, 0x20000
    s_lshl_b32 s48, s96, 8
    s_add_u32 s48, s48, 4096
    v_lshlrev_b32 v8, 2, v1
    v_add_u32 v8, s48, v8
    s_mov_b64 exec, 0xffff
    s_mov_b32 s49, 0
kB_kernel_poll2:
    buffer_load_dword v9, v8, s[92:95], 0 offen sc1
    s_add_u32 s49, s49, 1
    s_waitcnt vmcnt(0)
    v_cmp_ne_u32 vcc, 1, v9
    s_cmp_gt_u32 s49, 200000
    s_cbranch_scc1 kB_kernel_polld2
    s_cbranch_vccnz kB_kernel_poll2
kB_kernel_polld2:
    s_mov_b64 exec, -1
    s_mov_b32 s56, 0
    s_add_u32 m0, s55, 0
    s_nop 0
    buffer_load_dwordx4 v10, s[24:27], s56 offen lds
    s_add_u32 m0, s55, 1024
    s_nop 0
    buffer_load_dwordx4 v11, s[24:27], s56 offen lds
    s_add_u32 m0, s55, 2048
    s_nop 0
    buffer_load_dwordx4 v12, s[24:27], s56 offen lds
    s_add_u32 m0, s55, 3072
    s_nop 0
    buffer_load_dwordx4 v13, s[24:27], s56 offen lds
    s_add_u32 m0, s55, 4096
    s_nop 0
    buffer_load_dwordx4 v14, s[24:27], s56 offen lds
    s_add_u32 m0, s55, 5120
    s_nop 0
    buffer_load_dwordx4 v15, s[24:27], s56 offen lds
    s_add_u32 m0, s55, 6144
    s_nop 0
    buffer_load_dwordx4 v16, s[24:27], s56 offen lds
    s_add_u32 m0, s55, 7168
    s_nop 0
    buffer_load_dwordx4 v17, s[24:27], s56 offen lds
    s_mov_b32 s56, 256
    s_add_u32 m0, s55, 16384
    s_nop 0
    buffer_load_dwordx4 v10, s[24:27], s56 offen lds
    s_add_u32 m0, s55, 17408
    s_nop 0
    buffer_load_dwordx4 v11, s[24:27], s56 offen lds
    s_add_u32 m0, s55, 18432
    s_nop 0
    buffer_load_dwordx4 v12, s[24:27], s56 offen lds
    s_add_u32 m0, s55, 19456
    s_nop 0
    buffer_load_dwordx4 v13, s[24:27], s56 offen lds
    s_add_u32 m0, s55, 20480
    s_nop 0
    buffer_load_dwordx4 v14, s[24:27], s56 offen lds
    s_add_u32 m0, s55, 21504
    s_nop 0
    buffer_load_dwordx4 v15, s[24:27], s56 offen lds
    s_add_u32 m0, s55, 22528
    s_nop 0
    buffer_load_dwordx4 v16, s[24:27], s56 offen lds
    s_add_u32 m0, s55, 23552
    s_nop 0
    buffer_load_dwordx4 v17, s[24:27], s56 offen lds
    s_mov_b32 s56, 512
    s_add_u32 m0, s55, 32768
    s_nop 0
    buffer_load_dwordx4 v10, s[24:27], s56 offen lds
    s_add_u32 m0, s55, 33792
    s_nop 0
    buffer_load_dwordx4 v11, s[24:27], s56 offen lds
    s_add_u32 m0, s55, 34816
    s_nop 0
    buffer_load_dwordx4 v12, s[24:27], s56 offen lds
    s_add_u32 m0, s55, 35840
    s_nop 0
    buffer_load_dwordx4 v13, s[24:27], s56 offen lds
    s_add_u32 m0, s55, 36864
    s_nop 0
    buffer_load_dwordx4 v14, s[24:27], s56 offen lds
    s_add_u32 m0, s55, 37888
    s_nop 0
    buffer_load_dwordx4 v15, s[24:27], s56 offen lds
    s_add_u32 m0, s55, 38912
    s_nop 0
    buffer_load_dwordx4 v16, s[24:27], s56 offen lds
    s_add_u32 m0, s55, 39936
    s_nop 0
    buffer_load_dwordx4 v17, s[24:27], s56 offen lds
    s_waitcnt vmcnt(16)
    s_barrier
    s_mov_b32 s56, 768
    s_add_u32 m0, s55, 49152
    s_nop 0
    buffer_load_dwordx4 v10, s[24:27], s56 offen lds
    s_add_u32 m0, s55, 50176
    s_nop 0
    buffer_load_dwordx4 v11, s[24:27], s56 offen lds
    s_add_u32 m0, s55, 51200
    s_nop 0
    buffer_load_dwordx4 v12, s[24:27], s56 offen lds
    s_add_u32 m0, s55, 52224
    s_nop 0
    buffer_load_dwordx4 v13, s[24:27], s56 offen lds
    s_add_u32 m0, s55, 53248
    s_nop 0
    buffer_load_dwordx4 v14, s[24:27], s56 offen lds
    s_add_u32 m0, s55, 54272
    s_nop 0
    buffer_load_dwordx4 v15, s[24:27], s56 offen lds
    s_add_u32 m0, s55, 55296
    s_nop 0
    buffer_load_dwordx4 v16, s[24:27], s56 offen lds
    s_add_u32 m0, s55, 56320
    s_nop 0
    buffer_load_dwordx4 v17, s[24:27], s56 offen lds
    s_waitcnt vmcnt(16)
    s_barrier
    s_mov_b32 s56, 1024
    s_add_u32 m0, s55, 0
    s_nop 0
    buffer_load_dwordx4 v10, s[24:27], s56 offen lds
    s_add_u32 m0, s55, 1024
    s_nop 0
    buffer_load_dwordx4 v11, s[24:27], s56 offen lds
    s_add_u32 m0, s55, 2048
    s_nop 0
    buffer_load_dwordx4 v12, s[24:27], s56 offen lds
    s_add_u32 m0, s55, 3072
    s_nop 0
    buffer_load_dwordx4 v13, s[24:27], s56 offen lds
    s_add_u32 m0, s55, 4096
    s_nop 0
    buffer_load_dwordx4 v14, s[24:27], s56 offen lds
    s_add_u32 m0, s55, 5120
    s_nop 0
    buffer_load_dwordx4 v15, s[24:27], s56 offen lds
    s_add_u32 m0, s55, 6144
    s_nop 0
    buffer_load_dwordx4 v16, s[24:27], s56 offen lds
    s_add_u32 m0, s55, 7168
    s_nop 0
    buffer_load_dwordx4 v17, s[24:27], s56 offen lds
    s_waitcnt vmcnt(16)
    s_barrier
    s_mov_b32 s56, 1280
    s_add_u32 m0, s55, 16384
    s_nop 0
    buffer_load_dwordx4 v10, s[24:27], s56 offen lds
    s_add_u32 m0, s55, 17408
    s_nop 0
    buffer_load_dwordx4 v11, s[24:27], s56 offen lds
    s_add_u32 m0, s55, 18432
    s_nop 0
    buffer_load_dwordx4 v12, s[24:27], s56 offen lds
    s_add_u32 m0, s55, 19456
    s_nop 0
    buffer_load_dwordx4 v13, s[24:27], s56 offen lds
    s_add_u32 m0, s55, 20480
    s_nop 0
    buffer_load_dwordx4 v14, s[24:27], s56 offen lds
    s_add_u32 m0, s55, 21504
    s_nop 0
    buffer_load_dwordx4 v15, s[24:27], s56 offen lds
    s_add_u32 m0, s55, 22528
    s_nop 0
    buffer_load_dwordx4 v16, s[24:27], s56 offen lds
    s_add_u32 m0, s55, 23552
    s_nop 0
    buffer_load_dwordx4 v17, s[24:27], s56 offen lds
    s_waitcnt vmcnt(16)
    s_barrier
    s_mov_b32 s56, 1536
    s_add_u32 m0, s55, 32768
    s_nop 0
    buffer_load_dwordx4 v10, s[24:27], s56 offen lds
    s_add_u32 m0, s55, 33792
    s_nop 0
    buffer_load_dwordx4 v11, s[24:27], s56 offen lds
    s_add_u32 m0, s55, 34816
    s_nop 0
    buffer_load_dwordx4 v12, s[24:27], s56 offen lds
    s_add_u32 m0, s55, 35840
    s_nop 0
    buffer_load_dwordx4 v13, s[24:27], s56 offen lds
    s_add_u32 m0, s55, 36864
    s_nop 0
    buffer_load_dwordx4 v14, s[24:27], s56 offen lds
    s_add_u32 m0, s55, 37888
    s_nop 0
    buffer_load_dwordx4 v15, s[24:27], s56 offen lds
    s_add_u32 m0, s55, 38912
    s_nop 0
    buffer_load_dwordx4 v16, s[24:27], s56 offen lds
    s_add_u32 m0, s55, 39936
    s_nop 0
    buffer_load_dwordx4 v17, s[24:27], s56 offen lds
    s_waitcnt vmcnt(16)
    s_barrier
    s_mov_b32 s56, 1792
    s_add_u32 m0, s55, 49152
    s_nop 0
    buffer_load_dwordx4 v10, s[24:27], s56 offen lds
    s_add_u32 m0, s55, 50176
    s_nop 0
    buffer_load_dwordx4 v11, s[24:27], s56 offen lds
    s_add_u32 m0, s55, 51200
    s_nop 0
    buffer_load_dwordx4 v12, s[24:27], s56 offen lds
    s_add_u32 m0, s55, 52224
    s_nop 0
    buffer_load_dwordx4 v13, s[24:27], s56 offen lds
    s_add_u32 m0, s55, 53248
    s_nop 0
    buffer_load_dwordx4 v14, s[24:27], s56 offen lds
    s_add_u32 m0, s55, 54272
    s_nop 0
    buffer_load_dwordx4 v15, s[24:27], s56 offen lds
    s_add_u32 m0, s55, 55296
    s_nop 0
    buffer_load_dwordx4 v16, s[24:27], s56 offen lds
    s_add_u32 m0, s55, 56320
    s_nop 0
    buffer_load_dwordx4 v17, s[24:27], s56 offen lds
    s_waitcnt vmcnt(16)
    s_barrier
    s_mov_b32 s56, 2048
    s_add_u32 m0, s55, 0
    s_nop 0
    buffer_load_dwordx4 v10, s[24:27], s56 offen lds
    s_add_u32 m0, s55, 1024
    s_nop 0
    buffer_load_dwordx4 v11, s[24:27], s56 offen lds
    s_add_u32 m0, s55, 2048
    s_nop 0
    buffer_load_dwordx4 v12, s[24:27], s56 offen lds
    s_add_u32 m0, s55, 3072
    s_nop 0
    buffer_load_dwordx4 v13, s[24:27], s56 offen lds
    s_add_u32 m0, s55, 4096
    s_nop 0
    buffer_load_dwordx4 v14, s[24:27], s56 offen lds
    s_add_u32 m0, s55, 5120
    s_nop 0
    buffer_load_dwordx4 v15, s[24:27], s56 offen lds
    s_add_u32 m0, s55, 6144
    s_nop 0
    buffer_load_dwordx4 v16, s[24:27], s56 offen lds
    s_add_u32 m0, s55, 7168
    s_nop 0
    buffer_load_dwordx4 v17, s[24:27], s56 offen lds
    s_waitcnt vmcnt(16)
    s_barrier
    s_mov_b32 s56, 2304
    s_add_u32 m0, s55, 16384
    s_nop 0
    buffer_load_dwordx4 v10, s[24:27], s56 offen lds
    s_add_u32 m0, s55, 17408
    s_nop 0
    buffer_load_dwordx4 v11, s[24:27], s56 offen lds
    s_add_u32 m0, s55, 18432
    s_nop 0
    buffer_load_dwordx4 v12, s[24:27], s56 offen lds
    s_add_u32 m0, s55, 19456
    s_nop 0
    buffer_load_dwordx4 v13, s[24:27], s56 offen lds
    s_add_u32 m0, s55, 20480
    s_nop 0
    buffer_load_dwordx4 v14, s[24:27], s56 offen lds
    s_add_u32 m0, s55, 21504
    s_nop 0
    buffer_load_dwordx4 v15, s[24:27], s56 offen lds
    s_add_u32 m0, s55, 22528
    s_nop 0
    buffer_load_dwordx4 v16, s[24:27], s56 offen lds
    s_add_u32 m0, s55, 23552
    s_nop 0
    buffer_load_dwordx4 v17, s[24:27], s56 offen lds
    s_waitcnt vmcnt(16)
    s_barrier
    s_mov_b32 s56, 2560
    s_add_u32 m0, s55, 32768
    s_nop 0
    buffer_load_dwordx4 v10, s[24:27], s56 offen lds
    s_add_u32 m0, s55, 33792
    s_nop 0
    buffer_load_dwordx4 v11, s[24:27], s56 offen lds
    s_add_u32 m0, s55, 34816
    s_nop 0
    buffer_load_dwordx4 v12, s[24:27], s56 offen lds
    s_add_u32 m0, s55, 35840
    s_nop 0
    buffer_load_dwordx4 v13, s[24:27], s56 offen lds
    s_add_u32 m0, s55, 36864
    s_nop 0
    buffer_load_dwordx4 v14, s[24:27], s56 offen lds
    s_add_u32 m0, s55, 37888
    s_nop 0
    buffer_load_dwordx4 v15, s[24:27], s56 offen lds
    s_add_u32 m0, s55, 38912
    s_nop 0
    buffer_load_dwordx4 v16, s[24:27], s56 offen lds
    s_add_u32 m0, s55, 39936
    s_nop 0
    buffer_load_dwordx4 v17, s[24:27], s56 offen lds
    s_waitcnt vmcnt(16)
    s_barrier
    s_mov_b32 s56, 2816
    s_add_u32 m0, s55, 49152
    s_nop 0
    buffer_load_dwordx4 v10, s[24:27], s56 offen lds
    s_add_u32 m0, s55, 50176
    s_nop 0
    buffer_load_dwordx4 v11, s[24:27], s56 offen lds
    s_add_u32 m0, s55, 51200
    s_nop 0
    buffer_load_dwordx4 v12, s[24:27], s56 offen lds
    s_add_u32 m0, s55, 52224
    s_nop 0
    buffer_load_dwordx4 v13, s[24:27], s56 offen lds
    s_add_u32 m0, s55, 53248
    s_nop 0
    buffer_load_dwordx4 v14, s[24:27], s56 offen lds
    s_add_u32 m0, s55, 54272
    s_nop 0
    buffer_load_dwordx4 v15, s[24:27], s56 offen lds
    s_add_u32 m0, s55, 55296
    s_nop 0
    buffer_load_dwordx4 v16, s[24:27], s56 offen lds
    s_add_u32 m0, s55, 56320
    s_nop 0
    buffer_load_dwordx4 v17, s[24:27], s56 offen lds
    s_waitcnt vmcnt(16)
    s_barrier
    s_mov_b32 s56, 3072
    s_add_u32 m0, s55, 0
    s_nop 0
    buffer_load_dwordx4 v10, s[24:27], s56 offen lds
    s_add_u32 m0, s55, 1024
    s_nop 0
    buffer_load_dwordx4 v11, s[24:27], s56 offen lds
    s_add_u32 m0, s55, 2048
    s_nop 0
    buffer_load_dwordx4 v12, s[24:27], s56 offen lds
    s_add_u32 m0, s55, 3072
    s_nop 0
    buffer_load_dwordx4 v13, s[24:27], s56 offen lds
    s_add_u32 m0, s55, 4096
    s_nop 0
    buffer_load_dwordx4 v14, s[24:27], s56 offen lds
    s_add_u32 m0, s55, 5120
    s_nop 0
    buffer_load_dwordx4 v15, s[24:27], s56 offen lds
    s_add_u32 m0, s55, 6144
    s_nop 0
    buffer_load_dwordx4 v16, s[24:27], s56 offen lds
    s_add_u32 m0, s55, 7168
    s_nop 0
    buffer_load_dwordx4 v17, s[24:27], s56 offen lds
    s_waitcnt vmcnt(16)
    s_barrier
    s_mov_b32 s56, 3328
    s_add_u32 m0, s55, 16384
    s_nop 0
    buffer_load_dwordx4 v10, s[24:27], s56 offen lds
    s_add_u32 m0, s55, 17408
    s_nop 0
    buffer_load_dwordx4 v11, s[24:27], s56 offen lds
    s_add_u32 m0, s55, 18432
    s_nop 0
    buffer_load_dwordx4 v12, s[24:27], s56 offen lds
    s_add_u32 m0, s55, 19456
    s_nop 0
    buffer_load_dwordx4 v13, s[24:27], s56 offen lds
    s_add_u32 m0, s55, 20480
    s_nop 0
    buffer_load_dwordx4 v14, s[24:27], s56 offen lds
    s_add_u32 m0, s55, 21504
    s_nop 0
    buffer_load_dwordx4 v15, s[24:27], s56 offen lds
    s_add_u32 m0, s55, 22528
    s_nop 0
    buffer_load_dwordx4 v16, s[24:27], s56 offen lds
    s_add_u32 m0, s55, 23552
    s_nop 0
    buffer_load_dwordx4 v17, s[24:27], s56 offen lds
    s_waitcnt vmcnt(16)
    s_barrier
    s_waitcnt vmcnt(8)
    s_barrier
    s_waitcnt vmcnt(0)
    s_barrier
    s_barrier
    s_barrier
    s_barrier
    s_cmp_lg_u32 s59, 0
    s_cbranch_scc1 kB_kernel_pub2
    s_lshl_b32 s48, s96, 8
    s_lshl_b32 s49, s97, 2
    s_add_u32 s48, s48, s49
    s_add_u32 s48, s48, 8192
    v_mov_b32 v8, s48
    v_mov_b32 v9, 1
    s_mov_b64 exec, 1
    s_cmp_eq_u32 s99, 1
    s_cbranch_scc0 kB_kernel_pubs2
    buffer_store_dword v9, v8, s[92:95], 0 offen
    s_branch kB_kernel_pub2
kB_kernel_pubs2:
    buffer_store_dword v9, v8, s[92:95], 0 offen sc0 sc1
kB_kernel_pub2:
    s_mov_b64 exec, -1
    s_mov_b32 s22, s96
    s_mov_b32 s23, s97
    s_lshl_b32 s50, s22, 7
    s_lshl_b32 s54, s23, 6
    s_mul_i32 s58, s59, 64
    s_add_u32 s58, s58, s50
    v_lshrrev_b32 v5, 3, v1
    v_bfe_u32 v6, v5, 1, 3
    v_and_b32 v10, 7, v1
    v_xor_b32 v6, v6, v10
    v_add_u32 v5, s58, v5
    v_mul_u32_u24 v5, 1024, v5
    v_lshl_add_u32 v10, v6, 4, v5
    v_lshrrev_b32 v5, 3, v1
    v_add_u32 v5, 8, v5
    v_bfe_u32 v6, v5, 1, 3
    v_and_b32 v11, 7, v1
    v_xor_b32 v6, v6, v11
    v_add_u32 v5, s58, v5
    v_mul_u32_u24 v5, 1024, v5
    v_lshl_add_u32 v11, v6, 4, v5
    v_lshrrev_b32 v5, 3, v1
    v_add_u32 v5, 16, v5
    v_bfe_u32 v6, v5, 1, 3
    v_and_b32 v12, 7, v1
    v_xor_b32 v6, v6, v12
    v_add_u32 v5, s58, v5
    v_mul_u32_u24 v5, 1024, v5
    v_lshl_add_u32 v12, v6, 4, v5
    v_lshrrev_b32 v5, 3, v1
    v_add_u32 v5, 24, v5
    v_bfe_u32 v6, v5, 1, 3
    v_and_b32 v13, 7, v1
    v_xor_b32 v6, v6, v13
    v_add_u32 v5, s58, v5
    v_mul_u32_u24 v5, 1024, v5
    v_lshl_add_u32 v13, v6, 4, v5
    v_lshrrev_b32 v5, 3, v1
    v_add_u32 v5, 32, v5
    v_bfe_u32 v6, v5, 1, 3
    v_and_b32 v14, 7, v1
    v_xor_b32 v6, v6, v14
    v_add_u32 v5, s58, v5
    v_mul_u32_u24 v5, 1024, v5
    v_lshl_add_u32 v14, v6, 4, v5
    v_lshrrev_b32 v5, 3, v1
    v_add_u32 v5, 40, v5
    v_bfe_u32 v6, v5, 1, 3
    v_and_b32 v15, 7, v1
    v_xor_b32 v6, v6, v15
    v_add_u32 v5, s58, v5
    v_mul_u32_u24 v5, 1024, v5
    v_lshl_add_u32 v15, v6, 4, v5
    v_lshrrev_b32 v5, 3, v1
    v_add_u32 v5, 48, v5
    v_bfe_u32 v6, v5, 1, 3
    v_and_b32 v16, 7, v1
    v_xor_b32 v6, v6, v16
    v_add_u32 v5, s58, v5
    v_mul_u32_u24 v5, 1024, v5
    v_lshl_add_u32 v16, v6, 4, v5
    v_lshrrev_b32 v5, 3, v1
    v_add_u32 v5, 56, v5
    v_bfe_u32 v6, v5, 1, 3
    v_and_b32 v17, 7, v1
    v_xor_b32 v6, v6, v17
    v_add_u32 v5, s58, v5
    v_mul_u32_u24 v5, 1024, v5
    v_lshl_add_u32 v17, v6, 4, v5
    s_waitcnt lgkmcnt(0)
    s_add_u32 s24, s20, 4194304
    s_addc_u32 s25, s21, 0
    s_and_b32 s25, s25, 0xffff
    s_mov_b32 s26, 2097152
    s_mov_b32 s27, 0x20000
    s_lshl_b32 s48, s96, 8
    s_add_u32 s48, s48, 8192
    v_lshlrev_b32 v8, 2, v1
    v_add_u32 v8, s48, v8
    s_mov_b64 exec, 0xffff
    s_mov_b32 s49, 0
kB_kernel_poll3:
    buffer_load_dword v9, v8, s[92:95], 0 offen sc1
    s_add_u32 s49, s49, 1
    s_waitcnt vmcnt(0)
    v_cmp_ne_u32 vcc, 1, v9
    s_cmp_gt_u32 s49, 200000
    s_cbranch_scc1 kB_kernel_polld3
    s_cbranch_vccnz kB_kernel_poll3
kB_kernel_polld3:
    s_mov_b64 exec, -1
    s_mov_b32 s56, 0
    s_add_u32 m0, s55, 0
    s_nop 0
    buffer_load_dwordx4 v10, s[24:27], s56 offen lds
    s_add_u32 m0, s55, 1024
    s_nop 0
    buffer_load_dwordx4 v11, s[24:27], s56 offen lds
    s_add_u32 m0, s55, 2048
    s_nop 0
    buffer_load_dwordx4 v12, s[24:27], s56 offen lds
    s_add_u32 m0, s55, 3072
    s_nop 0
    buffer_load_dwordx4 v13, s[24:27], s56 offen lds
    s_add_u32 m0, s55, 4096
    s_nop 0
    buffer_load_dwordx4 v14, s[24:27], s56 offen lds
    s_add_u32 m0, s55, 5120
    s_nop 0
    buffer_load_dwordx4 v15, s[24:27], s56 offen lds
    s_add_u32 m0, s55, 6144
    s_nop 0
    buffer_load_dwordx4 v16, s[24:27], s56 offen lds
    s_add_u32 m0, s55, 7168
    s_nop 0
    buffer_load_dwordx4 v17, s[24:27], s56 offen lds
    s_mov_b32 s56, 128
    s_add_u32 m0, s55, 16384
    s_nop 0
    buffer_load_dwordx4 v10, s[24:27], s56 offen lds
    s_add_u32 m0, s55, 17408
    s_nop 0
    buffer_load_dwordx4 v11, s[24:27], s56 offen lds
    s_add_u32 m0, s55, 18432
    s_nop 0
    buffer_load_dwordx4 v12, s[24:27], s56 offen lds
    s_add_u32 m0, s55, 19456
    s_nop 0
    buffer_load_dwordx4 v13, s[24:27], s56 offen lds
    s_add_u32 m0, s55, 20480
    s_nop 0
    buffer_load_dwordx4 v14, s[24:27], s56 offen lds
    s_add_u32 m0, s55, 21504
    s_nop 0
    buffer_load_dwordx4 v15, s[24:27], s56 offen lds
    s_add_u32 m0, s55, 22528
    s_nop 0
    buffer_load_dwordx4 v16, s[24:27], s56 offen lds
    s_add_u32 m0, s55, 23552
    s_nop 0
    buffer_load_dwordx4 v17, s[24:27], s56 offen lds
    s_mov_b32 s56, 256
    s_add_u32 m0, s55, 32768
    s_nop 0
    buffer_load_dwordx4 v10, s[24:27], s56 offen lds
    s_add_u32 m0, s55, 33792
    s_nop 0
    buffer_load_dwordx4 v11, s[24:27], s56 offen lds
    s_add_u32 m0, s55, 34816
    s_nop 0
    buffer_load_dwordx4 v12, s[24:27], s56 offen lds
    s_add_u32 m0, s55, 35840
    s_nop 0
    buffer_load_dwordx4 v13, s[24:27], s56 offen lds
    s_add_u32 m0, s55, 36864
    s_nop 0
    buffer_load_dwordx4 v14, s[24:27], s56 offen lds
    s_add_u32 m0, s55, 37888
    s_nop 0
    buffer_load_dwordx4 v15, s[24:27], s56 offen lds
    s_add_u32 m0, s55, 38912
    s_nop 0
    buffer_load_dwordx4 v16, s[24:27], s56 offen lds
    s_add_u32 m0, s55, 39936
    s_nop 0
    buffer_load_dwordx4 v17, s[24:27], s56 offen lds
    s_waitcnt vmcnt(16)
    s_barrier
    s_mov_b32 s56, 384
    s_add_u32 m0, s55, 49152
    s_nop 0
    buffer_load_dwordx4 v10, s[24:27], s56 offen lds
    s_add_u32 m0, s55, 50176
    s_nop 0
    buffer_load_dwordx4 v11, s[24:27], s56 offen lds
    s_add_u32 m0, s55, 51200
    s_nop 0
    buffer_load_dwordx4 v12, s[24:27], s56 offen lds
    s_add_u32 m0, s55, 52224
    s_nop 0
    buffer_load_dwordx4 v13, s[24:27], s56 offen lds
    s_add_u32 m0, s55, 53248
    s_nop 0
    buffer_load_dwordx4 v14, s[24:27], s56 offen lds
    s_add_u32 m0, s55, 54272
    s_nop 0
    buffer_load_dwordx4 v15, s[24:27], s56 offen lds
    s_add_u32 m0, s55, 55296
    s_nop 0
    buffer_load_dwordx4 v16, s[24:27], s56 offen lds
    s_add_u32 m0, s55, 56320
    s_nop 0
    buffer_load_dwordx4 v17, s[24:27], s56 offen lds
    s_add_u32 s28, s20, 15204352
    s_addc_u32 s29, s21, 0
    s_and_b32 s29, s29, 0xffff
    s_mov_b32 s30, 131072
    s_mov_b32 s31, 0x20000
    s_lshl_b32 s48, s59, 6
    s_add_u32 s48, s48, s50
    v_add_u32 v5, s48, v1
    v_lshlrev_b32 v5, 6, v5
    buffer_load_dwordx4 v[20:23], v5, s[28:31], 0 offen offset:0
    buffer_load_dwordx4 v[24:27], v5, s[28:31], 0 offen offset:16
    buffer_load_dwordx4 v[28:31], v5, s[28:31], 0 offen offset:32
    buffer_load_dwordx4 v[32:35], v5, s[28:31], 0 offen offset:48
    s_waitcnt vmcnt(20)
    s_barrier
    s_mov_b32 s56, 512
    s_add_u32 m0, s55, 0
    s_nop 0
    buffer_load_dwordx4 v10, s[24:27], s56 offen lds
    s_add_u32 m0, s55, 1024
    s_nop 0
    buffer_load_dwordx4 v11, s[24:27], s56 offen lds
    s_add_u32 m0, s55, 2048
    s_nop 0
    buffer_load_dwordx4 v12, s[24:27], s56 offen lds
    s_add_u32 m0, s55, 3072
    s_nop 0
    buffer_load_dwordx4 v13, s[24:27], s56 offen lds
    s_add_u32 m0, s55, 4096
    s_nop 0
    buffer_load_dwordx4 v14, s[24:27], s56 offen lds
    s_add_u32 m0, s55, 5120
    s_nop 0
    buffer_load_dwordx4 v15, s[24:27], s56 offen lds
    s_add_u32 m0, s55, 6144
    s_nop 0
    buffer_load_dwordx4 v16, s[24:27], s56 offen lds
    s_add_u32 m0, s55, 7168
    s_nop 0
    buffer_load_dwordx4 v17, s[24:27], s56 offen lds
    s_waitcnt vmcnt(20)
    s_barrier
    s_mov_b32 s56, 640
    s_add_u32 m0, s55, 16384
    s_nop 0
    buffer_load_dwordx4 v10, s[24:27], s56 offen lds
    s_add_u32 m0, s55, 17408
    s_nop 0
    buffer_load_dwordx4 v11, s[24:27], s56 offen lds
    s_add_u32 m0, s55, 18432
    s_nop 0
    buffer_load_dwordx4 v12, s[24:27], s56 offen lds
    s_add_u32 m0, s55, 19456
    s_nop 0
    buffer_load_dwordx4 v13, s[24:27], s56 offen lds
    s_add_u32 m0, s55, 20480
    s_nop 0
    buffer_load_dwordx4 v14, s[24:27], s56 offen lds
    s_add_u32 m0, s55, 21504
    s_nop 0
    buffer_load_dwordx4 v15, s[24:27], s56 offen lds
    s_add_u32 m0, s55, 22528
    s_nop 0
    buffer_load_dwordx4 v16, s[24:27], s56 offen lds
    s_add_u32 m0, s55, 23552
    s_nop 0
    buffer_load_dwordx4 v17, s[24:27], s56 offen lds
    s_waitcnt vmcnt(20)
    s_barrier
    s_mov_b32 s56, 768
    s_add_u32 m0, s55, 32768
    s_nop 0
    buffer_load_dwordx4 v10, s[24:27], s56 offen lds
    s_add_u32 m0, s55, 33792
    s_nop 0
    buffer_load_dwordx4 v11, s[24:27], s56 offen lds
    s_add_u32 m0, s55, 34816
    s_nop 0
    buffer_load_dwordx4 v12, s[24:27], s56 offen lds
    s_add_u32 m0, s55, 35840
    s_nop 0
    buffer_load_dwordx4 v13, s[24:27], s56 offen lds
    s_add_u32 m0, s55, 36864
    s_nop 0
    buffer_load_dwordx4 v14, s[24:27], s56 offen lds
    s_add_u32 m0, s55, 37888
    s_nop 0
    buffer_load_dwordx4 v15, s[24:27], s56 offen lds
    s_add_u32 m0, s55, 38912
    s_nop 0
    buffer_load_dwordx4 v16, s[24:27], s56 offen lds
    s_add_u32 m0, s55, 39936
    s_nop 0
    buffer_load_dwordx4 v17, s[24:27], s56 offen lds
    s_waitcnt vmcnt(16)
    s_barrier
    s_mov_b32 s56, 896
    s_add_u32 m0, s55, 49152
    s_nop 0
    buffer_load_dwordx4 v10, s[24:27], s56 offen lds
    s_add_u32 m0, s55, 50176
    s_nop 0
    buffer_load_dwordx4 v11, s[24:27], s56 offen lds
    s_add_u32 m0, s55, 51200
    s_nop 0
    buffer_load_dwordx4 v12, s[24:27], s56 offen lds
    s_add_u32 m0, s55, 52224
    s_nop 0
    buffer_load_dwordx4 v13, s[24:27], s56 offen lds
    s_add_u32 m0, s55, 53248
    s_nop 0
    buffer_load_dwordx4 v14, s[24:27], s56 offen lds
    s_add_u32 m0, s55, 54272
    s_nop 0
    buffer_load_dwordx4 v15, s[24:27], s56 offen lds
    s_add_u32 m0, s55, 55296
    s_nop 0
    buffer_load_dwordx4 v16, s[24:27], s56 offen lds
    s_add_u32 m0, s55, 56320
    s_nop 0
    buffer_load_dwordx4 v17, s[24:27], s56 offen lds
    v_add_f32 v5, v20, v22
    v_add_f32 v6, v21, v23
    v_add_f32 v5, v5, v24
    v_add_f32 v6, v6, v25
    v_add_f32 v5, v5, v26
    v_add_f32 v6, v6, v27
    v_add_f32 v5, v5, v28
    v_add_f32 v6, v6, v29
    v_add_f32 v5, v5, v30
    v_add_f32 v6, v6, v31
    v_add_f32 v5, v5, v32
    v_add_f32 v6, v6, v33
    v_add_f32 v5, v5, v34
    v_add_f32 v6, v6, v35
    v_mul_f32 v5, 0x3b000000, v5
    v_mul_f32 v6, 0x3b000000, v6
    v_fma_f32 v6, -v5, v5, v6
    v_max_f32 v6, 0, v6
    v_cvt_pk_bf16_f32 v5, v5, v5
    v_lshlrev_b32 v5, 16, v5
    v_cvt_pk_bf16_f32 v6, v6, v6
    v_lshlrev_b32 v6, 16, v6
    v_add_f32 v6, 0x3727c5ac, v6
    v_cvt_pk_bf16_f32 v6, v6, v6
    v_lshlrev_b32 v6, 16, v6
    v_sqrt_f32 v6, v6
    s_nop 0
    v_cvt_pk_bf16_f32 v6, v6, v6
    v_lshlrev_b32 v6, 16, v6
    v_rcp_f32 v36, v6
    s_nop 0
    v_mul_f32 v37, v5, v36
    v_sub_f32 v37, 0, v37
    s_lshl_b32 s48, s59, 9
    s_add_u32 s48, s48, 147456
    v_lshlrev_b32 v5, 3, v1
    v_add_u32 v5, s48, v5
    ds_write_b64 v5, v[36:37]
    s_waitcnt lgkmcnt(0)
    s_waitcnt vmcnt(16)
    s_barrier
    s_waitcnt vmcnt(8)
    s_barrier
    s_waitcnt vmcnt(0)
    s_barrier
    s_barrier
    s_barrier
    s_endpgm
kB_kernel_compute:
    s_nop 7
    s_nop 7
    s_lshr_b32 s48, s97, 3
    s_lshl_b32 s22, s96, 1
    s_add_u32 s22, s22, s48
    s_and_b32 s23, s97, 7
    s_lshl_b32 s50, s22, 6
    s_lshl_b32 s54, s23, 7
    s_lshl_b32 s52, s3, 13
    v_lshlrev_b32 v5, 5, v1
    v_add_u32 v5, s52, v5
    v_add_u32 v6, 4096, v5
    s_waitcnt lgkmcnt(0)
    s_add_u32 s36, s20, 14680064
    s_addc_u32 s37, s21, 0
    s_and_b32 s37, s37, 0xffff
    s_mov_b32 s38, 34816
    s_mov_b32 s39, 0x20000
    buffer_load_dwordx4 v[20:23], v5, s[36:39], 0 offen offset:0
    buffer_load_dwordx4 v[24:27], v5, s[36:39], 0 offen offset:16
    buffer_load_dwordx4 v[28:31], v5, s[36:39], 0 offen offset:2048
    buffer_load_dwordx4 v[32:35], v5, s[36:39], 0 offen offset:2064
    buffer_load_dwordx4 v[36:39], v6, s[36:39], 0 offen offset:0
    buffer_load_dwordx4 v[40:43], v6, s[36:39], 0 offen offset:16
    buffer_load_dwordx4 v[44:47], v6, s[36:39], 0 offen offset:2048
    buffer_load_dwordx4 v[48:51], v6, s[36:39], 0 offen offset:2064
    v_lshlrev_b32 v7, 3, v0
    v_add_u32 v7, 32768, v7
    buffer_load_dwordx2 v[52:53], v7, s[36:39], 0 offen
    s_mov_b32 s24, s4
    s_and_b32 s25, s5, 0xffff
    s_mov_b32 s26, 2097152
    s_mov_b32 s27, 0x20000
    v_lshrrev_b32 v5, 3, v0
    v_and_b32 v6, 7, v0
    v_add_u32 v5, s50, v5
    v_lshlrev_b32 v5, 10, v5
    v_lshl_add_u32 v5, v6, 4, v5
    v_add_u32 v5, s54, v5
    s_mov_b32 s60, 32768
    buffer_load_dwordx4 v[12:15], v5, s[24:27], 0 offen
    buffer_load_dwordx4 v[16:19], v5, s[24:27], s60 offen
    s_lshl_b32 s52, s3, 4
    v_add_u32 v5, s52, v2
    v_mul_u32_u24 v5, 256, v5
    v_mov_b32 v6, v2
    v_xor_b32 v6, v6, v3
    v_xor_b32 v54, 0, v6
    v_lshl_add_u32 v54, v54, 4, v5
    v_add_u32 v55, 65536, v54
    v_xor_b32 v56, 4, v6
    v_lshl_add_u32 v56, v56, 4, v5
    v_add_u32 v57, 65536, v56
    v_xor_b32 v58, 8, v6
    v_lshl_add_u32 v58, v58, 4, v5
    v_add_u32 v59, 65536, v58
    v_xor_b32 v60, 12, v6
    v_lshl_add_u32 v60, v60, 4, v5
    v_add_u32 v61, 65536, v60
    v_lshlrev_b32 v5, 4, v1
    v_add_u32 v5, 131072, v5
    v_mov_b32 v6, 150528
    v_cmp_gt_u32 vcc, 2, v3
    s_nop 1
    v_cndmask_b32 v62, v6, v5, vcc
    v_cndmask_b32 v63, v5, v6, vcc
    v_mov_b32 v7, 1024
    v_cndmask_b32 v65, 0, v7, vcc
    v_cndmask_b32 v66, v7, 0, vcc
    v_and_b32 v5, 3, v1
    v_lshrrev_b32 v7, 1, v3
    v_cmp_eq_u32 vcc, v5, v7
    v_lshlrev_b32 v5, 4, v3
    v_add_u32 v5, 149504, v5
    v_cndmask_b32 v64, v6, v5, vcc
    v_cndmask_b32 v67, 0, 64, vcc
    v_bfe_u32 v5, v1, 2, 2
    v_lshl_add_u32 v5, v3, 2, v5
    v_bfe_u32 v6, v5, 1, 2
    v_lshlrev_b32 v5, 7, v5
    v_and_b32 v7, 3, v1
    v_lshl_add_u32 v5, v7, 3, v5
    v_xor_b32 v7, 0, v6
    v_lshl_add_u32 v68, v7, 5, v5
    v_add_u32 v69, 65536, v68
    v_add_u32 v70, 131072, v68
    v_xor_b32 v7, 1, v6
    v_lshl_add_u32 v71, v7, 5, v5
    v_add_u32 v72, 65536, v71
    v_add_u32 v73, 131072, v71
    v_xor_b32 v7, 2, v6
    v_lshl_add_u32 v74, v7, 5, v5
    v_add_u32 v75, 65536, v74
    v_add_u32 v76, 131072, v74
    v_xor_b32 v7, 3, v6
    v_lshl_add_u32 v77, v7, 5, v5
    v_add_u32 v78, 65536, v77
    v_add_u32 v79, 131072, v77
    v_mov_b32 v80, 0
    v_mov_b32 v81, 0
    v_mov_b32 v82, 0
    v_mov_b32 v83, 0
    v_mov_b32 v84, 0
    v_mov_b32 v85, 0
    v_mov_b32 v86, 0
    v_mov_b32 v87, 0
    v_mov_b32 v88, 0
    v_mov_b32 v89, 0
    v_mov_b32 v90, 0
    v_mov_b32 v91, 0
    v_mov_b32 v92, 0
    v_mov_b32 v93, 0
    v_mov_b32 v94, 0
    v_mov_b32 v95, 0
    s_lshl_b32 s57, s3, 12
    s_add_u32 s57, s57, 131072
    v_lshlrev_b32 v5, 4, v1
    v_add_u32 v5, s57, v5
    s_waitcnt vmcnt(10)
    v_cvt_pk_bf16_f32 v20, v20, v21
    v_cvt_pk_bf16_f32 v21, v22, v23
    s_waitcnt vmcnt(9)
    v_cvt_pk_bf16_f32 v22, v24, v25
    v_cvt_pk_bf16_f32 v23, v26, v27
    ds_write_b128 v5, v[20:23] offset:0
    s_waitcnt vmcnt(8)
    v_cvt_pk_bf16_f32 v28, v28, v29
    v_cvt_pk_bf16_f32 v29, v30, v31
    s_waitcnt vmcnt(7)
    v_cvt_pk_bf16_f32 v30, v32, v33
    v_cvt_pk_bf16_f32 v31, v34, v35
    ds_write_b128 v5, v[28:31] offset:1024
    s_waitcnt vmcnt(6)
    v_cvt_pk_bf16_f32 v36, v36, v37
    v_cvt_pk_bf16_f32 v37, v38, v39
    s_waitcnt vmcnt(5)
    v_cvt_pk_bf16_f32 v38, v40, v41
    v_cvt_pk_bf16_f32 v39, v42, v43
    ds_write_b128 v5, v[36:39] offset:2048
    s_waitcnt vmcnt(4)
    v_cvt_pk_bf16_f32 v44, v44, v45
    v_cvt_pk_bf16_f32 v45, v46, v47
    s_waitcnt vmcnt(3)
    v_cvt_pk_bf16_f32 v46, v48, v49
    v_cvt_pk_bf16_f32 v47, v50, v51
    ds_write_b128 v5, v[44:47] offset:3072
    s_waitcnt vmcnt(2)
    v_cvt_pk_bf16_f32 v52, v52, v53
    v_lshlrev_b32 v6, 2, v0
    v_add_u32 v6, 149504, v6
    ds_write_b32 v6, v52
    v_mov_b32 v52, 0
    v_and_b32 v6, 3, v0
    v_lshlrev_b32 v6, 2, v6
    v_add_u32 v6, 150528, v6
    ds_write_b32 v6, v52
    s_mov_b32 s62, 0x358637bd
    s_mov_b32 s63, 0x358637bd
    s_waitcnt lgkmcnt(0)
    s_barrier
    ds_read_b128 v[152:155], v54 offset:0
    ds_read_b128 v[128:131], v62
    ds_read_b128 v[132:135], v63
    ds_read_b128 v[136:139], v64
    v_add_u32 v62, v62, v65
    v_add_u32 v63, v63, v66
    v_add_u32 v64, v64, v67
    ds_read_b128 v[156:159], v56 offset:0
    ds_read_b128 v[140:143], v62
    ds_read_b128 v[144:147], v63
    ds_read_b128 v[148:151], v64
    v_add_u32 v62, v62, v65
    v_add_u32 v63, v63, v66
    v_add_u32 v64, v64, v67
    ds_read_b64_tr_b16 v[20:21], v69 offset:0
    ds_read_b64_tr_b16 v[22:23], v69 offset:2048
    ds_read_b64_tr_b16 v[24:25], v72 offset:0
    ds_read_b64_tr_b16 v[26:27], v72 offset:2048
    ds_read_b64_tr_b16 v[28:29], v75 offset:0
    ds_read_b64_tr_b16 v[30:31], v75 offset:2048
    ds_read_b64_tr_b16 v[32:33], v78 offset:0
    ds_read_b64_tr_b16 v[34:35], v78 offset:2048
    ds_read_b64_tr_b16 v[36:37], v69 offset:4096
    ds_read_b64_tr_b16 v[38:39], v69 offset:6144
    ds_read_b64_tr_b16 v[40:41], v72 offset:4096
    ds_read_b64_tr_b16 v[42:43], v72 offset:6144
    ds_read_b64_tr_b16 v[44:45], v75 offset:4096
    ds_read_b64_tr_b16 v[46:47], v75 offset:6144
    ds_read_b64_tr_b16 v[48:49], v78 offset:4096
    ds_read_b64_tr_b16 v[50:51], v78 offset:6144
    s_waitcnt lgkmcnt(15)
    v_mfma_f32_16x16x32_bf16 v[160:163], v[128:131], v[152:155], 0
    v_mfma_f32_16x16x32_bf16 v[164:167], v[132:135], v[152:155], 0
    v_mfma_f32_16x16x32_bf16 v[168:171], v[136:139], v[152:155], 0
    v_mfma_f32_16x16x32_bf16 v[172:175], v[140:143], v[156:159], 0
    v_mfma_f32_16x16x32_bf16 v[176:179], v[144:147], v[156:159], 0
    v_mfma_f32_16x16x32_bf16 v[180:183], v[148:151], v[156:159], 0
    ds_read_b128 v[152:155], v58 offset:0
    ds_read_b128 v[128:131], v62
    ds_read_b128 v[132:135], v63
    ds_read_b128 v[136:139], v64
    v_add_u32 v62, v62, v65
    v_add_u32 v63, v63, v66
    v_add_u32 v64, v64, v67
    ds_read_b128 v[156:159], v60 offset:0
    ds_read_b128 v[140:143], v62
    ds_read_b128 v[144:147], v63
    ds_read_b128 v[148:151], v64
    v_add_u32 v62, v62, v65
    v_add_u32 v63, v63, v66
    v_add_u32 v64, v64, v67
    s_waitcnt lgkmcnt(6)
    v_mfma_f32_16x16x32_bf16 v[184:187], v[128:131], v[152:155], 0
    v_add_f32 v224, s62, v168
    v_add_f32 v225, s62, v169
    ds_read_b64_tr_b16 v[96:97], v69 offset:8192
    ds_read_b64_tr_b16 v[98:99], v69 offset:10240
    ds_read_b64_tr_b16 v[100:101], v72 offset:8192
    s_waitcnt lgkmcnt(8)
    v_mfma_f32_16x16x32_bf16 v[188:191], v[132:135], v[152:155], 0
    v_add_f32 v226, s62, v180
    v_add_f32 v227, s62, v181
    ds_read_b64_tr_b16 v[102:103], v72 offset:10240
    ds_read_b64_tr_b16 v[104:105], v75 offset:8192
    ds_read_b64_tr_b16 v[106:107], v75 offset:10240
    s_waitcnt lgkmcnt(10)
    v_mfma_f32_16x16x32_bf16 v[192:195], v[136:139], v[152:155], 0
    v_rcp_f32 v224, v224
    v_rcp_f32 v225, v225
    ds_read_b64_tr_b16 v[108:109], v78 offset:8192
    ds_read_b64_tr_b16 v[110:111], v78 offset:10240
    ds_read_b64_tr_b16 v[112:113], v69 offset:12288
    s_waitcnt lgkmcnt(11)
    v_mfma_f32_16x16x32_bf16 v[196:199], v[140:143], v[156:159], 0
    v_rcp_f32 v226, v226
    v_rcp_f32 v227, v227
    ds_read_b64_tr_b16 v[114:115], v69 offset:14336
    ds_read_b64_tr_b16 v[116:117], v72 offset:12288
    ds_read_b64_tr_b16 v[118:119], v72 offset:14336
    s_waitcnt lgkmcnt(13)
    v_mfma_f32_16x16x32_bf16 v[200:203], v[144:147], v[156:159], 0
    v_mul_f32 v160, v160, v224
    v_mul_f32 v161, v161, v224
    ds_read_b64_tr_b16 v[120:121], v75 offset:12288
    ds_read_b64_tr_b16 v[122:123], v75 offset:14336
    ds_read_b64_tr_b16 v[124:125], v78 offset:12288
    s_waitcnt lgkmcnt(15)
    v_mfma_f32_16x16x32_bf16 v[204:207], v[148:151], v[156:159], 0
    v_mul_f32 v162, v162, v224
    v_mul_f32 v163, v163, v224
    ds_read_b64_tr_b16 v[126:127], v78 offset:14336
    v_mul_f32 v164, v164, v225
    v_mul_f32 v165, v165, v225
    v_mul_f32 v166, v166, v225
    v_mul_f32 v167, v167, v225
    v_mul_f32 v172, v172, v226
    v_mul_f32 v173, v173, v226
    v_mul_f32 v174, v174, v226
    v_mul_f32 v175, v175, v226
    v_mul_f32 v176, v176, v227
    v_mul_f32 v177, v177, v227
    v_mul_f32 v178, v178, v227
    v_mul_f32 v179, v179, v227
    v_cvt_pk_bf16_f32 v208, v160, v161
    v_cvt_pk_bf16_f32 v209, v162, v163
    v_cvt_pk_bf16_f32 v210, v164, v165
    v_cvt_pk_bf16_f32 v211, v166, v167
    v_cvt_pk_bf16_f32 v212, v172, v173
    v_cvt_pk_bf16_f32 v213, v174, v175
    v_cvt_pk_bf16_f32 v214, v176, v177
    v_cvt_pk_bf16_f32 v215, v178, v179
    s_waitcnt lgkmcnt(0)
    s_barrier
    ds_read_b128 v[152:155], v54 offset:16384
    ds_read_b128 v[128:131], v62
    ds_read_b128 v[132:135], v63
    ds_read_b128 v[136:139], v64
    v_add_u32 v62, v62, v65
    v_add_u32 v63, v63, v66
    v_add_u32 v64, v64, v67
    ds_read_b128 v[156:159], v56 offset:16384
    ds_read_b128 v[140:143], v62
    ds_read_b128 v[144:147], v63
    ds_read_b128 v[148:151], v64
    v_add_u32 v62, v62, v65
    v_add_u32 v63, v63, v66
    v_add_u32 v64, v64, v67
    v_mfma_f32_16x16x32_bf16 v[80:83], v[20:23], v[208:211], v[80:83]
    v_add_f32 v224, s62, v192
    v_add_f32 v225, s62, v193
    v_mfma_f32_16x16x32_bf16 v[84:87], v[24:27], v[208:211], v[84:87]
    v_add_f32 v226, s62, v204
    v_add_f32 v227, s62, v205
    v_mfma_f32_16x16x32_bf16 v[88:91], v[28:31], v[208:211], v[88:91]
    v_rcp_f32 v224, v224
    v_rcp_f32 v225, v225
    v_mfma_f32_16x16x32_bf16 v[92:95], v[32:35], v[208:211], v[92:95]
    v_rcp_f32 v226, v226
    v_rcp_f32 v227, v227
    v_mfma_f32_16x16x32_bf16 v[80:83], v[36:39], v[212:215], v[80:83]
    v_mul_f32 v184, v184, v224
    v_mul_f32 v185, v185, v224
    v_mfma_f32_16x16x32_bf16 v[84:87], v[40:43], v[212:215], v[84:87]
    v_mul_f32 v186, v186, v224
    v_mul_f32 v187, v187, v224
    v_mfma_f32_16x16x32_bf16 v[88:91], v[44:47], v[212:215], v[88:91]
    v_mul_f32 v188, v188, v225
    v_mul_f32 v189, v189, v225
    v_mfma_f32_16x16x32_bf16 v[92:95], v[48:51], v[212:215], v[92:95]
    v_mul_f32 v190, v190, v225
    v_mul_f32 v191, v191, v225
    ds_read_b64_tr_b16 v[20:21], v69 offset:16384
    ds_read_b64_tr_b16 v[22:23], v69 offset:18432
    ds_read_b64_tr_b16 v[24:25], v72 offset:16384
    s_waitcnt lgkmcnt(9)
    v_mfma_f32_16x16x32_bf16 v[160:163], v[128:131], v[152:155], 0
    v_mul_f32 v196, v196, v226
    v_mul_f32 v197, v197, v226
    ds_read_b64_tr_b16 v[26:27], v72 offset:18432
    ds_read_b64_tr_b16 v[28:29], v75 offset:16384
    ds_read_b64_tr_b16 v[30:31], v75 offset:18432
    s_waitcnt lgkmcnt(11)
    v_mfma_f32_16x16x32_bf16 v[164:167], v[132:135], v[152:155], 0
    v_mul_f32 v198, v198, v226
    v_mul_f32 v199, v199, v226
    ds_read_b64_tr_b16 v[32:33], v78 offset:16384
    ds_read_b64_tr_b16 v[34:35], v78 offset:18432
    ds_read_b64_tr_b16 v[36:37], v69 offset:20480
    s_waitcnt lgkmcnt(13)
    v_mfma_f32_16x16x32_bf16 v[168:171], v[136:139], v[152:155], 0
    v_mul_f32 v200, v200, v227
    v_mul_f32 v201, v201, v227
    ds_read_b64_tr_b16 v[38:39], v69 offset:22528
    ds_read_b64_tr_b16 v[40:41], v72 offset:20480
    ds_read_b64_tr_b16 v[42:43], v72 offset:22528
    s_waitcnt lgkmcnt(14)
    v_mfma_f32_16x16x32_bf16 v[172:175], v[140:143], v[156:159], 0
    v_mul_f32 v202, v202, v227
    v_mul_f32 v203, v203, v227
    ds_read_b64_tr_b16 v[44:45], v75 offset:20480
    ds_read_b64_tr_b16 v[46:47], v75 offset:22528
    ds_read_b64_tr_b16 v[48:49], v78 offset:20480
    s_waitcnt lgkmcnt(15)
    v_mfma_f32_16x16x32_bf16 v[176:179], v[144:147], v[156:159], 0
    v_cvt_pk_bf16_f32 v216, v184, v185
    v_cvt_pk_bf16_f32 v217, v186, v187
    ds_read_b64_tr_b16 v[50:51], v78 offset:22528
    v_mfma_f32_16x16x32_bf16 v[180:183], v[148:151], v[156:159], 0
    v_cvt_pk_bf16_f32 v218, v188, v189
    v_cvt_pk_bf16_f32 v219, v190, v191
    v_cvt_pk_bf16_f32 v220, v196, v197
    v_cvt_pk_bf16_f32 v221, v198, v199
    v_cvt_pk_bf16_f32 v222, v200, v201
    v_cvt_pk_bf16_f32 v223, v202, v203
    ds_read_b128 v[152:155], v58 offset:16384
    ds_read_b128 v[128:131], v62
    ds_read_b128 v[132:135], v63
    ds_read_b128 v[136:139], v64
    v_add_u32 v62, v62, v65
    v_add_u32 v63, v63, v66
    v_add_u32 v64, v64, v67
    ds_read_b128 v[156:159], v60 offset:16384
    ds_read_b128 v[140:143], v62
    ds_read_b128 v[144:147], v63
    ds_read_b128 v[148:151], v64
    v_add_u32 v62, v62, v65
    v_add_u32 v63, v63, v66
    v_add_u32 v64, v64, v67
    v_mfma_f32_16x16x32_bf16 v[80:83], v[96:99], v[216:219], v[80:83]
    v_add_f32 v224, s62, v168
    v_add_f32 v225, s62, v169
    v_mfma_f32_16x16x32_bf16 v[84:87], v[100:103], v[216:219], v[84:87]
    v_add_f32 v226, s62, v180
    v_add_f32 v227, s62, v181
    v_mfma_f32_16x16x32_bf16 v[88:91], v[104:107], v[216:219], v[88:91]
    v_rcp_f32 v224, v224
    v_rcp_f32 v225, v225
    v_mfma_f32_16x16x32_bf16 v[92:95], v[108:111], v[216:219], v[92:95]
    v_rcp_f32 v226, v226
    v_rcp_f32 v227, v227
    v_mfma_f32_16x16x32_bf16 v[80:83], v[112:115], v[220:223], v[80:83]
    v_mul_f32 v160, v160, v224
    v_mul_f32 v161, v161, v224
    v_mfma_f32_16x16x32_bf16 v[84:87], v[116:119], v[220:223], v[84:87]
    v_mul_f32 v162, v162, v224
    v_mul_f32 v163, v163, v224
    v_mfma_f32_16x16x32_bf16 v[88:91], v[120:123], v[220:223], v[88:91]
    v_mul_f32 v164, v164, v225
    v_mul_f32 v165, v165, v225
    v_mfma_f32_16x16x32_bf16 v[92:95], v[124:127], v[220:223], v[92:95]
    v_mul_f32 v166, v166, v225
    v_mul_f32 v167, v167, v225
    ds_read_b64_tr_b16 v[96:97], v69 offset:24576
    ds_read_b64_tr_b16 v[98:99], v69 offset:26624
    ds_read_b64_tr_b16 v[100:101], v72 offset:24576
    s_waitcnt lgkmcnt(9)
    v_mfma_f32_16x16x32_bf16 v[184:187], v[128:131], v[152:155], 0
    v_mul_f32 v172, v172, v226
    v_mul_f32 v173, v173, v226
    ds_read_b64_tr_b16 v[102:103], v72 offset:26624
    ds_read_b64_tr_b16 v[104:105], v75 offset:24576
    ds_read_b64_tr_b16 v[106:107], v75 offset:26624
    s_waitcnt lgkmcnt(11)
    v_mfma_f32_16x16x32_bf16 v[188:191], v[132:135], v[152:155], 0
    v_mul_f32 v174, v174, v226
    v_mul_f32 v175, v175, v226
    ds_read_b64_tr_b16 v[108:109], v78 offset:24576
    ds_read_b64_tr_b16 v[110:111], v78 offset:26624
    ds_read_b64_tr_b16 v[112:113], v69 offset:28672
    s_waitcnt lgkmcnt(13)
    v_mfma_f32_16x16x32_bf16 v[192:195], v[136:139], v[152:155], 0
    v_mul_f32 v176, v176, v227
    v_mul_f32 v177, v177, v227
    ds_read_b64_tr_b16 v[114:115], v69 offset:30720
    ds_read_b64_tr_b16 v[116:117], v72 offset:28672
    ds_read_b64_tr_b16 v[118:119], v72 offset:30720
    s_waitcnt lgkmcnt(14)
    v_mfma_f32_16x16x32_bf16 v[196:199], v[140:143], v[156:159], 0
    v_mul_f32 v178, v178, v227
    v_mul_f32 v179, v179, v227
    ds_read_b64_tr_b16 v[120:121], v75 offset:28672
    ds_read_b64_tr_b16 v[122:123], v75 offset:30720
    ds_read_b64_tr_b16 v[124:125], v78 offset:28672
    s_waitcnt lgkmcnt(15)
    v_mfma_f32_16x16x32_bf16 v[200:203], v[144:147], v[156:159], 0
    v_cvt_pk_bf16_f32 v208, v160, v161
    v_cvt_pk_bf16_f32 v209, v162, v163
    ds_read_b64_tr_b16 v[126:127], v78 offset:30720
    v_mfma_f32_16x16x32_bf16 v[204:207], v[148:151], v[156:159], 0
    v_cvt_pk_bf16_f32 v210, v164, v165
    v_cvt_pk_bf16_f32 v211, v166, v167
    v_cvt_pk_bf16_f32 v212, v172, v173
    v_cvt_pk_bf16_f32 v213, v174, v175
    v_cvt_pk_bf16_f32 v214, v176, v177
    v_cvt_pk_bf16_f32 v215, v178, v179
    s_waitcnt lgkmcnt(0)
    s_barrier
    ds_read_b128 v[152:155], v54 offset:32768
    ds_read_b128 v[128:131], v62
    ds_read_b128 v[132:135], v63
    ds_read_b128 v[136:139], v64
    v_add_u32 v62, v62, v65
    v_add_u32 v63, v63, v66
    v_add_u32 v64, v64, v67
    ds_read_b128 v[156:159], v56 offset:32768
    ds_read_b128 v[140:143], v62
    ds_read_b128 v[144:147], v63
    ds_read_b128 v[148:151], v64
    v_add_u32 v62, v62, v65
    v_add_u32 v63, v63, v66
    v_add_u32 v64, v64, v67
    v_mfma_f32_16x16x32_bf16 v[80:83], v[20:23], v[208:211], v[80:83]
    v_add_f32 v224, s62, v192
    v_add_f32 v225, s62, v193
    v_mfma_f32_16x16x32_bf16 v[84:87], v[24:27], v[208:211], v[84:87]
    v_add_f32 v226, s62, v204
    v_add_f32 v227, s62, v205
    v_mfma_f32_16x16x32_bf16 v[88:91], v[28:31], v[208:211], v[88:91]
    v_rcp_f32 v224, v224
    v_rcp_f32 v225, v225
    v_mfma_f32_16x16x32_bf16 v[92:95], v[32:35], v[208:211], v[92:95]
    v_rcp_f32 v226, v226
    v_rcp_f32 v227, v227
    v_mfma_f32_16x16x32_bf16 v[80:83], v[36:39], v[212:215], v[80:83]
    v_mul_f32 v184, v184, v224
    v_mul_f32 v185, v185, v224
    v_mfma_f32_16x16x32_bf16 v[84:87], v[40:43], v[212:215], v[84:87]
    v_mul_f32 v186, v186, v224
    v_mul_f32 v187, v187, v224
    v_mfma_f32_16x16x32_bf16 v[88:91], v[44:47], v[212:215], v[88:91]
    v_mul_f32 v188, v188, v225
    v_mul_f32 v189, v189, v225
    v_mfma_f32_16x16x32_bf16 v[92:95], v[48:51], v[212:215], v[92:95]
    v_mul_f32 v190, v190, v225
    v_mul_f32 v191, v191, v225
    ds_read_b64_tr_b16 v[20:21], v69 offset:32768
    ds_read_b64_tr_b16 v[22:23], v69 offset:34816
    ds_read_b64_tr_b16 v[24:25], v72 offset:32768
    s_waitcnt lgkmcnt(9)
    v_mfma_f32_16x16x32_bf16 v[160:163], v[128:131], v[152:155], 0
    v_mul_f32 v196, v196, v226
    v_mul_f32 v197, v197, v226
    ds_read_b64_tr_b16 v[26:27], v72 offset:34816
    ds_read_b64_tr_b16 v[28:29], v75 offset:32768
    ds_read_b64_tr_b16 v[30:31], v75 offset:34816
    s_waitcnt lgkmcnt(11)
    v_mfma_f32_16x16x32_bf16 v[164:167], v[132:135], v[152:155], 0
    v_mul_f32 v198, v198, v226
    v_mul_f32 v199, v199, v226
    ds_read_b64_tr_b16 v[32:33], v78 offset:32768
    ds_read_b64_tr_b16 v[34:35], v78 offset:34816
    ds_read_b64_tr_b16 v[36:37], v69 offset:36864
    s_waitcnt lgkmcnt(13)
    v_mfma_f32_16x16x32_bf16 v[168:171], v[136:139], v[152:155], 0
    v_mul_f32 v200, v200, v227
    v_mul_f32 v201, v201, v227
    ds_read_b64_tr_b16 v[38:39], v69 offset:38912
    ds_read_b64_tr_b16 v[40:41], v72 offset:36864
    ds_read_b64_tr_b16 v[42:43], v72 offset:38912
    s_waitcnt lgkmcnt(14)
    v_mfma_f32_16x16x32_bf16 v[172:175], v[140:143], v[156:159], 0
    v_mul_f32 v202, v202, v227
    v_mul_f32 v203, v203, v227
    ds_read_b64_tr_b16 v[44:45], v75 offset:36864
    ds_read_b64_tr_b16 v[46:47], v75 offset:38912
    ds_read_b64_tr_b16 v[48:49], v78 offset:36864
    s_waitcnt lgkmcnt(15)
    v_mfma_f32_16x16x32_bf16 v[176:179], v[144:147], v[156:159], 0
    v_cvt_pk_bf16_f32 v216, v184, v185
    v_cvt_pk_bf16_f32 v217, v186, v187
    ds_read_b64_tr_b16 v[50:51], v78 offset:38912
    v_mfma_f32_16x16x32_bf16 v[180:183], v[148:151], v[156:159], 0
    v_cvt_pk_bf16_f32 v218, v188, v189
    v_cvt_pk_bf16_f32 v219, v190, v191
    v_cvt_pk_bf16_f32 v220, v196, v197
    v_cvt_pk_bf16_f32 v221, v198, v199
    v_cvt_pk_bf16_f32 v222, v200, v201
    v_cvt_pk_bf16_f32 v223, v202, v203
    ds_read_b128 v[152:155], v58 offset:32768
    ds_read_b128 v[128:131], v62
    ds_read_b128 v[132:135], v63
    ds_read_b128 v[136:139], v64
    v_add_u32 v62, v62, v65
    v_add_u32 v63, v63, v66
    v_add_u32 v64, v64, v67
    ds_read_b128 v[156:159], v60 offset:32768
    ds_read_b128 v[140:143], v62
    ds_read_b128 v[144:147], v63
    ds_read_b128 v[148:151], v64
    v_add_u32 v62, v62, v65
    v_add_u32 v63, v63, v66
    v_add_u32 v64, v64, v67
    v_mfma_f32_16x16x32_bf16 v[80:83], v[96:99], v[216:219], v[80:83]
    v_add_f32 v224, s62, v168
    v_add_f32 v225, s62, v169
    v_mfma_f32_16x16x32_bf16 v[84:87], v[100:103], v[216:219], v[84:87]
    v_add_f32 v226, s62, v180
    v_add_f32 v227, s62, v181
    v_mfma_f32_16x16x32_bf16 v[88:91], v[104:107], v[216:219], v[88:91]
    v_rcp_f32 v224, v224
    v_rcp_f32 v225, v225
    v_mfma_f32_16x16x32_bf16 v[92:95], v[108:111], v[216:219], v[92:95]
    v_rcp_f32 v226, v226
    v_rcp_f32 v227, v227
    v_mfma_f32_16x16x32_bf16 v[80:83], v[112:115], v[220:223], v[80:83]
    v_mul_f32 v160, v160, v224
    v_mul_f32 v161, v161, v224
    v_mfma_f32_16x16x32_bf16 v[84:87], v[116:119], v[220:223], v[84:87]
    v_mul_f32 v162, v162, v224
    v_mul_f32 v163, v163, v224
    v_mfma_f32_16x16x32_bf16 v[88:91], v[120:123], v[220:223], v[88:91]
    v_mul_f32 v164, v164, v225
    v_mul_f32 v165, v165, v225
    v_mfma_f32_16x16x32_bf16 v[92:95], v[124:127], v[220:223], v[92:95]
    v_mul_f32 v166, v166, v225
    v_mul_f32 v167, v167, v225
    ds_read_b64_tr_b16 v[96:97], v69 offset:40960
    ds_read_b64_tr_b16 v[98:99], v69 offset:43008
    ds_read_b64_tr_b16 v[100:101], v72 offset:40960
    s_waitcnt lgkmcnt(9)
    v_mfma_f32_16x16x32_bf16 v[184:187], v[128:131], v[152:155], 0
    v_mul_f32 v172, v172, v226
    v_mul_f32 v173, v173, v226
    ds_read_b64_tr_b16 v[102:103], v72 offset:43008
    ds_read_b64_tr_b16 v[104:105], v75 offset:40960
    ds_read_b64_tr_b16 v[106:107], v75 offset:43008
    s_waitcnt lgkmcnt(11)
    v_mfma_f32_16x16x32_bf16 v[188:191], v[132:135], v[152:155], 0
    v_mul_f32 v174, v174, v226
    v_mul_f32 v175, v175, v226
    ds_read_b64_tr_b16 v[108:109], v78 offset:40960
    ds_read_b64_tr_b16 v[110:111], v78 offset:43008
    ds_read_b64_tr_b16 v[112:113], v69 offset:45056
    s_waitcnt lgkmcnt(13)
    v_mfma_f32_16x16x32_bf16 v[192:195], v[136:139], v[152:155], 0
    v_mul_f32 v176, v176, v227
    v_mul_f32 v177, v177, v227
    ds_read_b64_tr_b16 v[114:115], v69 offset:47104
    ds_read_b64_tr_b16 v[116:117], v72 offset:45056
    ds_read_b64_tr_b16 v[118:119], v72 offset:47104
    s_waitcnt lgkmcnt(14)
    v_mfma_f32_16x16x32_bf16 v[196:199], v[140:143], v[156:159], 0
    v_mul_f32 v178, v178, v227
    v_mul_f32 v179, v179, v227
    ds_read_b64_tr_b16 v[120:121], v75 offset:45056
    ds_read_b64_tr_b16 v[122:123], v75 offset:47104
    ds_read_b64_tr_b16 v[124:125], v78 offset:45056
    s_waitcnt lgkmcnt(15)
    v_mfma_f32_16x16x32_bf16 v[200:203], v[144:147], v[156:159], 0
    v_cvt_pk_bf16_f32 v208, v160, v161
    v_cvt_pk_bf16_f32 v209, v162, v163
    ds_read_b64_tr_b16 v[126:127], v78 offset:47104
    v_mfma_f32_16x16x32_bf16 v[204:207], v[148:151], v[156:159], 0
    v_cvt_pk_bf16_f32 v210, v164, v165
    v_cvt_pk_bf16_f32 v211, v166, v167
    v_cvt_pk_bf16_f32 v212, v172, v173
    v_cvt_pk_bf16_f32 v213, v174, v175
    v_cvt_pk_bf16_f32 v214, v176, v177
    v_cvt_pk_bf16_f32 v215, v178, v179
    s_waitcnt lgkmcnt(0)
    s_barrier
    ds_read_b128 v[152:155], v54 offset:49152
    ds_read_b128 v[128:131], v62
    ds_read_b128 v[132:135], v63
    ds_read_b128 v[136:139], v64
    v_add_u32 v62, v62, v65
    v_add_u32 v63, v63, v66
    v_add_u32 v64, v64, v67
    ds_read_b128 v[156:159], v56 offset:49152
    ds_read_b128 v[140:143], v62
    ds_read_b128 v[144:147], v63
    ds_read_b128 v[148:151], v64
    v_add_u32 v62, v62, v65
    v_add_u32 v63, v63, v66
    v_add_u32 v64, v64, v67
    v_mfma_f32_16x16x32_bf16 v[80:83], v[20:23], v[208:211], v[80:83]
    v_add_f32 v224, s62, v192
    v_add_f32 v225, s62, v193
    v_mfma_f32_16x16x32_bf16 v[84:87], v[24:27], v[208:211], v[84:87]
    v_add_f32 v226, s62, v204
    v_add_f32 v227, s62, v205
    v_mfma_f32_16x16x32_bf16 v[88:91], v[28:31], v[208:211], v[88:91]
    v_rcp_f32 v224, v224
    v_rcp_f32 v225, v225
    v_mfma_f32_16x16x32_bf16 v[92:95], v[32:35], v[208:211], v[92:95]
    v_rcp_f32 v226, v226
    v_rcp_f32 v227, v227
    v_mfma_f32_16x16x32_bf16 v[80:83], v[36:39], v[212:215], v[80:83]
    v_mul_f32 v184, v184, v224
    v_mul_f32 v185, v185, v224
    v_mfma_f32_16x16x32_bf16 v[84:87], v[40:43], v[212:215], v[84:87]
    v_mul_f32 v186, v186, v224
    v_mul_f32 v187, v187, v224
    v_mfma_f32_16x16x32_bf16 v[88:91], v[44:47], v[212:215], v[88:91]
    v_mul_f32 v188, v188, v225
    v_mul_f32 v189, v189, v225
    v_mfma_f32_16x16x32_bf16 v[92:95], v[48:51], v[212:215], v[92:95]
    v_mul_f32 v190, v190, v225
    v_mul_f32 v191, v191, v225
    ds_read_b64_tr_b16 v[20:21], v69 offset:49152
    ds_read_b64_tr_b16 v[22:23], v69 offset:51200
    ds_read_b64_tr_b16 v[24:25], v72 offset:49152
    s_waitcnt lgkmcnt(9)
    v_mfma_f32_16x16x32_bf16 v[160:163], v[128:131], v[152:155], 0
    v_mul_f32 v196, v196, v226
    v_mul_f32 v197, v197, v226
    ds_read_b64_tr_b16 v[26:27], v72 offset:51200
    ds_read_b64_tr_b16 v[28:29], v75 offset:49152
    ds_read_b64_tr_b16 v[30:31], v75 offset:51200
    s_waitcnt lgkmcnt(11)
    v_mfma_f32_16x16x32_bf16 v[164:167], v[132:135], v[152:155], 0
    v_mul_f32 v198, v198, v226
    v_mul_f32 v199, v199, v226
    ds_read_b64_tr_b16 v[32:33], v78 offset:49152
    ds_read_b64_tr_b16 v[34:35], v78 offset:51200
    ds_read_b64_tr_b16 v[36:37], v69 offset:53248
    s_waitcnt lgkmcnt(13)
    v_mfma_f32_16x16x32_bf16 v[168:171], v[136:139], v[152:155], 0
    v_mul_f32 v200, v200, v227
    v_mul_f32 v201, v201, v227
    ds_read_b64_tr_b16 v[38:39], v69 offset:55296
    ds_read_b64_tr_b16 v[40:41], v72 offset:53248
    ds_read_b64_tr_b16 v[42:43], v72 offset:55296
    s_waitcnt lgkmcnt(14)
    v_mfma_f32_16x16x32_bf16 v[172:175], v[140:143], v[156:159], 0
    v_mul_f32 v202, v202, v227
    v_mul_f32 v203, v203, v227
    ds_read_b64_tr_b16 v[44:45], v75 offset:53248
    ds_read_b64_tr_b16 v[46:47], v75 offset:55296
    ds_read_b64_tr_b16 v[48:49], v78 offset:53248
    s_waitcnt lgkmcnt(15)
    v_mfma_f32_16x16x32_bf16 v[176:179], v[144:147], v[156:159], 0
    v_cvt_pk_bf16_f32 v216, v184, v185
    v_cvt_pk_bf16_f32 v217, v186, v187
    ds_read_b64_tr_b16 v[50:51], v78 offset:55296
    v_mfma_f32_16x16x32_bf16 v[180:183], v[148:151], v[156:159], 0
    v_cvt_pk_bf16_f32 v218, v188, v189
    v_cvt_pk_bf16_f32 v219, v190, v191
    v_cvt_pk_bf16_f32 v220, v196, v197
    v_cvt_pk_bf16_f32 v221, v198, v199
    v_cvt_pk_bf16_f32 v222, v200, v201
    v_cvt_pk_bf16_f32 v223, v202, v203
    ds_read_b128 v[152:155], v58 offset:49152
    ds_read_b128 v[128:131], v62
    ds_read_b128 v[132:135], v63
    ds_read_b128 v[136:139], v64
    v_add_u32 v62, v62, v65
    v_add_u32 v63, v63, v66
    v_add_u32 v64, v64, v67
    ds_read_b128 v[156:159], v60 offset:49152
    ds_read_b128 v[140:143], v62
    ds_read_b128 v[144:147], v63
    ds_read_b128 v[148:151], v64
    v_add_u32 v62, v62, v65
    v_add_u32 v63, v63, v66
    v_add_u32 v64, v64, v67
    v_mfma_f32_16x16x32_bf16 v[80:83], v[96:99], v[216:219], v[80:83]
    v_add_f32 v224, s62, v168
    v_add_f32 v225, s62, v169
    v_mfma_f32_16x16x32_bf16 v[84:87], v[100:103], v[216:219], v[84:87]
    v_add_f32 v226, s62, v180
    v_add_f32 v227, s62, v181
    v_mfma_f32_16x16x32_bf16 v[88:91], v[104:107], v[216:219], v[88:91]
    v_rcp_f32 v224, v224
    v_rcp_f32 v225, v225
    v_mfma_f32_16x16x32_bf16 v[92:95], v[108:111], v[216:219], v[92:95]
    v_rcp_f32 v226, v226
    v_rcp_f32 v227, v227
    v_mfma_f32_16x16x32_bf16 v[80:83], v[112:115], v[220:223], v[80:83]
    v_mul_f32 v160, v160, v224
    v_mul_f32 v161, v161, v224
    v_mfma_f32_16x16x32_bf16 v[84:87], v[116:119], v[220:223], v[84:87]
    v_mul_f32 v162, v162, v224
    v_mul_f32 v163, v163, v224
    v_mfma_f32_16x16x32_bf16 v[88:91], v[120:123], v[220:223], v[88:91]
    v_mul_f32 v164, v164, v225
    v_mul_f32 v165, v165, v225
    v_mfma_f32_16x16x32_bf16 v[92:95], v[124:127], v[220:223], v[92:95]
    v_mul_f32 v166, v166, v225
    v_mul_f32 v167, v167, v225
    ds_read_b64_tr_b16 v[96:97], v69 offset:57344
    ds_read_b64_tr_b16 v[98:99], v69 offset:59392
    ds_read_b64_tr_b16 v[100:101], v72 offset:57344
    s_waitcnt lgkmcnt(9)
    v_mfma_f32_16x16x32_bf16 v[184:187], v[128:131], v[152:155], 0
    v_mul_f32 v172, v172, v226
    v_mul_f32 v173, v173, v226
    ds_read_b64_tr_b16 v[102:103], v72 offset:59392
    ds_read_b64_tr_b16 v[104:105], v75 offset:57344
    ds_read_b64_tr_b16 v[106:107], v75 offset:59392
    s_waitcnt lgkmcnt(11)
    v_mfma_f32_16x16x32_bf16 v[188:191], v[132:135], v[152:155], 0
    v_mul_f32 v174, v174, v226
    v_mul_f32 v175, v175, v226
    ds_read_b64_tr_b16 v[108:109], v78 offset:57344
    ds_read_b64_tr_b16 v[110:111], v78 offset:59392
    ds_read_b64_tr_b16 v[112:113], v69 offset:61440
    s_waitcnt lgkmcnt(13)
    v_mfma_f32_16x16x32_bf16 v[192:195], v[136:139], v[152:155], 0
    v_mul_f32 v176, v176, v227
    v_mul_f32 v177, v177, v227
    ds_read_b64_tr_b16 v[114:115], v69 offset:63488
    ds_read_b64_tr_b16 v[116:117], v72 offset:61440
    ds_read_b64_tr_b16 v[118:119], v72 offset:63488
    s_waitcnt lgkmcnt(14)
    v_mfma_f32_16x16x32_bf16 v[196:199], v[140:143], v[156:159], 0
    v_mul_f32 v178, v178, v227
    v_mul_f32 v179, v179, v227
    ds_read_b64_tr_b16 v[120:121], v75 offset:61440
    ds_read_b64_tr_b16 v[122:123], v75 offset:63488
    ds_read_b64_tr_b16 v[124:125], v78 offset:61440
    s_waitcnt lgkmcnt(15)
    v_mfma_f32_16x16x32_bf16 v[200:203], v[144:147], v[156:159], 0
    v_cvt_pk_bf16_f32 v208, v160, v161
    v_cvt_pk_bf16_f32 v209, v162, v163
    ds_read_b64_tr_b16 v[126:127], v78 offset:63488
    v_mfma_f32_16x16x32_bf16 v[204:207], v[148:151], v[156:159], 0
    v_cvt_pk_bf16_f32 v210, v164, v165
    v_cvt_pk_bf16_f32 v211, v166, v167
    v_cvt_pk_bf16_f32 v212, v172, v173
    v_cvt_pk_bf16_f32 v213, v174, v175
    v_cvt_pk_bf16_f32 v214, v176, v177
    v_cvt_pk_bf16_f32 v215, v178, v179
    v_mfma_f32_16x16x32_bf16 v[80:83], v[20:23], v[208:211], v[80:83]
    v_add_f32 v224, s62, v192
    v_add_f32 v225, s62, v193
    v_mfma_f32_16x16x32_bf16 v[84:87], v[24:27], v[208:211], v[84:87]
    v_add_f32 v226, s62, v204
    v_add_f32 v227, s62, v205
    v_mfma_f32_16x16x32_bf16 v[88:91], v[28:31], v[208:211], v[88:91]
    v_rcp_f32 v224, v224
    v_rcp_f32 v225, v225
    v_mfma_f32_16x16x32_bf16 v[92:95], v[32:35], v[208:211], v[92:95]
    v_rcp_f32 v226, v226
    v_rcp_f32 v227, v227
    v_mfma_f32_16x16x32_bf16 v[80:83], v[36:39], v[212:215], v[80:83]
    v_mul_f32 v184, v184, v224
    v_mul_f32 v185, v185, v224
    v_mfma_f32_16x16x32_bf16 v[84:87], v[40:43], v[212:215], v[84:87]
    v_mul_f32 v186, v186, v224
    v_mul_f32 v187, v187, v224
    v_mfma_f32_16x16x32_bf16 v[88:91], v[44:47], v[212:215], v[88:91]
    v_mul_f32 v188, v188, v225
    v_mul_f32 v189, v189, v225
    v_mfma_f32_16x16x32_bf16 v[92:95], v[48:51], v[212:215], v[92:95]
    v_mul_f32 v190, v190, v225
    v_mul_f32 v191, v191, v225
    v_mul_f32 v196, v196, v226
    v_mul_f32 v197, v197, v226
    v_mul_f32 v198, v198, v226
    v_mul_f32 v199, v199, v226
    v_mul_f32 v200, v200, v227
    v_mul_f32 v201, v201, v227
    v_mul_f32 v202, v202, v227
    v_mul_f32 v203, v203, v227
    v_cvt_pk_bf16_f32 v216, v184, v185
    v_cvt_pk_bf16_f32 v217, v186, v187
    v_cvt_pk_bf16_f32 v218, v188, v189
    v_cvt_pk_bf16_f32 v219, v190, v191
    v_cvt_pk_bf16_f32 v220, v196, v197
    v_cvt_pk_bf16_f32 v221, v198, v199
    v_cvt_pk_bf16_f32 v222, v200, v201
    v_cvt_pk_bf16_f32 v223, v202, v203
    s_waitcnt lgkmcnt(14)
    v_mfma_f32_16x16x32_bf16 v[80:83], v[96:99], v[216:219], v[80:83]
    s_waitcnt lgkmcnt(12)
    v_mfma_f32_16x16x32_bf16 v[84:87], v[100:103], v[216:219], v[84:87]
    s_waitcnt lgkmcnt(10)
    v_mfma_f32_16x16x32_bf16 v[88:91], v[104:107], v[216:219], v[88:91]
    s_waitcnt lgkmcnt(8)
    v_mfma_f32_16x16x32_bf16 v[92:95], v[108:111], v[216:219], v[92:95]
    s_waitcnt lgkmcnt(6)
    v_mfma_f32_16x16x32_bf16 v[80:83], v[112:115], v[220:223], v[80:83]
    s_waitcnt lgkmcnt(4)
    v_mfma_f32_16x16x32_bf16 v[84:87], v[116:119], v[220:223], v[84:87]
    s_waitcnt lgkmcnt(2)
    v_mfma_f32_16x16x32_bf16 v[88:91], v[120:123], v[220:223], v[88:91]
    s_waitcnt lgkmcnt(0)
    v_mfma_f32_16x16x32_bf16 v[92:95], v[124:127], v[220:223], v[92:95]
    s_barrier
    v_add_u32 v228, s52, v2
    v_mul_u32_u24 v228, 144, v228
    v_lshl_add_u32 v228, v3, 3, v228
    v_cvt_pk_bf16_f32 v80, v80, v81
    v_cvt_pk_bf16_f32 v81, v82, v83
    ds_write_b64 v228, v[80:81] offset:0
    v_cvt_pk_bf16_f32 v84, v84, v85
    v_cvt_pk_bf16_f32 v85, v86, v87
    ds_write_b64 v228, v[84:85] offset:32
    v_cvt_pk_bf16_f32 v88, v88, v89
    v_cvt_pk_bf16_f32 v89, v90, v91
    ds_write_b64 v228, v[88:89] offset:64
    v_cvt_pk_bf16_f32 v92, v92, v93
    v_cvt_pk_bf16_f32 v93, v94, v95
    ds_write_b64 v228, v[92:93] offset:96
    s_waitcnt lgkmcnt(0)
    s_add_u32 s40, s20, 2097152
    s_addc_u32 s41, s21, 0
    s_and_b32 s41, s41, 0xffff
    s_mov_b32 s42, 2097152
    s_mov_b32 s43, 0x20000
    s_add_u32 s44, s20, 15073280
    s_addc_u32 s45, s21, 0
    s_and_b32 s45, s45, 0xffff
    s_mov_b32 s46, 131072
    s_mov_b32 s47, 0x20000
    s_barrier
    v_lshrrev_b32 v42, 3, v0
    v_and_b32 v43, 7, v0
    v_mul_u32_u24 v32, 144, v42
    v_lshl_add_u32 v32, v43, 4, v32
    ds_read_b128 v[24:27], v32
    ds_read_b128 v[28:31], v32 offset:4608
    v_add_u32 v42, s50, v42
    v_lshlrev_b32 v33, 10, v42
    v_lshl_add_u32 v33, v43, 4, v33
    v_add_u32 v33, s54, v33
    v_mov_b32 v36, 0
    v_mov_b32 v37, 0
    v_mov_b32 v38, 0
    v_mov_b32 v39, 0
    s_mov_b32 s60, 0x3f803f80
    v_lshlrev_b32 v32, 6, v42
    s_lshr_b32 s61, s54, 4
    v_add_u32 v32, s61, v32
    s_waitcnt lgkmcnt(1)
    v_lshlrev_b32 v42, 16, v24
    v_and_b32 v43, 0xffff0000, v24
    s_waitcnt vmcnt(1)
    v_lshlrev_b32 v44, 16, v12
    v_and_b32 v45, 0xffff0000, v12
    v_add_f32 v42, v42, v44
    v_add_f32 v43, v43, v45
    v_cvt_pk_bf16_f32 v24, v42, v43
    v_dot2_f32_bf16 v36, v24, s60, v36
    v_dot2_f32_bf16 v37, v24, v24, v37
    v_lshlrev_b32 v42, 16, v25
    v_and_b32 v43, 0xffff0000, v25
    v_lshlrev_b32 v44, 16, v13
    v_and_b32 v45, 0xffff0000, v13
    v_add_f32 v42, v42, v44
    v_add_f32 v43, v43, v45
    v_cvt_pk_bf16_f32 v25, v42, v43
    v_dot2_f32_bf16 v36, v25, s60, v36
    v_dot2_f32_bf16 v37, v25, v25, v37
    v_lshlrev_b32 v42, 16, v26
    v_and_b32 v43, 0xffff0000, v26
    v_lshlrev_b32 v44, 16, v14
    v_and_b32 v45, 0xffff0000, v14
    v_add_f32 v42, v42, v44
    v_add_f32 v43, v43, v45
    v_cvt_pk_bf16_f32 v26, v42, v43
    v_dot2_f32_bf16 v36, v26, s60, v36
    v_dot2_f32_bf16 v37, v26, v26, v37
    v_lshlrev_b32 v42, 16, v27
    v_and_b32 v43, 0xffff0000, v27
    v_lshlrev_b32 v44, 16, v15
    v_and_b32 v45, 0xffff0000, v15
    v_add_f32 v42, v42, v44
    v_add_f32 v43, v43, v45
    v_cvt_pk_bf16_f32 v27, v42, v43
    v_dot2_f32_bf16 v36, v27, s60, v36
    v_dot2_f32_bf16 v37, v27, v27, v37
    s_waitcnt lgkmcnt(0)
    v_lshlrev_b32 v42, 16, v28
    v_and_b32 v43, 0xffff0000, v28
    s_waitcnt vmcnt(0)
    v_lshlrev_b32 v44, 16, v16
    v_and_b32 v45, 0xffff0000, v16
    v_add_f32 v42, v42, v44
    v_add_f32 v43, v43, v45
    v_cvt_pk_bf16_f32 v28, v42, v43
    v_dot2_f32_bf16 v38, v28, s60, v38
    v_dot2_f32_bf16 v39, v28, v28, v39
    v_lshlrev_b32 v42, 16, v29
    v_and_b32 v43, 0xffff0000, v29
    v_lshlrev_b32 v44, 16, v17
    v_and_b32 v45, 0xffff0000, v17
    v_add_f32 v42, v42, v44
    v_add_f32 v43, v43, v45
    v_cvt_pk_bf16_f32 v29, v42, v43
    v_dot2_f32_bf16 v38, v29, s60, v38
    v_dot2_f32_bf16 v39, v29, v29, v39
    v_lshlrev_b32 v42, 16, v30
    v_and_b32 v43, 0xffff0000, v30
    v_lshlrev_b32 v44, 16, v18
    v_and_b32 v45, 0xffff0000, v18
    v_add_f32 v42, v42, v44
    v_add_f32 v43, v43, v45
    v_cvt_pk_bf16_f32 v30, v42, v43
    v_dot2_f32_bf16 v38, v30, s60, v38
    v_dot2_f32_bf16 v39, v30, v30, v39
    v_lshlrev_b32 v42, 16, v31
    v_and_b32 v43, 0xffff0000, v31
    v_lshlrev_b32 v44, 16, v19
    v_and_b32 v45, 0xffff0000, v19
    v_add_f32 v42, v42, v44
    v_add_f32 v43, v43, v45
    v_cvt_pk_bf16_f32 v31, v42, v43
    v_dot2_f32_bf16 v38, v31, s60, v38
    v_dot2_f32_bf16 v39, v31, v31, v39
    v_add_f32_dpp v40, v36, v36 quad_perm:[1,0,3,2] row_mask:0xf bank_mask:0xf
    v_add_f32_dpp v41, v37, v37 quad_perm:[1,0,3,2] row_mask:0xf bank_mask:0xf
    v_mov_b32 v36, v40
    v_mov_b32 v37, v41
    v_add_f32_dpp v40, v38, v38 quad_perm:[1,0,3,2] row_mask:0xf bank_mask:0xf
    v_add_f32_dpp v41, v39, v39 quad_perm:[1,0,3,2] row_mask:0xf bank_mask:0xf
    v_mov_b32 v38, v40
    v_mov_b32 v39, v41
    v_add_f32_dpp v40, v36, v36 quad_perm:[2,3,0,1] row_mask:0xf bank_mask:0xf
    v_add_f32_dpp v41, v37, v37 quad_perm:[2,3,0,1] row_mask:0xf bank_mask:0xf
    v_mov_b32 v36, v40
    v_mov_b32 v37, v41
    v_add_f32_dpp v40, v38, v38 quad_perm:[2,3,0,1] row_mask:0xf bank_mask:0xf
    v_add_f32_dpp v41, v39, v39 quad_perm:[2,3,0,1] row_mask:0xf bank_mask:0xf
    v_mov_b32 v38, v40
    v_mov_b32 v39, v41
    v_add_f32_dpp v40, v36, v36 row_half_mirror row_mask:0xf bank_mask:0xf
    v_add_f32_dpp v41, v37, v37 row_half_mirror row_mask:0xf bank_mask:0xf
    v_mov_b32 v36, v40
    v_mov_b32 v37, v41
    v_add_f32_dpp v40, v38, v38 row_half_mirror row_mask:0xf bank_mask:0xf
    v_add_f32_dpp v41, v39, v39 row_half_mirror row_mask:0xf bank_mask:0xf
    v_mov_b32 v38, v40
    v_mov_b32 v39, v41
    s_mov_b32 s60, 32768
    v_mov_b32 v8, 148480
    ds_read_b32 v9, v8
    s_waitcnt lgkmcnt(0)
    v_readfirstlane_b32 s99, v9
    s_waitcnt vmcnt(0) lgkmcnt(0)
    s_nop 4
    s_cmp_eq_u32 s99, 1
    s_cbranch_scc0 kB_kernel_st0_slow
    buffer_store_dwordx4 v[24:27], v33, s[40:43], 0 offen
    buffer_store_dwordx4 v[28:31], v33, s[40:43], s60 offen
    buffer_store_dwordx2 v[36:37], v32, s[44:47], 0 offen
    buffer_store_dwordx2 v[38:39], v32, s[44:47], 0 offen offset:2048
    s_branch kB_kernel_st0_done
kB_kernel_st0_slow:
    buffer_store_dwordx4 v[24:27], v33, s[40:43], 0 offen sc0 sc1
    buffer_store_dwordx4 v[28:31], v33, s[40:43], s60 offen sc0 sc1
    buffer_store_dwordx2 v[36:37], v32, s[44:47], 0 offen sc0 sc1
    buffer_store_dwordx2 v[38:39], v32, s[44:47], 0 offen offset:2048 sc0 sc1
kB_kernel_st0_done:
    s_waitcnt vmcnt(0)
    s_barrier
    s_mov_b32 s22, s96
    s_mov_b32 s23, s97
    s_lshl_b32 s50, s22, 7
    s_mul_i32 s54, s23, 224
    s_lshl_b32 s52, s3, 5
    v_lshlrev_b32 v40, 4, v3
    v_add_u32 v40, 154624, v40
    v_add_u32 v5, s52, v2
    v_mul_u32_u24 v5, 128, v5
    v_bfe_u32 v6, v2, 1, 3
    v_xor_b32 v6, v6, v3
    v_xor_b32 v41, 0, v6
    v_lshl_add_u32 v41, v41, 4, v5
    v_xor_b32 v42, 4, v6
    v_lshl_add_u32 v42, v42, 4, v5
    v_bfe_u32 v5, v1, 2, 2
    v_and_b32 v6, 1, v3
    v_lshl_add_u32 v6, v6, 2, v5
    v_lshl_add_u32 v5, v3, 3, v5
    v_lshlrev_b32 v5, 8, v5
    v_and_b32 v7, 3, v1
    v_lshl_add_u32 v5, v7, 3, v5
    v_add_u32 v5, 65536, v5
    v_xor_b32 v7, 0, v6
    v_lshl_add_u32 v43, v7, 5, v5
    v_add_u32 v44, 65536, v43
    v_xor_b32 v7, 1, v6
    v_lshl_add_u32 v45, v7, 5, v5
    v_add_u32 v46, 65536, v45
    v_xor_b32 v7, 2, v6
    v_lshl_add_u32 v47, v7, 5, v5
    v_add_u32 v48, 65536, v47
    v_xor_b32 v7, 3, v6
    v_lshl_add_u32 v49, v7, 5, v5
    v_add_u32 v50, 65536, v49
    v_xor_b32 v7, 4, v6
    v_lshl_add_u32 v51, v7, 5, v5
    v_add_u32 v52, 65536, v51
    v_xor_b32 v7, 5, v6
    v_lshl_add_u32 v53, v7, 5, v5
    v_add_u32 v54, 65536, v53
    v_xor_b32 v7, 6, v6
    v_lshl_add_u32 v55, v7, 5, v5
    v_add_u32 v56, 65536, v55
    v_mov_b32 v60, 0
    v_mov_b32 v61, 0
    v_mov_b32 v62, 0
    v_mov_b32 v63, 0
    v_mov_b32 v64, 0
    v_mov_b32 v65, 0
    v_mov_b32 v66, 0
    v_mov_b32 v67, 0
    v_mov_b32 v68, 0
    v_mov_b32 v69, 0
    v_mov_b32 v70, 0
    v_mov_b32 v71, 0
    v_mov_b32 v72, 0
    v_mov_b32 v73, 0
    v_mov_b32 v74, 0
    v_mov_b32 v75, 0
    v_mov_b32 v76, 0
    v_mov_b32 v77, 0
    v_mov_b32 v78, 0
    v_mov_b32 v79, 0
    v_mov_b32 v80, 0
    v_mov_b32 v81, 0
    v_mov_b32 v82, 0
    v_mov_b32 v83, 0
    v_mov_b32 v84, 0
    v_mov_b32 v85, 0
    v_mov_b32 v86, 0
    v_mov_b32 v87, 0
    v_mov_b32 v88, 0
    v_mov_b32 v89, 0
    v_mov_b32 v90, 0
    v_mov_b32 v91, 0
    v_mov_b32 v92, 0
    v_mov_b32 v93, 0
    v_mov_b32 v94, 0
    v_mov_b32 v95, 0
    v_mov_b32 v96, 0
    v_mov_b32 v97, 0
    v_mov_b32 v98, 0
    v_mov_b32 v99, 0
    v_mov_b32 v100, 0
    v_mov_b32 v101, 0
    v_mov_b32 v102, 0
    v_mov_b32 v103, 0
    v_mov_b32 v104, 0
    v_mov_b32 v105, 0
    v_mov_b32 v106, 0
    v_mov_b32 v107, 0
    v_mov_b32 v108, 0
    v_mov_b32 v109, 0
    v_mov_b32 v110, 0
    v_mov_b32 v111, 0
    v_mov_b32 v112, 0
    v_mov_b32 v113, 0
    v_mov_b32 v114, 0
    v_mov_b32 v115, 0
    v_add_u32 v192, s52, v2
    v_lshlrev_b32 v192, 3, v192
    v_add_u32 v192, 147456, v192
    s_barrier
    ds_read_b128 v[116:119], v41 offset:0
    ds_read_b128 v[120:123], v41 offset:2048
    ds_read_b64_tr_b16 v[132:133], v43 offset:0
    ds_read_b64_tr_b16 v[134:135], v43 offset:1024
    ds_read_b64_tr_b16 v[136:137], v45 offset:0
    ds_read_b64_tr_b16 v[138:139], v45 offset:1024
    ds_read_b64_tr_b16 v[140:141], v47 offset:0
    ds_read_b64_tr_b16 v[142:143], v47 offset:1024
    ds_read_b64_tr_b16 v[144:145], v49 offset:0
    ds_read_b64_tr_b16 v[146:147], v49 offset:1024
    ds_read_b64_tr_b16 v[148:149], v51 offset:0
    ds_read_b64_tr_b16 v[150:151], v51 offset:1024
    ds_read_b64_tr_b16 v[152:153], v53 offset:0
    ds_read_b64_tr_b16 v[154:155], v53 offset:1024
    ds_read_b64_tr_b16 v[156:157], v55 offset:0
    ds_read_b64_tr_b16 v[158:159], v55 offset:1024
    ds_read_b128 v[124:127], v42 offset:0
    ds_read_b128 v[128:131], v42 offset:2048
    s_waitcnt lgkmcnt(14)
    v_mfma_f32_16x16x32_bf16 v[60:63], v[132:135], v[116:119], v[60:63]
    ds_read_b64_tr_b16 v[160:161], v43 offset:8192
    v_mfma_f32_16x16x32_bf16 v[88:91], v[132:135], v[120:123], v[88:91]
    ds_read_b64_tr_b16 v[162:163], v43 offset:9216
    s_waitcnt lgkmcnt(14)
    v_mfma_f32_16x16x32_bf16 v[64:67], v[136:139], v[116:119], v[64:67]
    ds_read_b64_tr_b16 v[164:165], v45 offset:8192
    v_mfma_f32_16x16x32_bf16 v[92:95], v[136:139], v[120:123], v[92:95]
    ds_read_b64_tr_b16 v[166:167], v45 offset:9216
    s_waitcnt lgkmcnt(14)
    v_mfma_f32_16x16x32_bf16 v[68:71], v[140:143], v[116:119], v[68:71]
    ds_read_b64_tr_b16 v[168:169], v47 offset:8192
    v_mfma_f32_16x16x32_bf16 v[96:99], v[140:143], v[120:123], v[96:99]
    ds_read_b64_tr_b16 v[170:171], v47 offset:9216
    s_waitcnt lgkmcnt(14)
    v_mfma_f32_16x16x32_bf16 v[72:75], v[144:147], v[116:119], v[72:75]
    ds_read_b64_tr_b16 v[172:173], v49 offset:8192
    v_mfma_f32_16x16x32_bf16 v[100:103], v[144:147], v[120:123], v[100:103]
    ds_read_b64_tr_b16 v[174:175], v49 offset:9216
    s_waitcnt lgkmcnt(14)
    v_mfma_f32_16x16x32_bf16 v[76:79], v[148:151], v[116:119], v[76:79]
    ds_read_b64_tr_b16 v[176:177], v51 offset:8192
    v_mfma_f32_16x16x32_bf16 v[104:107], v[148:151], v[120:123], v[104:107]
    ds_read_b64_tr_b16 v[178:179], v51 offset:9216
    s_waitcnt lgkmcnt(14)
    v_mfma_f32_16x16x32_bf16 v[80:83], v[152:155], v[116:119], v[80:83]
    ds_read_b64_tr_b16 v[180:181], v53 offset:8192
    v_mfma_f32_16x16x32_bf16 v[108:111], v[152:155], v[120:123], v[108:111]
    ds_read_b64_tr_b16 v[182:183], v53 offset:9216
    s_waitcnt lgkmcnt(14)
    v_mfma_f32_16x16x32_bf16 v[84:87], v[156:159], v[116:119], v[84:87]
    ds_read_b64_tr_b16 v[184:185], v55 offset:8192
    v_mfma_f32_16x16x32_bf16 v[112:115], v[156:159], v[120:123], v[112:115]
    ds_read_b64_tr_b16 v[186:187], v55 offset:9216
    s_waitcnt lgkmcnt(0)
    s_barrier
    ds_read_b128 v[116:119], v41 offset:16384
    ds_read_b128 v[120:123], v41 offset:18432
    v_mfma_f32_16x16x32_bf16 v[60:63], v[160:163], v[124:127], v[60:63]
    ds_read_b64_tr_b16 v[132:133], v43 offset:16384
    v_mfma_f32_16x16x32_bf16 v[88:91], v[160:163], v[128:131], v[88:91]
    ds_read_b64_tr_b16 v[134:135], v43 offset:17408
    v_mfma_f32_16x16x32_bf16 v[64:67], v[164:167], v[124:127], v[64:67]
    ds_read_b64_tr_b16 v[136:137], v45 offset:16384
    v_mfma_f32_16x16x32_bf16 v[92:95], v[164:167], v[128:131], v[92:95]
    ds_read_b64_tr_b16 v[138:139], v45 offset:17408
    v_mfma_f32_16x16x32_bf16 v[68:71], v[168:171], v[124:127], v[68:71]
    ds_read_b64_tr_b16 v[140:141], v47 offset:16384
    v_mfma_f32_16x16x32_bf16 v[96:99], v[168:171], v[128:131], v[96:99]
    ds_read_b64_tr_b16 v[142:143], v47 offset:17408
    v_mfma_f32_16x16x32_bf16 v[72:75], v[172:175], v[124:127], v[72:75]
    ds_read_b64_tr_b16 v[144:145], v49 offset:16384
    v_mfma_f32_16x16x32_bf16 v[100:103], v[172:175], v[128:131], v[100:103]
    ds_read_b64_tr_b16 v[146:147], v49 offset:17408
    v_mfma_f32_16x16x32_bf16 v[76:79], v[176:179], v[124:127], v[76:79]
    ds_read_b64_tr_b16 v[148:149], v51 offset:16384
    v_mfma_f32_16x16x32_bf16 v[104:107], v[176:179], v[128:131], v[104:107]
    ds_read_b64_tr_b16 v[150:151], v51 offset:17408
    v_mfma_f32_16x16x32_bf16 v[80:83], v[180:183], v[124:127], v[80:83]
    ds_read_b64_tr_b16 v[152:153], v53 offset:16384
    v_mfma_f32_16x16x32_bf16 v[108:111], v[180:183], v[128:131], v[108:111]
    ds_read_b64_tr_b16 v[154:155], v53 offset:17408
    v_mfma_f32_16x16x32_bf16 v[84:87], v[184:187], v[124:127], v[84:87]
    ds_read_b64_tr_b16 v[156:157], v55 offset:16384
    v_mfma_f32_16x16x32_bf16 v[112:115], v[184:187], v[128:131], v[112:115]
    ds_read_b64_tr_b16 v[158:159], v55 offset:17408
    ds_read_b128 v[124:127], v42 offset:16384
    ds_read_b128 v[128:131], v42 offset:18432
    s_waitcnt lgkmcnt(14)
    v_mfma_f32_16x16x32_bf16 v[60:63], v[132:135], v[116:119], v[60:63]
    ds_read_b64_tr_b16 v[160:161], v43 offset:24576
    v_mfma_f32_16x16x32_bf16 v[88:91], v[132:135], v[120:123], v[88:91]
    ds_read_b64_tr_b16 v[162:163], v43 offset:25600
    s_waitcnt lgkmcnt(14)
    v_mfma_f32_16x16x32_bf16 v[64:67], v[136:139], v[116:119], v[64:67]
    ds_read_b64_tr_b16 v[164:165], v45 offset:24576
    v_mfma_f32_16x16x32_bf16 v[92:95], v[136:139], v[120:123], v[92:95]
    ds_read_b64_tr_b16 v[166:167], v45 offset:25600
    s_waitcnt lgkmcnt(14)
    v_mfma_f32_16x16x32_bf16 v[68:71], v[140:143], v[116:119], v[68:71]
    ds_read_b64_tr_b16 v[168:169], v47 offset:24576
    v_mfma_f32_16x16x32_bf16 v[96:99], v[140:143], v[120:123], v[96:99]
    ds_read_b64_tr_b16 v[170:171], v47 offset:25600
    s_waitcnt lgkmcnt(14)
    v_mfma_f32_16x16x32_bf16 v[72:75], v[144:147], v[116:119], v[72:75]
    ds_read_b64_tr_b16 v[172:173], v49 offset:24576
    v_mfma_f32_16x16x32_bf16 v[100:103], v[144:147], v[120:123], v[100:103]
    ds_read_b64_tr_b16 v[174:175], v49 offset:25600
    s_waitcnt lgkmcnt(14)
    v_mfma_f32_16x16x32_bf16 v[76:79], v[148:151], v[116:119], v[76:79]
    ds_read_b64_tr_b16 v[176:177], v51 offset:24576
    v_mfma_f32_16x16x32_bf16 v[104:107], v[148:151], v[120:123], v[104:107]
    ds_read_b64_tr_b16 v[178:179], v51 offset:25600
    s_waitcnt lgkmcnt(14)
    v_mfma_f32_16x16x32_bf16 v[80:83], v[152:155], v[116:119], v[80:83]
    ds_read_b64_tr_b16 v[180:181], v53 offset:24576
    v_mfma_f32_16x16x32_bf16 v[108:111], v[152:155], v[120:123], v[108:111]
    ds_read_b64_tr_b16 v[182:183], v53 offset:25600
    s_waitcnt lgkmcnt(14)
    v_mfma_f32_16x16x32_bf16 v[84:87], v[156:159], v[116:119], v[84:87]
    ds_read_b64_tr_b16 v[184:185], v55 offset:24576
    v_mfma_f32_16x16x32_bf16 v[112:115], v[156:159], v[120:123], v[112:115]
    ds_read_b64_tr_b16 v[186:187], v55 offset:25600
    s_waitcnt lgkmcnt(0)
    s_barrier
    ds_read_b128 v[116:119], v41 offset:32768
    ds_read_b128 v[120:123], v41 offset:34816
    v_mfma_f32_16x16x32_bf16 v[60:63], v[160:163], v[124:127], v[60:63]
    ds_read_b64_tr_b16 v[132:133], v43 offset:32768
    v_mfma_f32_16x16x32_bf16 v[88:91], v[160:163], v[128:131], v[88:91]
    ds_read_b64_tr_b16 v[134:135], v43 offset:33792
    v_mfma_f32_16x16x32_bf16 v[64:67], v[164:167], v[124:127], v[64:67]
    ds_read_b64_tr_b16 v[136:137], v45 offset:32768
    v_mfma_f32_16x16x32_bf16 v[92:95], v[164:167], v[128:131], v[92:95]
    ds_read_b64_tr_b16 v[138:139], v45 offset:33792
    v_mfma_f32_16x16x32_bf16 v[68:71], v[168:171], v[124:127], v[68:71]
    ds_read_b64_tr_b16 v[140:141], v47 offset:32768
    v_mfma_f32_16x16x32_bf16 v[96:99], v[168:171], v[128:131], v[96:99]
    ds_read_b64_tr_b16 v[142:143], v47 offset:33792
    v_mfma_f32_16x16x32_bf16 v[72:75], v[172:175], v[124:127], v[72:75]
    ds_read_b64_tr_b16 v[144:145], v49 offset:32768
    v_mfma_f32_16x16x32_bf16 v[100:103], v[172:175], v[128:131], v[100:103]
    ds_read_b64_tr_b16 v[146:147], v49 offset:33792
    v_mfma_f32_16x16x32_bf16 v[76:79], v[176:179], v[124:127], v[76:79]
    ds_read_b64_tr_b16 v[148:149], v51 offset:32768
    v_mfma_f32_16x16x32_bf16 v[104:107], v[176:179], v[128:131], v[104:107]
    ds_read_b64_tr_b16 v[150:151], v51 offset:33792
    v_mfma_f32_16x16x32_bf16 v[80:83], v[180:183], v[124:127], v[80:83]
    ds_read_b64_tr_b16 v[152:153], v53 offset:32768
    v_mfma_f32_16x16x32_bf16 v[108:111], v[180:183], v[128:131], v[108:111]
    ds_read_b64_tr_b16 v[154:155], v53 offset:33792
    v_mfma_f32_16x16x32_bf16 v[84:87], v[184:187], v[124:127], v[84:87]
    ds_read_b64_tr_b16 v[156:157], v55 offset:32768
    v_mfma_f32_16x16x32_bf16 v[112:115], v[184:187], v[128:131], v[112:115]
    ds_read_b64_tr_b16 v[158:159], v55 offset:33792
    ds_read_b128 v[124:127], v42 offset:32768
    ds_read_b128 v[128:131], v42 offset:34816
    s_waitcnt lgkmcnt(14)
    v_mfma_f32_16x16x32_bf16 v[60:63], v[132:135], v[116:119], v[60:63]
    ds_read_b64_tr_b16 v[160:161], v43 offset:40960
    v_mfma_f32_16x16x32_bf16 v[88:91], v[132:135], v[120:123], v[88:91]
    ds_read_b64_tr_b16 v[162:163], v43 offset:41984
    s_waitcnt lgkmcnt(14)
    v_mfma_f32_16x16x32_bf16 v[64:67], v[136:139], v[116:119], v[64:67]
    ds_read_b64_tr_b16 v[164:165], v45 offset:40960
    v_mfma_f32_16x16x32_bf16 v[92:95], v[136:139], v[120:123], v[92:95]
    ds_read_b64_tr_b16 v[166:167], v45 offset:41984
    s_waitcnt lgkmcnt(14)
    v_mfma_f32_16x16x32_bf16 v[68:71], v[140:143], v[116:119], v[68:71]
    ds_read_b64_tr_b16 v[168:169], v47 offset:40960
    v_mfma_f32_16x16x32_bf16 v[96:99], v[140:143], v[120:123], v[96:99]
    ds_read_b64_tr_b16 v[170:171], v47 offset:41984
    s_waitcnt lgkmcnt(14)
    v_mfma_f32_16x16x32_bf16 v[72:75], v[144:147], v[116:119], v[72:75]
    ds_read_b64_tr_b16 v[172:173], v49 offset:40960
    v_mfma_f32_16x16x32_bf16 v[100:103], v[144:147], v[120:123], v[100:103]
    ds_read_b64_tr_b16 v[174:175], v49 offset:41984
    s_waitcnt lgkmcnt(14)
    v_mfma_f32_16x16x32_bf16 v[76:79], v[148:151], v[116:119], v[76:79]
    ds_read_b64_tr_b16 v[176:177], v51 offset:40960
    v_mfma_f32_16x16x32_bf16 v[104:107], v[148:151], v[120:123], v[104:107]
    ds_read_b64_tr_b16 v[178:179], v51 offset:41984
    s_waitcnt lgkmcnt(14)
    v_mfma_f32_16x16x32_bf16 v[80:83], v[152:155], v[116:119], v[80:83]
    ds_read_b64_tr_b16 v[180:181], v53 offset:40960
    v_mfma_f32_16x16x32_bf16 v[108:111], v[152:155], v[120:123], v[108:111]
    ds_read_b64_tr_b16 v[182:183], v53 offset:41984
    s_waitcnt lgkmcnt(14)
    v_mfma_f32_16x16x32_bf16 v[84:87], v[156:159], v[116:119], v[84:87]
    ds_read_b64_tr_b16 v[184:185], v55 offset:40960
    v_mfma_f32_16x16x32_bf16 v[112:115], v[156:159], v[120:123], v[112:115]
    ds_read_b64_tr_b16 v[186:187], v55 offset:41984
    s_waitcnt lgkmcnt(0)
    s_barrier
    ds_read_b128 v[116:119], v41 offset:49152
    ds_read_b128 v[120:123], v41 offset:51200
    v_mfma_f32_16x16x32_bf16 v[60:63], v[160:163], v[124:127], v[60:63]
    ds_read_b64_tr_b16 v[132:133], v43 offset:49152
    v_mfma_f32_16x16x32_bf16 v[88:91], v[160:163], v[128:131], v[88:91]
    ds_read_b64_tr_b16 v[134:135], v43 offset:50176
    v_mfma_f32_16x16x32_bf16 v[64:67], v[164:167], v[124:127], v[64:67]
    ds_read_b64_tr_b16 v[136:137], v45 offset:49152
    v_mfma_f32_16x16x32_bf16 v[92:95], v[164:167], v[128:131], v[92:95]
    ds_read_b64_tr_b16 v[138:139], v45 offset:50176
    v_mfma_f32_16x16x32_bf16 v[68:71], v[168:171], v[124:127], v[68:71]
    ds_read_b64_tr_b16 v[140:141], v47 offset:49152
    v_mfma_f32_16x16x32_bf16 v[96:99], v[168:171], v[128:131], v[96:99]
    ds_read_b64_tr_b16 v[142:143], v47 offset:50176
    v_mfma_f32_16x16x32_bf16 v[72:75], v[172:175], v[124:127], v[72:75]
    ds_read_b64_tr_b16 v[144:145], v49 offset:49152
    v_mfma_f32_16x16x32_bf16 v[100:103], v[172:175], v[128:131], v[100:103]
    ds_read_b64_tr_b16 v[146:147], v49 offset:50176
    v_mfma_f32_16x16x32_bf16 v[76:79], v[176:179], v[124:127], v[76:79]
    ds_read_b64_tr_b16 v[148:149], v51 offset:49152
    v_mfma_f32_16x16x32_bf16 v[104:107], v[176:179], v[128:131], v[104:107]
    ds_read_b64_tr_b16 v[150:151], v51 offset:50176
    v_mfma_f32_16x16x32_bf16 v[80:83], v[180:183], v[124:127], v[80:83]
    ds_read_b64_tr_b16 v[152:153], v53 offset:49152
    v_mfma_f32_16x16x32_bf16 v[108:111], v[180:183], v[128:131], v[108:111]
    ds_read_b64_tr_b16 v[154:155], v53 offset:50176
    v_mfma_f32_16x16x32_bf16 v[84:87], v[184:187], v[124:127], v[84:87]
    ds_read_b64_tr_b16 v[156:157], v55 offset:49152
    v_mfma_f32_16x16x32_bf16 v[112:115], v[184:187], v[128:131], v[112:115]
    ds_read_b64_tr_b16 v[158:159], v55 offset:50176
    ds_read_b128 v[124:127], v42 offset:49152
    ds_read_b128 v[128:131], v42 offset:51200
    s_waitcnt lgkmcnt(14)
    v_mfma_f32_16x16x32_bf16 v[60:63], v[132:135], v[116:119], v[60:63]
    ds_read_b64_tr_b16 v[160:161], v43 offset:57344
    v_mfma_f32_16x16x32_bf16 v[88:91], v[132:135], v[120:123], v[88:91]
    ds_read_b64_tr_b16 v[162:163], v43 offset:58368
    s_waitcnt lgkmcnt(14)
    v_mfma_f32_16x16x32_bf16 v[64:67], v[136:139], v[116:119], v[64:67]
    ds_read_b64_tr_b16 v[164:165], v45 offset:57344
    v_mfma_f32_16x16x32_bf16 v[92:95], v[136:139], v[120:123], v[92:95]
    ds_read_b64_tr_b16 v[166:167], v45 offset:58368
    s_waitcnt lgkmcnt(14)
    v_mfma_f32_16x16x32_bf16 v[68:71], v[140:143], v[116:119], v[68:71]
    ds_read_b64_tr_b16 v[168:169], v47 offset:57344
    v_mfma_f32_16x16x32_bf16 v[96:99], v[140:143], v[120:123], v[96:99]
    ds_read_b64_tr_b16 v[170:171], v47 offset:58368
    s_waitcnt lgkmcnt(14)
    v_mfma_f32_16x16x32_bf16 v[72:75], v[144:147], v[116:119], v[72:75]
    ds_read_b64_tr_b16 v[172:173], v49 offset:57344
    v_mfma_f32_16x16x32_bf16 v[100:103], v[144:147], v[120:123], v[100:103]
    ds_read_b64_tr_b16 v[174:175], v49 offset:58368
    s_waitcnt lgkmcnt(14)
    v_mfma_f32_16x16x32_bf16 v[76:79], v[148:151], v[116:119], v[76:79]
    ds_read_b64_tr_b16 v[176:177], v51 offset:57344
    v_mfma_f32_16x16x32_bf16 v[104:107], v[148:151], v[120:123], v[104:107]
    ds_read_b64_tr_b16 v[178:179], v51 offset:58368
    s_waitcnt lgkmcnt(14)
    v_mfma_f32_16x16x32_bf16 v[80:83], v[152:155], v[116:119], v[80:83]
    ds_read_b64_tr_b16 v[180:181], v53 offset:57344
    v_mfma_f32_16x16x32_bf16 v[108:111], v[152:155], v[120:123], v[108:111]
    ds_read_b64_tr_b16 v[182:183], v53 offset:58368
    s_waitcnt lgkmcnt(14)
    v_mfma_f32_16x16x32_bf16 v[84:87], v[156:159], v[116:119], v[84:87]
    ds_read_b64_tr_b16 v[184:185], v55 offset:57344
    v_mfma_f32_16x16x32_bf16 v[112:115], v[156:159], v[120:123], v[112:115]
    ds_read_b64_tr_b16 v[186:187], v55 offset:58368
    s_waitcnt lgkmcnt(0)
    s_barrier
    ds_read_b128 v[116:119], v41 offset:0
    ds_read_b128 v[120:123], v41 offset:2048
    v_mfma_f32_16x16x32_bf16 v[60:63], v[160:163], v[124:127], v[60:63]
    ds_read_b64_tr_b16 v[132:133], v44 offset:0
    v_mfma_f32_16x16x32_bf16 v[88:91], v[160:163], v[128:131], v[88:91]
    ds_read_b64_tr_b16 v[134:135], v44 offset:1024
    v_mfma_f32_16x16x32_bf16 v[64:67], v[164:167], v[124:127], v[64:67]
    ds_read_b64_tr_b16 v[136:137], v46 offset:0
    v_mfma_f32_16x16x32_bf16 v[92:95], v[164:167], v[128:131], v[92:95]
    ds_read_b64_tr_b16 v[138:139], v46 offset:1024
    v_mfma_f32_16x16x32_bf16 v[68:71], v[168:171], v[124:127], v[68:71]
    ds_read_b64_tr_b16 v[140:141], v48 offset:0
    v_mfma_f32_16x16x32_bf16 v[96:99], v[168:171], v[128:131], v[96:99]
    ds_read_b64_tr_b16 v[142:143], v48 offset:1024
    v_mfma_f32_16x16x32_bf16 v[72:75], v[172:175], v[124:127], v[72:75]
    ds_read_b64_tr_b16 v[144:145], v50 offset:0
    v_mfma_f32_16x16x32_bf16 v[100:103], v[172:175], v[128:131], v[100:103]
    ds_read_b64_tr_b16 v[146:147], v50 offset:1024
    v_mfma_f32_16x16x32_bf16 v[76:79], v[176:179], v[124:127], v[76:79]
    ds_read_b64_tr_b16 v[148:149], v52 offset:0
    v_mfma_f32_16x16x32_bf16 v[104:107], v[176:179], v[128:131], v[104:107]
    ds_read_b64_tr_b16 v[150:151], v52 offset:1024
    v_mfma_f32_16x16x32_bf16 v[80:83], v[180:183], v[124:127], v[80:83]
    ds_read_b64_tr_b16 v[152:153], v54 offset:0
    v_mfma_f32_16x16x32_bf16 v[108:111], v[180:183], v[128:131], v[108:111]
    ds_read_b64_tr_b16 v[154:155], v54 offset:1024
    v_mfma_f32_16x16x32_bf16 v[84:87], v[184:187], v[124:127], v[84:87]
    ds_read_b64_tr_b16 v[156:157], v56 offset:0
    v_mfma_f32_16x16x32_bf16 v[112:115], v[184:187], v[128:131], v[112:115]
    ds_read_b64_tr_b16 v[158:159], v56 offset:1024
    ds_read_b128 v[124:127], v42 offset:0
    ds_read_b128 v[128:131], v42 offset:2048
    s_waitcnt lgkmcnt(14)
    v_mfma_f32_16x16x32_bf16 v[60:63], v[132:135], v[116:119], v[60:63]
    ds_read_b64_tr_b16 v[160:161], v44 offset:8192
    v_mfma_f32_16x16x32_bf16 v[88:91], v[132:135], v[120:123], v[88:91]
    ds_read_b64_tr_b16 v[162:163], v44 offset:9216
    s_waitcnt lgkmcnt(14)
    v_mfma_f32_16x16x32_bf16 v[64:67], v[136:139], v[116:119], v[64:67]
    ds_read_b64_tr_b16 v[164:165], v46 offset:8192
    v_mfma_f32_16x16x32_bf16 v[92:95], v[136:139], v[120:123], v[92:95]
    ds_read_b64_tr_b16 v[166:167], v46 offset:9216
    s_waitcnt lgkmcnt(14)
    v_mfma_f32_16x16x32_bf16 v[68:71], v[140:143], v[116:119], v[68:71]
    ds_read_b64_tr_b16 v[168:169], v48 offset:8192
    v_mfma_f32_16x16x32_bf16 v[96:99], v[140:143], v[120:123], v[96:99]
    ds_read_b64_tr_b16 v[170:171], v48 offset:9216
    s_waitcnt lgkmcnt(14)
    v_mfma_f32_16x16x32_bf16 v[72:75], v[144:147], v[116:119], v[72:75]
    ds_read_b64_tr_b16 v[172:173], v50 offset:8192
    v_mfma_f32_16x16x32_bf16 v[100:103], v[144:147], v[120:123], v[100:103]
    ds_read_b64_tr_b16 v[174:175], v50 offset:9216
    s_waitcnt lgkmcnt(14)
    v_mfma_f32_16x16x32_bf16 v[76:79], v[148:151], v[116:119], v[76:79]
    ds_read_b64_tr_b16 v[176:177], v52 offset:8192
    v_mfma_f32_16x16x32_bf16 v[104:107], v[148:151], v[120:123], v[104:107]
    ds_read_b64_tr_b16 v[178:179], v52 offset:9216
    s_waitcnt lgkmcnt(14)
    v_mfma_f32_16x16x32_bf16 v[80:83], v[152:155], v[116:119], v[80:83]
    ds_read_b64_tr_b16 v[180:181], v54 offset:8192
    v_mfma_f32_16x16x32_bf16 v[108:111], v[152:155], v[120:123], v[108:111]
    ds_read_b64_tr_b16 v[182:183], v54 offset:9216
    s_waitcnt lgkmcnt(14)
    v_mfma_f32_16x16x32_bf16 v[84:87], v[156:159], v[116:119], v[84:87]
    ds_read_b64_tr_b16 v[184:185], v56 offset:8192
    v_mfma_f32_16x16x32_bf16 v[112:115], v[156:159], v[120:123], v[112:115]
    ds_read_b64_tr_b16 v[186:187], v56 offset:9216
    s_waitcnt lgkmcnt(0)
    s_barrier
    ds_read_b128 v[116:119], v41 offset:16384
    ds_read_b128 v[120:123], v41 offset:18432
    v_mfma_f32_16x16x32_bf16 v[60:63], v[160:163], v[124:127], v[60:63]
    ds_read_b64_tr_b16 v[132:133], v43 offset:0
    v_mfma_f32_16x16x32_bf16 v[88:91], v[160:163], v[128:131], v[88:91]
    ds_read_b64_tr_b16 v[134:135], v43 offset:1024
    v_mfma_f32_16x16x32_bf16 v[64:67], v[164:167], v[124:127], v[64:67]
    ds_read_b64_tr_b16 v[136:137], v45 offset:0
    v_mfma_f32_16x16x32_bf16 v[92:95], v[164:167], v[128:131], v[92:95]
    ds_read_b64_tr_b16 v[138:139], v45 offset:1024
    v_mfma_f32_16x16x32_bf16 v[68:71], v[168:171], v[124:127], v[68:71]
    ds_read_b64_tr_b16 v[140:141], v47 offset:0
    v_mfma_f32_16x16x32_bf16 v[96:99], v[168:171], v[128:131], v[96:99]
    ds_read_b64_tr_b16 v[142:143], v47 offset:1024
    v_mfma_f32_16x16x32_bf16 v[72:75], v[172:175], v[124:127], v[72:75]
    ds_read_b64_tr_b16 v[144:145], v49 offset:0
    v_mfma_f32_16x16x32_bf16 v[100:103], v[172:175], v[128:131], v[100:103]
    ds_read_b64_tr_b16 v[146:147], v49 offset:1024
    v_mfma_f32_16x16x32_bf16 v[76:79], v[176:179], v[124:127], v[76:79]
    ds_read_b64_tr_b16 v[148:149], v51 offset:0
    v_mfma_f32_16x16x32_bf16 v[104:107], v[176:179], v[128:131], v[104:107]
    ds_read_b64_tr_b16 v[150:151], v51 offset:1024
    v_mfma_f32_16x16x32_bf16 v[80:83], v[180:183], v[124:127], v[80:83]
    ds_read_b64_tr_b16 v[152:153], v53 offset:0
    v_mfma_f32_16x16x32_bf16 v[108:111], v[180:183], v[128:131], v[108:111]
    ds_read_b64_tr_b16 v[154:155], v53 offset:1024
    v_mfma_f32_16x16x32_bf16 v[84:87], v[184:187], v[124:127], v[84:87]
    ds_read_b64_tr_b16 v[156:157], v55 offset:0
    v_mfma_f32_16x16x32_bf16 v[112:115], v[184:187], v[128:131], v[112:115]
    ds_read_b64_tr_b16 v[158:159], v55 offset:1024
    ds_read_b128 v[124:127], v42 offset:16384
    ds_read_b128 v[128:131], v42 offset:18432
    s_waitcnt lgkmcnt(14)
    v_mfma_f32_16x16x32_bf16 v[60:63], v[132:135], v[116:119], v[60:63]
    ds_read_b64_tr_b16 v[160:161], v43 offset:8192
    v_mfma_f32_16x16x32_bf16 v[88:91], v[132:135], v[120:123], v[88:91]
    ds_read_b64_tr_b16 v[162:163], v43 offset:9216
    s_waitcnt lgkmcnt(14)
    v_mfma_f32_16x16x32_bf16 v[64:67], v[136:139], v[116:119], v[64:67]
    ds_read_b64_tr_b16 v[164:165], v45 offset:8192
    v_mfma_f32_16x16x32_bf16 v[92:95], v[136:139], v[120:123], v[92:95]
    ds_read_b64_tr_b16 v[166:167], v45 offset:9216
    s_waitcnt lgkmcnt(14)
    v_mfma_f32_16x16x32_bf16 v[68:71], v[140:143], v[116:119], v[68:71]
    ds_read_b64_tr_b16 v[168:169], v47 offset:8192
    v_mfma_f32_16x16x32_bf16 v[96:99], v[140:143], v[120:123], v[96:99]
    ds_read_b64_tr_b16 v[170:171], v47 offset:9216
    s_waitcnt lgkmcnt(14)
    v_mfma_f32_16x16x32_bf16 v[72:75], v[144:147], v[116:119], v[72:75]
    ds_read_b64_tr_b16 v[172:173], v49 offset:8192
    v_mfma_f32_16x16x32_bf16 v[100:103], v[144:147], v[120:123], v[100:103]
    ds_read_b64_tr_b16 v[174:175], v49 offset:9216
    s_waitcnt lgkmcnt(14)
    v_mfma_f32_16x16x32_bf16 v[76:79], v[148:151], v[116:119], v[76:79]
    ds_read_b64_tr_b16 v[176:177], v51 offset:8192
    v_mfma_f32_16x16x32_bf16 v[104:107], v[148:151], v[120:123], v[104:107]
    ds_read_b64_tr_b16 v[178:179], v51 offset:9216
    s_waitcnt lgkmcnt(14)
    v_mfma_f32_16x16x32_bf16 v[80:83], v[152:155], v[116:119], v[80:83]
    ds_read_b64_tr_b16 v[180:181], v53 offset:8192
    v_mfma_f32_16x16x32_bf16 v[108:111], v[152:155], v[120:123], v[108:111]
    ds_read_b64_tr_b16 v[182:183], v53 offset:9216
    s_waitcnt lgkmcnt(14)
    v_mfma_f32_16x16x32_bf16 v[84:87], v[156:159], v[116:119], v[84:87]
    ds_read_b64_tr_b16 v[184:185], v55 offset:8192
    v_mfma_f32_16x16x32_bf16 v[112:115], v[156:159], v[120:123], v[112:115]
    ds_read_b64_tr_b16 v[186:187], v55 offset:9216
    s_waitcnt lgkmcnt(0)
    s_barrier
    ds_read_b128 v[116:119], v41 offset:32768
    ds_read_b128 v[120:123], v41 offset:34816
    v_mfma_f32_16x16x32_bf16 v[60:63], v[160:163], v[124:127], v[60:63]
    ds_read_b64_tr_b16 v[132:133], v43 offset:16384
    v_mfma_f32_16x16x32_bf16 v[88:91], v[160:163], v[128:131], v[88:91]
    ds_read_b64_tr_b16 v[134:135], v43 offset:17408
    v_mfma_f32_16x16x32_bf16 v[64:67], v[164:167], v[124:127], v[64:67]
    ds_read_b64_tr_b16 v[136:137], v45 offset:16384
    v_mfma_f32_16x16x32_bf16 v[92:95], v[164:167], v[128:131], v[92:95]
    ds_read_b64_tr_b16 v[138:139], v45 offset:17408
    v_mfma_f32_16x16x32_bf16 v[68:71], v[168:171], v[124:127], v[68:71]
    ds_read_b64_tr_b16 v[140:141], v47 offset:16384
    v_mfma_f32_16x16x32_bf16 v[96:99], v[168:171], v[128:131], v[96:99]
    ds_read_b64_tr_b16 v[142:143], v47 offset:17408
    v_mfma_f32_16x16x32_bf16 v[72:75], v[172:175], v[124:127], v[72:75]
    ds_read_b64_tr_b16 v[144:145], v49 offset:16384
    v_mfma_f32_16x16x32_bf16 v[100:103], v[172:175], v[128:131], v[100:103]
    ds_read_b64_tr_b16 v[146:147], v49 offset:17408
    v_mfma_f32_16x16x32_bf16 v[76:79], v[176:179], v[124:127], v[76:79]
    ds_read_b64_tr_b16 v[148:149], v51 offset:16384
    v_mfma_f32_16x16x32_bf16 v[104:107], v[176:179], v[128:131], v[104:107]
    ds_read_b64_tr_b16 v[150:151], v51 offset:17408
    v_mfma_f32_16x16x32_bf16 v[80:83], v[180:183], v[124:127], v[80:83]
    ds_read_b64_tr_b16 v[152:153], v53 offset:16384
    v_mfma_f32_16x16x32_bf16 v[108:111], v[180:183], v[128:131], v[108:111]
    ds_read_b64_tr_b16 v[154:155], v53 offset:17408
    v_mfma_f32_16x16x32_bf16 v[84:87], v[184:187], v[124:127], v[84:87]
    ds_read_b64_tr_b16 v[156:157], v55 offset:16384
    v_mfma_f32_16x16x32_bf16 v[112:115], v[184:187], v[128:131], v[112:115]
    ds_read_b64_tr_b16 v[158:159], v55 offset:17408
    ds_read_b128 v[124:127], v42 offset:32768
    ds_read_b128 v[128:131], v42 offset:34816
    s_waitcnt lgkmcnt(14)
    v_mfma_f32_16x16x32_bf16 v[60:63], v[132:135], v[116:119], v[60:63]
    ds_read_b64_tr_b16 v[160:161], v43 offset:24576
    v_mfma_f32_16x16x32_bf16 v[88:91], v[132:135], v[120:123], v[88:91]
    ds_read_b64_tr_b16 v[162:163], v43 offset:25600
    s_waitcnt lgkmcnt(14)
    v_mfma_f32_16x16x32_bf16 v[64:67], v[136:139], v[116:119], v[64:67]
    ds_read_b64_tr_b16 v[164:165], v45 offset:24576
    v_mfma_f32_16x16x32_bf16 v[92:95], v[136:139], v[120:123], v[92:95]
    ds_read_b64_tr_b16 v[166:167], v45 offset:25600
    s_waitcnt lgkmcnt(14)
    v_mfma_f32_16x16x32_bf16 v[68:71], v[140:143], v[116:119], v[68:71]
    ds_read_b64_tr_b16 v[168:169], v47 offset:24576
    v_mfma_f32_16x16x32_bf16 v[96:99], v[140:143], v[120:123], v[96:99]
    ds_read_b64_tr_b16 v[170:171], v47 offset:25600
    s_waitcnt lgkmcnt(14)
    v_mfma_f32_16x16x32_bf16 v[72:75], v[144:147], v[116:119], v[72:75]
    ds_read_b64_tr_b16 v[172:173], v49 offset:24576
    v_mfma_f32_16x16x32_bf16 v[100:103], v[144:147], v[120:123], v[100:103]
    ds_read_b64_tr_b16 v[174:175], v49 offset:25600
    s_waitcnt lgkmcnt(14)
    v_mfma_f32_16x16x32_bf16 v[76:79], v[148:151], v[116:119], v[76:79]
    ds_read_b64_tr_b16 v[176:177], v51 offset:24576
    v_mfma_f32_16x16x32_bf16 v[104:107], v[148:151], v[120:123], v[104:107]
    ds_read_b64_tr_b16 v[178:179], v51 offset:25600
    s_waitcnt lgkmcnt(14)
    v_mfma_f32_16x16x32_bf16 v[80:83], v[152:155], v[116:119], v[80:83]
    ds_read_b64_tr_b16 v[180:181], v53 offset:24576
    v_mfma_f32_16x16x32_bf16 v[108:111], v[152:155], v[120:123], v[108:111]
    ds_read_b64_tr_b16 v[182:183], v53 offset:25600
    s_waitcnt lgkmcnt(14)
    v_mfma_f32_16x16x32_bf16 v[84:87], v[156:159], v[116:119], v[84:87]
    ds_read_b64_tr_b16 v[184:185], v55 offset:24576
    v_mfma_f32_16x16x32_bf16 v[112:115], v[156:159], v[120:123], v[112:115]
    ds_read_b64_tr_b16 v[186:187], v55 offset:25600
    s_waitcnt lgkmcnt(0)
    s_barrier
    ds_read_b128 v[116:119], v41 offset:49152
    ds_read_b128 v[120:123], v41 offset:51200
    v_mfma_f32_16x16x32_bf16 v[60:63], v[160:163], v[124:127], v[60:63]
    ds_read_b64_tr_b16 v[132:133], v43 offset:32768
    v_mfma_f32_16x16x32_bf16 v[88:91], v[160:163], v[128:131], v[88:91]
    ds_read_b64_tr_b16 v[134:135], v43 offset:33792
    v_mfma_f32_16x16x32_bf16 v[64:67], v[164:167], v[124:127], v[64:67]
    ds_read_b64_tr_b16 v[136:137], v45 offset:32768
    v_mfma_f32_16x16x32_bf16 v[92:95], v[164:167], v[128:131], v[92:95]
    ds_read_b64_tr_b16 v[138:139], v45 offset:33792
    v_mfma_f32_16x16x32_bf16 v[68:71], v[168:171], v[124:127], v[68:71]
    ds_read_b64_tr_b16 v[140:141], v47 offset:32768
    v_mfma_f32_16x16x32_bf16 v[96:99], v[168:171], v[128:131], v[96:99]
    ds_read_b64_tr_b16 v[142:143], v47 offset:33792
    v_mfma_f32_16x16x32_bf16 v[72:75], v[172:175], v[124:127], v[72:75]
    ds_read_b64_tr_b16 v[144:145], v49 offset:32768
    v_mfma_f32_16x16x32_bf16 v[100:103], v[172:175], v[128:131], v[100:103]
    ds_read_b64_tr_b16 v[146:147], v49 offset:33792
    v_mfma_f32_16x16x32_bf16 v[76:79], v[176:179], v[124:127], v[76:79]
    ds_read_b64_tr_b16 v[148:149], v51 offset:32768
    v_mfma_f32_16x16x32_bf16 v[104:107], v[176:179], v[128:131], v[104:107]
    ds_read_b64_tr_b16 v[150:151], v51 offset:33792
    v_mfma_f32_16x16x32_bf16 v[80:83], v[180:183], v[124:127], v[80:83]
    ds_read_b64_tr_b16 v[152:153], v53 offset:32768
    v_mfma_f32_16x16x32_bf16 v[108:111], v[180:183], v[128:131], v[108:111]
    ds_read_b64_tr_b16 v[154:155], v53 offset:33792
    v_mfma_f32_16x16x32_bf16 v[84:87], v[184:187], v[124:127], v[84:87]
    ds_read_b64_tr_b16 v[156:157], v55 offset:32768
    v_mfma_f32_16x16x32_bf16 v[112:115], v[184:187], v[128:131], v[112:115]
    ds_read_b64_tr_b16 v[158:159], v55 offset:33792
    ds_read_b128 v[124:127], v42 offset:49152
    ds_read_b128 v[128:131], v42 offset:51200
    s_waitcnt lgkmcnt(14)
    v_mfma_f32_16x16x32_bf16 v[60:63], v[132:135], v[116:119], v[60:63]
    ds_read_b64_tr_b16 v[160:161], v43 offset:40960
    v_mfma_f32_16x16x32_bf16 v[88:91], v[132:135], v[120:123], v[88:91]
    ds_read_b64_tr_b16 v[162:163], v43 offset:41984
    s_waitcnt lgkmcnt(14)
    v_mfma_f32_16x16x32_bf16 v[64:67], v[136:139], v[116:119], v[64:67]
    ds_read_b64_tr_b16 v[164:165], v45 offset:40960
    v_mfma_f32_16x16x32_bf16 v[92:95], v[136:139], v[120:123], v[92:95]
    ds_read_b64_tr_b16 v[166:167], v45 offset:41984
    s_waitcnt lgkmcnt(14)
    v_mfma_f32_16x16x32_bf16 v[68:71], v[140:143], v[116:119], v[68:71]
    ds_read_b64_tr_b16 v[168:169], v47 offset:40960
    v_mfma_f32_16x16x32_bf16 v[96:99], v[140:143], v[120:123], v[96:99]
    ds_read_b64_tr_b16 v[170:171], v47 offset:41984
    s_waitcnt lgkmcnt(14)
    v_mfma_f32_16x16x32_bf16 v[72:75], v[144:147], v[116:119], v[72:75]
    ds_read_b64_tr_b16 v[172:173], v49 offset:40960
    v_mfma_f32_16x16x32_bf16 v[100:103], v[144:147], v[120:123], v[100:103]
    ds_read_b64_tr_b16 v[174:175], v49 offset:41984
    s_waitcnt lgkmcnt(14)
    v_mfma_f32_16x16x32_bf16 v[76:79], v[148:151], v[116:119], v[76:79]
    ds_read_b64_tr_b16 v[176:177], v51 offset:40960
    v_mfma_f32_16x16x32_bf16 v[104:107], v[148:151], v[120:123], v[104:107]
    ds_read_b64_tr_b16 v[178:179], v51 offset:41984
    s_waitcnt lgkmcnt(14)
    v_mfma_f32_16x16x32_bf16 v[80:83], v[152:155], v[116:119], v[80:83]
    ds_read_b64_tr_b16 v[180:181], v53 offset:40960
    v_mfma_f32_16x16x32_bf16 v[108:111], v[152:155], v[120:123], v[108:111]
    ds_read_b64_tr_b16 v[182:183], v53 offset:41984
    s_waitcnt lgkmcnt(14)
    v_mfma_f32_16x16x32_bf16 v[84:87], v[156:159], v[116:119], v[84:87]
    ds_read_b64_tr_b16 v[184:185], v55 offset:40960
    v_mfma_f32_16x16x32_bf16 v[112:115], v[156:159], v[120:123], v[112:115]
    ds_read_b64_tr_b16 v[186:187], v55 offset:41984
    s_waitcnt lgkmcnt(12)
    v_mfma_f32_16x16x32_bf16 v[60:63], v[160:163], v[124:127], v[60:63]
    ds_read_b64 v[188:189], v192 offset:0
    v_mfma_f32_16x16x32_bf16 v[88:91], v[160:163], v[128:131], v[88:91]
    ds_read_b64 v[190:191], v192 offset:128
    s_waitcnt lgkmcnt(12)
    v_mfma_f32_16x16x32_bf16 v[64:67], v[164:167], v[124:127], v[64:67]
    ds_read_b128 v[12:15], v40 offset:0
    v_mfma_f32_16x16x32_bf16 v[92:95], v[164:167], v[128:131], v[92:95]
    ds_read_b128 v[16:19], v40 offset:64
    s_waitcnt lgkmcnt(12)
    v_mfma_f32_16x16x32_bf16 v[68:71], v[168:171], v[124:127], v[68:71]
    ds_read_b128 v[20:23], v40 offset:128
    v_mfma_f32_16x16x32_bf16 v[96:99], v[168:171], v[128:131], v[96:99]
    ds_read_b128 v[24:27], v40 offset:192
    s_waitcnt lgkmcnt(12)
    v_mfma_f32_16x16x32_bf16 v[72:75], v[172:175], v[124:127], v[72:75]
    ds_read_b128 v[28:31], v40 offset:256
    v_mfma_f32_16x16x32_bf16 v[100:103], v[172:175], v[128:131], v[100:103]
    ds_read_b128 v[32:35], v40 offset:320
    s_waitcnt lgkmcnt(12)
    v_mfma_f32_16x16x32_bf16 v[76:79], v[176:179], v[124:127], v[76:79]
    ds_read_b128 v[36:39], v40 offset:384
    v_mfma_f32_16x16x32_bf16 v[104:107], v[176:179], v[128:131], v[104:107]
    s_waitcnt lgkmcnt(11)
    v_mfma_f32_16x16x32_bf16 v[80:83], v[180:183], v[124:127], v[80:83]
    v_mfma_f32_16x16x32_bf16 v[108:111], v[180:183], v[128:131], v[108:111]
    s_waitcnt lgkmcnt(9)
    v_mfma_f32_16x16x32_bf16 v[84:87], v[184:187], v[124:127], v[84:87]
    v_mfma_f32_16x16x32_bf16 v[112:115], v[184:187], v[128:131], v[112:115]
    s_barrier
    v_add_u32 v193, s52, v2
    v_mul_u32_u24 v193, 240, v193
    v_lshl_add_u32 v193, v3, 3, v193
    s_mov_b32 s62, 0xbfb8aa3b
    s_mov_b32 s63, 0xbfb8aa3b
    s_mov_b32 s64, 1.0
    s_mov_b32 s65, 1.0
    s_waitcnt lgkmcnt(6)
    v_pk_mul_f32 v[196:197], v[12:13], v[188:189] op_sel:[0,1] op_sel_hi:[1,1]
    v_pk_mul_f32 v[198:199], v[14:15], v[188:189] op_sel:[0,1] op_sel_hi:[1,1]
    v_pk_fma_f32 v[60:61], v[60:61], v[188:189], v[196:197] op_sel:[0,0,0] op_sel_hi:[1,0,1]
    v_pk_fma_f32 v[62:63], v[62:63], v[188:189], v[198:199] op_sel:[0,0,0] op_sel_hi:[1,0,1]
    v_pk_mul_f32 v[196:197], v[60:61], s[62:63]
    v_pk_mul_f32 v[198:199], v[62:63], s[62:63]
    v_exp_f32 v196, v196
    v_exp_f32 v197, v197
    v_exp_f32 v198, v198
    v_exp_f32 v199, v199
    v_pk_add_f32 v[196:197], v[196:197], s[64:65]
    v_pk_add_f32 v[198:199], v[198:199], s[64:65]
    v_rcp_f32 v196, v196
    v_rcp_f32 v197, v197
    v_rcp_f32 v198, v198
    v_rcp_f32 v199, v199
    v_pk_mul_f32 v[60:61], v[60:61], v[196:197]
    v_pk_mul_f32 v[62:63], v[62:63], v[198:199]
    v_cvt_pk_bf16_f32 v60, v60, v61
    v_cvt_pk_bf16_f32 v61, v62, v63
    ds_write_b64 v193, v[60:61] offset:0
    s_waitcnt lgkmcnt(6)
    v_pk_mul_f32 v[200:201], v[16:17], v[188:189] op_sel:[0,1] op_sel_hi:[1,1]
    v_pk_mul_f32 v[202:203], v[18:19], v[188:189] op_sel:[0,1] op_sel_hi:[1,1]
    v_pk_fma_f32 v[64:65], v[64:65], v[188:189], v[200:201] op_sel:[0,0,0] op_sel_hi:[1,0,1]
    v_pk_fma_f32 v[66:67], v[66:67], v[188:189], v[202:203] op_sel:[0,0,0] op_sel_hi:[1,0,1]
    v_pk_mul_f32 v[200:201], v[64:65], s[62:63]
    v_pk_mul_f32 v[202:203], v[66:67], s[62:63]
    v_exp_f32 v200, v200
    v_exp_f32 v201, v201
    v_exp_f32 v202, v202
    v_exp_f32 v203, v203
    v_pk_add_f32 v[200:201], v[200:201], s[64:65]
    v_pk_add_f32 v[202:203], v[202:203], s[64:65]
    v_rcp_f32 v200, v200
    v_rcp_f32 v201, v201
    v_rcp_f32 v202, v202
    v_rcp_f32 v203, v203
    v_pk_mul_f32 v[64:65], v[64:65], v[200:201]
    v_pk_mul_f32 v[66:67], v[66:67], v[202:203]
    v_cvt_pk_bf16_f32 v64, v64, v65
    v_cvt_pk_bf16_f32 v65, v66, v67
    ds_write_b64 v193, v[64:65] offset:32
    s_waitcnt lgkmcnt(6)
    v_pk_mul_f32 v[196:197], v[20:21], v[188:189] op_sel:[0,1] op_sel_hi:[1,1]
    v_pk_mul_f32 v[198:199], v[22:23], v[188:189] op_sel:[0,1] op_sel_hi:[1,1]
    v_pk_fma_f32 v[68:69], v[68:69], v[188:189], v[196:197] op_sel:[0,0,0] op_sel_hi:[1,0,1]
    v_pk_fma_f32 v[70:71], v[70:71], v[188:189], v[198:199] op_sel:[0,0,0] op_sel_hi:[1,0,1]
    v_pk_mul_f32 v[196:197], v[68:69], s[62:63]
    v_pk_mul_f32 v[198:199], v[70:71], s[62:63]
    v_exp_f32 v196, v196
    v_exp_f32 v197, v197
    v_exp_f32 v198, v198
    v_exp_f32 v199, v199
    v_pk_add_f32 v[196:197], v[196:197], s[64:65]
    v_pk_add_f32 v[198:199], v[198:199], s[64:65]
    v_rcp_f32 v196, v196
    v_rcp_f32 v197, v197
    v_rcp_f32 v198, v198
    v_rcp_f32 v199, v199
    v_pk_mul_f32 v[68:69], v[68:69], v[196:197]
    v_pk_mul_f32 v[70:71], v[70:71], v[198:199]
    v_cvt_pk_bf16_f32 v68, v68, v69
    v_cvt_pk_bf16_f32 v69, v70, v71
    ds_write_b64 v193, v[68:69] offset:64
    s_waitcnt lgkmcnt(6)
    v_pk_mul_f32 v[200:201], v[24:25], v[188:189] op_sel:[0,1] op_sel_hi:[1,1]
    v_pk_mul_f32 v[202:203], v[26:27], v[188:189] op_sel:[0,1] op_sel_hi:[1,1]
    v_pk_fma_f32 v[72:73], v[72:73], v[188:189], v[200:201] op_sel:[0,0,0] op_sel_hi:[1,0,1]
    v_pk_fma_f32 v[74:75], v[74:75], v[188:189], v[202:203] op_sel:[0,0,0] op_sel_hi:[1,0,1]
    v_pk_mul_f32 v[200:201], v[72:73], s[62:63]
    v_pk_mul_f32 v[202:203], v[74:75], s[62:63]
    v_exp_f32 v200, v200
    v_exp_f32 v201, v201
    v_exp_f32 v202, v202
    v_exp_f32 v203, v203
    v_pk_add_f32 v[200:201], v[200:201], s[64:65]
    v_pk_add_f32 v[202:203], v[202:203], s[64:65]
    v_rcp_f32 v200, v200
    v_rcp_f32 v201, v201
    v_rcp_f32 v202, v202
    v_rcp_f32 v203, v203
    v_pk_mul_f32 v[72:73], v[72:73], v[200:201]
    v_pk_mul_f32 v[74:75], v[74:75], v[202:203]
    v_cvt_pk_bf16_f32 v72, v72, v73
    v_cvt_pk_bf16_f32 v73, v74, v75
    ds_write_b64 v193, v[72:73] offset:96
    s_waitcnt lgkmcnt(6)
    v_pk_mul_f32 v[196:197], v[28:29], v[188:189] op_sel:[0,1] op_sel_hi:[1,1]
    v_pk_mul_f32 v[198:199], v[30:31], v[188:189] op_sel:[0,1] op_sel_hi:[1,1]
    v_pk_fma_f32 v[76:77], v[76:77], v[188:189], v[196:197] op_sel:[0,0,0] op_sel_hi:[1,0,1]
    v_pk_fma_f32 v[78:79], v[78:79], v[188:189], v[198:199] op_sel:[0,0,0] op_sel_hi:[1,0,1]
    v_pk_mul_f32 v[196:197], v[76:77], s[62:63]
    v_pk_mul_f32 v[198:199], v[78:79], s[62:63]
    v_exp_f32 v196, v196
    v_exp_f32 v197, v197
    v_exp_f32 v198, v198
    v_exp_f32 v199, v199
    v_pk_add_f32 v[196:197], v[196:197], s[64:65]
    v_pk_add_f32 v[198:199], v[198:199], s[64:65]
    v_rcp_f32 v196, v196
    v_rcp_f32 v197, v197
    v_rcp_f32 v198, v198
    v_rcp_f32 v199, v199
    v_pk_mul_f32 v[76:77], v[76:77], v[196:197]
    v_pk_mul_f32 v[78:79], v[78:79], v[198:199]
    v_cvt_pk_bf16_f32 v76, v76, v77
    v_cvt_pk_bf16_f32 v77, v78, v79
    ds_write_b64 v193, v[76:77] offset:128
    s_waitcnt lgkmcnt(6)
    v_pk_mul_f32 v[200:201], v[32:33], v[188:189] op_sel:[0,1] op_sel_hi:[1,1]
    v_pk_mul_f32 v[202:203], v[34:35], v[188:189] op_sel:[0,1] op_sel_hi:[1,1]
    v_pk_fma_f32 v[80:81], v[80:81], v[188:189], v[200:201] op_sel:[0,0,0] op_sel_hi:[1,0,1]
    v_pk_fma_f32 v[82:83], v[82:83], v[188:189], v[202:203] op_sel:[0,0,0] op_sel_hi:[1,0,1]
    v_pk_mul_f32 v[200:201], v[80:81], s[62:63]
    v_pk_mul_f32 v[202:203], v[82:83], s[62:63]
    v_exp_f32 v200, v200
    v_exp_f32 v201, v201
    v_exp_f32 v202, v202
    v_exp_f32 v203, v203
    v_pk_add_f32 v[200:201], v[200:201], s[64:65]
    v_pk_add_f32 v[202:203], v[202:203], s[64:65]
    v_rcp_f32 v200, v200
    v_rcp_f32 v201, v201
    v_rcp_f32 v202, v202
    v_rcp_f32 v203, v203
    v_pk_mul_f32 v[80:81], v[80:81], v[200:201]
    v_pk_mul_f32 v[82:83], v[82:83], v[202:203]
    v_cvt_pk_bf16_f32 v80, v80, v81
    v_cvt_pk_bf16_f32 v81, v82, v83
    ds_write_b64 v193, v[80:81] offset:160
    s_waitcnt lgkmcnt(6)
    v_pk_mul_f32 v[196:197], v[36:37], v[188:189] op_sel:[0,1] op_sel_hi:[1,1]
    v_pk_mul_f32 v[198:199], v[38:39], v[188:189] op_sel:[0,1] op_sel_hi:[1,1]
    v_pk_fma_f32 v[84:85], v[84:85], v[188:189], v[196:197] op_sel:[0,0,0] op_sel_hi:[1,0,1]
    v_pk_fma_f32 v[86:87], v[86:87], v[188:189], v[198:199] op_sel:[0,0,0] op_sel_hi:[1,0,1]
    v_pk_mul_f32 v[196:197], v[84:85], s[62:63]
    v_pk_mul_f32 v[198:199], v[86:87], s[62:63]
    v_exp_f32 v196, v196
    v_exp_f32 v197, v197
    v_exp_f32 v198, v198
    v_exp_f32 v199, v199
    v_pk_add_f32 v[196:197], v[196:197], s[64:65]
    v_pk_add_f32 v[198:199], v[198:199], s[64:65]
    v_rcp_f32 v196, v196
    v_rcp_f32 v197, v197
    v_rcp_f32 v198, v198
    v_rcp_f32 v199, v199
    v_pk_mul_f32 v[84:85], v[84:85], v[196:197]
    v_pk_mul_f32 v[86:87], v[86:87], v[198:199]
    v_cvt_pk_bf16_f32 v84, v84, v85
    v_cvt_pk_bf16_f32 v85, v86, v87
    ds_write_b64 v193, v[84:85] offset:192
    v_pk_mul_f32 v[196:197], v[12:13], v[190:191] op_sel:[0,1] op_sel_hi:[1,1]
    v_pk_mul_f32 v[198:199], v[14:15], v[190:191] op_sel:[0,1] op_sel_hi:[1,1]
    v_pk_fma_f32 v[88:89], v[88:89], v[190:191], v[196:197] op_sel:[0,0,0] op_sel_hi:[1,0,1]
    v_pk_fma_f32 v[90:91], v[90:91], v[190:191], v[198:199] op_sel:[0,0,0] op_sel_hi:[1,0,1]
    v_pk_mul_f32 v[196:197], v[88:89], s[62:63]
    v_pk_mul_f32 v[198:199], v[90:91], s[62:63]
    v_exp_f32 v196, v196
    v_exp_f32 v197, v197
    v_exp_f32 v198, v198
    v_exp_f32 v199, v199
    v_pk_add_f32 v[196:197], v[196:197], s[64:65]
    v_pk_add_f32 v[198:199], v[198:199], s[64:65]
    v_rcp_f32 v196, v196
    v_rcp_f32 v197, v197
    v_rcp_f32 v198, v198
    v_rcp_f32 v199, v199
    v_pk_mul_f32 v[88:89], v[88:89], v[196:197]
    v_pk_mul_f32 v[90:91], v[90:91], v[198:199]
    v_cvt_pk_bf16_f32 v88, v88, v89
    v_cvt_pk_bf16_f32 v89, v90, v91
    ds_write_b64 v193, v[88:89] offset:3840
    v_pk_mul_f32 v[200:201], v[16:17], v[190:191] op_sel:[0,1] op_sel_hi:[1,1]
    v_pk_mul_f32 v[202:203], v[18:19], v[190:191] op_sel:[0,1] op_sel_hi:[1,1]
    v_pk_fma_f32 v[92:93], v[92:93], v[190:191], v[200:201] op_sel:[0,0,0] op_sel_hi:[1,0,1]
    v_pk_fma_f32 v[94:95], v[94:95], v[190:191], v[202:203] op_sel:[0,0,0] op_sel_hi:[1,0,1]
    v_pk_mul_f32 v[200:201], v[92:93], s[62:63]
    v_pk_mul_f32 v[202:203], v[94:95], s[62:63]
    v_exp_f32 v200, v200
    v_exp_f32 v201, v201
    v_exp_f32 v202, v202
    v_exp_f32 v203, v203
    v_pk_add_f32 v[200:201], v[200:201], s[64:65]
    v_pk_add_f32 v[202:203], v[202:203], s[64:65]
    v_rcp_f32 v200, v200
    v_rcp_f32 v201, v201
    v_rcp_f32 v202, v202
    v_rcp_f32 v203, v203
    v_pk_mul_f32 v[92:93], v[92:93], v[200:201]
    v_pk_mul_f32 v[94:95], v[94:95], v[202:203]
    v_cvt_pk_bf16_f32 v92, v92, v93
    v_cvt_pk_bf16_f32 v93, v94, v95
    ds_write_b64 v193, v[92:93] offset:3872
    v_pk_mul_f32 v[196:197], v[20:21], v[190:191] op_sel:[0,1] op_sel_hi:[1,1]
    v_pk_mul_f32 v[198:199], v[22:23], v[190:191] op_sel:[0,1] op_sel_hi:[1,1]
    v_pk_fma_f32 v[96:97], v[96:97], v[190:191], v[196:197] op_sel:[0,0,0] op_sel_hi:[1,0,1]
    v_pk_fma_f32 v[98:99], v[98:99], v[190:191], v[198:199] op_sel:[0,0,0] op_sel_hi:[1,0,1]
    v_pk_mul_f32 v[196:197], v[96:97], s[62:63]
    v_pk_mul_f32 v[198:199], v[98:99], s[62:63]
    v_exp_f32 v196, v196
    v_exp_f32 v197, v197
    v_exp_f32 v198, v198
    v_exp_f32 v199, v199
    v_pk_add_f32 v[196:197], v[196:197], s[64:65]
    v_pk_add_f32 v[198:199], v[198:199], s[64:65]
    v_rcp_f32 v196, v196
    v_rcp_f32 v197, v197
    v_rcp_f32 v198, v198
    v_rcp_f32 v199, v199
    v_pk_mul_f32 v[96:97], v[96:97], v[196:197]
    v_pk_mul_f32 v[98:99], v[98:99], v[198:199]
    v_cvt_pk_bf16_f32 v96, v96, v97
    v_cvt_pk_bf16_f32 v97, v98, v99
    ds_write_b64 v193, v[96:97] offset:3904
    v_pk_mul_f32 v[200:201], v[24:25], v[190:191] op_sel:[0,1] op_sel_hi:[1,1]
    v_pk_mul_f32 v[202:203], v[26:27], v[190:191] op_sel:[0,1] op_sel_hi:[1,1]
    v_pk_fma_f32 v[100:101], v[100:101], v[190:191], v[200:201] op_sel:[0,0,0] op_sel_hi:[1,0,1]
    v_pk_fma_f32 v[102:103], v[102:103], v[190:191], v[202:203] op_sel:[0,0,0] op_sel_hi:[1,0,1]
    v_pk_mul_f32 v[200:201], v[100:101], s[62:63]
    v_pk_mul_f32 v[202:203], v[102:103], s[62:63]
    v_exp_f32 v200, v200
    v_exp_f32 v201, v201
    v_exp_f32 v202, v202
    v_exp_f32 v203, v203
    v_pk_add_f32 v[200:201], v[200:201], s[64:65]
    v_pk_add_f32 v[202:203], v[202:203], s[64:65]
    v_rcp_f32 v200, v200
    v_rcp_f32 v201, v201
    v_rcp_f32 v202, v202
    v_rcp_f32 v203, v203
    v_pk_mul_f32 v[100:101], v[100:101], v[200:201]
    v_pk_mul_f32 v[102:103], v[102:103], v[202:203]
    v_cvt_pk_bf16_f32 v100, v100, v101
    v_cvt_pk_bf16_f32 v101, v102, v103
    ds_write_b64 v193, v[100:101] offset:3936
    v_pk_mul_f32 v[196:197], v[28:29], v[190:191] op_sel:[0,1] op_sel_hi:[1,1]
    v_pk_mul_f32 v[198:199], v[30:31], v[190:191] op_sel:[0,1] op_sel_hi:[1,1]
    v_pk_fma_f32 v[104:105], v[104:105], v[190:191], v[196:197] op_sel:[0,0,0] op_sel_hi:[1,0,1]
    v_pk_fma_f32 v[106:107], v[106:107], v[190:191], v[198:199] op_sel:[0,0,0] op_sel_hi:[1,0,1]
    v_pk_mul_f32 v[196:197], v[104:105], s[62:63]
    v_pk_mul_f32 v[198:199], v[106:107], s[62:63]
    v_exp_f32 v196, v196
    v_exp_f32 v197, v197
    v_exp_f32 v198, v198
    v_exp_f32 v199, v199
    v_pk_add_f32 v[196:197], v[196:197], s[64:65]
    v_pk_add_f32 v[198:199], v[198:199], s[64:65]
    v_rcp_f32 v196, v196
    v_rcp_f32 v197, v197
    v_rcp_f32 v198, v198
    v_rcp_f32 v199, v199
    v_pk_mul_f32 v[104:105], v[104:105], v[196:197]
    v_pk_mul_f32 v[106:107], v[106:107], v[198:199]
    v_cvt_pk_bf16_f32 v104, v104, v105
    v_cvt_pk_bf16_f32 v105, v106, v107
    ds_write_b64 v193, v[104:105] offset:3968
    v_pk_mul_f32 v[200:201], v[32:33], v[190:191] op_sel:[0,1] op_sel_hi:[1,1]
    v_pk_mul_f32 v[202:203], v[34:35], v[190:191] op_sel:[0,1] op_sel_hi:[1,1]
    v_pk_fma_f32 v[108:109], v[108:109], v[190:191], v[200:201] op_sel:[0,0,0] op_sel_hi:[1,0,1]
    v_pk_fma_f32 v[110:111], v[110:111], v[190:191], v[202:203] op_sel:[0,0,0] op_sel_hi:[1,0,1]
    v_pk_mul_f32 v[200:201], v[108:109], s[62:63]
    v_pk_mul_f32 v[202:203], v[110:111], s[62:63]
    v_exp_f32 v200, v200
    v_exp_f32 v201, v201
    v_exp_f32 v202, v202
    v_exp_f32 v203, v203
    v_pk_add_f32 v[200:201], v[200:201], s[64:65]
    v_pk_add_f32 v[202:203], v[202:203], s[64:65]
    v_rcp_f32 v200, v200
    v_rcp_f32 v201, v201
    v_rcp_f32 v202, v202
    v_rcp_f32 v203, v203
    v_pk_mul_f32 v[108:109], v[108:109], v[200:201]
    v_pk_mul_f32 v[110:111], v[110:111], v[202:203]
    v_cvt_pk_bf16_f32 v108, v108, v109
    v_cvt_pk_bf16_f32 v109, v110, v111
    ds_write_b64 v193, v[108:109] offset:4000
    v_pk_mul_f32 v[196:197], v[36:37], v[190:191] op_sel:[0,1] op_sel_hi:[1,1]
    v_pk_mul_f32 v[198:199], v[38:39], v[190:191] op_sel:[0,1] op_sel_hi:[1,1]
    v_pk_fma_f32 v[112:113], v[112:113], v[190:191], v[196:197] op_sel:[0,0,0] op_sel_hi:[1,0,1]
    v_pk_fma_f32 v[114:115], v[114:115], v[190:191], v[198:199] op_sel:[0,0,0] op_sel_hi:[1,0,1]
    v_pk_mul_f32 v[196:197], v[112:113], s[62:63]
    v_pk_mul_f32 v[198:199], v[114:115], s[62:63]
    v_exp_f32 v196, v196
    v_exp_f32 v197, v197
    v_exp_f32 v198, v198
    v_exp_f32 v199, v199
    v_pk_add_f32 v[196:197], v[196:197], s[64:65]
    v_pk_add_f32 v[198:199], v[198:199], s[64:65]
    v_rcp_f32 v196, v196
    v_rcp_f32 v197, v197
    v_rcp_f32 v198, v198
    v_rcp_f32 v199, v199
    v_pk_mul_f32 v[112:113], v[112:113], v[196:197]
    v_pk_mul_f32 v[114:115], v[114:115], v[198:199]
    v_cvt_pk_bf16_f32 v112, v112, v113
    v_cvt_pk_bf16_f32 v113, v114, v115
    ds_write_b64 v193, v[112:113] offset:4032
    s_waitcnt lgkmcnt(0)
    s_add_u32 s32, s20, 6291456
    s_addc_u32 s33, s21, 0
    s_and_b32 s33, s33, 0xffff
    s_mov_b32 s34, 7340032
    s_mov_b32 s35, 0x20000
    v_lshrrev_b32 v5, 4, v0
    v_and_b32 v6, 15, v0
    v_min_u32 v7, 13, v6
    v_mul_u32_u24 v56, 240, v5
    v_lshl_add_u32 v56, v7, 4, v56
    v_add_u32 v5, s50, v5
    v_mul_u32_u24 v57, 3584, v5
    v_lshl_add_u32 v57, v6, 4, v57
    v_add_u32 v57, s54, v57
    v_mov_b32 v7, 0x7f000000
    v_cmp_gt_u32 vcc, 14, v6
    s_nop 1
    v_cndmask_b32 v57, v7, v57, vcc
    s_barrier
    ds_read_b128 v[24:27], v56 offset:0
    ds_read_b128 v[28:31], v56 offset:3840
    ds_read_b128 v[32:35], v56 offset:7680
    ds_read_b128 v[36:39], v56 offset:11520
    ds_read_b128 v[40:43], v56 offset:15360
    ds_read_b128 v[44:47], v56 offset:19200
    ds_read_b128 v[48:51], v56 offset:23040
    ds_read_b128 v[52:55], v56 offset:26880
    s_waitcnt vmcnt(0) lgkmcnt(0)
    s_nop 4
    s_cmp_eq_u32 s99, 1
    s_cbranch_scc0 kB_kernel_st1_slow
    s_mov_b32 s56, 0
    buffer_store_dwordx4 v[24:27], v57, s[32:35], s56 offen
    s_mov_b32 s56, 57344
    buffer_store_dwordx4 v[28:31], v57, s[32:35], s56 offen
    s_mov_b32 s56, 114688
    buffer_store_dwordx4 v[32:35], v57, s[32:35], s56 offen
    s_mov_b32 s56, 172032
    buffer_store_dwordx4 v[36:39], v57, s[32:35], s56 offen
    s_mov_b32 s56, 229376
    buffer_store_dwordx4 v[40:43], v57, s[32:35], s56 offen
    s_mov_b32 s56, 286720
    buffer_store_dwordx4 v[44:47], v57, s[32:35], s56 offen
    s_mov_b32 s56, 344064
    buffer_store_dwordx4 v[48:51], v57, s[32:35], s56 offen
    s_mov_b32 s56, 401408
    buffer_store_dwordx4 v[52:55], v57, s[32:35], s56 offen
    s_branch kB_kernel_st1_done
kB_kernel_st1_slow:
    s_mov_b32 s56, 0
    buffer_store_dwordx4 v[24:27], v57, s[32:35], s56 offen sc0 sc1
    s_mov_b32 s56, 57344
    buffer_store_dwordx4 v[28:31], v57, s[32:35], s56 offen sc0 sc1
    s_mov_b32 s56, 114688
    buffer_store_dwordx4 v[32:35], v57, s[32:35], s56 offen sc0 sc1
    s_mov_b32 s56, 172032
    buffer_store_dwordx4 v[36:39], v57, s[32:35], s56 offen sc0 sc1
    s_mov_b32 s56, 229376
    buffer_store_dwordx4 v[40:43], v57, s[32:35], s56 offen sc0 sc1
    s_mov_b32 s56, 286720
    buffer_store_dwordx4 v[44:47], v57, s[32:35], s56 offen sc0 sc1
    s_mov_b32 s56, 344064
    buffer_store_dwordx4 v[48:51], v57, s[32:35], s56 offen sc0 sc1
    s_mov_b32 s56, 401408
    buffer_store_dwordx4 v[52:55], v57, s[32:35], s56 offen sc0 sc1
kB_kernel_st1_done:
    s_waitcnt vmcnt(0)
    s_barrier
    s_lshr_b32 s48, s97, 3
    s_lshl_b32 s22, s96, 1
    s_add_u32 s22, s22, s48
    s_and_b32 s23, s97, 7
    s_lshl_b32 s50, s22, 6
    s_lshl_b32 s54, s23, 7
    s_waitcnt lgkmcnt(0)
    s_add_u32 s24, s20, 2097152
    s_addc_u32 s25, s21, 0
    s_and_b32 s25, s25, 0xffff
    s_mov_b32 s26, 2097152
    s_mov_b32 s27, 0x20000
    v_lshrrev_b32 v5, 3, v0
    v_and_b32 v6, 7, v0
    v_add_u32 v5, s50, v5
    v_lshlrev_b32 v5, 10, v5
    v_lshl_add_u32 v5, v6, 4, v5
    v_add_u32 v5, s54, v5
    s_mov_b32 s60, 32768
    buffer_load_dwordx4 v[12:15], v5, s[24:27], 0 offen
    buffer_load_dwordx4 v[16:19], v5, s[24:27], s60 offen
    s_lshr_b32 s52, s3, 1
    s_lshl_b32 s52, s52, 5
    s_and_b32 s53, s3, 1
    v_add_u32 v5, s52, v2
    v_mul_u32_u24 v5, 256, v5
    v_mov_b32 v6, v2
    v_xor_b32 v6, v6, v3
    v_xor_b32 v20, 0, v6
    v_lshl_add_u32 v20, v20, 4, v5
    v_add_u32 v21, 65536, v20
    v_xor_b32 v22, 4, v6
    v_lshl_add_u32 v22, v22, 4, v5
    v_add_u32 v23, 65536, v22
    v_xor_b32 v24, 8, v6
    v_lshl_add_u32 v24, v24, 4, v5
    v_add_u32 v25, 65536, v24
    v_xor_b32 v26, 12, v6
    v_lshl_add_u32 v26, v26, 4, v5
    v_add_u32 v27, 65536, v26
    v_bfe_u32 v5, v1, 2, 2
    v_and_b32 v6, 1, v3
    v_lshlrev_b32 v6, 1, v6
    v_bfe_u32 v7, v1, 3, 1
    v_or_b32 v6, v6, v7
    s_lshl_b32 s57, s53, 1
    v_xor_b32 v6, s57, v6
    v_lshl_add_u32 v5, v3, 3, v5
    v_lshlrev_b32 v5, 7, v5
    v_and_b32 v7, 3, v1
    v_lshl_add_u32 v5, v7, 3, v5
    v_xor_b32 v7, 0, v6
    v_lshl_add_u32 v28, v7, 5, v5
    v_add_u32 v29, 65536, v28
    v_add_u32 v30, 131072, v28
    v_xor_b32 v7, 1, v6
    v_lshl_add_u32 v31, v7, 5, v5
    v_add_u32 v32, 65536, v31
    v_add_u32 v33, 131072, v31
    v_mov_b32 v36, 0
    v_mov_b32 v37, 0
    v_mov_b32 v38, 0
    v_mov_b32 v39, 0
    v_mov_b32 v40, 0
    v_mov_b32 v41, 0
    v_mov_b32 v42, 0
    v_mov_b32 v43, 0
    v_mov_b32 v44, 0
    v_mov_b32 v45, 0
    v_mov_b32 v46, 0
    v_mov_b32 v47, 0
    v_mov_b32 v48, 0
    v_mov_b32 v49, 0
    v_mov_b32 v50, 0
    v_mov_b32 v51, 0
    s_barrier
    ds_read_b128 v[52:55], v20 offset:0
    ds_read_b64_tr_b16 v[116:117], v29 offset:49152
    ds_read_b64_tr_b16 v[118:119], v29 offset:49664
    ds_read_b64_tr_b16 v[120:121], v32 offset:49152
    ds_read_b64_tr_b16 v[122:123], v32 offset:49664
    ds_read_b128 v[56:59], v20 offset:4096
    ds_read_b128 v[60:63], v22 offset:0
    ds_read_b64_tr_b16 v[124:125], v29 offset:53248
    ds_read_b64_tr_b16 v[126:127], v29 offset:53760
    ds_read_b64_tr_b16 v[128:129], v32 offset:53248
    ds_read_b64_tr_b16 v[130:131], v32 offset:53760
    ds_read_b128 v[64:67], v22 offset:4096
    ds_read_b128 v[68:71], v24 offset:0
    ds_read_b64_tr_b16 v[132:133], v29 offset:57344
    ds_read_b64_tr_b16 v[134:135], v29 offset:57856
    ds_read_b64_tr_b16 v[136:137], v32 offset:57344
    ds_read_b64_tr_b16 v[138:139], v32 offset:57856
    ds_read_b128 v[72:75], v24 offset:4096
    ds_read_b128 v[76:79], v26 offset:0
    ds_read_b64_tr_b16 v[140:141], v29 offset:61440
    ds_read_b64_tr_b16 v[142:143], v29 offset:61952
    ds_read_b64_tr_b16 v[144:145], v32 offset:61440
    ds_read_b64_tr_b16 v[146:147], v32 offset:61952
    ds_read_b128 v[80:83], v26 offset:4096
    s_waitcnt lgkmcnt(0)
    s_barrier
    ds_read_b128 v[84:87], v20 offset:16384
    ds_read_b64_tr_b16 v[148:149], v30 offset:0
    v_mfma_f32_16x16x32_bf16 v[36:39], v[116:119], v[52:55], v[36:39]
    ds_read_b64_tr_b16 v[150:151], v30 offset:512
    v_mfma_f32_16x16x32_bf16 v[40:43], v[120:123], v[52:55], v[40:43]
    ds_read_b64_tr_b16 v[152:153], v33 offset:0
    ds_read_b64_tr_b16 v[154:155], v33 offset:512
    v_mfma_f32_16x16x32_bf16 v[44:47], v[116:119], v[56:59], v[44:47]
    ds_read_b128 v[88:91], v20 offset:20480
    v_mfma_f32_16x16x32_bf16 v[48:51], v[120:123], v[56:59], v[48:51]
    ds_read_b128 v[92:95], v22 offset:16384
    ds_read_b64_tr_b16 v[156:157], v30 offset:4096
    v_mfma_f32_16x16x32_bf16 v[36:39], v[124:127], v[60:63], v[36:39]
    ds_read_b64_tr_b16 v[158:159], v30 offset:4608
    v_mfma_f32_16x16x32_bf16 v[40:43], v[128:131], v[60:63], v[40:43]
    ds_read_b64_tr_b16 v[160:161], v33 offset:4096
    ds_read_b64_tr_b16 v[162:163], v33 offset:4608
    v_mfma_f32_16x16x32_bf16 v[44:47], v[124:127], v[64:67], v[44:47]
    ds_read_b128 v[96:99], v22 offset:20480
    v_mfma_f32_16x16x32_bf16 v[48:51], v[128:131], v[64:67], v[48:51]
    ds_read_b128 v[100:103], v24 offset:16384
    ds_read_b64_tr_b16 v[164:165], v30 offset:8192
    v_mfma_f32_16x16x32_bf16 v[36:39], v[132:135], v[68:71], v[36:39]
    ds_read_b64_tr_b16 v[166:167], v30 offset:8704
    v_mfma_f32_16x16x32_bf16 v[40:43], v[136:139], v[68:71], v[40:43]
    ds_read_b64_tr_b16 v[168:169], v33 offset:8192
    ds_read_b64_tr_b16 v[170:171], v33 offset:8704
    v_mfma_f32_16x16x32_bf16 v[44:47], v[132:135], v[72:75], v[44:47]
    ds_read_b128 v[104:107], v24 offset:20480
    v_mfma_f32_16x16x32_bf16 v[48:51], v[136:139], v[72:75], v[48:51]
    ds_read_b128 v[108:111], v26 offset:16384
    ds_read_b64_tr_b16 v[172:173], v30 offset:12288
    v_mfma_f32_16x16x32_bf16 v[36:39], v[140:143], v[76:79], v[36:39]
    ds_read_b64_tr_b16 v[174:175], v30 offset:12800
    v_mfma_f32_16x16x32_bf16 v[40:43], v[144:147], v[76:79], v[40:43]
    ds_read_b64_tr_b16 v[176:177], v33 offset:12288
    ds_read_b64_tr_b16 v[178:179], v33 offset:12800
    v_mfma_f32_16x16x32_bf16 v[44:47], v[140:143], v[80:83], v[44:47]
    ds_read_b128 v[112:115], v26 offset:20480
    v_mfma_f32_16x16x32_bf16 v[48:51], v[144:147], v[80:83], v[48:51]
    s_waitcnt lgkmcnt(0)
    s_barrier
    ds_read_b128 v[52:55], v20 offset:32768
    ds_read_b64_tr_b16 v[116:117], v29 offset:0
    v_mfma_f32_16x16x32_bf16 v[36:39], v[148:151], v[84:87], v[36:39]
    ds_read_b64_tr_b16 v[118:119], v29 offset:512
    v_mfma_f32_16x16x32_bf16 v[40:43], v[152:155], v[84:87], v[40:43]
    ds_read_b64_tr_b16 v[120:121], v32 offset:0
    ds_read_b64_tr_b16 v[122:123], v32 offset:512
    v_mfma_f32_16x16x32_bf16 v[44:47], v[148:151], v[88:91], v[44:47]
    ds_read_b128 v[56:59], v20 offset:36864
    v_mfma_f32_16x16x32_bf16 v[48:51], v[152:155], v[88:91], v[48:51]
    ds_read_b128 v[60:63], v22 offset:32768
    ds_read_b64_tr_b16 v[124:125], v29 offset:4096
    v_mfma_f32_16x16x32_bf16 v[36:39], v[156:159], v[92:95], v[36:39]
    ds_read_b64_tr_b16 v[126:127], v29 offset:4608
    v_mfma_f32_16x16x32_bf16 v[40:43], v[160:163], v[92:95], v[40:43]
    ds_read_b64_tr_b16 v[128:129], v32 offset:4096
    ds_read_b64_tr_b16 v[130:131], v32 offset:4608
    v_mfma_f32_16x16x32_bf16 v[44:47], v[156:159], v[96:99], v[44:47]
    ds_read_b128 v[64:67], v22 offset:36864
    v_mfma_f32_16x16x32_bf16 v[48:51], v[160:163], v[96:99], v[48:51]
    ds_read_b128 v[68:71], v24 offset:32768
    ds_read_b64_tr_b16 v[132:133], v29 offset:8192
    v_mfma_f32_16x16x32_bf16 v[36:39], v[164:167], v[100:103], v[36:39]
    ds_read_b64_tr_b16 v[134:135], v29 offset:8704
    v_mfma_f32_16x16x32_bf16 v[40:43], v[168:171], v[100:103], v[40:43]
    ds_read_b64_tr_b16 v[136:137], v32 offset:8192
    ds_read_b64_tr_b16 v[138:139], v32 offset:8704
    v_mfma_f32_16x16x32_bf16 v[44:47], v[164:167], v[104:107], v[44:47]
    ds_read_b128 v[72:75], v24 offset:36864
    v_mfma_f32_16x16x32_bf16 v[48:51], v[168:171], v[104:107], v[48:51]
    ds_read_b128 v[76:79], v26 offset:32768
    ds_read_b64_tr_b16 v[140:141], v29 offset:12288
    v_mfma_f32_16x16x32_bf16 v[36:39], v[172:175], v[108:111], v[36:39]
    ds_read_b64_tr_b16 v[142:143], v29 offset:12800
    v_mfma_f32_16x16x32_bf16 v[40:43], v[176:179], v[108:111], v[40:43]
    ds_read_b64_tr_b16 v[144:145], v32 offset:12288
    ds_read_b64_tr_b16 v[146:147], v32 offset:12800
    v_mfma_f32_16x16x32_bf16 v[44:47], v[172:175], v[112:115], v[44:47]
    ds_read_b128 v[80:83], v26 offset:36864
    v_mfma_f32_16x16x32_bf16 v[48:51], v[176:179], v[112:115], v[48:51]
    s_waitcnt lgkmcnt(0)
    s_barrier
    ds_read_b128 v[84:87], v20 offset:49152
    ds_read_b64_tr_b16 v[148:149], v29 offset:16384
    v_mfma_f32_16x16x32_bf16 v[36:39], v[116:119], v[52:55], v[36:39]
    ds_read_b64_tr_b16 v[150:151], v29 offset:16896
    v_mfma_f32_16x16x32_bf16 v[40:43], v[120:123], v[52:55], v[40:43]
    ds_read_b64_tr_b16 v[152:153], v32 offset:16384
    ds_read_b64_tr_b16 v[154:155], v32 offset:16896
    v_mfma_f32_16x16x32_bf16 v[44:47], v[116:119], v[56:59], v[44:47]
    ds_read_b128 v[88:91], v20 offset:53248
    v_mfma_f32_16x16x32_bf16 v[48:51], v[120:123], v[56:59], v[48:51]
    ds_read_b128 v[92:95], v22 offset:49152
    ds_read_b64_tr_b16 v[156:157], v29 offset:20480
    v_mfma_f32_16x16x32_bf16 v[36:39], v[124:127], v[60:63], v[36:39]
    ds_read_b64_tr_b16 v[158:159], v29 offset:20992
    v_mfma_f32_16x16x32_bf16 v[40:43], v[128:131], v[60:63], v[40:43]
    ds_read_b64_tr_b16 v[160:161], v32 offset:20480
    ds_read_b64_tr_b16 v[162:163], v32 offset:20992
    v_mfma_f32_16x16x32_bf16 v[44:47], v[124:127], v[64:67], v[44:47]
    ds_read_b128 v[96:99], v22 offset:53248
    v_mfma_f32_16x16x32_bf16 v[48:51], v[128:131], v[64:67], v[48:51]
    ds_read_b128 v[100:103], v24 offset:49152
    ds_read_b64_tr_b16 v[164:165], v29 offset:24576
    v_mfma_f32_16x16x32_bf16 v[36:39], v[132:135], v[68:71], v[36:39]
    ds_read_b64_tr_b16 v[166:167], v29 offset:25088
    v_mfma_f32_16x16x32_bf16 v[40:43], v[136:139], v[68:71], v[40:43]
    ds_read_b64_tr_b16 v[168:169], v32 offset:24576
    ds_read_b64_tr_b16 v[170:171], v32 offset:25088
    v_mfma_f32_16x16x32_bf16 v[44:47], v[132:135], v[72:75], v[44:47]
    ds_read_b128 v[104:107], v24 offset:53248
    v_mfma_f32_16x16x32_bf16 v[48:51], v[136:139], v[72:75], v[48:51]
    ds_read_b128 v[108:111], v26 offset:49152
    ds_read_b64_tr_b16 v[172:173], v29 offset:28672
    v_mfma_f32_16x16x32_bf16 v[36:39], v[140:143], v[76:79], v[36:39]
    ds_read_b64_tr_b16 v[174:175], v29 offset:29184
    v_mfma_f32_16x16x32_bf16 v[40:43], v[144:147], v[76:79], v[40:43]
    ds_read_b64_tr_b16 v[176:177], v32 offset:28672
    ds_read_b64_tr_b16 v[178:179], v32 offset:29184
    v_mfma_f32_16x16x32_bf16 v[44:47], v[140:143], v[80:83], v[44:47]
    ds_read_b128 v[112:115], v26 offset:53248
    v_mfma_f32_16x16x32_bf16 v[48:51], v[144:147], v[80:83], v[48:51]
    s_waitcnt lgkmcnt(0)
    s_barrier
    ds_read_b128 v[52:55], v20 offset:0
    ds_read_b64_tr_b16 v[116:117], v29 offset:32768
    v_mfma_f32_16x16x32_bf16 v[36:39], v[148:151], v[84:87], v[36:39]
    ds_read_b64_tr_b16 v[118:119], v29 offset:33280
    v_mfma_f32_16x16x32_bf16 v[40:43], v[152:155], v[84:87], v[40:43]
    ds_read_b64_tr_b16 v[120:121], v32 offset:32768
    ds_read_b64_tr_b16 v[122:123], v32 offset:33280
    v_mfma_f32_16x16x32_bf16 v[44:47], v[148:151], v[88:91], v[44:47]
    ds_read_b128 v[56:59], v20 offset:4096
    v_mfma_f32_16x16x32_bf16 v[48:51], v[152:155], v[88:91], v[48:51]
    ds_read_b128 v[60:63], v22 offset:0
    ds_read_b64_tr_b16 v[124:125], v29 offset:36864
    v_mfma_f32_16x16x32_bf16 v[36:39], v[156:159], v[92:95], v[36:39]
    ds_read_b64_tr_b16 v[126:127], v29 offset:37376
    v_mfma_f32_16x16x32_bf16 v[40:43], v[160:163], v[92:95], v[40:43]
    ds_read_b64_tr_b16 v[128:129], v32 offset:36864
    ds_read_b64_tr_b16 v[130:131], v32 offset:37376
    v_mfma_f32_16x16x32_bf16 v[44:47], v[156:159], v[96:99], v[44:47]
    ds_read_b128 v[64:67], v22 offset:4096
    v_mfma_f32_16x16x32_bf16 v[48:51], v[160:163], v[96:99], v[48:51]
    ds_read_b128 v[68:71], v24 offset:0
    ds_read_b64_tr_b16 v[132:133], v29 offset:40960
    v_mfma_f32_16x16x32_bf16 v[36:39], v[164:167], v[100:103], v[36:39]
    ds_read_b64_tr_b16 v[134:135], v29 offset:41472
    v_mfma_f32_16x16x32_bf16 v[40:43], v[168:171], v[100:103], v[40:43]
    ds_read_b64_tr_b16 v[136:137], v32 offset:40960
    ds_read_b64_tr_b16 v[138:139], v32 offset:41472
    v_mfma_f32_16x16x32_bf16 v[44:47], v[164:167], v[104:107], v[44:47]
    ds_read_b128 v[72:75], v24 offset:4096
    v_mfma_f32_16x16x32_bf16 v[48:51], v[168:171], v[104:107], v[48:51]
    ds_read_b128 v[76:79], v26 offset:0
    ds_read_b64_tr_b16 v[140:141], v29 offset:45056
    v_mfma_f32_16x16x32_bf16 v[36:39], v[172:175], v[108:111], v[36:39]
    ds_read_b64_tr_b16 v[142:143], v29 offset:45568
    v_mfma_f32_16x16x32_bf16 v[40:43], v[176:179], v[108:111], v[40:43]
    ds_read_b64_tr_b16 v[144:145], v32 offset:45056
    ds_read_b64_tr_b16 v[146:147], v32 offset:45568
    v_mfma_f32_16x16x32_bf16 v[44:47], v[172:175], v[112:115], v[44:47]
    ds_read_b128 v[80:83], v26 offset:4096
    v_mfma_f32_16x16x32_bf16 v[48:51], v[176:179], v[112:115], v[48:51]
    s_waitcnt lgkmcnt(0)
    s_barrier
    ds_read_b128 v[84:87], v20 offset:16384
    ds_read_b64_tr_b16 v[148:149], v29 offset:49152
    v_mfma_f32_16x16x32_bf16 v[36:39], v[116:119], v[52:55], v[36:39]
    ds_read_b64_tr_b16 v[150:151], v29 offset:49664
    v_mfma_f32_16x16x32_bf16 v[40:43], v[120:123], v[52:55], v[40:43]
    ds_read_b64_tr_b16 v[152:153], v32 offset:49152
    ds_read_b64_tr_b16 v[154:155], v32 offset:49664
    v_mfma_f32_16x16x32_bf16 v[44:47], v[116:119], v[56:59], v[44:47]
    ds_read_b128 v[88:91], v20 offset:20480
    v_mfma_f32_16x16x32_bf16 v[48:51], v[120:123], v[56:59], v[48:51]
    ds_read_b128 v[92:95], v22 offset:16384
    ds_read_b64_tr_b16 v[156:157], v29 offset:53248
    v_mfma_f32_16x16x32_bf16 v[36:39], v[124:127], v[60:63], v[36:39]
    ds_read_b64_tr_b16 v[158:159], v29 offset:53760
    v_mfma_f32_16x16x32_bf16 v[40:43], v[128:131], v[60:63], v[40:43]
    ds_read_b64_tr_b16 v[160:161], v32 offset:53248
    ds_read_b64_tr_b16 v[162:163], v32 offset:53760
    v_mfma_f32_16x16x32_bf16 v[44:47], v[124:127], v[64:67], v[44:47]
    ds_read_b128 v[96:99], v22 offset:20480
    v_mfma_f32_16x16x32_bf16 v[48:51], v[128:131], v[64:67], v[48:51]
    ds_read_b128 v[100:103], v24 offset:16384
    ds_read_b64_tr_b16 v[164:165], v29 offset:57344
    v_mfma_f32_16x16x32_bf16 v[36:39], v[132:135], v[68:71], v[36:39]
    ds_read_b64_tr_b16 v[166:167], v29 offset:57856
    v_mfma_f32_16x16x32_bf16 v[40:43], v[136:139], v[68:71], v[40:43]
    ds_read_b64_tr_b16 v[168:169], v32 offset:57344
    ds_read_b64_tr_b16 v[170:171], v32 offset:57856
    v_mfma_f32_16x16x32_bf16 v[44:47], v[132:135], v[72:75], v[44:47]
    ds_read_b128 v[104:107], v24 offset:20480
    v_mfma_f32_16x16x32_bf16 v[48:51], v[136:139], v[72:75], v[48:51]
    ds_read_b128 v[108:111], v26 offset:16384
    ds_read_b64_tr_b16 v[172:173], v29 offset:61440
    v_mfma_f32_16x16x32_bf16 v[36:39], v[140:143], v[76:79], v[36:39]
    ds_read_b64_tr_b16 v[174:175], v29 offset:61952
    v_mfma_f32_16x16x32_bf16 v[40:43], v[144:147], v[76:79], v[40:43]
    ds_read_b64_tr_b16 v[176:177], v32 offset:61440
    ds_read_b64_tr_b16 v[178:179], v32 offset:61952
    v_mfma_f32_16x16x32_bf16 v[44:47], v[140:143], v[80:83], v[44:47]
    ds_read_b128 v[112:115], v26 offset:20480
    v_mfma_f32_16x16x32_bf16 v[48:51], v[144:147], v[80:83], v[48:51]
    s_waitcnt lgkmcnt(0)
    s_barrier
    ds_read_b128 v[52:55], v20 offset:32768
    ds_read_b64_tr_b16 v[116:117], v30 offset:0
    v_mfma_f32_16x16x32_bf16 v[36:39], v[148:151], v[84:87], v[36:39]
    ds_read_b64_tr_b16 v[118:119], v30 offset:512
    v_mfma_f32_16x16x32_bf16 v[40:43], v[152:155], v[84:87], v[40:43]
    ds_read_b64_tr_b16 v[120:121], v33 offset:0
    ds_read_b64_tr_b16 v[122:123], v33 offset:512
    v_mfma_f32_16x16x32_bf16 v[44:47], v[148:151], v[88:91], v[44:47]
    ds_read_b128 v[56:59], v20 offset:36864
    v_mfma_f32_16x16x32_bf16 v[48:51], v[152:155], v[88:91], v[48:51]
    ds_read_b128 v[60:63], v22 offset:32768
    ds_read_b64_tr_b16 v[124:125], v30 offset:4096
    v_mfma_f32_16x16x32_bf16 v[36:39], v[156:159], v[92:95], v[36:39]
    ds_read_b64_tr_b16 v[126:127], v30 offset:4608
    v_mfma_f32_16x16x32_bf16 v[40:43], v[160:163], v[92:95], v[40:43]
    ds_read_b64_tr_b16 v[128:129], v33 offset:4096
    ds_read_b64_tr_b16 v[130:131], v33 offset:4608
    v_mfma_f32_16x16x32_bf16 v[44:47], v[156:159], v[96:99], v[44:47]
    ds_read_b128 v[64:67], v22 offset:36864
    v_mfma_f32_16x16x32_bf16 v[48:51], v[160:163], v[96:99], v[48:51]
    ds_read_b128 v[68:71], v24 offset:32768
    ds_read_b64_tr_b16 v[132:133], v30 offset:8192
    v_mfma_f32_16x16x32_bf16 v[36:39], v[164:167], v[100:103], v[36:39]
    ds_read_b64_tr_b16 v[134:135], v30 offset:8704
    v_mfma_f32_16x16x32_bf16 v[40:43], v[168:171], v[100:103], v[40:43]
    ds_read_b64_tr_b16 v[136:137], v33 offset:8192
    ds_read_b64_tr_b16 v[138:139], v33 offset:8704
    v_mfma_f32_16x16x32_bf16 v[44:47], v[164:167], v[104:107], v[44:47]
    ds_read_b128 v[72:75], v24 offset:36864
    v_mfma_f32_16x16x32_bf16 v[48:51], v[168:171], v[104:107], v[48:51]
    ds_read_b128 v[76:79], v26 offset:32768
    ds_read_b64_tr_b16 v[140:141], v30 offset:12288
    v_mfma_f32_16x16x32_bf16 v[36:39], v[172:175], v[108:111], v[36:39]
    ds_read_b64_tr_b16 v[142:143], v30 offset:12800
    v_mfma_f32_16x16x32_bf16 v[40:43], v[176:179], v[108:111], v[40:43]
    ds_read_b64_tr_b16 v[144:145], v33 offset:12288
    ds_read_b64_tr_b16 v[146:147], v33 offset:12800
    v_mfma_f32_16x16x32_bf16 v[44:47], v[172:175], v[112:115], v[44:47]
    ds_read_b128 v[80:83], v26 offset:36864
    v_mfma_f32_16x16x32_bf16 v[48:51], v[176:179], v[112:115], v[48:51]
    s_waitcnt lgkmcnt(0)
    s_barrier
    ds_read_b128 v[84:87], v20 offset:49152
    ds_read_b64_tr_b16 v[148:149], v29 offset:0
    v_mfma_f32_16x16x32_bf16 v[36:39], v[116:119], v[52:55], v[36:39]
    ds_read_b64_tr_b16 v[150:151], v29 offset:512
    v_mfma_f32_16x16x32_bf16 v[40:43], v[120:123], v[52:55], v[40:43]
    ds_read_b64_tr_b16 v[152:153], v32 offset:0
    ds_read_b64_tr_b16 v[154:155], v32 offset:512
    v_mfma_f32_16x16x32_bf16 v[44:47], v[116:119], v[56:59], v[44:47]
    ds_read_b128 v[88:91], v20 offset:53248
    v_mfma_f32_16x16x32_bf16 v[48:51], v[120:123], v[56:59], v[48:51]
    ds_read_b128 v[92:95], v22 offset:49152
    ds_read_b64_tr_b16 v[156:157], v29 offset:4096
    v_mfma_f32_16x16x32_bf16 v[36:39], v[124:127], v[60:63], v[36:39]
    ds_read_b64_tr_b16 v[158:159], v29 offset:4608
    v_mfma_f32_16x16x32_bf16 v[40:43], v[128:131], v[60:63], v[40:43]
    ds_read_b64_tr_b16 v[160:161], v32 offset:4096
    ds_read_b64_tr_b16 v[162:163], v32 offset:4608
    v_mfma_f32_16x16x32_bf16 v[44:47], v[124:127], v[64:67], v[44:47]
    ds_read_b128 v[96:99], v22 offset:53248
    v_mfma_f32_16x16x32_bf16 v[48:51], v[128:131], v[64:67], v[48:51]
    ds_read_b128 v[100:103], v24 offset:49152
    ds_read_b64_tr_b16 v[164:165], v29 offset:8192
    v_mfma_f32_16x16x32_bf16 v[36:39], v[132:135], v[68:71], v[36:39]
    ds_read_b64_tr_b16 v[166:167], v29 offset:8704
    v_mfma_f32_16x16x32_bf16 v[40:43], v[136:139], v[68:71], v[40:43]
    ds_read_b64_tr_b16 v[168:169], v32 offset:8192
    ds_read_b64_tr_b16 v[170:171], v32 offset:8704
    v_mfma_f32_16x16x32_bf16 v[44:47], v[132:135], v[72:75], v[44:47]
    ds_read_b128 v[104:107], v24 offset:53248
    v_mfma_f32_16x16x32_bf16 v[48:51], v[136:139], v[72:75], v[48:51]
    ds_read_b128 v[108:111], v26 offset:49152
    ds_read_b64_tr_b16 v[172:173], v29 offset:12288
    v_mfma_f32_16x16x32_bf16 v[36:39], v[140:143], v[76:79], v[36:39]
    ds_read_b64_tr_b16 v[174:175], v29 offset:12800
    v_mfma_f32_16x16x32_bf16 v[40:43], v[144:147], v[76:79], v[40:43]
    ds_read_b64_tr_b16 v[176:177], v32 offset:12288
    ds_read_b64_tr_b16 v[178:179], v32 offset:12800
    v_mfma_f32_16x16x32_bf16 v[44:47], v[140:143], v[80:83], v[44:47]
    ds_read_b128 v[112:115], v26 offset:53248
    v_mfma_f32_16x16x32_bf16 v[48:51], v[144:147], v[80:83], v[48:51]
    s_waitcnt lgkmcnt(0)
    s_barrier
    ds_read_b128 v[52:55], v20 offset:0
    ds_read_b64_tr_b16 v[116:117], v29 offset:16384
    v_mfma_f32_16x16x32_bf16 v[36:39], v[148:151], v[84:87], v[36:39]
    ds_read_b64_tr_b16 v[118:119], v29 offset:16896
    v_mfma_f32_16x16x32_bf16 v[40:43], v[152:155], v[84:87], v[40:43]
    ds_read_b64_tr_b16 v[120:121], v32 offset:16384
    ds_read_b64_tr_b16 v[122:123], v32 offset:16896
    v_mfma_f32_16x16x32_bf16 v[44:47], v[148:151], v[88:91], v[44:47]
    ds_read_b128 v[56:59], v20 offset:4096
    v_mfma_f32_16x16x32_bf16 v[48:51], v[152:155], v[88:91], v[48:51]
    ds_read_b128 v[60:63], v22 offset:0
    ds_read_b64_tr_b16 v[124:125], v29 offset:20480
    v_mfma_f32_16x16x32_bf16 v[36:39], v[156:159], v[92:95], v[36:39]
    ds_read_b64_tr_b16 v[126:127], v29 offset:20992
    v_mfma_f32_16x16x32_bf16 v[40:43], v[160:163], v[92:95], v[40:43]
    ds_read_b64_tr_b16 v[128:129], v32 offset:20480
    ds_read_b64_tr_b16 v[130:131], v32 offset:20992
    v_mfma_f32_16x16x32_bf16 v[44:47], v[156:159], v[96:99], v[44:47]
    ds_read_b128 v[64:67], v22 offset:4096
    v_mfma_f32_16x16x32_bf16 v[48:51], v[160:163], v[96:99], v[48:51]
    ds_read_b128 v[68:71], v24 offset:0
    ds_read_b64_tr_b16 v[132:133], v29 offset:24576
    v_mfma_f32_16x16x32_bf16 v[36:39], v[164:167], v[100:103], v[36:39]
    ds_read_b64_tr_b16 v[134:135], v29 offset:25088
    v_mfma_f32_16x16x32_bf16 v[40:43], v[168:171], v[100:103], v[40:43]
    ds_read_b64_tr_b16 v[136:137], v32 offset:24576
    ds_read_b64_tr_b16 v[138:139], v32 offset:25088
    v_mfma_f32_16x16x32_bf16 v[44:47], v[164:167], v[104:107], v[44:47]
    ds_read_b128 v[72:75], v24 offset:4096
    v_mfma_f32_16x16x32_bf16 v[48:51], v[168:171], v[104:107], v[48:51]
    ds_read_b128 v[76:79], v26 offset:0
    ds_read_b64_tr_b16 v[140:141], v29 offset:28672
    v_mfma_f32_16x16x32_bf16 v[36:39], v[172:175], v[108:111], v[36:39]
    ds_read_b64_tr_b16 v[142:143], v29 offset:29184
    v_mfma_f32_16x16x32_bf16 v[40:43], v[176:179], v[108:111], v[40:43]
    ds_read_b64_tr_b16 v[144:145], v32 offset:28672
    ds_read_b64_tr_b16 v[146:147], v32 offset:29184
    v_mfma_f32_16x16x32_bf16 v[44:47], v[172:175], v[112:115], v[44:47]
    ds_read_b128 v[80:83], v26 offset:4096
    v_mfma_f32_16x16x32_bf16 v[48:51], v[176:179], v[112:115], v[48:51]
    s_waitcnt lgkmcnt(0)
    s_barrier
    ds_read_b128 v[84:87], v20 offset:16384
    ds_read_b64_tr_b16 v[148:149], v29 offset:32768
    v_mfma_f32_16x16x32_bf16 v[36:39], v[116:119], v[52:55], v[36:39]
    ds_read_b64_tr_b16 v[150:151], v29 offset:33280
    v_mfma_f32_16x16x32_bf16 v[40:43], v[120:123], v[52:55], v[40:43]
    ds_read_b64_tr_b16 v[152:153], v32 offset:32768
    ds_read_b64_tr_b16 v[154:155], v32 offset:33280
    v_mfma_f32_16x16x32_bf16 v[44:47], v[116:119], v[56:59], v[44:47]
    ds_read_b128 v[88:91], v20 offset:20480
    v_mfma_f32_16x16x32_bf16 v[48:51], v[120:123], v[56:59], v[48:51]
    ds_read_b128 v[92:95], v22 offset:16384
    ds_read_b64_tr_b16 v[156:157], v29 offset:36864
    v_mfma_f32_16x16x32_bf16 v[36:39], v[124:127], v[60:63], v[36:39]
    ds_read_b64_tr_b16 v[158:159], v29 offset:37376
    v_mfma_f32_16x16x32_bf16 v[40:43], v[128:131], v[60:63], v[40:43]
    ds_read_b64_tr_b16 v[160:161], v32 offset:36864
    ds_read_b64_tr_b16 v[162:163], v32 offset:37376
    v_mfma_f32_16x16x32_bf16 v[44:47], v[124:127], v[64:67], v[44:47]
    ds_read_b128 v[96:99], v22 offset:20480
    v_mfma_f32_16x16x32_bf16 v[48:51], v[128:131], v[64:67], v[48:51]
    ds_read_b128 v[100:103], v24 offset:16384
    ds_read_b64_tr_b16 v[164:165], v29 offset:40960
    v_mfma_f32_16x16x32_bf16 v[36:39], v[132:135], v[68:71], v[36:39]
    ds_read_b64_tr_b16 v[166:167], v29 offset:41472
    v_mfma_f32_16x16x32_bf16 v[40:43], v[136:139], v[68:71], v[40:43]
    ds_read_b64_tr_b16 v[168:169], v32 offset:40960
    ds_read_b64_tr_b16 v[170:171], v32 offset:41472
    v_mfma_f32_16x16x32_bf16 v[44:47], v[132:135], v[72:75], v[44:47]
    ds_read_b128 v[104:107], v24 offset:20480
    v_mfma_f32_16x16x32_bf16 v[48:51], v[136:139], v[72:75], v[48:51]
    ds_read_b128 v[108:111], v26 offset:16384
    ds_read_b64_tr_b16 v[172:173], v29 offset:45056
    v_mfma_f32_16x16x32_bf16 v[36:39], v[140:143], v[76:79], v[36:39]
    ds_read_b64_tr_b16 v[174:175], v29 offset:45568
    v_mfma_f32_16x16x32_bf16 v[40:43], v[144:147], v[76:79], v[40:43]
    ds_read_b64_tr_b16 v[176:177], v32 offset:45056
    ds_read_b64_tr_b16 v[178:179], v32 offset:45568
    v_mfma_f32_16x16x32_bf16 v[44:47], v[140:143], v[80:83], v[44:47]
    ds_read_b128 v[112:115], v26 offset:20480
    v_mfma_f32_16x16x32_bf16 v[48:51], v[144:147], v[80:83], v[48:51]
    s_waitcnt lgkmcnt(0)
    s_barrier
    ds_read_b128 v[52:55], v20 offset:32768
    ds_read_b64_tr_b16 v[116:117], v29 offset:49152
    v_mfma_f32_16x16x32_bf16 v[36:39], v[148:151], v[84:87], v[36:39]
    ds_read_b64_tr_b16 v[118:119], v29 offset:49664
    v_mfma_f32_16x16x32_bf16 v[40:43], v[152:155], v[84:87], v[40:43]
    ds_read_b64_tr_b16 v[120:121], v32 offset:49152
    ds_read_b64_tr_b16 v[122:123], v32 offset:49664
    v_mfma_f32_16x16x32_bf16 v[44:47], v[148:151], v[88:91], v[44:47]
    ds_read_b128 v[56:59], v20 offset:36864
    v_mfma_f32_16x16x32_bf16 v[48:51], v[152:155], v[88:91], v[48:51]
    ds_read_b128 v[60:63], v22 offset:32768
    ds_read_b64_tr_b16 v[124:125], v29 offset:53248
    v_mfma_f32_16x16x32_bf16 v[36:39], v[156:159], v[92:95], v[36:39]
    ds_read_b64_tr_b16 v[126:127], v29 offset:53760
    v_mfma_f32_16x16x32_bf16 v[40:43], v[160:163], v[92:95], v[40:43]
    ds_read_b64_tr_b16 v[128:129], v32 offset:53248
    ds_read_b64_tr_b16 v[130:131], v32 offset:53760
    v_mfma_f32_16x16x32_bf16 v[44:47], v[156:159], v[96:99], v[44:47]
    ds_read_b128 v[64:67], v22 offset:36864
    v_mfma_f32_16x16x32_bf16 v[48:51], v[160:163], v[96:99], v[48:51]
    ds_read_b128 v[68:71], v24 offset:32768
    ds_read_b64_tr_b16 v[132:133], v29 offset:57344
    v_mfma_f32_16x16x32_bf16 v[36:39], v[164:167], v[100:103], v[36:39]
    ds_read_b64_tr_b16 v[134:135], v29 offset:57856
    v_mfma_f32_16x16x32_bf16 v[40:43], v[168:171], v[100:103], v[40:43]
    ds_read_b64_tr_b16 v[136:137], v32 offset:57344
    ds_read_b64_tr_b16 v[138:139], v32 offset:57856
    v_mfma_f32_16x16x32_bf16 v[44:47], v[164:167], v[104:107], v[44:47]
    ds_read_b128 v[72:75], v24 offset:36864
    v_mfma_f32_16x16x32_bf16 v[48:51], v[168:171], v[104:107], v[48:51]
    ds_read_b128 v[76:79], v26 offset:32768
    ds_read_b64_tr_b16 v[140:141], v29 offset:61440
    v_mfma_f32_16x16x32_bf16 v[36:39], v[172:175], v[108:111], v[36:39]
    ds_read_b64_tr_b16 v[142:143], v29 offset:61952
    v_mfma_f32_16x16x32_bf16 v[40:43], v[176:179], v[108:111], v[40:43]
    ds_read_b64_tr_b16 v[144:145], v32 offset:61440
    ds_read_b64_tr_b16 v[146:147], v32 offset:61952
    v_mfma_f32_16x16x32_bf16 v[44:47], v[172:175], v[112:115], v[44:47]
    ds_read_b128 v[80:83], v26 offset:36864
    v_mfma_f32_16x16x32_bf16 v[48:51], v[176:179], v[112:115], v[48:51]
    s_waitcnt lgkmcnt(0)
    s_barrier
    ds_read_b128 v[84:87], v20 offset:49152
    ds_read_b64_tr_b16 v[148:149], v30 offset:0
    v_mfma_f32_16x16x32_bf16 v[36:39], v[116:119], v[52:55], v[36:39]
    ds_read_b64_tr_b16 v[150:151], v30 offset:512
    v_mfma_f32_16x16x32_bf16 v[40:43], v[120:123], v[52:55], v[40:43]
    ds_read_b64_tr_b16 v[152:153], v33 offset:0
    ds_read_b64_tr_b16 v[154:155], v33 offset:512
    v_mfma_f32_16x16x32_bf16 v[44:47], v[116:119], v[56:59], v[44:47]
    ds_read_b128 v[88:91], v20 offset:53248
    v_mfma_f32_16x16x32_bf16 v[48:51], v[120:123], v[56:59], v[48:51]
    ds_read_b128 v[92:95], v22 offset:49152
    ds_read_b64_tr_b16 v[156:157], v30 offset:4096
    v_mfma_f32_16x16x32_bf16 v[36:39], v[124:127], v[60:63], v[36:39]
    ds_read_b64_tr_b16 v[158:159], v30 offset:4608
    v_mfma_f32_16x16x32_bf16 v[40:43], v[128:131], v[60:63], v[40:43]
    ds_read_b64_tr_b16 v[160:161], v33 offset:4096
    ds_read_b64_tr_b16 v[162:163], v33 offset:4608
    v_mfma_f32_16x16x32_bf16 v[44:47], v[124:127], v[64:67], v[44:47]
    ds_read_b128 v[96:99], v22 offset:53248
    v_mfma_f32_16x16x32_bf16 v[48:51], v[128:131], v[64:67], v[48:51]
    ds_read_b128 v[100:103], v24 offset:49152
    ds_read_b64_tr_b16 v[164:165], v30 offset:8192
    v_mfma_f32_16x16x32_bf16 v[36:39], v[132:135], v[68:71], v[36:39]
    ds_read_b64_tr_b16 v[166:167], v30 offset:8704
    v_mfma_f32_16x16x32_bf16 v[40:43], v[136:139], v[68:71], v[40:43]
    ds_read_b64_tr_b16 v[168:169], v33 offset:8192
    ds_read_b64_tr_b16 v[170:171], v33 offset:8704
    v_mfma_f32_16x16x32_bf16 v[44:47], v[132:135], v[72:75], v[44:47]
    ds_read_b128 v[104:107], v24 offset:53248
    v_mfma_f32_16x16x32_bf16 v[48:51], v[136:139], v[72:75], v[48:51]
    ds_read_b128 v[108:111], v26 offset:49152
    ds_read_b64_tr_b16 v[172:173], v30 offset:12288
    v_mfma_f32_16x16x32_bf16 v[36:39], v[140:143], v[76:79], v[36:39]
    ds_read_b64_tr_b16 v[174:175], v30 offset:12800
    v_mfma_f32_16x16x32_bf16 v[40:43], v[144:147], v[76:79], v[40:43]
    ds_read_b64_tr_b16 v[176:177], v33 offset:12288
    ds_read_b64_tr_b16 v[178:179], v33 offset:12800
    v_mfma_f32_16x16x32_bf16 v[44:47], v[140:143], v[80:83], v[44:47]
    ds_read_b128 v[112:115], v26 offset:53248
    v_mfma_f32_16x16x32_bf16 v[48:51], v[144:147], v[80:83], v[48:51]
    s_waitcnt lgkmcnt(0)
    s_barrier
    ds_read_b128 v[52:55], v20 offset:0
    ds_read_b64_tr_b16 v[116:117], v29 offset:0
    v_mfma_f32_16x16x32_bf16 v[36:39], v[148:151], v[84:87], v[36:39]
    ds_read_b64_tr_b16 v[118:119], v29 offset:512
    v_mfma_f32_16x16x32_bf16 v[40:43], v[152:155], v[84:87], v[40:43]
    ds_read_b64_tr_b16 v[120:121], v32 offset:0
    ds_read_b64_tr_b16 v[122:123], v32 offset:512
    v_mfma_f32_16x16x32_bf16 v[44:47], v[148:151], v[88:91], v[44:47]
    ds_read_b128 v[56:59], v20 offset:4096
    v_mfma_f32_16x16x32_bf16 v[48:51], v[152:155], v[88:91], v[48:51]
    ds_read_b128 v[60:63], v22 offset:0
    ds_read_b64_tr_b16 v[124:125], v29 offset:4096
    v_mfma_f32_16x16x32_bf16 v[36:39], v[156:159], v[92:95], v[36:39]
    ds_read_b64_tr_b16 v[126:127], v29 offset:4608
    v_mfma_f32_16x16x32_bf16 v[40:43], v[160:163], v[92:95], v[40:43]
    ds_read_b64_tr_b16 v[128:129], v32 offset:4096
    ds_read_b64_tr_b16 v[130:131], v32 offset:4608
    v_mfma_f32_16x16x32_bf16 v[44:47], v[156:159], v[96:99], v[44:47]
    ds_read_b128 v[64:67], v22 offset:4096
    v_mfma_f32_16x16x32_bf16 v[48:51], v[160:163], v[96:99], v[48:51]
    ds_read_b128 v[68:71], v24 offset:0
    ds_read_b64_tr_b16 v[132:133], v29 offset:8192
    v_mfma_f32_16x16x32_bf16 v[36:39], v[164:167], v[100:103], v[36:39]
    ds_read_b64_tr_b16 v[134:135], v29 offset:8704
    v_mfma_f32_16x16x32_bf16 v[40:43], v[168:171], v[100:103], v[40:43]
    ds_read_b64_tr_b16 v[136:137], v32 offset:8192
    ds_read_b64_tr_b16 v[138:139], v32 offset:8704
    v_mfma_f32_16x16x32_bf16 v[44:47], v[164:167], v[104:107], v[44:47]
    ds_read_b128 v[72:75], v24 offset:4096
    v_mfma_f32_16x16x32_bf16 v[48:51], v[168:171], v[104:107], v[48:51]
    ds_read_b128 v[76:79], v26 offset:0
    ds_read_b64_tr_b16 v[140:141], v29 offset:12288
    v_mfma_f32_16x16x32_bf16 v[36:39], v[172:175], v[108:111], v[36:39]
    ds_read_b64_tr_b16 v[142:143], v29 offset:12800
    v_mfma_f32_16x16x32_bf16 v[40:43], v[176:179], v[108:111], v[40:43]
    ds_read_b64_tr_b16 v[144:145], v32 offset:12288
    ds_read_b64_tr_b16 v[146:147], v32 offset:12800
    v_mfma_f32_16x16x32_bf16 v[44:47], v[172:175], v[112:115], v[44:47]
    ds_read_b128 v[80:83], v26 offset:4096
    v_mfma_f32_16x16x32_bf16 v[48:51], v[176:179], v[112:115], v[48:51]
    s_waitcnt lgkmcnt(0)
    s_barrier
    ds_read_b128 v[84:87], v20 offset:16384
    ds_read_b64_tr_b16 v[148:149], v29 offset:16384
    v_mfma_f32_16x16x32_bf16 v[36:39], v[116:119], v[52:55], v[36:39]
    ds_read_b64_tr_b16 v[150:151], v29 offset:16896
    v_mfma_f32_16x16x32_bf16 v[40:43], v[120:123], v[52:55], v[40:43]
    ds_read_b64_tr_b16 v[152:153], v32 offset:16384
    ds_read_b64_tr_b16 v[154:155], v32 offset:16896
    v_mfma_f32_16x16x32_bf16 v[44:47], v[116:119], v[56:59], v[44:47]
    ds_read_b128 v[88:91], v20 offset:20480
    v_mfma_f32_16x16x32_bf16 v[48:51], v[120:123], v[56:59], v[48:51]
    ds_read_b128 v[92:95], v22 offset:16384
    ds_read_b64_tr_b16 v[156:157], v29 offset:20480
    v_mfma_f32_16x16x32_bf16 v[36:39], v[124:127], v[60:63], v[36:39]
    ds_read_b64_tr_b16 v[158:159], v29 offset:20992
    v_mfma_f32_16x16x32_bf16 v[40:43], v[128:131], v[60:63], v[40:43]
    ds_read_b64_tr_b16 v[160:161], v32 offset:20480
    ds_read_b64_tr_b16 v[162:163], v32 offset:20992
    v_mfma_f32_16x16x32_bf16 v[44:47], v[124:127], v[64:67], v[44:47]
    ds_read_b128 v[96:99], v22 offset:20480
    v_mfma_f32_16x16x32_bf16 v[48:51], v[128:131], v[64:67], v[48:51]
    ds_read_b128 v[100:103], v24 offset:16384
    ds_read_b64_tr_b16 v[164:165], v29 offset:24576
    v_mfma_f32_16x16x32_bf16 v[36:39], v[132:135], v[68:71], v[36:39]
    ds_read_b64_tr_b16 v[166:167], v29 offset:25088
    v_mfma_f32_16x16x32_bf16 v[40:43], v[136:139], v[68:71], v[40:43]
    ds_read_b64_tr_b16 v[168:169], v32 offset:24576
    ds_read_b64_tr_b16 v[170:171], v32 offset:25088
    v_mfma_f32_16x16x32_bf16 v[44:47], v[132:135], v[72:75], v[44:47]
    ds_read_b128 v[104:107], v24 offset:20480
    v_mfma_f32_16x16x32_bf16 v[48:51], v[136:139], v[72:75], v[48:51]
    ds_read_b128 v[108:111], v26 offset:16384
    ds_read_b64_tr_b16 v[172:173], v29 offset:28672
    v_mfma_f32_16x16x32_bf16 v[36:39], v[140:143], v[76:79], v[36:39]
    ds_read_b64_tr_b16 v[174:175], v29 offset:29184
    v_mfma_f32_16x16x32_bf16 v[40:43], v[144:147], v[76:79], v[40:43]
    ds_read_b64_tr_b16 v[176:177], v32 offset:28672
    ds_read_b64_tr_b16 v[178:179], v32 offset:29184
    v_mfma_f32_16x16x32_bf16 v[44:47], v[140:143], v[80:83], v[44:47]
    ds_read_b128 v[112:115], v26 offset:20480
    v_mfma_f32_16x16x32_bf16 v[48:51], v[144:147], v[80:83], v[48:51]
    s_waitcnt lgkmcnt(15)
    v_mfma_f32_16x16x32_bf16 v[36:39], v[148:151], v[84:87], v[36:39]
    v_mfma_f32_16x16x32_bf16 v[40:43], v[152:155], v[84:87], v[40:43]
    v_mfma_f32_16x16x32_bf16 v[44:47], v[148:151], v[88:91], v[44:47]
    v_mfma_f32_16x16x32_bf16 v[48:51], v[152:155], v[88:91], v[48:51]
    v_mfma_f32_16x16x32_bf16 v[36:39], v[156:159], v[92:95], v[36:39]
    s_waitcnt lgkmcnt(13)
    v_mfma_f32_16x16x32_bf16 v[40:43], v[160:163], v[92:95], v[40:43]
    s_waitcnt lgkmcnt(12)
    v_mfma_f32_16x16x32_bf16 v[44:47], v[156:159], v[96:99], v[44:47]
    v_mfma_f32_16x16x32_bf16 v[48:51], v[160:163], v[96:99], v[48:51]
    s_waitcnt lgkmcnt(9)
    v_mfma_f32_16x16x32_bf16 v[36:39], v[164:167], v[100:103], v[36:39]
    s_waitcnt lgkmcnt(7)
    v_mfma_f32_16x16x32_bf16 v[40:43], v[168:171], v[100:103], v[40:43]
    s_waitcnt lgkmcnt(6)
    v_mfma_f32_16x16x32_bf16 v[44:47], v[164:167], v[104:107], v[44:47]
    v_mfma_f32_16x16x32_bf16 v[48:51], v[168:171], v[104:107], v[48:51]
    s_waitcnt lgkmcnt(3)
    v_mfma_f32_16x16x32_bf16 v[36:39], v[172:175], v[108:111], v[36:39]
    s_waitcnt lgkmcnt(1)
    v_mfma_f32_16x16x32_bf16 v[40:43], v[176:179], v[108:111], v[40:43]
    s_waitcnt lgkmcnt(0)
    v_mfma_f32_16x16x32_bf16 v[44:47], v[172:175], v[112:115], v[44:47]
    v_mfma_f32_16x16x32_bf16 v[48:51], v[176:179], v[112:115], v[48:51]
    s_barrier
    v_add_u32 v180, s52, v2
    v_mul_u32_u24 v180, 144, v180
    v_lshl_add_u32 v180, v3, 3, v180
    s_lshl_b32 s57, s53, 6
    v_add_u32 v180, s57, v180
    v_cvt_pk_bf16_f32 v36, v36, v37
    v_cvt_pk_bf16_f32 v37, v38, v39
    ds_write_b64 v180, v[36:37] offset:0
    v_cvt_pk_bf16_f32 v40, v40, v41
    v_cvt_pk_bf16_f32 v41, v42, v43
    ds_write_b64 v180, v[40:41] offset:32
    v_cvt_pk_bf16_f32 v44, v44, v45
    v_cvt_pk_bf16_f32 v45, v46, v47
    ds_write_b64 v180, v[44:45] offset:2304
    v_cvt_pk_bf16_f32 v48, v48, v49
    v_cvt_pk_bf16_f32 v49, v50, v51
    ds_write_b64 v180, v[48:49] offset:2336
    s_waitcnt lgkmcnt(0)
    s_add_u32 s40, s20, 4194304
    s_addc_u32 s41, s21, 0
    s_and_b32 s41, s41, 0xffff
    s_mov_b32 s42, 2097152
    s_mov_b32 s43, 0x20000
    s_add_u32 s44, s20, 15204352
    s_addc_u32 s45, s21, 0
    s_and_b32 s45, s45, 0xffff
    s_mov_b32 s46, 131072
    s_mov_b32 s47, 0x20000
    s_barrier
    v_lshrrev_b32 v42, 3, v0
    v_and_b32 v43, 7, v0
    v_mul_u32_u24 v32, 144, v42
    v_lshl_add_u32 v32, v43, 4, v32
    ds_read_b128 v[24:27], v32
    ds_read_b128 v[28:31], v32 offset:4608
    v_add_u32 v42, s50, v42
    v_lshlrev_b32 v33, 10, v42
    v_lshl_add_u32 v33, v43, 4, v33
    v_add_u32 v33, s54, v33
    v_mov_b32 v36, 0
    v_mov_b32 v37, 0
    v_mov_b32 v38, 0
    v_mov_b32 v39, 0
    s_mov_b32 s60, 0x3f803f80
    v_lshlrev_b32 v32, 6, v42
    s_lshr_b32 s61, s54, 4
    v_add_u32 v32, s61, v32
    s_waitcnt lgkmcnt(1)
    v_lshlrev_b32 v42, 16, v24
    v_and_b32 v43, 0xffff0000, v24
    s_waitcnt vmcnt(1)
    v_lshlrev_b32 v44, 16, v12
    v_and_b32 v45, 0xffff0000, v12
    v_add_f32 v42, v42, v44
    v_add_f32 v43, v43, v45
    v_cvt_pk_bf16_f32 v24, v42, v43
    v_dot2_f32_bf16 v36, v24, s60, v36
    v_dot2_f32_bf16 v37, v24, v24, v37
    v_lshlrev_b32 v42, 16, v25
    v_and_b32 v43, 0xffff0000, v25
    v_lshlrev_b32 v44, 16, v13
    v_and_b32 v45, 0xffff0000, v13
    v_add_f32 v42, v42, v44
    v_add_f32 v43, v43, v45
    v_cvt_pk_bf16_f32 v25, v42, v43
    v_dot2_f32_bf16 v36, v25, s60, v36
    v_dot2_f32_bf16 v37, v25, v25, v37
    v_lshlrev_b32 v42, 16, v26
    v_and_b32 v43, 0xffff0000, v26
    v_lshlrev_b32 v44, 16, v14
    v_and_b32 v45, 0xffff0000, v14
    v_add_f32 v42, v42, v44
    v_add_f32 v43, v43, v45
    v_cvt_pk_bf16_f32 v26, v42, v43
    v_dot2_f32_bf16 v36, v26, s60, v36
    v_dot2_f32_bf16 v37, v26, v26, v37
    v_lshlrev_b32 v42, 16, v27
    v_and_b32 v43, 0xffff0000, v27
    v_lshlrev_b32 v44, 16, v15
    v_and_b32 v45, 0xffff0000, v15
    v_add_f32 v42, v42, v44
    v_add_f32 v43, v43, v45
    v_cvt_pk_bf16_f32 v27, v42, v43
    v_dot2_f32_bf16 v36, v27, s60, v36
    v_dot2_f32_bf16 v37, v27, v27, v37
    s_waitcnt lgkmcnt(0)
    v_lshlrev_b32 v42, 16, v28
    v_and_b32 v43, 0xffff0000, v28
    s_waitcnt vmcnt(0)
    v_lshlrev_b32 v44, 16, v16
    v_and_b32 v45, 0xffff0000, v16
    v_add_f32 v42, v42, v44
    v_add_f32 v43, v43, v45
    v_cvt_pk_bf16_f32 v28, v42, v43
    v_dot2_f32_bf16 v38, v28, s60, v38
    v_dot2_f32_bf16 v39, v28, v28, v39
    v_lshlrev_b32 v42, 16, v29
    v_and_b32 v43, 0xffff0000, v29
    v_lshlrev_b32 v44, 16, v17
    v_and_b32 v45, 0xffff0000, v17
    v_add_f32 v42, v42, v44
    v_add_f32 v43, v43, v45
    v_cvt_pk_bf16_f32 v29, v42, v43
    v_dot2_f32_bf16 v38, v29, s60, v38
    v_dot2_f32_bf16 v39, v29, v29, v39
    v_lshlrev_b32 v42, 16, v30
    v_and_b32 v43, 0xffff0000, v30
    v_lshlrev_b32 v44, 16, v18
    v_and_b32 v45, 0xffff0000, v18
    v_add_f32 v42, v42, v44
    v_add_f32 v43, v43, v45
    v_cvt_pk_bf16_f32 v30, v42, v43
    v_dot2_f32_bf16 v38, v30, s60, v38
    v_dot2_f32_bf16 v39, v30, v30, v39
    v_lshlrev_b32 v42, 16, v31
    v_and_b32 v43, 0xffff0000, v31
    v_lshlrev_b32 v44, 16, v19
    v_and_b32 v45, 0xffff0000, v19
    v_add_f32 v42, v42, v44
    v_add_f32 v43, v43, v45
    v_cvt_pk_bf16_f32 v31, v42, v43
    v_dot2_f32_bf16 v38, v31, s60, v38
    v_dot2_f32_bf16 v39, v31, v31, v39
    v_add_f32_dpp v40, v36, v36 quad_perm:[1,0,3,2] row_mask:0xf bank_mask:0xf
    v_add_f32_dpp v41, v37, v37 quad_perm:[1,0,3,2] row_mask:0xf bank_mask:0xf
    v_mov_b32 v36, v40
    v_mov_b32 v37, v41
    v_add_f32_dpp v40, v38, v38 quad_perm:[1,0,3,2] row_mask:0xf bank_mask:0xf
    v_add_f32_dpp v41, v39, v39 quad_perm:[1,0,3,2] row_mask:0xf bank_mask:0xf
    v_mov_b32 v38, v40
    v_mov_b32 v39, v41
    v_add_f32_dpp v40, v36, v36 quad_perm:[2,3,0,1] row_mask:0xf bank_mask:0xf
    v_add_f32_dpp v41, v37, v37 quad_perm:[2,3,0,1] row_mask:0xf bank_mask:0xf
    v_mov_b32 v36, v40
    v_mov_b32 v37, v41
    v_add_f32_dpp v40, v38, v38 quad_perm:[2,3,0,1] row_mask:0xf bank_mask:0xf
    v_add_f32_dpp v41, v39, v39 quad_perm:[2,3,0,1] row_mask:0xf bank_mask:0xf
    v_mov_b32 v38, v40
    v_mov_b32 v39, v41
    v_add_f32_dpp v40, v36, v36 row_half_mirror row_mask:0xf bank_mask:0xf
    v_add_f32_dpp v41, v37, v37 row_half_mirror row_mask:0xf bank_mask:0xf
    v_mov_b32 v36, v40
    v_mov_b32 v37, v41
    v_add_f32_dpp v40, v38, v38 row_half_mirror row_mask:0xf bank_mask:0xf
    v_add_f32_dpp v41, v39, v39 row_half_mirror row_mask:0xf bank_mask:0xf
    v_mov_b32 v38, v40
    v_mov_b32 v39, v41
    s_mov_b32 s60, 32768
    s_waitcnt vmcnt(0) lgkmcnt(0)
    s_nop 4
    s_cmp_eq_u32 s99, 1
    s_cbranch_scc0 kB_kernel_st2_slow
    buffer_store_dwordx4 v[24:27], v33, s[40:43], 0 offen
    buffer_store_dwordx4 v[28:31], v33, s[40:43], s60 offen
    buffer_store_dwordx2 v[36:37], v32, s[44:47], 0 offen
    buffer_store_dwordx2 v[38:39], v32, s[44:47], 0 offen offset:2048
    s_branch kB_kernel_st2_done
kB_kernel_st2_slow:
    buffer_store_dwordx4 v[24:27], v33, s[40:43], 0 offen sc0 sc1
    buffer_store_dwordx4 v[28:31], v33, s[40:43], s60 offen sc0 sc1
    buffer_store_dwordx2 v[36:37], v32, s[44:47], 0 offen sc0 sc1
    buffer_store_dwordx2 v[38:39], v32, s[44:47], 0 offen offset:2048 sc0 sc1
kB_kernel_st2_done:
    s_waitcnt vmcnt(0)
    s_barrier
    s_mov_b32 s22, s96
    s_mov_b32 s23, s97
    s_lshl_b32 s50, s22, 7
    s_lshl_b32 s54, s23, 6
    s_lshr_b32 s52, s3, 1
    s_lshl_b32 s52, s52, 6
    s_and_b32 s53, s3, 1
    s_lshl_b32 s56, s23, 7
    s_lshl_b32 s57, s53, 6
    s_add_u32 s56, s56, s57
    v_lshlrev_b32 v24, 4, v3
    v_add_u32 v24, s56, v24
    v_lshlrev_b32 v25, 2, v2
    v_add_u32 v25, s56, v25
    v_add_u32 v25, 2048, v25
    s_waitcnt lgkmcnt(0)
    s_add_u32 s40, s20, 14811136
    s_addc_u32 s41, s21, 0
    s_and_b32 s41, s41, 0xffff
    s_mov_b32 s42, 6144
    s_mov_b32 s43, 0x20000
    buffer_load_dwordx4 v[12:15], v24, s[40:43], 0 offen
    buffer_load_dword v16, v25, s[40:43], 0 offen offset:0
    buffer_load_dword v20, v25, s[40:43], 0 offen offset:2048
    v_mov_b32 v28, 0x3f803f80
    v_mov_b32 v29, 0x3f803f80
    v_mov_b32 v30, 0x3f803f80
    v_mov_b32 v31, 0x3f803f80
    s_lshl_b32 s57, s53, 5
    s_add_u32 s66, s52, s57
    s_xor_b32 s57, s57, 32
    s_add_u32 s67, s52, s57
    v_add_u32 v5, s66, v2
    v_mul_u32_u24 v5, 128, v5
    v_bfe_u32 v6, v2, 1, 3
    v_xor_b32 v6, v6, v3
    v_xor_b32 v32, 0, v6
    v_lshl_add_u32 v32, v32, 4, v5
    v_add_u32 v33, 65536, v32
    v_xor_b32 v34, 4, v6
    v_lshl_add_u32 v34, v34, 4, v5
    v_add_u32 v35, 65536, v34
    v_add_u32 v5, s67, v2
    v_mul_u32_u24 v5, 128, v5
    v_bfe_u32 v6, v2, 1, 3
    v_xor_b32 v6, v6, v3
    v_xor_b32 v36, 0, v6
    v_lshl_add_u32 v36, v36, 4, v5
    v_add_u32 v37, 65536, v36
    v_xor_b32 v38, 4, v6
    v_lshl_add_u32 v38, v38, 4, v5
    v_add_u32 v39, 65536, v38
    v_bfe_u32 v5, v1, 2, 2
    v_lshl_add_u32 v5, v3, 3, v5
    v_mul_u32_u24 v5, 192, v5
    v_and_b32 v6, 3, v1
    v_lshl_add_u32 v5, v6, 3, v5
    v_and_b32 v6, 1, v3
    v_add_u32 v6, s53, v6
    v_add_u32 v7, 0, v6
    v_lshl_add_u32 v40, v7, 5, v5
    v_add_u32 v41, 65536, v40
    v_add_u32 v42, 131072, v40
    v_add_u32 v7, 2, v6
    v_lshl_add_u32 v43, v7, 5, v5
    v_add_u32 v44, 65536, v43
    v_add_u32 v45, 131072, v43
    v_add_u32 v7, 4, v6
    v_subrev_u32 v46, 6, v7
    v_min_u32 v7, v7, v46
    v_lshl_add_u32 v46, v7, 5, v5
    v_add_u32 v47, 65536, v46
    v_add_u32 v48, 131072, v46
    v_mov_b32 v52, 0
    v_mov_b32 v53, 0
    v_mov_b32 v54, 0
    v_mov_b32 v55, 0
    v_mov_b32 v56, 0
    v_mov_b32 v57, 0
    v_mov_b32 v58, 0
    v_mov_b32 v59, 0
    v_mov_b32 v60, 0
    v_mov_b32 v61, 0
    v_mov_b32 v62, 0
    v_mov_b32 v63, 0
    v_mov_b32 v64, 0
    v_mov_b32 v65, 0
    v_mov_b32 v66, 0
    v_mov_b32 v67, 0
    v_mov_b32 v68, 0
    v_mov_b32 v69, 0
    v_mov_b32 v70, 0
    v_mov_b32 v71, 0
    v_mov_b32 v72, 0
    v_mov_b32 v73, 0
    v_mov_b32 v74, 0
    v_mov_b32 v75, 0
    v_mov_b32 v76, 0
    v_mov_b32 v77, 0
    v_mov_b32 v78, 0
    v_mov_b32 v79, 0
    v_mov_b32 v80, 0
    v_mov_b32 v81, 0
    v_mov_b32 v82, 0
    v_mov_b32 v83, 0
    v_mov_b32 v84, 0
    v_mov_b32 v85, 0
    v_mov_b32 v86, 0
    v_mov_b32 v87, 0
    v_mov_b32 v88, 0
    v_mov_b32 v89, 0
    v_mov_b32 v90, 0
    v_mov_b32 v91, 0
    v_mov_b32 v92, 0
    v_mov_b32 v93, 0
    v_mov_b32 v94, 0
    v_mov_b32 v95, 0
    v_mov_b32 v96, 0
    v_mov_b32 v97, 0
    v_mov_b32 v98, 0
    v_mov_b32 v99, 0
    v_add_u32 v196, s66, v2
    v_lshlrev_b32 v196, 3, v196
    v_add_u32 v196, 147456, v196
    v_lshlrev_b32 v198, 2, v3
    v_add_u32 v198, s66, v198
    v_lshlrev_b32 v198, 3, v198
    v_add_u32 v198, 147456, v198
    v_add_u32 v197, s67, v2
    v_lshlrev_b32 v197, 3, v197
    v_add_u32 v197, 147456, v197
    v_lshlrev_b32 v199, 2, v3
    v_add_u32 v199, s67, v199
    v_lshlrev_b32 v199, 3, v199
    v_add_u32 v199, 147456, v199
    s_barrier
    ds_read_b128 v[100:103], v32 offset:0
    ds_read_b64_tr_b16 v[132:133], v41 offset:32768
    ds_read_b64_tr_b16 v[134:135], v41 offset:33536
    ds_read_b64_tr_b16 v[136:137], v44 offset:32768
    ds_read_b64_tr_b16 v[138:139], v44 offset:33536
    ds_read_b64_tr_b16 v[140:141], v47 offset:32768
    ds_read_b64_tr_b16 v[142:143], v47 offset:33536
    ds_read_b128 v[104:107], v32 offset:2048
    ds_read_b128 v[108:111], v36 offset:0
    ds_read_b128 v[112:115], v36 offset:2048
    s_waitcnt lgkmcnt(7)
    v_mfma_f32_16x16x32_bf16 v[52:55], v[132:135], v[100:103], v[52:55]
    ds_read_b128 v[116:119], v34 offset:0
    s_waitcnt lgkmcnt(6)
    v_mfma_f32_16x16x32_bf16 v[56:59], v[100:103], v[136:139], v[56:59]
    ds_read_b64_tr_b16 v[144:145], v41 offset:38912
    s_waitcnt lgkmcnt(5)
    v_mfma_f32_16x16x32_bf16 v[60:63], v[100:103], v[140:143], v[60:63]
    ds_read_b64_tr_b16 v[146:147], v41 offset:39680
    s_waitcnt lgkmcnt(5)
    v_mfma_f32_16x16x32_bf16 v[64:67], v[132:135], v[104:107], v[64:67]
    ds_read_b64_tr_b16 v[148:149], v44 offset:38912
    v_mfma_f32_16x16x32_bf16 v[68:71], v[104:107], v[136:139], v[68:71]
    ds_read_b64_tr_b16 v[150:151], v44 offset:39680
    v_mfma_f32_16x16x32_bf16 v[72:75], v[104:107], v[140:143], v[72:75]
    ds_read_b64_tr_b16 v[152:153], v47 offset:38912
    s_waitcnt lgkmcnt(7)
    v_mfma_f32_16x16x32_bf16 v[76:79], v[132:135], v[108:111], v[76:79]
    ds_read_b64_tr_b16 v[154:155], v47 offset:39680
    v_mfma_f32_16x16x32_bf16 v[80:83], v[108:111], v[136:139], v[80:83]
    ds_read_b128 v[120:123], v34 offset:2048
    v_mfma_f32_16x16x32_bf16 v[84:87], v[108:111], v[140:143], v[84:87]
    ds_read_b128 v[124:127], v38 offset:0
    s_waitcnt lgkmcnt(9)
    v_mfma_f32_16x16x32_bf16 v[88:91], v[132:135], v[112:115], v[88:91]
    ds_read_b128 v[128:131], v38 offset:2048
    v_mfma_f32_16x16x32_bf16 v[92:95], v[112:115], v[136:139], v[92:95]
    v_mfma_f32_16x16x32_bf16 v[96:99], v[112:115], v[140:143], v[96:99]
    s_waitcnt lgkmcnt(0)
    s_barrier
    v_mfma_f32_16x16x32_bf16 v[52:55], v[144:147], v[116:119], v[52:55]
    ds_read_b128 v[100:103], v32 offset:16384
    v_mfma_f32_16x16x32_bf16 v[56:59], v[116:119], v[148:151], v[56:59]
    ds_read_b64_tr_b16 v[132:133], v41 offset:49152
    v_mfma_f32_16x16x32_bf16 v[60:63], v[116:119], v[152:155], v[60:63]
    ds_read_b64_tr_b16 v[134:135], v41 offset:49920
    v_mfma_f32_16x16x32_bf16 v[64:67], v[144:147], v[120:123], v[64:67]
    ds_read_b64_tr_b16 v[136:137], v44 offset:49152
    v_mfma_f32_16x16x32_bf16 v[68:71], v[120:123], v[148:151], v[68:71]
    ds_read_b64_tr_b16 v[138:139], v44 offset:49920
    v_mfma_f32_16x16x32_bf16 v[72:75], v[120:123], v[152:155], v[72:75]
    ds_read_b64_tr_b16 v[140:141], v47 offset:49152
    v_mfma_f32_16x16x32_bf16 v[76:79], v[144:147], v[124:127], v[76:79]
    ds_read_b64_tr_b16 v[142:143], v47 offset:49920
    v_mfma_f32_16x16x32_bf16 v[80:83], v[124:127], v[148:151], v[80:83]
    ds_read_b128 v[104:107], v32 offset:18432
    v_mfma_f32_16x16x32_bf16 v[84:87], v[124:127], v[152:155], v[84:87]
    ds_read_b128 v[108:111], v36 offset:16384
    v_mfma_f32_16x16x32_bf16 v[88:91], v[144:147], v[128:131], v[88:91]
    ds_read_b128 v[112:115], v36 offset:18432
    v_mfma_f32_16x16x32_bf16 v[92:95], v[128:131], v[148:151], v[92:95]
    v_mfma_f32_16x16x32_bf16 v[96:99], v[128:131], v[152:155], v[96:99]
    s_waitcnt lgkmcnt(7)
    v_mfma_f32_16x16x32_bf16 v[52:55], v[132:135], v[100:103], v[52:55]
    ds_read_b128 v[116:119], v34 offset:16384
    s_waitcnt lgkmcnt(6)
    v_mfma_f32_16x16x32_bf16 v[56:59], v[100:103], v[136:139], v[56:59]
    ds_read_b64_tr_b16 v[144:145], v41 offset:55296
    s_waitcnt lgkmcnt(5)
    v_mfma_f32_16x16x32_bf16 v[60:63], v[100:103], v[140:143], v[60:63]
    ds_read_b64_tr_b16 v[146:147], v41 offset:56064
    s_waitcnt lgkmcnt(5)
    v_mfma_f32_16x16x32_bf16 v[64:67], v[132:135], v[104:107], v[64:67]
    ds_read_b64_tr_b16 v[148:149], v44 offset:55296
    v_mfma_f32_16x16x32_bf16 v[68:71], v[104:107], v[136:139], v[68:71]
    ds_read_b64_tr_b16 v[150:151], v44 offset:56064
    v_mfma_f32_16x16x32_bf16 v[72:75], v[104:107], v[140:143], v[72:75]
    ds_read_b64_tr_b16 v[152:153], v47 offset:55296
    s_waitcnt lgkmcnt(7)
    v_mfma_f32_16x16x32_bf16 v[76:79], v[132:135], v[108:111], v[76:79]
    ds_read_b64_tr_b16 v[154:155], v47 offset:56064
    v_mfma_f32_16x16x32_bf16 v[80:83], v[108:111], v[136:139], v[80:83]
    ds_read_b128 v[120:123], v34 offset:18432
    v_mfma_f32_16x16x32_bf16 v[84:87], v[108:111], v[140:143], v[84:87]
    ds_read_b128 v[124:127], v38 offset:16384
    s_waitcnt lgkmcnt(9)
    v_mfma_f32_16x16x32_bf16 v[88:91], v[132:135], v[112:115], v[88:91]
    ds_read_b128 v[128:131], v38 offset:18432
    v_mfma_f32_16x16x32_bf16 v[92:95], v[112:115], v[136:139], v[92:95]
    v_mfma_f32_16x16x32_bf16 v[96:99], v[112:115], v[140:143], v[96:99]
    s_waitcnt lgkmcnt(0)
    s_barrier
    v_mfma_f32_16x16x32_bf16 v[52:55], v[144:147], v[116:119], v[52:55]
    ds_read_b128 v[100:103], v32 offset:32768
    v_mfma_f32_16x16x32_bf16 v[56:59], v[116:119], v[148:151], v[56:59]
    ds_read_b64_tr_b16 v[132:133], v42 offset:0
    v_mfma_f32_16x16x32_bf16 v[60:63], v[116:119], v[152:155], v[60:63]
    ds_read_b64_tr_b16 v[134:135], v42 offset:768
    v_mfma_f32_16x16x32_bf16 v[64:67], v[144:147], v[120:123], v[64:67]
    ds_read_b64_tr_b16 v[136:137], v45 offset:0
    v_mfma_f32_16x16x32_bf16 v[68:71], v[120:123], v[148:151], v[68:71]
    ds_read_b64_tr_b16 v[138:139], v45 offset:768
    v_mfma_f32_16x16x32_bf16 v[72:75], v[120:123], v[152:155], v[72:75]
    ds_read_b64_tr_b16 v[140:141], v48 offset:0
    v_mfma_f32_16x16x32_bf16 v[76:79], v[144:147], v[124:127], v[76:79]
    ds_read_b64_tr_b16 v[142:143], v48 offset:768
    v_mfma_f32_16x16x32_bf16 v[80:83], v[124:127], v[148:151], v[80:83]
    ds_read_b128 v[104:107], v32 offset:34816
    v_mfma_f32_16x16x32_bf16 v[84:87], v[124:127], v[152:155], v[84:87]
    ds_read_b128 v[108:111], v36 offset:32768
    v_mfma_f32_16x16x32_bf16 v[88:91], v[144:147], v[128:131], v[88:91]
    ds_read_b128 v[112:115], v36 offset:34816
    v_mfma_f32_16x16x32_bf16 v[92:95], v[128:131], v[148:151], v[92:95]
    v_mfma_f32_16x16x32_bf16 v[96:99], v[128:131], v[152:155], v[96:99]
    s_waitcnt lgkmcnt(7)
    v_mfma_f32_16x16x32_bf16 v[52:55], v[132:135], v[100:103], v[52:55]
    ds_read_b128 v[116:119], v34 offset:32768
    s_waitcnt lgkmcnt(6)
    v_mfma_f32_16x16x32_bf16 v[56:59], v[100:103], v[136:139], v[56:59]
    ds_read_b64_tr_b16 v[144:145], v42 offset:6144
    s_waitcnt lgkmcnt(5)
    v_mfma_f32_16x16x32_bf16 v[60:63], v[100:103], v[140:143], v[60:63]
    ds_read_b64_tr_b16 v[146:147], v42 offset:6912
    s_waitcnt lgkmcnt(5)
    v_mfma_f32_16x16x32_bf16 v[64:67], v[132:135], v[104:107], v[64:67]
    ds_read_b64_tr_b16 v[148:149], v45 offset:6144
    v_mfma_f32_16x16x32_bf16 v[68:71], v[104:107], v[136:139], v[68:71]
    ds_read_b64_tr_b16 v[150:151], v45 offset:6912
    v_mfma_f32_16x16x32_bf16 v[72:75], v[104:107], v[140:143], v[72:75]
    ds_read_b64_tr_b16 v[152:153], v48 offset:6144
    s_waitcnt lgkmcnt(7)
    v_mfma_f32_16x16x32_bf16 v[76:79], v[132:135], v[108:111], v[76:79]
    ds_read_b64_tr_b16 v[154:155], v48 offset:6912
    v_mfma_f32_16x16x32_bf16 v[80:83], v[108:111], v[136:139], v[80:83]
    ds_read_b128 v[120:123], v34 offset:34816
    v_mfma_f32_16x16x32_bf16 v[84:87], v[108:111], v[140:143], v[84:87]
    ds_read_b128 v[124:127], v38 offset:32768
    s_waitcnt lgkmcnt(9)
    v_mfma_f32_16x16x32_bf16 v[88:91], v[132:135], v[112:115], v[88:91]
    ds_read_b128 v[128:131], v38 offset:34816
    v_mfma_f32_16x16x32_bf16 v[92:95], v[112:115], v[136:139], v[92:95]
    v_mfma_f32_16x16x32_bf16 v[96:99], v[112:115], v[140:143], v[96:99]
    s_waitcnt lgkmcnt(0)
    s_barrier
    v_mfma_f32_16x16x32_bf16 v[52:55], v[144:147], v[116:119], v[52:55]
    ds_read_b128 v[100:103], v32 offset:49152
    v_mfma_f32_16x16x32_bf16 v[56:59], v[116:119], v[148:151], v[56:59]
    ds_read_b64_tr_b16 v[132:133], v41 offset:0
    v_mfma_f32_16x16x32_bf16 v[60:63], v[116:119], v[152:155], v[60:63]
    ds_read_b64_tr_b16 v[134:135], v41 offset:768
    v_mfma_f32_16x16x32_bf16 v[64:67], v[144:147], v[120:123], v[64:67]
    ds_read_b64_tr_b16 v[136:137], v44 offset:0
    v_mfma_f32_16x16x32_bf16 v[68:71], v[120:123], v[148:151], v[68:71]
    ds_read_b64_tr_b16 v[138:139], v44 offset:768
    v_mfma_f32_16x16x32_bf16 v[72:75], v[120:123], v[152:155], v[72:75]
    ds_read_b64_tr_b16 v[140:141], v47 offset:0
    v_mfma_f32_16x16x32_bf16 v[76:79], v[144:147], v[124:127], v[76:79]
    ds_read_b64_tr_b16 v[142:143], v47 offset:768
    v_mfma_f32_16x16x32_bf16 v[80:83], v[124:127], v[148:151], v[80:83]
    ds_read_b128 v[104:107], v32 offset:51200
    v_mfma_f32_16x16x32_bf16 v[84:87], v[124:127], v[152:155], v[84:87]
    ds_read_b128 v[108:111], v36 offset:49152
    v_mfma_f32_16x16x32_bf16 v[88:91], v[144:147], v[128:131], v[88:91]
    ds_read_b128 v[112:115], v36 offset:51200
    v_mfma_f32_16x16x32_bf16 v[92:95], v[128:131], v[148:151], v[92:95]
    v_mfma_f32_16x16x32_bf16 v[96:99], v[128:131], v[152:155], v[96:99]
    s_waitcnt lgkmcnt(7)
    v_mfma_f32_16x16x32_bf16 v[52:55], v[132:135], v[100:103], v[52:55]
    ds_read_b128 v[116:119], v34 offset:49152
    s_waitcnt lgkmcnt(6)
    v_mfma_f32_16x16x32_bf16 v[56:59], v[100:103], v[136:139], v[56:59]
    ds_read_b64_tr_b16 v[144:145], v41 offset:6144
    s_waitcnt lgkmcnt(5)
    v_mfma_f32_16x16x32_bf16 v[60:63], v[100:103], v[140:143], v[60:63]
    ds_read_b64_tr_b16 v[146:147], v41 offset:6912
    s_waitcnt lgkmcnt(5)
    v_mfma_f32_16x16x32_bf16 v[64:67], v[132:135], v[104:107], v[64:67]
    ds_read_b64_tr_b16 v[148:149], v44 offset:6144
    v_mfma_f32_16x16x32_bf16 v[68:71], v[104:107], v[136:139], v[68:71]
    ds_read_b64_tr_b16 v[150:151], v44 offset:6912
    v_mfma_f32_16x16x32_bf16 v[72:75], v[104:107], v[140:143], v[72:75]
    ds_read_b64_tr_b16 v[152:153], v47 offset:6144
    s_waitcnt lgkmcnt(7)
    v_mfma_f32_16x16x32_bf16 v[76:79], v[132:135], v[108:111], v[76:79]
    ds_read_b64_tr_b16 v[154:155], v47 offset:6912
    v_mfma_f32_16x16x32_bf16 v[80:83], v[108:111], v[136:139], v[80:83]
    ds_read_b128 v[120:123], v34 offset:51200
    v_mfma_f32_16x16x32_bf16 v[84:87], v[108:111], v[140:143], v[84:87]
    ds_read_b128 v[124:127], v38 offset:49152
    s_waitcnt lgkmcnt(9)
    v_mfma_f32_16x16x32_bf16 v[88:91], v[132:135], v[112:115], v[88:91]
    ds_read_b128 v[128:131], v38 offset:51200
    v_mfma_f32_16x16x32_bf16 v[92:95], v[112:115], v[136:139], v[92:95]
    v_mfma_f32_16x16x32_bf16 v[96:99], v[112:115], v[140:143], v[96:99]
    s_waitcnt lgkmcnt(0)
    s_barrier
    v_mfma_f32_16x16x32_bf16 v[52:55], v[144:147], v[116:119], v[52:55]
    ds_read_b128 v[100:103], v32 offset:0
    v_mfma_f32_16x16x32_bf16 v[56:59], v[116:119], v[148:151], v[56:59]
    ds_read_b64_tr_b16 v[132:133], v41 offset:16384
    v_mfma_f32_16x16x32_bf16 v[60:63], v[116:119], v[152:155], v[60:63]
    ds_read_b64_tr_b16 v[134:135], v41 offset:17152
    v_mfma_f32_16x16x32_bf16 v[64:67], v[144:147], v[120:123], v[64:67]
    ds_read_b64_tr_b16 v[136:137], v44 offset:16384
    v_mfma_f32_16x16x32_bf16 v[68:71], v[120:123], v[148:151], v[68:71]
    ds_read_b64_tr_b16 v[138:139], v44 offset:17152
    v_mfma_f32_16x16x32_bf16 v[72:75], v[120:123], v[152:155], v[72:75]
    ds_read_b64_tr_b16 v[140:141], v47 offset:16384
    v_mfma_f32_16x16x32_bf16 v[76:79], v[144:147], v[124:127], v[76:79]
    ds_read_b64_tr_b16 v[142:143], v47 offset:17152
    v_mfma_f32_16x16x32_bf16 v[80:83], v[124:127], v[148:151], v[80:83]
    ds_read_b128 v[104:107], v32 offset:2048
    v_mfma_f32_16x16x32_bf16 v[84:87], v[124:127], v[152:155], v[84:87]
    ds_read_b128 v[108:111], v36 offset:0
    v_mfma_f32_16x16x32_bf16 v[88:91], v[144:147], v[128:131], v[88:91]
    ds_read_b128 v[112:115], v36 offset:2048
    v_mfma_f32_16x16x32_bf16 v[92:95], v[128:131], v[148:151], v[92:95]
    v_mfma_f32_16x16x32_bf16 v[96:99], v[128:131], v[152:155], v[96:99]
    s_waitcnt lgkmcnt(7)
    v_mfma_f32_16x16x32_bf16 v[52:55], v[132:135], v[100:103], v[52:55]
    ds_read_b128 v[116:119], v34 offset:0
    s_waitcnt lgkmcnt(6)
    v_mfma_f32_16x16x32_bf16 v[56:59], v[100:103], v[136:139], v[56:59]
    ds_read_b64_tr_b16 v[144:145], v41 offset:22528
    s_waitcnt lgkmcnt(5)
    v_mfma_f32_16x16x32_bf16 v[60:63], v[100:103], v[140:143], v[60:63]
    ds_read_b64_tr_b16 v[146:147], v41 offset:23296
    s_waitcnt lgkmcnt(5)
    v_mfma_f32_16x16x32_bf16 v[64:67], v[132:135], v[104:107], v[64:67]
    ds_read_b64_tr_b16 v[148:149], v44 offset:22528
    v_mfma_f32_16x16x32_bf16 v[68:71], v[104:107], v[136:139], v[68:71]
    ds_read_b64_tr_b16 v[150:151], v44 offset:23296
    v_mfma_f32_16x16x32_bf16 v[72:75], v[104:107], v[140:143], v[72:75]
    ds_read_b64_tr_b16 v[152:153], v47 offset:22528
    s_waitcnt lgkmcnt(7)
    v_mfma_f32_16x16x32_bf16 v[76:79], v[132:135], v[108:111], v[76:79]
    ds_read_b64_tr_b16 v[154:155], v47 offset:23296
    v_mfma_f32_16x16x32_bf16 v[80:83], v[108:111], v[136:139], v[80:83]
    ds_read_b128 v[120:123], v34 offset:2048
    v_mfma_f32_16x16x32_bf16 v[84:87], v[108:111], v[140:143], v[84:87]
    ds_read_b128 v[124:127], v38 offset:0
    s_waitcnt lgkmcnt(9)
    v_mfma_f32_16x16x32_bf16 v[88:91], v[132:135], v[112:115], v[88:91]
    ds_read_b128 v[128:131], v38 offset:2048
    v_mfma_f32_16x16x32_bf16 v[92:95], v[112:115], v[136:139], v[92:95]
    v_mfma_f32_16x16x32_bf16 v[96:99], v[112:115], v[140:143], v[96:99]
    s_waitcnt lgkmcnt(0)
    s_barrier
    v_mfma_f32_16x16x32_bf16 v[52:55], v[144:147], v[116:119], v[52:55]
    ds_read_b128 v[100:103], v32 offset:16384
    v_mfma_f32_16x16x32_bf16 v[56:59], v[116:119], v[148:151], v[56:59]
    ds_read_b64_tr_b16 v[132:133], v41 offset:32768
    v_mfma_f32_16x16x32_bf16 v[60:63], v[116:119], v[152:155], v[60:63]
    ds_read_b64_tr_b16 v[134:135], v41 offset:33536
    v_mfma_f32_16x16x32_bf16 v[64:67], v[144:147], v[120:123], v[64:67]
    ds_read_b64_tr_b16 v[136:137], v44 offset:32768
    v_mfma_f32_16x16x32_bf16 v[68:71], v[120:123], v[148:151], v[68:71]
    ds_read_b64_tr_b16 v[138:139], v44 offset:33536
    v_mfma_f32_16x16x32_bf16 v[72:75], v[120:123], v[152:155], v[72:75]
    ds_read_b64_tr_b16 v[140:141], v47 offset:32768
    v_mfma_f32_16x16x32_bf16 v[76:79], v[144:147], v[124:127], v[76:79]
    ds_read_b64_tr_b16 v[142:143], v47 offset:33536
    v_mfma_f32_16x16x32_bf16 v[80:83], v[124:127], v[148:151], v[80:83]
    ds_read_b128 v[104:107], v32 offset:18432
    v_mfma_f32_16x16x32_bf16 v[84:87], v[124:127], v[152:155], v[84:87]
    ds_read_b128 v[108:111], v36 offset:16384
    v_mfma_f32_16x16x32_bf16 v[88:91], v[144:147], v[128:131], v[88:91]
    ds_read_b128 v[112:115], v36 offset:18432
    v_mfma_f32_16x16x32_bf16 v[92:95], v[128:131], v[148:151], v[92:95]
    v_mfma_f32_16x16x32_bf16 v[96:99], v[128:131], v[152:155], v[96:99]
    s_waitcnt lgkmcnt(7)
    v_mfma_f32_16x16x32_bf16 v[52:55], v[132:135], v[100:103], v[52:55]
    ds_read_b128 v[116:119], v34 offset:16384
    s_waitcnt lgkmcnt(6)
    v_mfma_f32_16x16x32_bf16 v[56:59], v[100:103], v[136:139], v[56:59]
    ds_read_b64_tr_b16 v[144:145], v41 offset:38912
    s_waitcnt lgkmcnt(5)
    v_mfma_f32_16x16x32_bf16 v[60:63], v[100:103], v[140:143], v[60:63]
    ds_read_b64_tr_b16 v[146:147], v41 offset:39680
    s_waitcnt lgkmcnt(5)
    v_mfma_f32_16x16x32_bf16 v[64:67], v[132:135], v[104:107], v[64:67]
    ds_read_b64_tr_b16 v[148:149], v44 offset:38912
    v_mfma_f32_16x16x32_bf16 v[68:71], v[104:107], v[136:139], v[68:71]
    ds_read_b64_tr_b16 v[150:151], v44 offset:39680
    v_mfma_f32_16x16x32_bf16 v[72:75], v[104:107], v[140:143], v[72:75]
    ds_read_b64_tr_b16 v[152:153], v47 offset:38912
    s_waitcnt lgkmcnt(7)
    v_mfma_f32_16x16x32_bf16 v[76:79], v[132:135], v[108:111], v[76:79]
    ds_read_b64_tr_b16 v[154:155], v47 offset:39680
    v_mfma_f32_16x16x32_bf16 v[80:83], v[108:111], v[136:139], v[80:83]
    ds_read_b128 v[120:123], v34 offset:18432
    v_mfma_f32_16x16x32_bf16 v[84:87], v[108:111], v[140:143], v[84:87]
    ds_read_b128 v[124:127], v38 offset:16384
    s_waitcnt lgkmcnt(9)
    v_mfma_f32_16x16x32_bf16 v[88:91], v[132:135], v[112:115], v[88:91]
    ds_read_b128 v[128:131], v38 offset:18432
    v_mfma_f32_16x16x32_bf16 v[92:95], v[112:115], v[136:139], v[92:95]
    v_mfma_f32_16x16x32_bf16 v[96:99], v[112:115], v[140:143], v[96:99]
    s_waitcnt lgkmcnt(0)
    s_barrier
    v_mfma_f32_16x16x32_bf16 v[52:55], v[144:147], v[116:119], v[52:55]
    ds_read_b128 v[100:103], v32 offset:32768
    v_mfma_f32_16x16x32_bf16 v[56:59], v[116:119], v[148:151], v[56:59]
    ds_read_b64_tr_b16 v[132:133], v41 offset:49152
    v_mfma_f32_16x16x32_bf16 v[60:63], v[116:119], v[152:155], v[60:63]
    ds_read_b64_tr_b16 v[134:135], v41 offset:49920
    v_mfma_f32_16x16x32_bf16 v[64:67], v[144:147], v[120:123], v[64:67]
    ds_read_b64_tr_b16 v[136:137], v44 offset:49152
    v_mfma_f32_16x16x32_bf16 v[68:71], v[120:123], v[148:151], v[68:71]
    ds_read_b64_tr_b16 v[138:139], v44 offset:49920
    v_mfma_f32_16x16x32_bf16 v[72:75], v[120:123], v[152:155], v[72:75]
    ds_read_b64_tr_b16 v[140:141], v47 offset:49152
    v_mfma_f32_16x16x32_bf16 v[76:79], v[144:147], v[124:127], v[76:79]
    ds_read_b64_tr_b16 v[142:143], v47 offset:49920
    v_mfma_f32_16x16x32_bf16 v[80:83], v[124:127], v[148:151], v[80:83]
    ds_read_b128 v[104:107], v32 offset:34816
    v_mfma_f32_16x16x32_bf16 v[84:87], v[124:127], v[152:155], v[84:87]
    ds_read_b128 v[108:111], v36 offset:32768
    v_mfma_f32_16x16x32_bf16 v[88:91], v[144:147], v[128:131], v[88:91]
    ds_read_b128 v[112:115], v36 offset:34816
    v_mfma_f32_16x16x32_bf16 v[92:95], v[128:131], v[148:151], v[92:95]
    v_mfma_f32_16x16x32_bf16 v[96:99], v[128:131], v[152:155], v[96:99]
    s_waitcnt lgkmcnt(7)
    v_mfma_f32_16x16x32_bf16 v[52:55], v[132:135], v[100:103], v[52:55]
    ds_read_b128 v[116:119], v34 offset:32768
    s_waitcnt lgkmcnt(6)
    v_mfma_f32_16x16x32_bf16 v[56:59], v[100:103], v[136:139], v[56:59]
    ds_read_b64_tr_b16 v[144:145], v41 offset:55296
    s_waitcnt lgkmcnt(5)
    v_mfma_f32_16x16x32_bf16 v[60:63], v[100:103], v[140:143], v[60:63]
    ds_read_b64_tr_b16 v[146:147], v41 offset:56064
    s_waitcnt lgkmcnt(5)
    v_mfma_f32_16x16x32_bf16 v[64:67], v[132:135], v[104:107], v[64:67]
    ds_read_b64_tr_b16 v[148:149], v44 offset:55296
    v_mfma_f32_16x16x32_bf16 v[68:71], v[104:107], v[136:139], v[68:71]
    ds_read_b64_tr_b16 v[150:151], v44 offset:56064
    v_mfma_f32_16x16x32_bf16 v[72:75], v[104:107], v[140:143], v[72:75]
    ds_read_b64_tr_b16 v[152:153], v47 offset:55296
    s_waitcnt lgkmcnt(7)
    v_mfma_f32_16x16x32_bf16 v[76:79], v[132:135], v[108:111], v[76:79]
    ds_read_b64_tr_b16 v[154:155], v47 offset:56064
    v_mfma_f32_16x16x32_bf16 v[80:83], v[108:111], v[136:139], v[80:83]
    ds_read_b128 v[120:123], v34 offset:34816
    v_mfma_f32_16x16x32_bf16 v[84:87], v[108:111], v[140:143], v[84:87]
    ds_read_b128 v[124:127], v38 offset:32768
    s_waitcnt lgkmcnt(9)
    v_mfma_f32_16x16x32_bf16 v[88:91], v[132:135], v[112:115], v[88:91]
    ds_read_b128 v[128:131], v38 offset:34816
    v_mfma_f32_16x16x32_bf16 v[92:95], v[112:115], v[136:139], v[92:95]
    v_mfma_f32_16x16x32_bf16 v[96:99], v[112:115], v[140:143], v[96:99]
    s_waitcnt lgkmcnt(0)
    s_barrier
    v_mfma_f32_16x16x32_bf16 v[52:55], v[144:147], v[116:119], v[52:55]
    ds_read_b128 v[100:103], v32 offset:49152
    v_mfma_f32_16x16x32_bf16 v[56:59], v[116:119], v[148:151], v[56:59]
    ds_read_b64_tr_b16 v[132:133], v42 offset:0
    v_mfma_f32_16x16x32_bf16 v[60:63], v[116:119], v[152:155], v[60:63]
    ds_read_b64_tr_b16 v[134:135], v42 offset:768
    v_mfma_f32_16x16x32_bf16 v[64:67], v[144:147], v[120:123], v[64:67]
    ds_read_b64_tr_b16 v[136:137], v45 offset:0
    v_mfma_f32_16x16x32_bf16 v[68:71], v[120:123], v[148:151], v[68:71]
    ds_read_b64_tr_b16 v[138:139], v45 offset:768
    v_mfma_f32_16x16x32_bf16 v[72:75], v[120:123], v[152:155], v[72:75]
    ds_read_b64_tr_b16 v[140:141], v48 offset:0
    v_mfma_f32_16x16x32_bf16 v[76:79], v[144:147], v[124:127], v[76:79]
    ds_read_b64_tr_b16 v[142:143], v48 offset:768
    v_mfma_f32_16x16x32_bf16 v[80:83], v[124:127], v[148:151], v[80:83]
    ds_read_b128 v[104:107], v32 offset:51200
    v_mfma_f32_16x16x32_bf16 v[84:87], v[124:127], v[152:155], v[84:87]
    ds_read_b128 v[108:111], v36 offset:49152
    v_mfma_f32_16x16x32_bf16 v[88:91], v[144:147], v[128:131], v[88:91]
    ds_read_b128 v[112:115], v36 offset:51200
    v_mfma_f32_16x16x32_bf16 v[92:95], v[128:131], v[148:151], v[92:95]
    v_mfma_f32_16x16x32_bf16 v[96:99], v[128:131], v[152:155], v[96:99]
    s_waitcnt lgkmcnt(7)
    v_mfma_f32_16x16x32_bf16 v[52:55], v[132:135], v[100:103], v[52:55]
    ds_read_b128 v[116:119], v34 offset:49152
    s_waitcnt lgkmcnt(6)
    v_mfma_f32_16x16x32_bf16 v[56:59], v[100:103], v[136:139], v[56:59]
    ds_read_b64_tr_b16 v[144:145], v42 offset:6144
    s_waitcnt lgkmcnt(5)
    v_mfma_f32_16x16x32_bf16 v[60:63], v[100:103], v[140:143], v[60:63]
    ds_read_b64_tr_b16 v[146:147], v42 offset:6912
    s_waitcnt lgkmcnt(5)
    v_mfma_f32_16x16x32_bf16 v[64:67], v[132:135], v[104:107], v[64:67]
    ds_read_b64_tr_b16 v[148:149], v45 offset:6144
    v_mfma_f32_16x16x32_bf16 v[68:71], v[104:107], v[136:139], v[68:71]
    ds_read_b64_tr_b16 v[150:151], v45 offset:6912
    v_mfma_f32_16x16x32_bf16 v[72:75], v[104:107], v[140:143], v[72:75]
    ds_read_b64_tr_b16 v[152:153], v48 offset:6144
    s_waitcnt lgkmcnt(7)
    v_mfma_f32_16x16x32_bf16 v[76:79], v[132:135], v[108:111], v[76:79]
    ds_read_b64_tr_b16 v[154:155], v48 offset:6912
    v_mfma_f32_16x16x32_bf16 v[80:83], v[108:111], v[136:139], v[80:83]
    ds_read_b128 v[120:123], v34 offset:51200
    v_mfma_f32_16x16x32_bf16 v[84:87], v[108:111], v[140:143], v[84:87]
    ds_read_b128 v[124:127], v38 offset:49152
    s_waitcnt lgkmcnt(9)
    v_mfma_f32_16x16x32_bf16 v[88:91], v[132:135], v[112:115], v[88:91]
    ds_read_b128 v[128:131], v38 offset:51200
    v_mfma_f32_16x16x32_bf16 v[92:95], v[112:115], v[136:139], v[92:95]
    v_mfma_f32_16x16x32_bf16 v[96:99], v[112:115], v[140:143], v[96:99]
    s_waitcnt lgkmcnt(7)
    v_mfma_f32_16x16x32_bf16 v[52:55], v[144:147], v[116:119], v[52:55]
    ds_read_b128 v[164:167], v198 offset:0
    s_waitcnt lgkmcnt(6)
    v_mfma_f32_16x16x32_bf16 v[56:59], v[116:119], v[148:151], v[56:59]
    ds_read_b128 v[168:171], v198 offset:16
    s_waitcnt lgkmcnt(5)
    v_mfma_f32_16x16x32_bf16 v[60:63], v[116:119], v[152:155], v[60:63]
    ds_read_b64 v[156:157], v196 offset:0
    s_waitcnt lgkmcnt(5)
    v_mfma_f32_16x16x32_bf16 v[64:67], v[144:147], v[120:123], v[64:67]
    ds_read_b128 v[172:175], v198 offset:128
    v_mfma_f32_16x16x32_bf16 v[68:71], v[120:123], v[148:151], v[68:71]
    ds_read_b128 v[176:179], v198 offset:144
    v_mfma_f32_16x16x32_bf16 v[72:75], v[120:123], v[152:155], v[72:75]
    ds_read_b64 v[158:159], v196 offset:128
    s_waitcnt lgkmcnt(7)
    v_mfma_f32_16x16x32_bf16 v[76:79], v[144:147], v[124:127], v[76:79]
    ds_read_b128 v[180:183], v199 offset:0
    v_mfma_f32_16x16x32_bf16 v[80:83], v[124:127], v[148:151], v[80:83]
    ds_read_b128 v[184:187], v199 offset:16
    v_mfma_f32_16x16x32_bf16 v[84:87], v[124:127], v[152:155], v[84:87]
    ds_read_b64 v[160:161], v197 offset:0
    s_waitcnt lgkmcnt(9)
    v_mfma_f32_16x16x32_bf16 v[88:91], v[144:147], v[128:131], v[88:91]
    ds_read_b128 v[188:191], v199 offset:128
    v_mfma_f32_16x16x32_bf16 v[92:95], v[128:131], v[148:151], v[92:95]
    ds_read_b128 v[192:195], v199 offset:144
    v_mfma_f32_16x16x32_bf16 v[96:99], v[128:131], v[152:155], v[96:99]
    ds_read_b64 v[162:163], v197 offset:128
    s_barrier
    s_mov_b32 s62, 0x3fb8aa3b
    s_mov_b32 s63, 0x3fb8aa3b
    s_mov_b32 s64, 0x358637bd
    s_mov_b32 s65, 0x358637bd
    s_waitcnt vmcnt(1) lgkmcnt(11)
    v_mul_f32 v200, v165, v16
    v_mul_f32 v201, v167, v16
    s_waitcnt lgkmcnt(10)
    v_mul_f32 v202, v169, v16
    v_mul_f32 v203, v171, v16
    v_fma_f32 v56, v164, v56, v200
    v_fma_f32 v57, v166, v57, v201
    v_fma_f32 v58, v168, v58, v202
    v_fma_f32 v59, v170, v59, v203
    v_pk_mul_f32 v[200:201], v[56:57], s[62:63]
    v_pk_mul_f32 v[202:203], v[58:59], s[62:63]
    v_min_f32 v200, 0, v200
    v_min_f32 v201, 0, v201
    v_min_f32 v202, 0, v202
    v_min_f32 v203, 0, v203
    v_exp_f32 v200, v200
    v_exp_f32 v201, v201
    v_exp_f32 v202, v202
    v_exp_f32 v203, v203
    v_max_f32 v56, 0, v56
    v_max_f32 v57, 0, v57
    v_max_f32 v58, 0, v58
    v_max_f32 v59, 0, v59
    v_pk_add_f32 v[56:57], v[56:57], s[64:65]
    v_pk_add_f32 v[58:59], v[58:59], s[64:65]
    v_pk_add_f32 v[56:57], v[56:57], v[200:201]
    v_pk_add_f32 v[58:59], v[58:59], v[202:203]
    v_cvt_pk_bf16_f32 v204, v56, v57
    v_cvt_pk_bf16_f32 v205, v58, v59
    s_waitcnt vmcnt(0)
    v_mul_f32 v200, v165, v20
    v_mul_f32 v201, v167, v20
    v_mul_f32 v202, v169, v20
    v_mul_f32 v203, v171, v20
    v_fma_f32 v60, v164, v60, v200
    v_fma_f32 v61, v166, v61, v201
    v_fma_f32 v62, v168, v62, v202
    v_fma_f32 v63, v170, v63, v203
    v_cvt_pk_bf16_f32 v212, v60, v61
    v_cvt_pk_bf16_f32 v213, v62, v63
    s_waitcnt lgkmcnt(8)
    v_mul_f32 v200, v173, v16
    v_mul_f32 v201, v175, v16
    s_waitcnt lgkmcnt(7)
    v_mul_f32 v202, v177, v16
    v_mul_f32 v203, v179, v16
    v_fma_f32 v68, v172, v68, v200
    v_fma_f32 v69, v174, v69, v201
    v_fma_f32 v70, v176, v70, v202
    v_fma_f32 v71, v178, v71, v203
    v_pk_mul_f32 v[200:201], v[68:69], s[62:63]
    v_pk_mul_f32 v[202:203], v[70:71], s[62:63]
    v_min_f32 v200, 0, v200
    v_min_f32 v201, 0, v201
    v_min_f32 v202, 0, v202
    v_min_f32 v203, 0, v203
    v_exp_f32 v200, v200
    v_exp_f32 v201, v201
    v_exp_f32 v202, v202
    v_exp_f32 v203, v203
    v_max_f32 v68, 0, v68
    v_max_f32 v69, 0, v69
    v_max_f32 v70, 0, v70
    v_max_f32 v71, 0, v71
    v_pk_add_f32 v[68:69], v[68:69], s[64:65]
    v_pk_add_f32 v[70:71], v[70:71], s[64:65]
    v_pk_add_f32 v[68:69], v[68:69], v[200:201]
    v_pk_add_f32 v[70:71], v[70:71], v[202:203]
    v_cvt_pk_bf16_f32 v206, v68, v69
    v_cvt_pk_bf16_f32 v207, v70, v71
    v_mul_f32 v200, v173, v20
    v_mul_f32 v201, v175, v20
    v_mul_f32 v202, v177, v20
    v_mul_f32 v203, v179, v20
    v_fma_f32 v72, v172, v72, v200
    v_fma_f32 v73, v174, v73, v201
    v_fma_f32 v74, v176, v74, v202
    v_fma_f32 v75, v178, v75, v203
    v_cvt_pk_bf16_f32 v214, v72, v73
    v_cvt_pk_bf16_f32 v215, v74, v75
    s_waitcnt lgkmcnt(5)
    v_mul_f32 v200, v181, v16
    v_mul_f32 v201, v183, v16
    s_waitcnt lgkmcnt(4)
    v_mul_f32 v202, v185, v16
    v_mul_f32 v203, v187, v16
    v_fma_f32 v80, v180, v80, v200
    v_fma_f32 v81, v182, v81, v201
    v_fma_f32 v82, v184, v82, v202
    v_fma_f32 v83, v186, v83, v203
    v_pk_mul_f32 v[200:201], v[80:81], s[62:63]
    v_pk_mul_f32 v[202:203], v[82:83], s[62:63]
    v_min_f32 v200, 0, v200
    v_min_f32 v201, 0, v201
    v_min_f32 v202, 0, v202
    v_min_f32 v203, 0, v203
    v_exp_f32 v200, v200
    v_exp_f32 v201, v201
    v_exp_f32 v202, v202
    v_exp_f32 v203, v203
    v_max_f32 v80, 0, v80
    v_max_f32 v81, 0, v81
    v_max_f32 v82, 0, v82
    v_max_f32 v83, 0, v83
    v_pk_add_f32 v[80:81], v[80:81], s[64:65]
    v_pk_add_f32 v[82:83], v[82:83], s[64:65]
    v_pk_add_f32 v[80:81], v[80:81], v[200:201]
    v_pk_add_f32 v[82:83], v[82:83], v[202:203]
    v_cvt_pk_bf16_f32 v208, v80, v81
    v_cvt_pk_bf16_f32 v209, v82, v83
    v_mul_f32 v200, v181, v20
    v_mul_f32 v201, v183, v20
    v_mul_f32 v202, v185, v20
    v_mul_f32 v203, v187, v20
    v_fma_f32 v84, v180, v84, v200
    v_fma_f32 v85, v182, v85, v201
    v_fma_f32 v86, v184, v86, v202
    v_fma_f32 v87, v186, v87, v203
    v_cvt_pk_bf16_f32 v216, v84, v85
    v_cvt_pk_bf16_f32 v217, v86, v87
    s_waitcnt lgkmcnt(2)
    v_mul_f32 v200, v189, v16
    v_mul_f32 v201, v191, v16
    s_waitcnt lgkmcnt(1)
    v_mul_f32 v202, v193, v16
    v_mul_f32 v203, v195, v16
    v_fma_f32 v92, v188, v92, v200
    v_fma_f32 v93, v190, v93, v201
    v_fma_f32 v94, v192, v94, v202
    v_fma_f32 v95, v194, v95, v203
    v_pk_mul_f32 v[200:201], v[92:93], s[62:63]
    v_pk_mul_f32 v[202:203], v[94:95], s[62:63]
    v_min_f32 v200, 0, v200
    v_min_f32 v201, 0, v201
    v_min_f32 v202, 0, v202
    v_min_f32 v203, 0, v203
    v_exp_f32 v200, v200
    v_exp_f32 v201, v201
    v_exp_f32 v202, v202
    v_exp_f32 v203, v203
    v_max_f32 v92, 0, v92
    v_max_f32 v93, 0, v93
    v_max_f32 v94, 0, v94
    v_max_f32 v95, 0, v95
    v_pk_add_f32 v[92:93], v[92:93], s[64:65]
    v_pk_add_f32 v[94:95], v[94:95], s[64:65]
    v_pk_add_f32 v[92:93], v[92:93], v[200:201]
    v_pk_add_f32 v[94:95], v[94:95], v[202:203]
    v_cvt_pk_bf16_f32 v210, v92, v93
    v_cvt_pk_bf16_f32 v211, v94, v95
    v_mul_f32 v200, v189, v20
    v_mul_f32 v201, v191, v20
    v_mul_f32 v202, v193, v20
    v_mul_f32 v203, v195, v20
    v_fma_f32 v96, v188, v96, v200
    v_fma_f32 v97, v190, v97, v201
    v_fma_f32 v98, v192, v98, v202
    v_fma_f32 v99, v194, v99, v203
    v_cvt_pk_bf16_f32 v218, v96, v97
    v_cvt_pk_bf16_f32 v219, v98, v99
    v_mfma_f32_16x16x32_bf16 v[220:223], v[204:207], v[212:215], 0
    v_mfma_f32_16x16x32_bf16 v[224:227], v[204:207], v[28:31], 0
    v_mfma_f32_16x16x32_bf16 v[220:223], v[208:211], v[216:219], v[220:223]
    v_mfma_f32_16x16x32_bf16 v[224:227], v[208:211], v[28:31], v[224:227]
    s_lshl_b32 s57, s53, 5
    v_add_u32 v228, s66, v2
    v_mul_u32_u24 v228, 80, v228
    v_lshl_add_u32 v228, v3, 3, v228
    v_add_u32 v228, s57, v228
    v_add_u32 v229, s67, v2
    v_mul_u32_u24 v229, 80, v229
    v_lshl_add_u32 v229, v3, 3, v229
    v_add_u32 v229, s57, v229
    v_pk_mul_f32 v[200:201], v[12:13], v[156:157] op_sel:[0,1] op_sel_hi:[1,1]
    v_pk_mul_f32 v[202:203], v[14:15], v[156:157] op_sel:[0,1] op_sel_hi:[1,1]
    v_pk_fma_f32 v[52:53], v[52:53], v[156:157], v[200:201] op_sel:[0,0,0] op_sel_hi:[1,0,1]
    v_pk_fma_f32 v[54:55], v[54:55], v[156:157], v[202:203] op_sel:[0,0,0] op_sel_hi:[1,0,1]
    v_pk_mul_f32 v[200:201], v[52:53], s[62:63]
    v_pk_mul_f32 v[202:203], v[54:55], s[62:63]
    v_min_f32 v200, 0, v200
    v_min_f32 v201, 0, v201
    v_min_f32 v202, 0, v202
    v_min_f32 v203, 0, v203
    v_exp_f32 v200, v200
    v_exp_f32 v201, v201
    v_exp_f32 v202, v202
    v_exp_f32 v203, v203
    v_max_f32 v52, 0, v52
    v_max_f32 v53, 0, v53
    v_max_f32 v54, 0, v54
    v_max_f32 v55, 0, v55
    v_pk_add_f32 v[52:53], v[52:53], s[64:65]
    v_pk_add_f32 v[54:55], v[54:55], s[64:65]
    v_pk_add_f32 v[52:53], v[52:53], v[200:201]
    v_pk_add_f32 v[54:55], v[54:55], v[202:203]
    v_cvt_pk_bf16_f32 v52, v52, v53
    v_cvt_pk_bf16_f32 v53, v54, v55
    ds_write_b64 v228, v[52:53] offset:0
    v_pk_mul_f32 v[200:201], v[12:13], v[158:159] op_sel:[0,1] op_sel_hi:[1,1]
    v_pk_mul_f32 v[202:203], v[14:15], v[158:159] op_sel:[0,1] op_sel_hi:[1,1]
    v_pk_fma_f32 v[64:65], v[64:65], v[158:159], v[200:201] op_sel:[0,0,0] op_sel_hi:[1,0,1]
    v_pk_fma_f32 v[66:67], v[66:67], v[158:159], v[202:203] op_sel:[0,0,0] op_sel_hi:[1,0,1]
    v_pk_mul_f32 v[200:201], v[64:65], s[62:63]
    v_pk_mul_f32 v[202:203], v[66:67], s[62:63]
    v_min_f32 v200, 0, v200
    v_min_f32 v201, 0, v201
    v_min_f32 v202, 0, v202
    v_min_f32 v203, 0, v203
    v_exp_f32 v200, v200
    v_exp_f32 v201, v201
    v_exp_f32 v202, v202
    v_exp_f32 v203, v203
    v_max_f32 v64, 0, v64
    v_max_f32 v65, 0, v65
    v_max_f32 v66, 0, v66
    v_max_f32 v67, 0, v67
    v_pk_add_f32 v[64:65], v[64:65], s[64:65]
    v_pk_add_f32 v[66:67], v[66:67], s[64:65]
    v_pk_add_f32 v[64:65], v[64:65], v[200:201]
    v_pk_add_f32 v[66:67], v[66:67], v[202:203]
    v_cvt_pk_bf16_f32 v64, v64, v65
    v_cvt_pk_bf16_f32 v65, v66, v67
    ds_write_b64 v228, v[64:65] offset:1280
    v_pk_mul_f32 v[200:201], v[12:13], v[160:161] op_sel:[0,1] op_sel_hi:[1,1]
    v_pk_mul_f32 v[202:203], v[14:15], v[160:161] op_sel:[0,1] op_sel_hi:[1,1]
    v_pk_fma_f32 v[76:77], v[76:77], v[160:161], v[200:201] op_sel:[0,0,0] op_sel_hi:[1,0,1]
    v_pk_fma_f32 v[78:79], v[78:79], v[160:161], v[202:203] op_sel:[0,0,0] op_sel_hi:[1,0,1]
    v_pk_mul_f32 v[200:201], v[76:77], s[62:63]
    v_pk_mul_f32 v[202:203], v[78:79], s[62:63]
    v_min_f32 v200, 0, v200
    v_min_f32 v201, 0, v201
    v_min_f32 v202, 0, v202
    v_min_f32 v203, 0, v203
    v_exp_f32 v200, v200
    v_exp_f32 v201, v201
    v_exp_f32 v202, v202
    v_exp_f32 v203, v203
    v_max_f32 v76, 0, v76
    v_max_f32 v77, 0, v77
    v_max_f32 v78, 0, v78
    v_max_f32 v79, 0, v79
    v_pk_add_f32 v[76:77], v[76:77], s[64:65]
    v_pk_add_f32 v[78:79], v[78:79], s[64:65]
    v_pk_add_f32 v[76:77], v[76:77], v[200:201]
    v_pk_add_f32 v[78:79], v[78:79], v[202:203]
    v_cvt_pk_bf16_f32 v76, v76, v77
    v_cvt_pk_bf16_f32 v77, v78, v79
    ds_write_b64 v229, v[76:77] offset:0
    s_waitcnt lgkmcnt(3)
    v_pk_mul_f32 v[200:201], v[12:13], v[162:163] op_sel:[0,1] op_sel_hi:[1,1]
    v_pk_mul_f32 v[202:203], v[14:15], v[162:163] op_sel:[0,1] op_sel_hi:[1,1]
    v_pk_fma_f32 v[88:89], v[88:89], v[162:163], v[200:201] op_sel:[0,0,0] op_sel_hi:[1,0,1]
    v_pk_fma_f32 v[90:91], v[90:91], v[162:163], v[202:203] op_sel:[0,0,0] op_sel_hi:[1,0,1]
    v_pk_mul_f32 v[200:201], v[88:89], s[62:63]
    v_pk_mul_f32 v[202:203], v[90:91], s[62:63]
    v_min_f32 v200, 0, v200
    v_min_f32 v201, 0, v201
    v_min_f32 v202, 0, v202
    v_min_f32 v203, 0, v203
    v_exp_f32 v200, v200
    v_exp_f32 v201, v201
    v_exp_f32 v202, v202
    v_exp_f32 v203, v203
    v_max_f32 v88, 0, v88
    v_max_f32 v89, 0, v89
    v_max_f32 v90, 0, v90
    v_max_f32 v91, 0, v91
    v_pk_add_f32 v[88:89], v[88:89], s[64:65]
    v_pk_add_f32 v[90:91], v[90:91], s[64:65]
    v_pk_add_f32 v[88:89], v[88:89], v[200:201]
    v_pk_add_f32 v[90:91], v[90:91], v[202:203]
    v_cvt_pk_bf16_f32 v88, v88, v89
    v_cvt_pk_bf16_f32 v89, v90, v91
    ds_write_b64 v229, v[88:89] offset:1280
    s_lshl_b32 s57, s3, 10
    s_add_u32 s57, s57, 149504
    v_lshlrev_b32 v5, 4, v1
    v_add_u32 v5, s57, v5
    s_lshl_b32 s58, s3, 6
    s_add_u32 s58, s58, 153600
    v_lshlrev_b32 v6, 4, v3
    v_add_u32 v6, s58, v6
    ds_write_b128 v5, v[220:223]
    ds_write_b128 v6, v[224:227]
    s_waitcnt lgkmcnt(0)
    s_mov_b32 s32, s20
    s_and_b32 s33, s21, 0xffff
    s_mov_b32 s34, 2097152
    s_mov_b32 s35, 0x20000
    s_add_u32 s36, s20, 14745600
    s_addc_u32 s37, s21, 0
    s_and_b32 s37, s37, 0xffff
    s_mov_b32 s38, 34816
    s_mov_b32 s39, 0x20000
    s_barrier
    v_lshrrev_b32 v5, 2, v0
    v_and_b32 v6, 3, v0
    v_mul_u32_u24 v32, 80, v5
    v_lshl_add_u32 v32, v6, 4, v32
    ds_read_b128 v[24:27], v32
    ds_read_b128 v[28:31], v32 offset:5120
    v_add_u32 v5, s50, v5
    v_lshlrev_b32 v33, 10, v5
    v_lshl_add_u32 v33, v6, 4, v33
    v_add_u32 v33, s54, v33
    v_bfe_u32 v5, v0, 3, 4
    v_lshlrev_b32 v5, 4, v5
    v_bfe_u32 v6, v0, 7, 1
    v_lshl_add_u32 v5, v6, 9, v5
    v_bfe_u32 v6, v0, 2, 1
    v_lshl_add_u32 v5, v6, 8, v5
    v_and_b32 v6, 3, v0
    v_lshl_add_u32 v5, v6, 2, v5
    v_add_u32 v5, 149504, v5
    ds_read_b32 v36, v5 offset:0
    ds_read_b32 v37, v5 offset:2048
    ds_read_b32 v38, v5 offset:1024
    ds_read_b32 v39, v5 offset:3072
    v_and_b32 v7, 31, v0
    v_lshlrev_b32 v7, 2, v7
    v_add_u32 v6, 153600, v7
    ds_read_b32 v40, v6
    ds_read_b32 v41, v6 offset:128
    s_mov_b32 s60, 65536
    s_waitcnt lgkmcnt(7)
    buffer_store_dwordx4 v[24:27], v33, s[32:35], 0 offen
    s_waitcnt lgkmcnt(6)
    buffer_store_dwordx4 v[28:31], v33, s[32:35], s60 offen
    s_lshl_b32 s57, s23, 11
    v_lshlrev_b32 v6, 2, v0
    v_add_u32 v6, s57, v6
    s_waitcnt lgkmcnt(4)
    v_add_f32 v36, v36, v37
    buffer_atomic_add_f32 v36, v6, s[36:39], 0 offen offset:0
    s_waitcnt lgkmcnt(2)
    v_add_f32 v38, v38, v39
    buffer_atomic_add_f32 v38, v6, s[36:39], 0 offen offset:1024
    s_lshl_b32 s57, s23, 7
    s_add_u32 s57, s57, 32768
    v_add_u32 v7, s57, v7
    v_mov_b32 v6, 0x7ffffff0
    v_cmp_gt_u32 vcc, 32, v0
    s_nop 1
    v_cndmask_b32 v7, v6, v7, vcc
    s_waitcnt lgkmcnt(0)
    v_add_f32 v40, v40, v41
    buffer_atomic_add_f32 v40, v7, s[36:39], 0 offen
kB_kernel_end:
    s_endpgm
.globl kC_kernel
.p2align 8
.type kC_kernel,@function
kC_kernel:
    s_cmp_ge_u32 s2, 256
    s_cbranch_scc1 kC_kernel_end
    s_load_dwordx16 s[4:19], s[0:1], 0
    s_load_dwordx2 s[20:21], s[0:1], 64
    v_lshrrev_b32 v4, 6, v0
    v_and_b32 v1, 63, v0
    v_readfirstlane_b32 s3, v4
    v_and_b32 v2, 15, v0
    v_bfe_u32 v3, v0, 4, 2
    s_sub_u32 s59, s3, 4
    s_and_b32 s48, s2, 7
    s_lshl_b32 s48, s48, 1
    s_lshr_b32 s49, s2, 7
    s_add_u32 s96, s48, s49
    s_bfe_u32 s97, s2, 0x40003
    s_cmp_lt_u32 s3, 4
    s_cbranch_scc1 kC_kernel_compute
    s_cmp_lt_u32 s3, 6
    s_cbranch_scc1 kC_kernel_aload
    s_sub_u32 s59, s3, 6
    v_lshlrev_b32 v15, 4, v1
    v_lshrrev_b32 v5, 3, v1
    v_bfe_u32 v6, v1, 4, 2
    v_lshlrev_b32 v6, 1, v6
    v_and_b32 v7, 7, v1
    v_xor_b32 v6, v6, v7
    v_lshlrev_b32 v6, 4, v6
    v_lshl_add_u32 v5, v5, 10, v6
    s_lshl_b32 s52, s59, 16
    s_and_b32 s54, s97, 7
    s_lshl_b32 s54, s54, 7
    s_add_u32 s52, s52, s54
    v_add_u32 v16, s52, v5
    v_add_u32 v17, 8192, v16
    v_add_u32 v18, 16384, v16
    v_add_u32 v19, 24576, v16
    v_add_u32 v20, 32768, v16
    v_add_u32 v21, 40960, v16
    v_add_u32 v22, 49152, v16
    v_add_u32 v23, 57344, v16
    s_lshl_b32 s44, s59, 13
    s_waitcnt lgkmcnt(0)
    s_mov_b32 s24, s8
    s_and_b32 s25, s9, 0xffff
    s_mov_b32 s26, 524288
    s_mov_b32 s27, 0x20000
    s_mov_b32 s57, 0
    s_add_u32 m0, s44, 65536
    s_nop 0
    buffer_load_dwordx4 v16, s[24:27], s57 offen lds
    s_add_u32 m0, s44, 66560
    s_nop 0
    buffer_load_dwordx4 v17, s[24:27], s57 offen lds
    s_add_u32 m0, s44, 67584
    s_nop 0
    buffer_load_dwordx4 v18, s[24:27], s57 offen lds
    s_add_u32 m0, s44, 68608
    s_nop 0
    buffer_load_dwordx4 v19, s[24:27], s57 offen lds
    s_add_u32 m0, s44, 69632
    s_nop 0
    buffer_load_dwordx4 v20, s[24:27], s57 offen lds
    s_add_u32 m0, s44, 70656
    s_nop 0
    buffer_load_dwordx4 v21, s[24:27], s57 offen lds
    s_add_u32 m0, s44, 71680
    s_nop 0
    buffer_load_dwordx4 v22, s[24:27], s57 offen lds
    s_add_u32 m0, s44, 72704
    s_nop 0
    buffer_load_dwordx4 v23, s[24:27], s57 offen lds
    s_mov_b32 s57, 131072
    s_add_u32 m0, s44, 81920
    s_nop 0
    buffer_load_dwordx4 v16, s[24:27], s57 offen lds
    s_add_u32 m0, s44, 82944
    s_nop 0
    buffer_load_dwordx4 v17, s[24:27], s57 offen lds
    s_add_u32 m0, s44, 83968
    s_nop 0
    buffer_load_dwordx4 v18, s[24:27], s57 offen lds
    s_add_u32 m0, s44, 84992
    s_nop 0
    buffer_load_dwordx4 v19, s[24:27], s57 offen lds
    s_add_u32 m0, s44, 86016
    s_nop 0
    buffer_load_dwordx4 v20, s[24:27], s57 offen lds
    s_add_u32 m0, s44, 87040
    s_nop 0
    buffer_load_dwordx4 v21, s[24:27], s57 offen lds
    s_add_u32 m0, s44, 88064
    s_nop 0
    buffer_load_dwordx4 v22, s[24:27], s57 offen lds
    s_add_u32 m0, s44, 89088
    s_nop 0
    buffer_load_dwordx4 v23, s[24:27], s57 offen lds
    s_getpc_b64 s[40:41]
kC_kernel_pc:
    s_mov_b32 s42, kC_kernel_end-kC_kernel_pc-16
    s_bfe_u32 s43, s2, 0x50003
    s_lshl_b32 s43, s43, 1
    s_add_u32 s43, s43, s59
    s_lshl_b32 s43, s43, 10
    v_add_u32 v5, s43, v15
    v_min_u32 v5, s42, v5
    v_and_b32 v5, -4, v5
    global_load_dwordx4 v[28:31], v5, s[40:41]
    s_waitcnt vmcnt(9)
    s_barrier
    s_mov_b32 s57, 262144
    s_add_u32 m0, s44, 98304
    s_nop 0
    buffer_load_dwordx4 v16, s[24:27], s57 offen lds
    s_add_u32 m0, s44, 99328
    s_nop 0
    buffer_load_dwordx4 v17, s[24:27], s57 offen lds
    s_add_u32 m0, s44, 100352
    s_nop 0
    buffer_load_dwordx4 v18, s[24:27], s57 offen lds
    s_add_u32 m0, s44, 101376
    s_nop 0
    buffer_load_dwordx4 v19, s[24:27], s57 offen lds
    s_add_u32 m0, s44, 102400
    s_nop 0
    buffer_load_dwordx4 v20, s[24:27], s57 offen lds
    s_add_u32 m0, s44, 103424
    s_nop 0
    buffer_load_dwordx4 v21, s[24:27], s57 offen lds
    s_add_u32 m0, s44, 104448
    s_nop 0
    buffer_load_dwordx4 v22, s[24:27], s57 offen lds
    s_add_u32 m0, s44, 105472
    s_nop 0
    buffer_load_dwordx4 v23, s[24:27], s57 offen lds
    s_mov_b32 s57, 393216
    s_add_u32 m0, s44, 114688
    s_nop 0
    buffer_load_dwordx4 v16, s[24:27], s57 offen lds
    s_add_u32 m0, s44, 115712
    s_nop 0
    buffer_load_dwordx4 v17, s[24:27], s57 offen lds
    s_add_u32 m0, s44, 116736
    s_nop 0
    buffer_load_dwordx4 v18, s[24:27], s57 offen lds
    s_add_u32 m0, s44, 117760
    s_nop 0
    buffer_load_dwordx4 v19, s[24:27], s57 offen lds
    s_add_u32 m0, s44, 118784
    s_nop 0
    buffer_load_dwordx4 v20, s[24:27], s57 offen lds
    s_add_u32 m0, s44, 119808
    s_nop 0
    buffer_load_dwordx4 v21, s[24:27], s57 offen lds
    s_add_u32 m0, s44, 120832
    s_nop 0
    buffer_load_dwordx4 v22, s[24:27], s57 offen lds
    s_add_u32 m0, s44, 121856
    s_nop 0
    buffer_load_dwordx4 v23, s[24:27], s57 offen lds
    s_waitcnt vmcnt(17)
    s_barrier
    s_lshl_b32 s52, s59, 5
    s_mul_i32 s54, s97, 224
    v_lshlrev_b32 v5, 1, v3
    v_xor_b32 v5, v5, v2
    v_cmp_gt_u32 s[62:63], 14, v5
    v_lshlrev_b32 v5, 4, v5
    v_add3_u32 v6, v3, s52, 0
    v_mul_u32_u24 v6, 3584, v6
    v_add3_u32 v32, v6, v5, s54
    v_lshlrev_b32 v5, 1, v3
    v_xor_b32 v5, v5, v2
    v_lshlrev_b32 v5, 4, v5
    v_add3_u32 v6, v3, s52, 4
    v_mul_u32_u24 v6, 3584, v6
    v_add3_u32 v33, v6, v5, s54
    v_lshlrev_b32 v5, 1, v3
    v_or_b32 v5, 8, v5
    v_xor_b32 v5, v5, v2
    v_cmp_gt_u32 s[64:65], 14, v5
    v_lshlrev_b32 v5, 4, v5
    v_add3_u32 v6, v3, s52, 8
    v_mul_u32_u24 v6, 3584, v6
    v_add3_u32 v34, v6, v5, s54
    v_lshlrev_b32 v5, 1, v3
    v_or_b32 v5, 8, v5
    v_xor_b32 v5, v5, v2
    v_lshlrev_b32 v5, 4, v5
    v_add3_u32 v6, v3, s52, 12
    v_mul_u32_u24 v6, 3584, v6
    v_add3_u32 v35, v6, v5, s54
    v_lshlrev_b32 v5, 1, v3
    v_xor_b32 v5, v5, v2
    v_lshlrev_b32 v5, 4, v5
    v_add3_u32 v6, v3, s52, 16
    v_mul_u32_u24 v6, 3584, v6
    v_add3_u32 v36, v6, v5, s54
    v_lshlrev_b32 v5, 1, v3
    v_xor_b32 v5, v5, v2
    v_lshlrev_b32 v5, 4, v5
    v_add3_u32 v6, v3, s52, 20
    v_mul_u32_u24 v6, 3584, v6
    v_add3_u32 v37, v6, v5, s54
    v_lshlrev_b32 v5, 1, v3
    v_or_b32 v5, 8, v5
    v_xor_b32 v5, v5, v2
    v_lshlrev_b32 v5, 4, v5
    v_add3_u32 v6, v3, s52, 24
    v_mul_u32_u24 v6, 3584, v6
    v_add3_u32 v38, v6, v5, s54
    v_lshlrev_b32 v5, 1, v3
    v_or_b32 v5, 8, v5
    v_xor_b32 v5, v5, v2
    v_lshlrev_b32 v5, 4, v5
    v_add3_u32 v6, v3, s52, 28
    v_mul_u32_u24 v6, 3584, v6
    v_add3_u32 v39, v6, v5, s54
    s_lshl_b32 s45, s59, 13
    s_waitcnt lgkmcnt(0)
    s_mov_b32 s28, s12
    s_and_b32 s29, s13, 0xffff
    s_mov_b32 s30, 1835008
    s_mov_b32 s31, 0x20000
    s_mov_b32 s57, 0
    s_mov_b64 exec, s[62:63]
    s_add_u32 m0, s45, 65536
    s_nop 0
    buffer_load_dwordx4 v32, s[28:31], s57 offen lds
    s_add_u32 m0, s45, 66560
    s_nop 0
    buffer_load_dwordx4 v33, s[28:31], s57 offen lds
    s_mov_b64 exec, s[64:65]
    s_add_u32 m0, s45, 67584
    s_nop 0
    buffer_load_dwordx4 v34, s[28:31], s57 offen lds
    s_add_u32 m0, s45, 68608
    s_nop 0
    buffer_load_dwordx4 v35, s[28:31], s57 offen lds
    s_mov_b64 exec, s[62:63]
    s_add_u32 m0, s45, 69632
    s_nop 0
    buffer_load_dwordx4 v36, s[28:31], s57 offen lds
    s_add_u32 m0, s45, 70656
    s_nop 0
    buffer_load_dwordx4 v37, s[28:31], s57 offen lds
    s_mov_b64 exec, s[64:65]
    s_add_u32 m0, s45, 71680
    s_nop 0
    buffer_load_dwordx4 v38, s[28:31], s57 offen lds
    s_add_u32 m0, s45, 72704
    s_nop 0
    buffer_load_dwordx4 v39, s[28:31], s57 offen lds
    s_mov_b64 exec, -1
    s_waitcnt vmcnt(16)
    s_barrier
    s_mov_b32 s57, 229376
    s_mov_b64 exec, s[62:63]
    s_add_u32 m0, s45, 81920
    s_nop 0
    buffer_load_dwordx4 v32, s[28:31], s57 offen lds
    s_add_u32 m0, s45, 82944
    s_nop 0
    buffer_load_dwordx4 v33, s[28:31], s57 offen lds
    s_mov_b64 exec, s[64:65]
    s_add_u32 m0, s45, 83968
    s_nop 0
    buffer_load_dwordx4 v34, s[28:31], s57 offen lds
    s_add_u32 m0, s45, 84992
    s_nop 0
    buffer_load_dwordx4 v35, s[28:31], s57 offen lds
    s_mov_b64 exec, s[62:63]
    s_add_u32 m0, s45, 86016
    s_nop 0
    buffer_load_dwordx4 v36, s[28:31], s57 offen lds
    s_add_u32 m0, s45, 87040
    s_nop 0
    buffer_load_dwordx4 v37, s[28:31], s57 offen lds
    s_mov_b64 exec, s[64:65]
    s_add_u32 m0, s45, 88064
    s_nop 0
    buffer_load_dwordx4 v38, s[28:31], s57 offen lds
    s_add_u32 m0, s45, 89088
    s_nop 0
    buffer_load_dwordx4 v39, s[28:31], s57 offen lds
    s_mov_b64 exec, -1
    s_waitcnt vmcnt(16)
    s_barrier
    s_mov_b32 s57, 458752
    s_mov_b64 exec, s[62:63]
    s_add_u32 m0, s45, 98304
    s_nop 0
    buffer_load_dwordx4 v32, s[28:31], s57 offen lds
    s_add_u32 m0, s45, 99328
    s_nop 0
    buffer_load_dwordx4 v33, s[28:31], s57 offen lds
    s_mov_b64 exec, s[64:65]
    s_add_u32 m0, s45, 100352
    s_nop 0
    buffer_load_dwordx4 v34, s[28:31], s57 offen lds
    s_add_u32 m0, s45, 101376
    s_nop 0
    buffer_load_dwordx4 v35, s[28:31], s57 offen lds
    s_mov_b64 exec, s[62:63]
    s_add_u32 m0, s45, 102400
    s_nop 0
    buffer_load_dwordx4 v36, s[28:31], s57 offen lds
    s_add_u32 m0, s45, 103424
    s_nop 0
    buffer_load_dwordx4 v37, s[28:31], s57 offen lds
    s_mov_b64 exec, s[64:65]
    s_add_u32 m0, s45, 104448
    s_nop 0
    buffer_load_dwordx4 v38, s[28:31], s57 offen lds
    s_add_u32 m0, s45, 105472
    s_nop 0
    buffer_load_dwordx4 v39, s[28:31], s57 offen lds
    s_mov_b64 exec, -1
    s_barrier
    s_mov_b32 s57, 688128
    s_mov_b64 exec, s[62:63]
    s_add_u32 m0, s45, 114688
    s_nop 0
    buffer_load_dwordx4 v32, s[28:31], s57 offen lds
    s_add_u32 m0, s45, 115712
    s_nop 0
    buffer_load_dwordx4 v33, s[28:31], s57 offen lds
    s_mov_b64 exec, s[64:65]
    s_add_u32 m0, s45, 116736
    s_nop 0
    buffer_load_dwordx4 v34, s[28:31], s57 offen lds
    s_add_u32 m0, s45, 117760
    s_nop 0
    buffer_load_dwordx4 v35, s[28:31], s57 offen lds
    s_mov_b64 exec, s[62:63]
    s_add_u32 m0, s45, 118784
    s_nop 0
    buffer_load_dwordx4 v36, s[28:31], s57 offen lds
    s_add_u32 m0, s45, 119808
    s_nop 0
    buffer_load_dwordx4 v37, s[28:31], s57 offen lds
    s_mov_b64 exec, s[64:65]
    s_add_u32 m0, s45, 120832
    s_nop 0
    buffer_load_dwordx4 v38, s[28:31], s57 offen lds
    s_add_u32 m0, s45, 121856
    s_nop 0
    buffer_load_dwordx4 v39, s[28:31], s57 offen lds
    s_mov_b64 exec, -1
    s_barrier
    s_waitcnt vmcnt(24)
    s_mov_b32 s57, 917504
    s_mov_b64 exec, s[62:63]
    s_add_u32 m0, s45, 131072
    s_nop 0
    buffer_load_dwordx4 v32, s[28:31], s57 offen lds
    s_add_u32 m0, s45, 132096
    s_nop 0
    buffer_load_dwordx4 v33, s[28:31], s57 offen lds
    s_mov_b64 exec, s[64:65]
    s_add_u32 m0, s45, 133120
    s_nop 0
    buffer_load_dwordx4 v34, s[28:31], s57 offen lds
    s_add_u32 m0, s45, 134144
    s_nop 0
    buffer_load_dwordx4 v35, s[28:31], s57 offen lds
    s_mov_b64 exec, s[62:63]
    s_add_u32 m0, s45, 135168
    s_nop 0
    buffer_load_dwordx4 v36, s[28:31], s57 offen lds
    s_add_u32 m0, s45, 136192
    s_nop 0
    buffer_load_dwordx4 v37, s[28:31], s57 offen lds
    s_mov_b64 exec, s[64:65]
    s_add_u32 m0, s45, 137216
    s_nop 0
    buffer_load_dwordx4 v38, s[28:31], s57 offen lds
    s_add_u32 m0, s45, 138240
    s_nop 0
    buffer_load_dwordx4 v39, s[28:31], s57 offen lds
    s_mov_b64 exec, -1
    s_barrier
    s_barrier
    s_waitcnt vmcnt(24)
    s_barrier
    s_mov_b32 s57, 1146880
    s_mov_b64 exec, s[62:63]
    s_add_u32 m0, s45, 65536
    s_nop 0
    buffer_load_dwordx4 v32, s[28:31], s57 offen lds
    s_add_u32 m0, s45, 66560
    s_nop 0
    buffer_load_dwordx4 v33, s[28:31], s57 offen lds
    s_mov_b64 exec, s[64:65]
    s_add_u32 m0, s45, 67584
    s_nop 0
    buffer_load_dwordx4 v34, s[28:31], s57 offen lds
    s_add_u32 m0, s45, 68608
    s_nop 0
    buffer_load_dwordx4 v35, s[28:31], s57 offen lds
    s_mov_b64 exec, s[62:63]
    s_add_u32 m0, s45, 69632
    s_nop 0
    buffer_load_dwordx4 v36, s[28:31], s57 offen lds
    s_add_u32 m0, s45, 70656
    s_nop 0
    buffer_load_dwordx4 v37, s[28:31], s57 offen lds
    s_mov_b64 exec, s[64:65]
    s_add_u32 m0, s45, 71680
    s_nop 0
    buffer_load_dwordx4 v38, s[28:31], s57 offen lds
    s_add_u32 m0, s45, 72704
    s_nop 0
    buffer_load_dwordx4 v39, s[28:31], s57 offen lds
    s_mov_b64 exec, -1
    s_waitcnt vmcnt(24)
    s_barrier
    s_mov_b32 s57, 1376256
    s_mov_b64 exec, s[62:63]
    s_add_u32 m0, s45, 81920
    s_nop 0
    buffer_load_dwordx4 v32, s[28:31], s57 offen lds
    s_add_u32 m0, s45, 82944
    s_nop 0
    buffer_load_dwordx4 v33, s[28:31], s57 offen lds
    s_mov_b64 exec, s[64:65]
    s_add_u32 m0, s45, 83968
    s_nop 0
    buffer_load_dwordx4 v34, s[28:31], s57 offen lds
    s_add_u32 m0, s45, 84992
    s_nop 0
    buffer_load_dwordx4 v35, s[28:31], s57 offen lds
    s_mov_b64 exec, s[62:63]
    s_add_u32 m0, s45, 86016
    s_nop 0
    buffer_load_dwordx4 v36, s[28:31], s57 offen lds
    s_add_u32 m0, s45, 87040
    s_nop 0
    buffer_load_dwordx4 v37, s[28:31], s57 offen lds
    s_mov_b64 exec, s[64:65]
    s_add_u32 m0, s45, 88064
    s_nop 0
    buffer_load_dwordx4 v38, s[28:31], s57 offen lds
    s_add_u32 m0, s45, 89088
    s_nop 0
    buffer_load_dwordx4 v39, s[28:31], s57 offen lds
    s_mov_b64 exec, -1
    s_waitcnt vmcnt(24)
    s_barrier
    s_mov_b32 s57, 1605632
    s_mov_b64 exec, s[62:63]
    s_add_u32 m0, s45, 98304
    s_nop 0
    buffer_load_dwordx4 v32, s[28:31], s57 offen lds
    s_add_u32 m0, s45, 99328
    s_nop 0
    buffer_load_dwordx4 v33, s[28:31], s57 offen lds
    s_mov_b64 exec, s[64:65]
    s_add_u32 m0, s45, 100352
    s_nop 0
    buffer_load_dwordx4 v34, s[28:31], s57 offen lds
    s_add_u32 m0, s45, 101376
    s_nop 0
    buffer_load_dwordx4 v35, s[28:31], s57 offen lds
    s_mov_b64 exec, s[62:63]
    s_add_u32 m0, s45, 102400
    s_nop 0
    buffer_load_dwordx4 v36, s[28:31], s57 offen lds
    s_add_u32 m0, s45, 103424
    s_nop 0
    buffer_load_dwordx4 v37, s[28:31], s57 offen lds
    s_mov_b64 exec, s[64:65]
    s_add_u32 m0, s45, 104448
    s_nop 0
    buffer_load_dwordx4 v38, s[28:31], s57 offen lds
    s_add_u32 m0, s45, 105472
    s_nop 0
    buffer_load_dwordx4 v39, s[28:31], s57 offen lds
    s_mov_b64 exec, -1
    s_waitcnt vmcnt(24)
    s_barrier
    s_waitcnt vmcnt(16)
    s_barrier
    s_lshl_b32 s52, s59, 16
    s_and_b32 s54, s97, 7
    s_lshl_b32 s54, s54, 7
    s_add_u32 s52, s52, s54
    v_bfe_u32 v5, v1, 4, 1
    v_lshlrev_b32 v5, 1, v5
    v_and_b32 v6, 7, v1
    v_xor_b32 v5, v5, v6
    v_lshlrev_b32 v5, 4, v5
    v_lshrrev_b32 v6, 3, v1
    v_add_u32 v6, 0, v6
    v_lshl_add_u32 v5, v6, 10, v5
    v_add_u32 v40, s52, v5
    v_bfe_u32 v5, v1, 4, 1
    v_lshlrev_b32 v5, 1, v5
    v_or_b32 v5, 4, v5
    v_and_b32 v6, 7, v1
    v_xor_b32 v5, v5, v6
    v_lshlrev_b32 v5, 4, v5
    v_lshrrev_b32 v6, 3, v1
    v_add_u32 v6, 8, v6
    v_lshl_add_u32 v5, v6, 10, v5
    v_add_u32 v41, s52, v5
    v_bfe_u32 v5, v1, 4, 1
    v_lshlrev_b32 v5, 1, v5
    v_and_b32 v6, 7, v1
    v_xor_b32 v5, v5, v6
    v_lshlrev_b32 v5, 4, v5
    v_lshrrev_b32 v6, 3, v1
    v_add_u32 v6, 16, v6
    v_lshl_add_u32 v5, v6, 10, v5
    v_add_u32 v42, s52, v5
    v_bfe_u32 v5, v1, 4, 1
    v_lshlrev_b32 v5, 1, v5
    v_or_b32 v5, 4, v5
    v_and_b32 v6, 7, v1
    v_xor_b32 v5, v5, v6
    v_lshlrev_b32 v5, 4, v5
    v_lshrrev_b32 v6, 3, v1
    v_add_u32 v6, 24, v6
    v_lshl_add_u32 v5, v6, 10, v5
    v_add_u32 v43, s52, v5
    v_bfe_u32 v5, v1, 4, 1
    v_lshlrev_b32 v5, 1, v5
    v_and_b32 v6, 7, v1
    v_xor_b32 v5, v5, v6
    v_lshlrev_b32 v5, 4, v5
    v_lshrrev_b32 v6, 3, v1
    v_add_u32 v6, 32, v6
    v_lshl_add_u32 v5, v6, 10, v5
    v_add_u32 v44, s52, v5
    v_bfe_u32 v5, v1, 4, 1
    v_lshlrev_b32 v5, 1, v5
    v_or_b32 v5, 4, v5
    v_and_b32 v6, 7, v1
    v_xor_b32 v5, v5, v6
    v_lshlrev_b32 v5, 4, v5
    v_lshrrev_b32 v6, 3, v1
    v_add_u32 v6, 40, v6
    v_lshl_add_u32 v5, v6, 10, v5
    v_add_u32 v45, s52, v5
    v_bfe_u32 v5, v1, 4, 1
    v_lshlrev_b32 v5, 1, v5
    v_and_b32 v6, 7, v1
    v_xor_b32 v5, v5, v6
    v_lshlrev_b32 v5, 4, v5
    v_lshrrev_b32 v6, 3, v1
    v_add_u32 v6, 48, v6
    v_lshl_add_u32 v5, v6, 10, v5
    v_add_u32 v46, s52, v5
    v_bfe_u32 v5, v1, 4, 1
    v_lshlrev_b32 v5, 1, v5
    v_or_b32 v5, 4, v5
    v_and_b32 v6, 7, v1
    v_xor_b32 v5, v5, v6
    v_lshlrev_b32 v5, 4, v5
    v_lshrrev_b32 v6, 3, v1
    v_add_u32 v6, 56, v6
    v_lshl_add_u32 v5, v6, 10, v5
    v_add_u32 v47, s52, v5
    s_lshl_b32 s46, s59, 13
    s_waitcnt lgkmcnt(0)
    s_mov_b32 s32, s14
    s_and_b32 s33, s15, 0xffff
    s_mov_b32 s34, 1835008
    s_mov_b32 s35, 0x20000
    s_mov_b32 s57, 0
    s_add_u32 m0, s46, 114688
    s_nop 0
    buffer_load_dwordx4 v40, s[32:35], s57 offen lds
    s_add_u32 m0, s46, 115712
    s_nop 0
    buffer_load_dwordx4 v41, s[32:35], s57 offen lds
    s_add_u32 m0, s46, 116736
    s_nop 0
    buffer_load_dwordx4 v42, s[32:35], s57 offen lds
    s_add_u32 m0, s46, 117760
    s_nop 0
    buffer_load_dwordx4 v43, s[32:35], s57 offen lds
    s_add_u32 m0, s46, 118784
    s_nop 0
    buffer_load_dwordx4 v44, s[32:35], s57 offen lds
    s_add_u32 m0, s46, 119808
    s_nop 0
    buffer_load_dwordx4 v45, s[32:35], s57 offen lds
    s_add_u32 m0, s46, 120832
    s_nop 0
    buffer_load_dwordx4 v46, s[32:35], s57 offen lds
    s_add_u32 m0, s46, 121856
    s_nop 0
    buffer_load_dwordx4 v47, s[32:35], s57 offen lds
    s_waitcnt vmcnt(16)
    s_barrier
    s_mov_b32 s57, 131072
    s_add_u32 m0, s46, 131072
    s_nop 0
    buffer_load_dwordx4 v40, s[32:35], s57 offen lds
    s_add_u32 m0, s46, 132096
    s_nop 0
    buffer_load_dwordx4 v41, s[32:35], s57 offen lds
    s_add_u32 m0, s46, 133120
    s_nop 0
    buffer_load_dwordx4 v42, s[32:35], s57 offen lds
    s_add_u32 m0, s46, 134144
    s_nop 0
    buffer_load_dwordx4 v43, s[32:35], s57 offen lds
    s_add_u32 m0, s46, 135168
    s_nop 0
    buffer_load_dwordx4 v44, s[32:35], s57 offen lds
    s_add_u32 m0, s46, 136192
    s_nop 0
    buffer_load_dwordx4 v45, s[32:35], s57 offen lds
    s_add_u32 m0, s46, 137216
    s_nop 0
    buffer_load_dwordx4 v46, s[32:35], s57 offen lds
    s_add_u32 m0, s46, 138240
    s_nop 0
    buffer_load_dwordx4 v47, s[32:35], s57 offen lds
    s_waitcnt vmcnt(16)
    s_barrier
    s_mov_b32 s57, 262144
    s_add_u32 m0, s46, 65536
    s_nop 0
    buffer_load_dwordx4 v40, s[32:35], s57 offen lds
    s_add_u32 m0, s46, 66560
    s_nop 0
    buffer_load_dwordx4 v41, s[32:35], s57 offen lds
    s_add_u32 m0, s46, 67584
    s_nop 0
    buffer_load_dwordx4 v42, s[32:35], s57 offen lds
    s_add_u32 m0, s46, 68608
    s_nop 0
    buffer_load_dwordx4 v43, s[32:35], s57 offen lds
    s_add_u32 m0, s46, 69632
    s_nop 0
    buffer_load_dwordx4 v44, s[32:35], s57 offen lds
    s_add_u32 m0, s46, 70656
    s_nop 0
    buffer_load_dwordx4 v45, s[32:35], s57 offen lds
    s_add_u32 m0, s46, 71680
    s_nop 0
    buffer_load_dwordx4 v46, s[32:35], s57 offen lds
    s_add_u32 m0, s46, 72704
    s_nop 0
    buffer_load_dwordx4 v47, s[32:35], s57 offen lds
    s_barrier
    s_mov_b32 s57, 393216
    s_add_u32 m0, s46, 81920
    s_nop 0
    buffer_load_dwordx4 v40, s[32:35], s57 offen lds
    s_add_u32 m0, s46, 82944
    s_nop 0
    buffer_load_dwordx4 v41, s[32:35], s57 offen lds
    s_add_u32 m0, s46, 83968
    s_nop 0
    buffer_load_dwordx4 v42, s[32:35], s57 offen lds
    s_add_u32 m0, s46, 84992
    s_nop 0
    buffer_load_dwordx4 v43, s[32:35], s57 offen lds
    s_add_u32 m0, s46, 86016
    s_nop 0
    buffer_load_dwordx4 v44, s[32:35], s57 offen lds
    s_add_u32 m0, s46, 87040
    s_nop 0
    buffer_load_dwordx4 v45, s[32:35], s57 offen lds
    s_add_u32 m0, s46, 88064
    s_nop 0
    buffer_load_dwordx4 v46, s[32:35], s57 offen lds
    s_add_u32 m0, s46, 89088
    s_nop 0
    buffer_load_dwordx4 v47, s[32:35], s57 offen lds
    s_waitcnt vmcnt(24)
    s_mov_b32 s57, 524288
    s_add_u32 m0, s46, 98304
    s_nop 0
    buffer_load_dwordx4 v40, s[32:35], s57 offen lds
    s_add_u32 m0, s46, 99328
    s_nop 0
    buffer_load_dwordx4 v41, s[32:35], s57 offen lds
    s_add_u32 m0, s46, 100352
    s_nop 0
    buffer_load_dwordx4 v42, s[32:35], s57 offen lds
    s_add_u32 m0, s46, 101376
    s_nop 0
    buffer_load_dwordx4 v43, s[32:35], s57 offen lds
    s_add_u32 m0, s46, 102400
    s_nop 0
    buffer_load_dwordx4 v44, s[32:35], s57 offen lds
    s_add_u32 m0, s46, 103424
    s_nop 0
    buffer_load_dwordx4 v45, s[32:35], s57 offen lds
    s_add_u32 m0, s46, 104448
    s_nop 0
    buffer_load_dwordx4 v46, s[32:35], s57 offen lds
    s_add_u32 m0, s46, 105472
    s_nop 0
    buffer_load_dwordx4 v47, s[32:35], s57 offen lds
    s_barrier
    s_barrier
    s_barrier
    s_waitcnt vmcnt(24)
    s_barrier
    s_mov_b32 s57, 655360
    s_add_u32 m0, s46, 114688
    s_nop 0
    buffer_load_dwordx4 v40, s[32:35], s57 offen lds
    s_add_u32 m0, s46, 115712
    s_nop 0
    buffer_load_dwordx4 v41, s[32:35], s57 offen lds
    s_add_u32 m0, s46, 116736
    s_nop 0
    buffer_load_dwordx4 v42, s[32:35], s57 offen lds
    s_add_u32 m0, s46, 117760
    s_nop 0
    buffer_load_dwordx4 v43, s[32:35], s57 offen lds
    s_add_u32 m0, s46, 118784
    s_nop 0
    buffer_load_dwordx4 v44, s[32:35], s57 offen lds
    s_add_u32 m0, s46, 119808
    s_nop 0
    buffer_load_dwordx4 v45, s[32:35], s57 offen lds
    s_add_u32 m0, s46, 120832
    s_nop 0
    buffer_load_dwordx4 v46, s[32:35], s57 offen lds
    s_add_u32 m0, s46, 121856
    s_nop 0
    buffer_load_dwordx4 v47, s[32:35], s57 offen lds
    s_waitcnt vmcnt(24)
    s_barrier
    s_mov_b32 s57, 786432
    s_add_u32 m0, s46, 131072
    s_nop 0
    buffer_load_dwordx4 v40, s[32:35], s57 offen lds
    s_add_u32 m0, s46, 132096
    s_nop 0
    buffer_load_dwordx4 v41, s[32:35], s57 offen lds
    s_add_u32 m0, s46, 133120
    s_nop 0
    buffer_load_dwordx4 v42, s[32:35], s57 offen lds
    s_add_u32 m0, s46, 134144
    s_nop 0
    buffer_load_dwordx4 v43, s[32:35], s57 offen lds
    s_add_u32 m0, s46, 135168
    s_nop 0
    buffer_load_dwordx4 v44, s[32:35], s57 offen lds
    s_add_u32 m0, s46, 136192
    s_nop 0
    buffer_load_dwordx4 v45, s[32:35], s57 offen lds
    s_add_u32 m0, s46, 137216
    s_nop 0
    buffer_load_dwordx4 v46, s[32:35], s57 offen lds
    s_add_u32 m0, s46, 138240
    s_nop 0
    buffer_load_dwordx4 v47, s[32:35], s57 offen lds
    s_waitcnt vmcnt(24)
    s_barrier
    s_mov_b32 s57, 917504
    s_add_u32 m0, s46, 65536
    s_nop 0
    buffer_load_dwordx4 v40, s[32:35], s57 offen lds
    s_add_u32 m0, s46, 66560
    s_nop 0
    buffer_load_dwordx4 v41, s[32:35], s57 offen lds
    s_add_u32 m0, s46, 67584
    s_nop 0
    buffer_load_dwordx4 v42, s[32:35], s57 offen lds
    s_add_u32 m0, s46, 68608
    s_nop 0
    buffer_load_dwordx4 v43, s[32:35], s57 offen lds
    s_add_u32 m0, s46, 69632
    s_nop 0
    buffer_load_dwordx4 v44, s[32:35], s57 offen lds
    s_add_u32 m0, s46, 70656
    s_nop 0
    buffer_load_dwordx4 v45, s[32:35], s57 offen lds
    s_add_u32 m0, s46, 71680
    s_nop 0
    buffer_load_dwordx4 v46, s[32:35], s57 offen lds
    s_add_u32 m0, s46, 72704
    s_nop 0
    buffer_load_dwordx4 v47, s[32:35], s57 offen lds
    s_waitcnt vmcnt(24)
    s_barrier
    s_mov_b32 s57, 1048576
    s_add_u32 m0, s46, 81920
    s_nop 0
    buffer_load_dwordx4 v40, s[32:35], s57 offen lds
    s_add_u32 m0, s46, 82944
    s_nop 0
    buffer_load_dwordx4 v41, s[32:35], s57 offen lds
    s_add_u32 m0, s46, 83968
    s_nop 0
    buffer_load_dwordx4 v42, s[32:35], s57 offen lds
    s_add_u32 m0, s46, 84992
    s_nop 0
    buffer_load_dwordx4 v43, s[32:35], s57 offen lds
    s_add_u32 m0, s46, 86016
    s_nop 0
    buffer_load_dwordx4 v44, s[32:35], s57 offen lds
    s_add_u32 m0, s46, 87040
    s_nop 0
    buffer_load_dwordx4 v45, s[32:35], s57 offen lds
    s_add_u32 m0, s46, 88064
    s_nop 0
    buffer_load_dwordx4 v46, s[32:35], s57 offen lds
    s_add_u32 m0, s46, 89088
    s_nop 0
    buffer_load_dwordx4 v47, s[32:35], s57 offen lds
    s_waitcnt vmcnt(24)
    s_barrier
    s_mov_b32 s57, 1179648
    s_add_u32 m0, s46, 98304
    s_nop 0
    buffer_load_dwordx4 v40, s[32:35], s57 offen lds
    s_add_u32 m0, s46, 99328
    s_nop 0
    buffer_load_dwordx4 v41, s[32:35], s57 offen lds
    s_add_u32 m0, s46, 100352
    s_nop 0
    buffer_load_dwordx4 v42, s[32:35], s57 offen lds
    s_add_u32 m0, s46, 101376
    s_nop 0
    buffer_load_dwordx4 v43, s[32:35], s57 offen lds
    s_add_u32 m0, s46, 102400
    s_nop 0
    buffer_load_dwordx4 v44, s[32:35], s57 offen lds
    s_add_u32 m0, s46, 103424
    s_nop 0
    buffer_load_dwordx4 v45, s[32:35], s57 offen lds
    s_add_u32 m0, s46, 104448
    s_nop 0
    buffer_load_dwordx4 v46, s[32:35], s57 offen lds
    s_add_u32 m0, s46, 105472
    s_nop 0
    buffer_load_dwordx4 v47, s[32:35], s57 offen lds
    s_waitcnt vmcnt(24)
    s_barrier
    s_mov_b32 s57, 1310720
    s_add_u32 m0, s46, 114688
    s_nop 0
    buffer_load_dwordx4 v40, s[32:35], s57 offen lds
    s_add_u32 m0, s46, 115712
    s_nop 0
    buffer_load_dwordx4 v41, s[32:35], s57 offen lds
    s_add_u32 m0, s46, 116736
    s_nop 0
    buffer_load_dwordx4 v42, s[32:35], s57 offen lds
    s_add_u32 m0, s46, 117760
    s_nop 0
    buffer_load_dwordx4 v43, s[32:35], s57 offen lds
    s_add_u32 m0, s46, 118784
    s_nop 0
    buffer_load_dwordx4 v44, s[32:35], s57 offen lds
    s_add_u32 m0, s46, 119808
    s_nop 0
    buffer_load_dwordx4 v45, s[32:35], s57 offen lds
    s_add_u32 m0, s46, 120832
    s_nop 0
    buffer_load_dwordx4 v46, s[32:35], s57 offen lds
    s_add_u32 m0, s46, 121856
    s_nop 0
    buffer_load_dwordx4 v47, s[32:35], s57 offen lds
    s_waitcnt vmcnt(24)
    s_barrier
    s_mov_b32 s57, 1441792
    s_add_u32 m0, s46, 131072
    s_nop 0
    buffer_load_dwordx4 v40, s[32:35], s57 offen lds
    s_add_u32 m0, s46, 132096
    s_nop 0
    buffer_load_dwordx4 v41, s[32:35], s57 offen lds
    s_add_u32 m0, s46, 133120
    s_nop 0
    buffer_load_dwordx4 v42, s[32:35], s57 offen lds
    s_add_u32 m0, s46, 134144
    s_nop 0
    buffer_load_dwordx4 v43, s[32:35], s57 offen lds
    s_add_u32 m0, s46, 135168
    s_nop 0
    buffer_load_dwordx4 v44, s[32:35], s57 offen lds
    s_add_u32 m0, s46, 136192
    s_nop 0
    buffer_load_dwordx4 v45, s[32:35], s57 offen lds
    s_add_u32 m0, s46, 137216
    s_nop 0
    buffer_load_dwordx4 v46, s[32:35], s57 offen lds
    s_add_u32 m0, s46, 138240
    s_nop 0
    buffer_load_dwordx4 v47, s[32:35], s57 offen lds
    s_waitcnt vmcnt(24)
    s_barrier
    s_mov_b32 s57, 1572864
    s_add_u32 m0, s46, 65536
    s_nop 0
    buffer_load_dwordx4 v40, s[32:35], s57 offen lds
    s_add_u32 m0, s46, 66560
    s_nop 0
    buffer_load_dwordx4 v41, s[32:35], s57 offen lds
    s_add_u32 m0, s46, 67584
    s_nop 0
    buffer_load_dwordx4 v42, s[32:35], s57 offen lds
    s_add_u32 m0, s46, 68608
    s_nop 0
    buffer_load_dwordx4 v43, s[32:35], s57 offen lds
    s_add_u32 m0, s46, 69632
    s_nop 0
    buffer_load_dwordx4 v44, s[32:35], s57 offen lds
    s_add_u32 m0, s46, 70656
    s_nop 0
    buffer_load_dwordx4 v45, s[32:35], s57 offen lds
    s_add_u32 m0, s46, 71680
    s_nop 0
    buffer_load_dwordx4 v46, s[32:35], s57 offen lds
    s_add_u32 m0, s46, 72704
    s_nop 0
    buffer_load_dwordx4 v47, s[32:35], s57 offen lds
    s_waitcnt vmcnt(24)
    s_barrier
    s_mov_b32 s57, 1703936
    s_add_u32 m0, s46, 81920
    s_nop 0
    buffer_load_dwordx4 v40, s[32:35], s57 offen lds
    s_add_u32 m0, s46, 82944
    s_nop 0
    buffer_load_dwordx4 v41, s[32:35], s57 offen lds
    s_add_u32 m0, s46, 83968
    s_nop 0
    buffer_load_dwordx4 v42, s[32:35], s57 offen lds
    s_add_u32 m0, s46, 84992
    s_nop 0
    buffer_load_dwordx4 v43, s[32:35], s57 offen lds
    s_add_u32 m0, s46, 86016
    s_nop 0
    buffer_load_dwordx4 v44, s[32:35], s57 offen lds
    s_add_u32 m0, s46, 87040
    s_nop 0
    buffer_load_dwordx4 v45, s[32:35], s57 offen lds
    s_add_u32 m0, s46, 88064
    s_nop 0
    buffer_load_dwordx4 v46, s[32:35], s57 offen lds
    s_add_u32 m0, s46, 89088
    s_nop 0
    buffer_load_dwordx4 v47, s[32:35], s57 offen lds
    s_waitcnt vmcnt(24)
    s_barrier
    s_waitcnt vmcnt(16)
    s_barrier
    s_waitcnt vmcnt(8)
    s_barrier
    s_waitcnt vmcnt(0)
    s_barrier
    s_barrier
    s_barrier
    s_endpgm
kC_kernel_aload:
    s_nop 7
    s_nop 7
    s_lshl_b32 s55, s59, 13
    s_lshr_b32 s48, s97, 3
    s_lshl_b32 s22, s96, 1
    s_add_u32 s22, s22, s48
    s_and_b32 s23, s97, 7
    s_lshl_b32 s50, s22, 6
    s_lshl_b32 s54, s23, 7
    s_mul_i32 s58, s59, 32
    s_add_u32 s58, s58, s50
    v_lshrrev_b32 v5, 4, v1
    v_and_b32 v6, 15, v5
    v_and_b32 v10, 15, v1
    v_xor_b32 v6, v6, v10
    v_add_u32 v5, s58, v5
    v_mul_u32_u24 v5, 1024, v5
    v_lshl_add_u32 v10, v6, 4, v5
    v_lshrrev_b32 v5, 4, v1
    v_add_u32 v5, 4, v5
    v_and_b32 v6, 15, v5
    v_and_b32 v11, 15, v1
    v_xor_b32 v6, v6, v11
    v_add_u32 v5, s58, v5
    v_mul_u32_u24 v5, 1024, v5
    v_lshl_add_u32 v11, v6, 4, v5
    v_lshrrev_b32 v5, 4, v1
    v_add_u32 v5, 8, v5
    v_and_b32 v6, 15, v5
    v_and_b32 v12, 15, v1
    v_xor_b32 v6, v6, v12
    v_add_u32 v5, s58, v5
    v_mul_u32_u24 v5, 1024, v5
    v_lshl_add_u32 v12, v6, 4, v5
    v_lshrrev_b32 v5, 4, v1
    v_add_u32 v5, 12, v5
    v_and_b32 v6, 15, v5
    v_and_b32 v13, 15, v1
    v_xor_b32 v6, v6, v13
    v_add_u32 v5, s58, v5
    v_mul_u32_u24 v5, 1024, v5
    v_lshl_add_u32 v13, v6, 4, v5
    v_lshrrev_b32 v5, 4, v1
    v_add_u32 v5, 16, v5
    v_and_b32 v6, 15, v5
    v_and_b32 v14, 15, v1
    v_xor_b32 v6, v6, v14
    v_add_u32 v5, s58, v5
    v_mul_u32_u24 v5, 1024, v5
    v_lshl_add_u32 v14, v6, 4, v5
    v_lshrrev_b32 v5, 4, v1
    v_add_u32 v5, 20, v5
    v_and_b32 v6, 15, v5
    v_and_b32 v15, 15, v1
    v_xor_b32 v6, v6, v15
    v_add_u32 v5, s58, v5
    v_mul_u32_u24 v5, 1024, v5
    v_lshl_add_u32 v15, v6, 4, v5
    v_lshrrev_b32 v5, 4, v1
    v_add_u32 v5, 24, v5
    v_and_b32 v6, 15, v5
    v_and_b32 v16, 15, v1
    v_xor_b32 v6, v6, v16
    v_add_u32 v5, s58, v5
    v_mul_u32_u24 v5, 1024, v5
    v_lshl_add_u32 v16, v6, 4, v5
    v_lshrrev_b32 v5, 4, v1
    v_add_u32 v5, 28, v5
    v_and_b32 v6, 15, v5
    v_and_b32 v17, 15, v1
    v_xor_b32 v6, v6, v17
    v_add_u32 v5, s58, v5
    v_mul_u32_u24 v5, 1024, v5
    v_lshl_add_u32 v17, v6, 4, v5
    s_waitcnt lgkmcnt(0)
    s_mov_b32 s24, s20
    s_and_b32 s25, s21, 0xffff
    s_mov_b32 s26, 2097152
    s_mov_b32 s27, 0x20000
    s_add_u32 s92, s20, 14780416
    s_addc_u32 s93, s21, 0
    s_and_b32 s93, s93, 0xffff
    s_mov_b32 s94, 28672
    s_mov_b32 s95, 0x20000
    s_getreg_b32 s98, hwreg(HW_REG_XCC_ID)
    s_and_b32 s98, s98, 15
    s_add_u32 s98, s98, 1
    s_lshl_b32 s48, s96, 6
    s_lshl_b32 s49, s97, 2
    s_add_u32 s48, s48, s49
    s_add_u32 s48, s48, 25600
    v_mov_b32 v8, s48
    v_mov_b32 v9, s98
    s_mov_b64 exec, 1
    buffer_store_dword v9, v8, s[92:95], 0 offen sc0 sc1
    s_mov_b64 exec, -1
    s_mov_b32 s56, 0
    s_add_u32 m0, s55, 0
    s_nop 0
    buffer_load_dwordx4 v10, s[24:27], s56 offen lds
    s_add_u32 m0, s55, 1024
    s_nop 0
    buffer_load_dwordx4 v11, s[24:27], s56 offen lds
    s_add_u32 m0, s55, 2048
    s_nop 0
    buffer_load_dwordx4 v12, s[24:27], s56 offen lds
    s_add_u32 m0, s55, 3072
    s_nop 0
    buffer_load_dwordx4 v13, s[24:27], s56 offen lds
    s_add_u32 m0, s55, 4096
    s_nop 0
    buffer_load_dwordx4 v14, s[24:27], s56 offen lds
    s_add_u32 m0, s55, 5120
    s_nop 0
    buffer_load_dwordx4 v15, s[24:27], s56 offen lds
    s_add_u32 m0, s55, 6144
    s_nop 0
    buffer_load_dwordx4 v16, s[24:27], s56 offen lds
    s_add_u32 m0, s55, 7168
    s_nop 0
    buffer_load_dwordx4 v17, s[24:27], s56 offen lds
    s_mov_b32 s56, 256
    s_add_u32 m0, s55, 16384
    s_nop 0
    buffer_load_dwordx4 v10, s[24:27], s56 offen lds
    s_add_u32 m0, s55, 17408
    s_nop 0
    buffer_load_dwordx4 v11, s[24:27], s56 offen lds
    s_add_u32 m0, s55, 18432
    s_nop 0
    buffer_load_dwordx4 v12, s[24:27], s56 offen lds
    s_add_u32 m0, s55, 19456
    s_nop 0
    buffer_load_dwordx4 v13, s[24:27], s56 offen lds
    s_add_u32 m0, s55, 20480
    s_nop 0
    buffer_load_dwordx4 v14, s[24:27], s56 offen lds
    s_add_u32 m0, s55, 21504
    s_nop 0
    buffer_load_dwordx4 v15, s[24:27], s56 offen lds
    s_add_u32 m0, s55, 22528
    s_nop 0
    buffer_load_dwordx4 v16, s[24:27], s56 offen lds
    s_add_u32 m0, s55, 23552
    s_nop 0
    buffer_load_dwordx4 v17, s[24:27], s56 offen lds
    s_mov_b32 s56, 512
    s_add_u32 m0, s55, 32768
    s_nop 0
    buffer_load_dwordx4 v10, s[24:27], s56 offen lds
    s_add_u32 m0, s55, 33792
    s_nop 0
    buffer_load_dwordx4 v11, s[24:27], s56 offen lds
    s_add_u32 m0, s55, 34816
    s_nop 0
    buffer_load_dwordx4 v12, s[24:27], s56 offen lds
    s_add_u32 m0, s55, 35840
    s_nop 0
    buffer_load_dwordx4 v13, s[24:27], s56 offen lds
    s_add_u32 m0, s55, 36864
    s_nop 0
    buffer_load_dwordx4 v14, s[24:27], s56 offen lds
    s_add_u32 m0, s55, 37888
    s_nop 0
    buffer_load_dwordx4 v15, s[24:27], s56 offen lds
    s_add_u32 m0, s55, 38912
    s_nop 0
    buffer_load_dwordx4 v16, s[24:27], s56 offen lds
    s_add_u32 m0, s55, 39936
    s_nop 0
    buffer_load_dwordx4 v17, s[24:27], s56 offen lds
    s_waitcnt vmcnt(16)
    s_barrier
    s_mov_b32 s56, 768
    s_add_u32 m0, s55, 49152
    s_nop 0
    buffer_load_dwordx4 v10, s[24:27], s56 offen lds
    s_add_u32 m0, s55, 50176
    s_nop 0
    buffer_load_dwordx4 v11, s[24:27], s56 offen lds
    s_add_u32 m0, s55, 51200
    s_nop 0
    buffer_load_dwordx4 v12, s[24:27], s56 offen lds
    s_add_u32 m0, s55, 52224
    s_nop 0
    buffer_load_dwordx4 v13, s[24:27], s56 offen lds
    s_add_u32 m0, s55, 53248
    s_nop 0
    buffer_load_dwordx4 v14, s[24:27], s56 offen lds
    s_add_u32 m0, s55, 54272
    s_nop 0
    buffer_load_dwordx4 v15, s[24:27], s56 offen lds
    s_add_u32 m0, s55, 55296
    s_nop 0
    buffer_load_dwordx4 v16, s[24:27], s56 offen lds
    s_add_u32 m0, s55, 56320
    s_nop 0
    buffer_load_dwordx4 v17, s[24:27], s56 offen lds
    s_add_u32 s28, s20, 14819328
    s_addc_u32 s29, s21, 0
    s_and_b32 s29, s29, 0xffff
    s_mov_b32 s30, 57344
    s_mov_b32 s31, 0x20000
    s_mul_i32 s48, s97, 448
    v_lshlrev_b32 v5, 3, v1
    v_add_u32 v5, s48, v5
    s_mov_b32 s49, 0
    buffer_load_dwordx2 v[20:21], v5, s[28:31], s49 offen
    s_mov_b32 s49, 7168
    buffer_load_dwordx2 v[22:23], v5, s[28:31], s49 offen
    s_mov_b32 s49, 14336
    buffer_load_dwordx2 v[24:25], v5, s[28:31], s49 offen
    s_mov_b32 s49, 21504
    buffer_load_dwordx2 v[26:27], v5, s[28:31], s49 offen
    s_mov_b32 s49, 28672
    buffer_load_dwordx2 v[28:29], v5, s[28:31], s49 offen
    s_mov_b32 s49, 35840
    buffer_load_dwordx2 v[30:31], v5, s[28:31], s49 offen
    s_mov_b32 s49, 43008
    buffer_load_dwordx2 v[32:33], v5, s[28:31], s49 offen
    s_mov_b32 s49, 50176
    buffer_load_dwordx2 v[34:35], v5, s[28:31], s49 offen
    s_waitcnt vmcnt(24)
    s_barrier
    s_waitcnt vmcnt(16)
    s_barrier
    s_waitcnt vmcnt(6)
    v_pk_add_f32 v[20:21], v[20:21], v[22:23]
    s_waitcnt vmcnt(5)
    v_pk_add_f32 v[20:21], v[20:21], v[24:25]
    s_waitcnt vmcnt(4)
    v_pk_add_f32 v[20:21], v[20:21], v[26:27]
    s_waitcnt vmcnt(3)
    v_pk_add_f32 v[20:21], v[20:21], v[28:29]
    s_waitcnt vmcnt(2)
    v_pk_add_f32 v[20:21], v[20:21], v[30:31]
    s_waitcnt vmcnt(1)
    v_pk_add_f32 v[20:21], v[20:21], v[32:33]
    s_waitcnt vmcnt(0)
    v_pk_add_f32 v[20:21], v[20:21], v[34:35]
    v_lshlrev_b32 v5, 3, v1
    v_add_u32 v5, 154624, v5
    ds_write_b64 v5, v[20:21]
    s_waitcnt lgkmcnt(0)
    s_barrier
    s_lshl_b32 s48, s96, 6
    s_add_u32 s48, s48, 25600
    v_and_b32 v8, 15, v1
    v_lshlrev_b32 v8, 2, v8
    v_add_u32 v8, s48, v8
    buffer_load_dword v9, v8, s[92:95], 0 offen sc0 sc1
    s_waitcnt vmcnt(0)
    v_cmp_ne_u32 vcc, s98, v9
    s_nop 0
    s_cmp_eq_u64 vcc, 0
    s_cselect_b32 s99, 1, 0
    v_mov_b32 v9, s99
    v_mov_b32 v8, 148480
    s_lshl_b32 s48, s59, 2
    v_add_u32 v8, s48, v8
    ds_write_b32 v8, v9
    s_waitcnt lgkmcnt(0)
    s_barrier
    s_barrier
    s_barrier
    s_cmp_lg_u32 s59, 0
    s_cbranch_scc1 kC_kernel_pub0
    s_lshl_b32 s48, s96, 8
    s_lshl_b32 s49, s97, 2
    s_add_u32 s48, s48, s49
    s_add_u32 s48, s48, 12288
    v_mov_b32 v8, s48
    v_mov_b32 v9, 1
    s_mov_b64 exec, 1
    s_cmp_eq_u32 s99, 1
    s_cbranch_scc0 kC_kernel_pubs0
    buffer_store_dword v9, v8, s[92:95], 0 offen
    s_branch kC_kernel_pub0
kC_kernel_pubs0:
    buffer_store_dword v9, v8, s[92:95], 0 offen sc0 sc1
kC_kernel_pub0:
    s_mov_b64 exec, -1
    s_mov_b32 s22, s96
    s_mov_b32 s23, s97
    s_lshl_b32 s50, s22, 7
    s_mul_i32 s54, s23, 224
    s_mul_i32 s58, s59, 64
    s_add_u32 s58, s58, s50
    v_lshrrev_b32 v5, 3, v1
    v_bfe_u32 v6, v5, 1, 3
    v_and_b32 v10, 7, v1
    v_xor_b32 v6, v6, v10
    v_add_u32 v5, s58, v5
    v_mul_u32_u24 v5, 1024, v5
    v_lshl_add_u32 v10, v6, 4, v5
    v_lshrrev_b32 v5, 3, v1
    v_add_u32 v5, 8, v5
    v_bfe_u32 v6, v5, 1, 3
    v_and_b32 v11, 7, v1
    v_xor_b32 v6, v6, v11
    v_add_u32 v5, s58, v5
    v_mul_u32_u24 v5, 1024, v5
    v_lshl_add_u32 v11, v6, 4, v5
    v_lshrrev_b32 v5, 3, v1
    v_add_u32 v5, 16, v5
    v_bfe_u32 v6, v5, 1, 3
    v_and_b32 v12, 7, v1
    v_xor_b32 v6, v6, v12
    v_add_u32 v5, s58, v5
    v_mul_u32_u24 v5, 1024, v5
    v_lshl_add_u32 v12, v6, 4, v5
    v_lshrrev_b32 v5, 3, v1
    v_add_u32 v5, 24, v5
    v_bfe_u32 v6, v5, 1, 3
    v_and_b32 v13, 7, v1
    v_xor_b32 v6, v6, v13
    v_add_u32 v5, s58, v5
    v_mul_u32_u24 v5, 1024, v5
    v_lshl_add_u32 v13, v6, 4, v5
    v_lshrrev_b32 v5, 3, v1
    v_add_u32 v5, 32, v5
    v_bfe_u32 v6, v5, 1, 3
    v_and_b32 v14, 7, v1
    v_xor_b32 v6, v6, v14
    v_add_u32 v5, s58, v5
    v_mul_u32_u24 v5, 1024, v5
    v_lshl_add_u32 v14, v6, 4, v5
    v_lshrrev_b32 v5, 3, v1
    v_add_u32 v5, 40, v5
    v_bfe_u32 v6, v5, 1, 3
    v_and_b32 v15, 7, v1
    v_xor_b32 v6, v6, v15
    v_add_u32 v5, s58, v5
    v_mul_u32_u24 v5, 1024, v5
    v_lshl_add_u32 v15, v6, 4, v5
    v_lshrrev_b32 v5, 3, v1
    v_add_u32 v5, 48, v5
    v_bfe_u32 v6, v5, 1, 3
    v_and_b32 v16, 7, v1
    v_xor_b32 v6, v6, v16
    v_add_u32 v5, s58, v5
    v_mul_u32_u24 v5, 1024, v5
    v_lshl_add_u32 v16, v6, 4, v5
    v_lshrrev_b32 v5, 3, v1
    v_add_u32 v5, 56, v5
    v_bfe_u32 v6, v5, 1, 3
    v_and_b32 v17, 7, v1
    v_xor_b32 v6, v6, v17
    v_add_u32 v5, s58, v5
    v_mul_u32_u24 v5, 1024, v5
    v_lshl_add_u32 v17, v6, 4, v5
    s_waitcnt lgkmcnt(0)
    s_add_u32 s24, s20, 2097152
    s_addc_u32 s25, s21, 0
    s_and_b32 s25, s25, 0xffff
    s_mov_b32 s26, 2097152
    s_mov_b32 s27, 0x20000
    s_lshl_b32 s48, s96, 8
    s_add_u32 s48, s48, 12288
    v_lshlrev_b32 v8, 2, v1
    v_add_u32 v8, s48, v8
    s_mov_b64 exec, 0xffff
    s_mov_b32 s49, 0
kC_kernel_poll1:
    buffer_load_dword v9, v8, s[92:95], 0 offen sc1
    s_add_u32 s49, s49, 1
    s_waitcnt vmcnt(0)
    v_cmp_ne_u32 vcc, 1, v9
    s_cmp_gt_u32 s49, 200000
    s_cbranch_scc1 kC_kernel_polld1
    s_cbranch_vccnz kC_kernel_poll1
kC_kernel_polld1:
    s_mov_b64 exec, -1
    s_mov_b32 s56, 0
    s_add_u32 m0, s55, 0
    s_nop 0
    buffer_load_dwordx4 v10, s[24:27], s56 offen lds
    s_add_u32 m0, s55, 1024
    s_nop 0
    buffer_load_dwordx4 v11, s[24:27], s56 offen lds
    s_add_u32 m0, s55, 2048
    s_nop 0
    buffer_load_dwordx4 v12, s[24:27], s56 offen lds
    s_add_u32 m0, s55, 3072
    s_nop 0
    buffer_load_dwordx4 v13, s[24:27], s56 offen lds
    s_add_u32 m0, s55, 4096
    s_nop 0
    buffer_load_dwordx4 v14, s[24:27], s56 offen lds
    s_add_u32 m0, s55, 5120
    s_nop 0
    buffer_load_dwordx4 v15, s[24:27], s56 offen lds
    s_add_u32 m0, s55, 6144
    s_nop 0
    buffer_load_dwordx4 v16, s[24:27], s56 offen lds
    s_add_u32 m0, s55, 7168
    s_nop 0
    buffer_load_dwordx4 v17, s[24:27], s56 offen lds
    s_mov_b32 s56, 128
    s_add_u32 m0, s55, 16384
    s_nop 0
    buffer_load_dwordx4 v10, s[24:27], s56 offen lds
    s_add_u32 m0, s55, 17408
    s_nop 0
    buffer_load_dwordx4 v11, s[24:27], s56 offen lds
    s_add_u32 m0, s55, 18432
    s_nop 0
    buffer_load_dwordx4 v12, s[24:27], s56 offen lds
    s_add_u32 m0, s55, 19456
    s_nop 0
    buffer_load_dwordx4 v13, s[24:27], s56 offen lds
    s_add_u32 m0, s55, 20480
    s_nop 0
    buffer_load_dwordx4 v14, s[24:27], s56 offen lds
    s_add_u32 m0, s55, 21504
    s_nop 0
    buffer_load_dwordx4 v15, s[24:27], s56 offen lds
    s_add_u32 m0, s55, 22528
    s_nop 0
    buffer_load_dwordx4 v16, s[24:27], s56 offen lds
    s_add_u32 m0, s55, 23552
    s_nop 0
    buffer_load_dwordx4 v17, s[24:27], s56 offen lds
    s_mov_b32 s56, 256
    s_add_u32 m0, s55, 32768
    s_nop 0
    buffer_load_dwordx4 v10, s[24:27], s56 offen lds
    s_add_u32 m0, s55, 33792
    s_nop 0
    buffer_load_dwordx4 v11, s[24:27], s56 offen lds
    s_add_u32 m0, s55, 34816
    s_nop 0
    buffer_load_dwordx4 v12, s[24:27], s56 offen lds
    s_add_u32 m0, s55, 35840
    s_nop 0
    buffer_load_dwordx4 v13, s[24:27], s56 offen lds
    s_add_u32 m0, s55, 36864
    s_nop 0
    buffer_load_dwordx4 v14, s[24:27], s56 offen lds
    s_add_u32 m0, s55, 37888
    s_nop 0
    buffer_load_dwordx4 v15, s[24:27], s56 offen lds
    s_add_u32 m0, s55, 38912
    s_nop 0
    buffer_load_dwordx4 v16, s[24:27], s56 offen lds
    s_add_u32 m0, s55, 39936
    s_nop 0
    buffer_load_dwordx4 v17, s[24:27], s56 offen lds
    s_waitcnt vmcnt(16)
    s_barrier
    s_mov_b32 s56, 384
    s_add_u32 m0, s55, 49152
    s_nop 0
    buffer_load_dwordx4 v10, s[24:27], s56 offen lds
    s_add_u32 m0, s55, 50176
    s_nop 0
    buffer_load_dwordx4 v11, s[24:27], s56 offen lds
    s_add_u32 m0, s55, 51200
    s_nop 0
    buffer_load_dwordx4 v12, s[24:27], s56 offen lds
    s_add_u32 m0, s55, 52224
    s_nop 0
    buffer_load_dwordx4 v13, s[24:27], s56 offen lds
    s_add_u32 m0, s55, 53248
    s_nop 0
    buffer_load_dwordx4 v14, s[24:27], s56 offen lds
    s_add_u32 m0, s55, 54272
    s_nop 0
    buffer_load_dwordx4 v15, s[24:27], s56 offen lds
    s_add_u32 m0, s55, 55296
    s_nop 0
    buffer_load_dwordx4 v16, s[24:27], s56 offen lds
    s_add_u32 m0, s55, 56320
    s_nop 0
    buffer_load_dwordx4 v17, s[24:27], s56 offen lds
    s_add_u32 s28, s20, 15073280
    s_addc_u32 s29, s21, 0
    s_and_b32 s29, s29, 0xffff
    s_mov_b32 s30, 131072
    s_mov_b32 s31, 0x20000
    s_lshl_b32 s48, s59, 6
    s_add_u32 s48, s48, s50
    v_add_u32 v5, s48, v1
    v_lshlrev_b32 v5, 6, v5
    buffer_load_dwordx4 v[20:23], v5, s[28:31], 0 offen offset:0
    buffer_load_dwordx4 v[24:27], v5, s[28:31], 0 offen offset:16
    buffer_load_dwordx4 v[28:31], v5, s[28:31], 0 offen offset:32
    buffer_load_dwordx4 v[32:35], v5, s[28:31], 0 offen offset:48
    s_waitcnt vmcnt(20)
    s_barrier
    s_mov_b32 s56, 512
    s_add_u32 m0, s55, 0
    s_nop 0
    buffer_load_dwordx4 v10, s[24:27], s56 offen lds
    s_add_u32 m0, s55, 1024
    s_nop 0
    buffer_load_dwordx4 v11, s[24:27], s56 offen lds
    s_add_u32 m0, s55, 2048
    s_nop 0
    buffer_load_dwordx4 v12, s[24:27], s56 offen lds
    s_add_u32 m0, s55, 3072
    s_nop 0
    buffer_load_dwordx4 v13, s[24:27], s56 offen lds
    s_add_u32 m0, s55, 4096
    s_nop 0
    buffer_load_dwordx4 v14, s[24:27], s56 offen lds
    s_add_u32 m0, s55, 5120
    s_nop 0
    buffer_load_dwordx4 v15, s[24:27], s56 offen lds
    s_add_u32 m0, s55, 6144
    s_nop 0
    buffer_load_dwordx4 v16, s[24:27], s56 offen lds
    s_add_u32 m0, s55, 7168
    s_nop 0
    buffer_load_dwordx4 v17, s[24:27], s56 offen lds
    s_waitcnt vmcnt(20)
    s_barrier
    s_mov_b32 s56, 640
    s_add_u32 m0, s55, 16384
    s_nop 0
    buffer_load_dwordx4 v10, s[24:27], s56 offen lds
    s_add_u32 m0, s55, 17408
    s_nop 0
    buffer_load_dwordx4 v11, s[24:27], s56 offen lds
    s_add_u32 m0, s55, 18432
    s_nop 0
    buffer_load_dwordx4 v12, s[24:27], s56 offen lds
    s_add_u32 m0, s55, 19456
    s_nop 0
    buffer_load_dwordx4 v13, s[24:27], s56 offen lds
    s_add_u32 m0, s55, 20480
    s_nop 0
    buffer_load_dwordx4 v14, s[24:27], s56 offen lds
    s_add_u32 m0, s55, 21504
    s_nop 0
    buffer_load_dwordx4 v15, s[24:27], s56 offen lds
    s_add_u32 m0, s55, 22528
    s_nop 0
    buffer_load_dwordx4 v16, s[24:27], s56 offen lds
    s_add_u32 m0, s55, 23552
    s_nop 0
    buffer_load_dwordx4 v17, s[24:27], s56 offen lds
    s_waitcnt vmcnt(20)
    s_barrier
    s_mov_b32 s56, 768
    s_add_u32 m0, s55, 32768
    s_nop 0
    buffer_load_dwordx4 v10, s[24:27], s56 offen lds
    s_add_u32 m0, s55, 33792
    s_nop 0
    buffer_load_dwordx4 v11, s[24:27], s56 offen lds
    s_add_u32 m0, s55, 34816
    s_nop 0
    buffer_load_dwordx4 v12, s[24:27], s56 offen lds
    s_add_u32 m0, s55, 35840
    s_nop 0
    buffer_load_dwordx4 v13, s[24:27], s56 offen lds
    s_add_u32 m0, s55, 36864
    s_nop 0
    buffer_load_dwordx4 v14, s[24:27], s56 offen lds
    s_add_u32 m0, s55, 37888
    s_nop 0
    buffer_load_dwordx4 v15, s[24:27], s56 offen lds
    s_add_u32 m0, s55, 38912
    s_nop 0
    buffer_load_dwordx4 v16, s[24:27], s56 offen lds
    s_add_u32 m0, s55, 39936
    s_nop 0
    buffer_load_dwordx4 v17, s[24:27], s56 offen lds
    s_waitcnt vmcnt(16)
    s_barrier
    s_mov_b32 s56, 896
    s_add_u32 m0, s55, 49152
    s_nop 0
    buffer_load_dwordx4 v10, s[24:27], s56 offen lds
    s_add_u32 m0, s55, 50176
    s_nop 0
    buffer_load_dwordx4 v11, s[24:27], s56 offen lds
    s_add_u32 m0, s55, 51200
    s_nop 0
    buffer_load_dwordx4 v12, s[24:27], s56 offen lds
    s_add_u32 m0, s55, 52224
    s_nop 0
    buffer_load_dwordx4 v13, s[24:27], s56 offen lds
    s_add_u32 m0, s55, 53248
    s_nop 0
    buffer_load_dwordx4 v14, s[24:27], s56 offen lds
    s_add_u32 m0, s55, 54272
    s_nop 0
    buffer_load_dwordx4 v15, s[24:27], s56 offen lds
    s_add_u32 m0, s55, 55296
    s_nop 0
    buffer_load_dwordx4 v16, s[24:27], s56 offen lds
    s_add_u32 m0, s55, 56320
    s_nop 0
    buffer_load_dwordx4 v17, s[24:27], s56 offen lds
    v_add_f32 v5, v20, v22
    v_add_f32 v6, v21, v23
    v_add_f32 v5, v5, v24
    v_add_f32 v6, v6, v25
    v_add_f32 v5, v5, v26
    v_add_f32 v6, v6, v27
    v_add_f32 v5, v5, v28
    v_add_f32 v6, v6, v29
    v_add_f32 v5, v5, v30
    v_add_f32 v6, v6, v31
    v_add_f32 v5, v5, v32
    v_add_f32 v6, v6, v33
    v_add_f32 v5, v5, v34
    v_add_f32 v6, v6, v35
    v_mul_f32 v5, 0x3b000000, v5
    v_mul_f32 v6, 0x3b000000, v6
    v_fma_f32 v6, -v5, v5, v6
    v_max_f32 v6, 0, v6
    v_cvt_pk_bf16_f32 v5, v5, v5
    v_lshlrev_b32 v5, 16, v5
    v_cvt_pk_bf16_f32 v6, v6, v6
    v_lshlrev_b32 v6, 16, v6
    v_add_f32 v6, 0x3727c5ac, v6
    v_cvt_pk_bf16_f32 v6, v6, v6
    v_lshlrev_b32 v6, 16, v6
    v_sqrt_f32 v6, v6
    s_nop 0
    v_cvt_pk_bf16_f32 v6, v6, v6
    v_lshlrev_b32 v6, 16, v6
    v_rcp_f32 v36, v6
    s_nop 0
    v_mul_f32 v37, v5, v36
    v_sub_f32 v37, 0, v37
    s_lshl_b32 s48, s59, 9
    s_add_u32 s48, s48, 147456
    v_lshlrev_b32 v5, 3, v1
    v_add_u32 v5, s48, v5
    ds_write_b64 v5, v[36:37]
    s_waitcnt lgkmcnt(0)
    s_waitcnt vmcnt(16)
    s_barrier
    s_waitcnt vmcnt(8)
    s_barrier
    s_waitcnt vmcnt(0)
    s_barrier
    s_barrier
    s_barrier
    s_barrier
    s_cmp_lg_u32 s59, 0
    s_cbranch_scc1 kC_kernel_pub1
    s_lshl_b32 s48, s96, 8
    s_lshl_b32 s49, s97, 2
    s_add_u32 s48, s48, s49
    s_add_u32 s48, s48, 16384
    v_mov_b32 v8, s48
    v_mov_b32 v9, 1
    s_mov_b64 exec, 1
    s_cmp_eq_u32 s99, 1
    s_cbranch_scc0 kC_kernel_pubs1
    buffer_store_dword v9, v8, s[92:95], 0 offen
    s_branch kC_kernel_pub1
kC_kernel_pubs1:
    buffer_store_dword v9, v8, s[92:95], 0 offen sc0 sc1
kC_kernel_pub1:
    s_mov_b64 exec, -1
    s_lshr_b32 s48, s97, 3
    s_lshl_b32 s22, s96, 1
    s_add_u32 s22, s22, s48
    s_and_b32 s23, s97, 7
    s_lshl_b32 s50, s22, 6
    s_lshl_b32 s54, s23, 7
    s_mul_i32 s58, s59, 32
    s_add_u32 s58, s58, s50
    v_lshrrev_b32 v5, 4, v1
    v_and_b32 v6, 15, v5
    v_and_b32 v10, 15, v1
    v_xor_b32 v6, v6, v10
    v_add_u32 v5, s58, v5
    v_mul_u32_u24 v5, 3584, v5
    v_lshl_add_u32 v10, v6, 4, v5
    v_lshrrev_b32 v5, 4, v1
    v_add_u32 v5, 4, v5
    v_and_b32 v6, 15, v5
    v_and_b32 v11, 15, v1
    v_xor_b32 v6, v6, v11
    v_add_u32 v5, s58, v5
    v_mul_u32_u24 v5, 3584, v5
    v_lshl_add_u32 v11, v6, 4, v5
    v_lshrrev_b32 v5, 4, v1
    v_add_u32 v5, 8, v5
    v_and_b32 v6, 15, v5
    v_and_b32 v12, 15, v1
    v_xor_b32 v6, v6, v12
    v_add_u32 v5, s58, v5
    v_mul_u32_u24 v5, 3584, v5
    v_lshl_add_u32 v12, v6, 4, v5
    v_lshrrev_b32 v5, 4, v1
    v_add_u32 v5, 12, v5
    v_and_b32 v6, 15, v5
    v_and_b32 v13, 15, v1
    v_xor_b32 v6, v6, v13
    v_add_u32 v5, s58, v5
    v_mul_u32_u24 v5, 3584, v5
    v_lshl_add_u32 v13, v6, 4, v5
    v_lshrrev_b32 v5, 4, v1
    v_add_u32 v5, 16, v5
    v_and_b32 v6, 15, v5
    v_and_b32 v14, 15, v1
    v_xor_b32 v6, v6, v14
    v_add_u32 v5, s58, v5
    v_mul_u32_u24 v5, 3584, v5
    v_lshl_add_u32 v14, v6, 4, v5
    v_lshrrev_b32 v5, 4, v1
    v_add_u32 v5, 20, v5
    v_and_b32 v6, 15, v5
    v_and_b32 v15, 15, v1
    v_xor_b32 v6, v6, v15
    v_add_u32 v5, s58, v5
    v_mul_u32_u24 v5, 3584, v5
    v_lshl_add_u32 v15, v6, 4, v5
    v_lshrrev_b32 v5, 4, v1
    v_add_u32 v5, 24, v5
    v_and_b32 v6, 15, v5
    v_and_b32 v16, 15, v1
    v_xor_b32 v6, v6, v16
    v_add_u32 v5, s58, v5
    v_mul_u32_u24 v5, 3584, v5
    v_lshl_add_u32 v16, v6, 4, v5
    v_lshrrev_b32 v5, 4, v1
    v_add_u32 v5, 28, v5
    v_and_b32 v6, 15, v5
    v_and_b32 v17, 15, v1
    v_xor_b32 v6, v6, v17
    v_add_u32 v5, s58, v5
    v_mul_u32_u24 v5, 3584, v5
    v_lshl_add_u32 v17, v6, 4, v5
    s_waitcnt lgkmcnt(0)
    s_add_u32 s24, s20, 6291456
    s_addc_u32 s25, s21, 0
    s_and_b32 s25, s25, 0xffff
    s_mov_b32 s26, 7340032
    s_mov_b32 s27, 0x20000
    s_lshl_b32 s48, s96, 8
    s_add_u32 s48, s48, 16384
    v_lshlrev_b32 v8, 2, v1
    v_add_u32 v8, s48, v8
    s_mov_b64 exec, 0xffff
    s_mov_b32 s49, 0
kC_kernel_poll2:
    buffer_load_dword v9, v8, s[92:95], 0 offen sc1
    s_add_u32 s49, s49, 1
    s_waitcnt vmcnt(0)
    v_cmp_ne_u32 vcc, 1, v9
    s_cmp_gt_u32 s49, 200000
    s_cbranch_scc1 kC_kernel_polld2
    s_cbranch_vccnz kC_kernel_poll2
kC_kernel_polld2:
    s_mov_b64 exec, -1
    s_mov_b32 s56, 0
    s_add_u32 m0, s55, 0
    s_nop 0
    buffer_load_dwordx4 v10, s[24:27], s56 offen lds
    s_add_u32 m0, s55, 1024
    s_nop 0
    buffer_load_dwordx4 v11, s[24:27], s56 offen lds
    s_add_u32 m0, s55, 2048
    s_nop 0
    buffer_load_dwordx4 v12, s[24:27], s56 offen lds
    s_add_u32 m0, s55, 3072
    s_nop 0
    buffer_load_dwordx4 v13, s[24:27], s56 offen lds
    s_add_u32 m0, s55, 4096
    s_nop 0
    buffer_load_dwordx4 v14, s[24:27], s56 offen lds
    s_add_u32 m0, s55, 5120
    s_nop 0
    buffer_load_dwordx4 v15, s[24:27], s56 offen lds
    s_add_u32 m0, s55, 6144
    s_nop 0
    buffer_load_dwordx4 v16, s[24:27], s56 offen lds
    s_add_u32 m0, s55, 7168
    s_nop 0
    buffer_load_dwordx4 v17, s[24:27], s56 offen lds
    s_mov_b32 s56, 256
    s_add_u32 m0, s55, 16384
    s_nop 0
    buffer_load_dwordx4 v10, s[24:27], s56 offen lds
    s_add_u32 m0, s55, 17408
    s_nop 0
    buffer_load_dwordx4 v11, s[24:27], s56 offen lds
    s_add_u32 m0, s55, 18432
    s_nop 0
    buffer_load_dwordx4 v12, s[24:27], s56 offen lds
    s_add_u32 m0, s55, 19456
    s_nop 0
    buffer_load_dwordx4 v13, s[24:27], s56 offen lds
    s_add_u32 m0, s55, 20480
    s_nop 0
    buffer_load_dwordx4 v14, s[24:27], s56 offen lds
    s_add_u32 m0, s55, 21504
    s_nop 0
    buffer_load_dwordx4 v15, s[24:27], s56 offen lds
    s_add_u32 m0, s55, 22528
    s_nop 0
    buffer_load_dwordx4 v16, s[24:27], s56 offen lds
    s_add_u32 m0, s55, 23552
    s_nop 0
    buffer_load_dwordx4 v17, s[24:27], s56 offen lds
    s_mov_b32 s56, 512
    s_add_u32 m0, s55, 32768
    s_nop 0
    buffer_load_dwordx4 v10, s[24:27], s56 offen lds
    s_add_u32 m0, s55, 33792
    s_nop 0
    buffer_load_dwordx4 v11, s[24:27], s56 offen lds
    s_add_u32 m0, s55, 34816
    s_nop 0
    buffer_load_dwordx4 v12, s[24:27], s56 offen lds
    s_add_u32 m0, s55, 35840
    s_nop 0
    buffer_load_dwordx4 v13, s[24:27], s56 offen lds
    s_add_u32 m0, s55, 36864
    s_nop 0
    buffer_load_dwordx4 v14, s[24:27], s56 offen lds
    s_add_u32 m0, s55, 37888
    s_nop 0
    buffer_load_dwordx4 v15, s[24:27], s56 offen lds
    s_add_u32 m0, s55, 38912
    s_nop 0
    buffer_load_dwordx4 v16, s[24:27], s56 offen lds
    s_add_u32 m0, s55, 39936
    s_nop 0
    buffer_load_dwordx4 v17, s[24:27], s56 offen lds
    s_waitcnt vmcnt(16)
    s_barrier
    s_mov_b32 s56, 768
    s_add_u32 m0, s55, 49152
    s_nop 0
    buffer_load_dwordx4 v10, s[24:27], s56 offen lds
    s_add_u32 m0, s55, 50176
    s_nop 0
    buffer_load_dwordx4 v11, s[24:27], s56 offen lds
    s_add_u32 m0, s55, 51200
    s_nop 0
    buffer_load_dwordx4 v12, s[24:27], s56 offen lds
    s_add_u32 m0, s55, 52224
    s_nop 0
    buffer_load_dwordx4 v13, s[24:27], s56 offen lds
    s_add_u32 m0, s55, 53248
    s_nop 0
    buffer_load_dwordx4 v14, s[24:27], s56 offen lds
    s_add_u32 m0, s55, 54272
    s_nop 0
    buffer_load_dwordx4 v15, s[24:27], s56 offen lds
    s_add_u32 m0, s55, 55296
    s_nop 0
    buffer_load_dwordx4 v16, s[24:27], s56 offen lds
    s_add_u32 m0, s55, 56320
    s_nop 0
    buffer_load_dwordx4 v17, s[24:27], s56 offen lds
    s_waitcnt vmcnt(16)
    s_barrier
    s_mov_b32 s56, 1024
    s_add_u32 m0, s55, 0
    s_nop 0
    buffer_load_dwordx4 v10, s[24:27], s56 offen lds
    s_add_u32 m0, s55, 1024
    s_nop 0
    buffer_load_dwordx4 v11, s[24:27], s56 offen lds
    s_add_u32 m0, s55, 2048
    s_nop 0
    buffer_load_dwordx4 v12, s[24:27], s56 offen lds
    s_add_u32 m0, s55, 3072
    s_nop 0
    buffer_load_dwordx4 v13, s[24:27], s56 offen lds
    s_add_u32 m0, s55, 4096
    s_nop 0
    buffer_load_dwordx4 v14, s[24:27], s56 offen lds
    s_add_u32 m0, s55, 5120
    s_nop 0
    buffer_load_dwordx4 v15, s[24:27], s56 offen lds
    s_add_u32 m0, s55, 6144
    s_nop 0
    buffer_load_dwordx4 v16, s[24:27], s56 offen lds
    s_add_u32 m0, s55, 7168
    s_nop 0
    buffer_load_dwordx4 v17, s[24:27], s56 offen lds
    s_waitcnt vmcnt(16)
    s_barrier
    s_mov_b32 s56, 1280
    s_add_u32 m0, s55, 16384
    s_nop 0
    buffer_load_dwordx4 v10, s[24:27], s56 offen lds
    s_add_u32 m0, s55, 17408
    s_nop 0
    buffer_load_dwordx4 v11, s[24:27], s56 offen lds
    s_add_u32 m0, s55, 18432
    s_nop 0
    buffer_load_dwordx4 v12, s[24:27], s56 offen lds
    s_add_u32 m0, s55, 19456
    s_nop 0
    buffer_load_dwordx4 v13, s[24:27], s56 offen lds
    s_add_u32 m0, s55, 20480
    s_nop 0
    buffer_load_dwordx4 v14, s[24:27], s56 offen lds
    s_add_u32 m0, s55, 21504
    s_nop 0
    buffer_load_dwordx4 v15, s[24:27], s56 offen lds
    s_add_u32 m0, s55, 22528
    s_nop 0
    buffer_load_dwordx4 v16, s[24:27], s56 offen lds
    s_add_u32 m0, s55, 23552
    s_nop 0
    buffer_load_dwordx4 v17, s[24:27], s56 offen lds
    s_waitcnt vmcnt(16)
    s_barrier
    s_mov_b32 s56, 1536
    s_add_u32 m0, s55, 32768
    s_nop 0
    buffer_load_dwordx4 v10, s[24:27], s56 offen lds
    s_add_u32 m0, s55, 33792
    s_nop 0
    buffer_load_dwordx4 v11, s[24:27], s56 offen lds
    s_add_u32 m0, s55, 34816
    s_nop 0
    buffer_load_dwordx4 v12, s[24:27], s56 offen lds
    s_add_u32 m0, s55, 35840
    s_nop 0
    buffer_load_dwordx4 v13, s[24:27], s56 offen lds
    s_add_u32 m0, s55, 36864
    s_nop 0
    buffer_load_dwordx4 v14, s[24:27], s56 offen lds
    s_add_u32 m0, s55, 37888
    s_nop 0
    buffer_load_dwordx4 v15, s[24:27], s56 offen lds
    s_add_u32 m0, s55, 38912
    s_nop 0
    buffer_load_dwordx4 v16, s[24:27], s56 offen lds
    s_add_u32 m0, s55, 39936
    s_nop 0
    buffer_load_dwordx4 v17, s[24:27], s56 offen lds
    s_waitcnt vmcnt(16)
    s_barrier
    s_mov_b32 s56, 1792
    s_add_u32 m0, s55, 49152
    s_nop 0
    buffer_load_dwordx4 v10, s[24:27], s56 offen lds
    s_add_u32 m0, s55, 50176
    s_nop 0
    buffer_load_dwordx4 v11, s[24:27], s56 offen lds
    s_add_u32 m0, s55, 51200
    s_nop 0
    buffer_load_dwordx4 v12, s[24:27], s56 offen lds
    s_add_u32 m0, s55, 52224
    s_nop 0
    buffer_load_dwordx4 v13, s[24:27], s56 offen lds
    s_add_u32 m0, s55, 53248
    s_nop 0
    buffer_load_dwordx4 v14, s[24:27], s56 offen lds
    s_add_u32 m0, s55, 54272
    s_nop 0
    buffer_load_dwordx4 v15, s[24:27], s56 offen lds
    s_add_u32 m0, s55, 55296
    s_nop 0
    buffer_load_dwordx4 v16, s[24:27], s56 offen lds
    s_add_u32 m0, s55, 56320
    s_nop 0
    buffer_load_dwordx4 v17, s[24:27], s56 offen lds
    s_waitcnt vmcnt(16)
    s_barrier
    s_mov_b32 s56, 2048
    s_add_u32 m0, s55, 0
    s_nop 0
    buffer_load_dwordx4 v10, s[24:27], s56 offen lds
    s_add_u32 m0, s55, 1024
    s_nop 0
    buffer_load_dwordx4 v11, s[24:27], s56 offen lds
    s_add_u32 m0, s55, 2048
    s_nop 0
    buffer_load_dwordx4 v12, s[24:27], s56 offen lds
    s_add_u32 m0, s55, 3072
    s_nop 0
    buffer_load_dwordx4 v13, s[24:27], s56 offen lds
    s_add_u32 m0, s55, 4096
    s_nop 0
    buffer_load_dwordx4 v14, s[24:27], s56 offen lds
    s_add_u32 m0, s55, 5120
    s_nop 0
    buffer_load_dwordx4 v15, s[24:27], s56 offen lds
    s_add_u32 m0, s55, 6144
    s_nop 0
    buffer_load_dwordx4 v16, s[24:27], s56 offen lds
    s_add_u32 m0, s55, 7168
    s_nop 0
    buffer_load_dwordx4 v17, s[24:27], s56 offen lds
    s_waitcnt vmcnt(16)
    s_barrier
    s_mov_b32 s56, 2304
    s_add_u32 m0, s55, 16384
    s_nop 0
    buffer_load_dwordx4 v10, s[24:27], s56 offen lds
    s_add_u32 m0, s55, 17408
    s_nop 0
    buffer_load_dwordx4 v11, s[24:27], s56 offen lds
    s_add_u32 m0, s55, 18432
    s_nop 0
    buffer_load_dwordx4 v12, s[24:27], s56 offen lds
    s_add_u32 m0, s55, 19456
    s_nop 0
    buffer_load_dwordx4 v13, s[24:27], s56 offen lds
    s_add_u32 m0, s55, 20480
    s_nop 0
    buffer_load_dwordx4 v14, s[24:27], s56 offen lds
    s_add_u32 m0, s55, 21504
    s_nop 0
    buffer_load_dwordx4 v15, s[24:27], s56 offen lds
    s_add_u32 m0, s55, 22528
    s_nop 0
    buffer_load_dwordx4 v16, s[24:27], s56 offen lds
    s_add_u32 m0, s55, 23552
    s_nop 0
    buffer_load_dwordx4 v17, s[24:27], s56 offen lds
    s_waitcnt vmcnt(16)
    s_barrier
    s_mov_b32 s56, 2560
    s_add_u32 m0, s55, 32768
    s_nop 0
    buffer_load_dwordx4 v10, s[24:27], s56 offen lds
    s_add_u32 m0, s55, 33792
    s_nop 0
    buffer_load_dwordx4 v11, s[24:27], s56 offen lds
    s_add_u32 m0, s55, 34816
    s_nop 0
    buffer_load_dwordx4 v12, s[24:27], s56 offen lds
    s_add_u32 m0, s55, 35840
    s_nop 0
    buffer_load_dwordx4 v13, s[24:27], s56 offen lds
    s_add_u32 m0, s55, 36864
    s_nop 0
    buffer_load_dwordx4 v14, s[24:27], s56 offen lds
    s_add_u32 m0, s55, 37888
    s_nop 0
    buffer_load_dwordx4 v15, s[24:27], s56 offen lds
    s_add_u32 m0, s55, 38912
    s_nop 0
    buffer_load_dwordx4 v16, s[24:27], s56 offen lds
    s_add_u32 m0, s55, 39936
    s_nop 0
    buffer_load_dwordx4 v17, s[24:27], s56 offen lds
    s_waitcnt vmcnt(16)
    s_barrier
    s_mov_b32 s56, 2816
    s_add_u32 m0, s55, 49152
    s_nop 0
    buffer_load_dwordx4 v10, s[24:27], s56 offen lds
    s_add_u32 m0, s55, 50176
    s_nop 0
    buffer_load_dwordx4 v11, s[24:27], s56 offen lds
    s_add_u32 m0, s55, 51200
    s_nop 0
    buffer_load_dwordx4 v12, s[24:27], s56 offen lds
    s_add_u32 m0, s55, 52224
    s_nop 0
    buffer_load_dwordx4 v13, s[24:27], s56 offen lds
    s_add_u32 m0, s55, 53248
    s_nop 0
    buffer_load_dwordx4 v14, s[24:27], s56 offen lds
    s_add_u32 m0, s55, 54272
    s_nop 0
    buffer_load_dwordx4 v15, s[24:27], s56 offen lds
    s_add_u32 m0, s55, 55296
    s_nop 0
    buffer_load_dwordx4 v16, s[24:27], s56 offen lds
    s_add_u32 m0, s55, 56320
    s_nop 0
    buffer_load_dwordx4 v17, s[24:27], s56 offen lds
    s_waitcnt vmcnt(16)
    s_barrier
    s_mov_b32 s56, 3072
    s_add_u32 m0, s55, 0
    s_nop 0
    buffer_load_dwordx4 v10, s[24:27], s56 offen lds
    s_add_u32 m0, s55, 1024
    s_nop 0
    buffer_load_dwordx4 v11, s[24:27], s56 offen lds
    s_add_u32 m0, s55, 2048
    s_nop 0
    buffer_load_dwordx4 v12, s[24:27], s56 offen lds
    s_add_u32 m0, s55, 3072
    s_nop 0
    buffer_load_dwordx4 v13, s[24:27], s56 offen lds
    s_add_u32 m0, s55, 4096
    s_nop 0
    buffer_load_dwordx4 v14, s[24:27], s56 offen lds
    s_add_u32 m0, s55, 5120
    s_nop 0
    buffer_load_dwordx4 v15, s[24:27], s56 offen lds
    s_add_u32 m0, s55, 6144
    s_nop 0
    buffer_load_dwordx4 v16, s[24:27], s56 offen lds
    s_add_u32 m0, s55, 7168
    s_nop 0
    buffer_load_dwordx4 v17, s[24:27], s56 offen lds
    s_waitcnt vmcnt(16)
    s_barrier
    s_mov_b32 s56, 3328
    s_add_u32 m0, s55, 16384
    s_nop 0
    buffer_load_dwordx4 v10, s[24:27], s56 offen lds
    s_add_u32 m0, s55, 17408
    s_nop 0
    buffer_load_dwordx4 v11, s[24:27], s56 offen lds
    s_add_u32 m0, s55, 18432
    s_nop 0
    buffer_load_dwordx4 v12, s[24:27], s56 offen lds
    s_add_u32 m0, s55, 19456
    s_nop 0
    buffer_load_dwordx4 v13, s[24:27], s56 offen lds
    s_add_u32 m0, s55, 20480
    s_nop 0
    buffer_load_dwordx4 v14, s[24:27], s56 offen lds
    s_add_u32 m0, s55, 21504
    s_nop 0
    buffer_load_dwordx4 v15, s[24:27], s56 offen lds
    s_add_u32 m0, s55, 22528
    s_nop 0
    buffer_load_dwordx4 v16, s[24:27], s56 offen lds
    s_add_u32 m0, s55, 23552
    s_nop 0
    buffer_load_dwordx4 v17, s[24:27], s56 offen lds
    s_waitcnt vmcnt(16)
    s_barrier
    s_waitcnt vmcnt(8)
    s_barrier
    s_waitcnt vmcnt(0)
    s_barrier
    s_barrier
    s_barrier
    s_endpgm
kC_kernel_compute:
    s_nop 7
    s_nop 7
    s_lshr_b32 s48, s97, 3
    s_lshl_b32 s22, s96, 1
    s_add_u32 s22, s22, s48
    s_and_b32 s23, s97, 7
    s_lshl_b32 s50, s22, 6
    s_lshl_b32 s54, s23, 7
    s_lshl_b32 s52, s3, 13
    v_lshlrev_b32 v5, 5, v1
    v_add_u32 v5, s52, v5
    v_add_u32 v6, 4096, v5
    s_waitcnt lgkmcnt(0)
    s_add_u32 s36, s20, 14745600
    s_addc_u32 s37, s21, 0
    s_and_b32 s37, s37, 0xffff
    s_mov_b32 s38, 34816
    s_mov_b32 s39, 0x20000
    buffer_load_dwordx4 v[20:23], v5, s[36:39], 0 offen offset:0
    buffer_load_dwordx4 v[24:27], v5, s[36:39], 0 offen offset:16
    buffer_load_dwordx4 v[28:31], v5, s[36:39], 0 offen offset:2048
    buffer_load_dwordx4 v[32:35], v5, s[36:39], 0 offen offset:2064
    buffer_load_dwordx4 v[36:39], v6, s[36:39], 0 offen offset:0
    buffer_load_dwordx4 v[40:43], v6, s[36:39], 0 offen offset:16
    buffer_load_dwordx4 v[44:47], v6, s[36:39], 0 offen offset:2048
    buffer_load_dwordx4 v[48:51], v6, s[36:39], 0 offen offset:2064
    v_lshlrev_b32 v7, 3, v0
    v_add_u32 v7, 32768, v7
    buffer_load_dwordx2 v[52:53], v7, s[36:39], 0 offen
    s_add_u32 s24, s20, 4194304
    s_addc_u32 s25, s21, 0
    s_and_b32 s25, s25, 0xffff
    s_mov_b32 s26, 2097152
    s_mov_b32 s27, 0x20000
    v_lshrrev_b32 v5, 3, v0
    v_and_b32 v6, 7, v0
    v_add_u32 v5, s50, v5
    v_lshlrev_b32 v5, 10, v5
    v_lshl_add_u32 v5, v6, 4, v5
    v_add_u32 v5, s54, v5
    s_mov_b32 s60, 32768
    buffer_load_dwordx4 v[12:15], v5, s[24:27], 0 offen
    buffer_load_dwordx4 v[16:19], v5, s[24:27], s60 offen
    s_lshl_b32 s52, s3, 4
    v_add_u32 v5, s52, v2
    v_mul_u32_u24 v5, 256, v5
    v_mov_b32 v6, v2
    v_xor_b32 v6, v6, v3
    v_xor_b32 v54, 0, v6
    v_lshl_add_u32 v54, v54, 4, v5
    v_add_u32 v55, 65536, v54
    v_xor_b32 v56, 4, v6
    v_lshl_add_u32 v56, v56, 4, v5
    v_add_u32 v57, 65536, v56
    v_xor_b32 v58, 8, v6
    v_lshl_add_u32 v58, v58, 4, v5
    v_add_u32 v59, 65536, v58
    v_xor_b32 v60, 12, v6
    v_lshl_add_u32 v60, v60, 4, v5
    v_add_u32 v61, 65536, v60
    v_lshlrev_b32 v5, 4, v1
    v_add_u32 v5, 131072, v5
    v_mov_b32 v6, 150528
    v_cmp_gt_u32 vcc, 2, v3
    s_nop 1
    v_cndmask_b32 v62, v6, v5, vcc
    v_cndmask_b32 v63, v5, v6, vcc
    v_mov_b32 v7, 1024
    v_cndmask_b32 v65, 0, v7, vcc
    v_cndmask_b32 v66, v7, 0, vcc
    v_and_b32 v5, 3, v1
    v_lshrrev_b32 v7, 1, v3
    v_cmp_eq_u32 vcc, v5, v7
    v_lshlrev_b32 v5, 4, v3
    v_add_u32 v5, 149504, v5
    v_cndmask_b32 v64, v6, v5, vcc
    v_cndmask_b32 v67, 0, 64, vcc
    v_bfe_u32 v5, v1, 2, 2
    v_lshl_add_u32 v5, v3, 2, v5
    v_bfe_u32 v6, v5, 1, 2
    v_lshlrev_b32 v5, 7, v5
    v_and_b32 v7, 3, v1
    v_lshl_add_u32 v5, v7, 3, v5
    v_xor_b32 v7, 0, v6
    v_lshl_add_u32 v68, v7, 5, v5
    v_add_u32 v69, 65536, v68
    v_add_u32 v70, 131072, v68
    v_xor_b32 v7, 1, v6
    v_lshl_add_u32 v71, v7, 5, v5
    v_add_u32 v72, 65536, v71
    v_add_u32 v73, 131072, v71
    v_xor_b32 v7, 2, v6
    v_lshl_add_u32 v74, v7, 5, v5
    v_add_u32 v75, 65536, v74
    v_add_u32 v76, 131072, v74
    v_xor_b32 v7, 3, v6
    v_lshl_add_u32 v77, v7, 5, v5
    v_add_u32 v78, 65536, v77
    v_add_u32 v79, 131072, v77
    v_mov_b32 v80, 0
    v_mov_b32 v81, 0
    v_mov_b32 v82, 0
    v_mov_b32 v83, 0
    v_mov_b32 v84, 0
    v_mov_b32 v85, 0
    v_mov_b32 v86, 0
    v_mov_b32 v87, 0
    v_mov_b32 v88, 0
    v_mov_b32 v89, 0
    v_mov_b32 v90, 0
    v_mov_b32 v91, 0
    v_mov_b32 v92, 0
    v_mov_b32 v93, 0
    v_mov_b32 v94, 0
    v_mov_b32 v95, 0
    s_lshl_b32 s57, s3, 12
    s_add_u32 s57, s57, 131072
    v_lshlrev_b32 v5, 4, v1
    v_add_u32 v5, s57, v5
    s_waitcnt vmcnt(10)
    v_cvt_pk_bf16_f32 v20, v20, v21
    v_cvt_pk_bf16_f32 v21, v22, v23
    s_waitcnt vmcnt(9)
    v_cvt_pk_bf16_f32 v22, v24, v25
    v_cvt_pk_bf16_f32 v23, v26, v27
    ds_write_b128 v5, v[20:23] offset:0
    s_waitcnt vmcnt(8)
    v_cvt_pk_bf16_f32 v28, v28, v29
    v_cvt_pk_bf16_f32 v29, v30, v31
    s_waitcnt vmcnt(7)
    v_cvt_pk_bf16_f32 v30, v32, v33
    v_cvt_pk_bf16_f32 v31, v34, v35
    ds_write_b128 v5, v[28:31] offset:1024
    s_waitcnt vmcnt(6)
    v_cvt_pk_bf16_f32 v36, v36, v37
    v_cvt_pk_bf16_f32 v37, v38, v39
    s_waitcnt vmcnt(5)
    v_cvt_pk_bf16_f32 v38, v40, v41
    v_cvt_pk_bf16_f32 v39, v42, v43
    ds_write_b128 v5, v[36:39] offset:2048
    s_waitcnt vmcnt(4)
    v_cvt_pk_bf16_f32 v44, v44, v45
    v_cvt_pk_bf16_f32 v45, v46, v47
    s_waitcnt vmcnt(3)
    v_cvt_pk_bf16_f32 v46, v48, v49
    v_cvt_pk_bf16_f32 v47, v50, v51
    ds_write_b128 v5, v[44:47] offset:3072
    s_waitcnt vmcnt(2)
    v_cvt_pk_bf16_f32 v52, v52, v53
    v_lshlrev_b32 v6, 2, v0
    v_add_u32 v6, 149504, v6
    ds_write_b32 v6, v52
    v_mov_b32 v52, 0
    v_and_b32 v6, 3, v0
    v_lshlrev_b32 v6, 2, v6
    v_add_u32 v6, 150528, v6
    ds_write_b32 v6, v52
    s_mov_b32 s62, 0x358637bd
    s_mov_b32 s63, 0x358637bd
    s_waitcnt lgkmcnt(0)
    s_barrier
    ds_read_b128 v[152:155], v54 offset:0
    ds_read_b128 v[128:131], v62
    ds_read_b128 v[132:135], v63
    ds_read_b128 v[136:139], v64
    v_add_u32 v62, v62, v65
    v_add_u32 v63, v63, v66
    v_add_u32 v64, v64, v67
    ds_read_b128 v[156:159], v56 offset:0
    ds_read_b128 v[140:143], v62
    ds_read_b128 v[144:147], v63
    ds_read_b128 v[148:151], v64
    v_add_u32 v62, v62, v65
    v_add_u32 v63, v63, v66
    v_add_u32 v64, v64, v67
    ds_read_b64_tr_b16 v[20:21], v69 offset:0
    ds_read_b64_tr_b16 v[22:23], v69 offset:2048
    ds_read_b64_tr_b16 v[24:25], v72 offset:0
    ds_read_b64_tr_b16 v[26:27], v72 offset:2048
    ds_read_b64_tr_b16 v[28:29], v75 offset:0
    ds_read_b64_tr_b16 v[30:31], v75 offset:2048
    ds_read_b64_tr_b16 v[32:33], v78 offset:0
    ds_read_b64_tr_b16 v[34:35], v78 offset:2048
    ds_read_b64_tr_b16 v[36:37], v69 offset:4096
    ds_read_b64_tr_b16 v[38:39], v69 offset:6144
    ds_read_b64_tr_b16 v[40:41], v72 offset:4096
    ds_read_b64_tr_b16 v[42:43], v72 offset:6144
    ds_read_b64_tr_b16 v[44:45], v75 offset:4096
    ds_read_b64_tr_b16 v[46:47], v75 offset:6144
    ds_read_b64_tr_b16 v[48:49], v78 offset:4096
    ds_read_b64_tr_b16 v[50:51], v78 offset:6144
    s_waitcnt lgkmcnt(15)
    v_mfma_f32_16x16x32_bf16 v[160:163], v[128:131], v[152:155], 0
    v_mfma_f32_16x16x32_bf16 v[164:167], v[132:135], v[152:155], 0
    v_mfma_f32_16x16x32_bf16 v[168:171], v[136:139], v[152:155], 0
    v_mfma_f32_16x16x32_bf16 v[172:175], v[140:143], v[156:159], 0
    v_mfma_f32_16x16x32_bf16 v[176:179], v[144:147], v[156:159], 0
    v_mfma_f32_16x16x32_bf16 v[180:183], v[148:151], v[156:159], 0
    ds_read_b128 v[152:155], v58 offset:0
    ds_read_b128 v[128:131], v62
    ds_read_b128 v[132:135], v63
    ds_read_b128 v[136:139], v64
    v_add_u32 v62, v62, v65
    v_add_u32 v63, v63, v66
    v_add_u32 v64, v64, v67
    ds_read_b128 v[156:159], v60 offset:0
    ds_read_b128 v[140:143], v62
    ds_read_b128 v[144:147], v63
    ds_read_b128 v[148:151], v64
    v_add_u32 v62, v62, v65
    v_add_u32 v63, v63, v66
    v_add_u32 v64, v64, v67
    s_waitcnt lgkmcnt(6)
    v_mfma_f32_16x16x32_bf16 v[184:187], v[128:131], v[152:155], 0
    v_add_f32 v224, s62, v168
    v_add_f32 v225, s62, v169
    ds_read_b64_tr_b16 v[96:97], v69 offset:8192
    ds_read_b64_tr_b16 v[98:99], v69 offset:10240
    ds_read_b64_tr_b16 v[100:101], v72 offset:8192
    s_waitcnt lgkmcnt(8)
    v_mfma_f32_16x16x32_bf16 v[188:191], v[132:135], v[152:155], 0
    v_add_f32 v226, s62, v180
    v_add_f32 v227, s62, v181
    ds_read_b64_tr_b16 v[102:103], v72 offset:10240
    ds_read_b64_tr_b16 v[104:105], v75 offset:8192
    ds_read_b64_tr_b16 v[106:107], v75 offset:10240
    s_waitcnt lgkmcnt(10)
    v_mfma_f32_16x16x32_bf16 v[192:195], v[136:139], v[152:155], 0
    v_rcp_f32 v224, v224
    v_rcp_f32 v225, v225
    ds_read_b64_tr_b16 v[108:109], v78 offset:8192
    ds_read_b64_tr_b16 v[110:111], v78 offset:10240
    ds_read_b64_tr_b16 v[112:113], v69 offset:12288
    s_waitcnt lgkmcnt(11)
    v_mfma_f32_16x16x32_bf16 v[196:199], v[140:143], v[156:159], 0
    v_rcp_f32 v226, v226
    v_rcp_f32 v227, v227
    ds_read_b64_tr_b16 v[114:115], v69 offset:14336
    ds_read_b64_tr_b16 v[116:117], v72 offset:12288
    ds_read_b64_tr_b16 v[118:119], v72 offset:14336
    s_waitcnt lgkmcnt(13)
    v_mfma_f32_16x16x32_bf16 v[200:203], v[144:147], v[156:159], 0
    v_mul_f32 v160, v160, v224
    v_mul_f32 v161, v161, v224
    ds_read_b64_tr_b16 v[120:121], v75 offset:12288
    ds_read_b64_tr_b16 v[122:123], v75 offset:14336
    ds_read_b64_tr_b16 v[124:125], v78 offset:12288
    s_waitcnt lgkmcnt(15)
    v_mfma_f32_16x16x32_bf16 v[204:207], v[148:151], v[156:159], 0
    v_mul_f32 v162, v162, v224
    v_mul_f32 v163, v163, v224
    ds_read_b64_tr_b16 v[126:127], v78 offset:14336
    v_mul_f32 v164, v164, v225
    v_mul_f32 v165, v165, v225
    v_mul_f32 v166, v166, v225
    v_mul_f32 v167, v167, v225
    v_mul_f32 v172, v172, v226
    v_mul_f32 v173, v173, v226
    v_mul_f32 v174, v174, v226
    v_mul_f32 v175, v175, v226
    v_mul_f32 v176, v176, v227
    v_mul_f32 v177, v177, v227
    v_mul_f32 v178, v178, v227
    v_mul_f32 v179, v179, v227
    v_cvt_pk_bf16_f32 v208, v160, v161
    v_cvt_pk_bf16_f32 v209, v162, v163
    v_cvt_pk_bf16_f32 v210, v164, v165
    v_cvt_pk_bf16_f32 v211, v166, v167
    v_cvt_pk_bf16_f32 v212, v172, v173
    v_cvt_pk_bf16_f32 v213, v174, v175
    v_cvt_pk_bf16_f32 v214, v176, v177
    v_cvt_pk_bf16_f32 v215, v178, v179
    s_waitcnt lgkmcnt(0)
    s_barrier
    ds_read_b128 v[152:155], v54 offset:16384
    ds_read_b128 v[128:131], v62
    ds_read_b128 v[132:135], v63
    ds_read_b128 v[136:139], v64
    v_add_u32 v62, v62, v65
    v_add_u32 v63, v63, v66
    v_add_u32 v64, v64, v67
    ds_read_b128 v[156:159], v56 offset:16384
    ds_read_b128 v[140:143], v62
    ds_read_b128 v[144:147], v63
    ds_read_b128 v[148:151], v64
    v_add_u32 v62, v62, v65
    v_add_u32 v63, v63, v66
    v_add_u32 v64, v64, v67
    v_mfma_f32_16x16x32_bf16 v[80:83], v[20:23], v[208:211], v[80:83]
    v_add_f32 v224, s62, v192
    v_add_f32 v225, s62, v193
    v_mfma_f32_16x16x32_bf16 v[84:87], v[24:27], v[208:211], v[84:87]
    v_add_f32 v226, s62, v204
    v_add_f32 v227, s62, v205
    v_mfma_f32_16x16x32_bf16 v[88:91], v[28:31], v[208:211], v[88:91]
    v_rcp_f32 v224, v224
    v_rcp_f32 v225, v225
    v_mfma_f32_16x16x32_bf16 v[92:95], v[32:35], v[208:211], v[92:95]
    v_rcp_f32 v226, v226
    v_rcp_f32 v227, v227
    v_mfma_f32_16x16x32_bf16 v[80:83], v[36:39], v[212:215], v[80:83]
    v_mul_f32 v184, v184, v224
    v_mul_f32 v185, v185, v224
    v_mfma_f32_16x16x32_bf16 v[84:87], v[40:43], v[212:215], v[84:87]
    v_mul_f32 v186, v186, v224
    v_mul_f32 v187, v187, v224
    v_mfma_f32_16x16x32_bf16 v[88:91], v[44:47], v[212:215], v[88:91]
    v_mul_f32 v188, v188, v225
    v_mul_f32 v189, v189, v225
    v_mfma_f32_16x16x32_bf16 v[92:95], v[48:51], v[212:215], v[92:95]
    v_mul_f32 v190, v190, v225
    v_mul_f32 v191, v191, v225
    ds_read_b64_tr_b16 v[20:21], v69 offset:16384
    ds_read_b64_tr_b16 v[22:23], v69 offset:18432
    ds_read_b64_tr_b16 v[24:25], v72 offset:16384
    s_waitcnt lgkmcnt(9)
    v_mfma_f32_16x16x32_bf16 v[160:163], v[128:131], v[152:155], 0
    v_mul_f32 v196, v196, v226
    v_mul_f32 v197, v197, v226
    ds_read_b64_tr_b16 v[26:27], v72 offset:18432
    ds_read_b64_tr_b16 v[28:29], v75 offset:16384
    ds_read_b64_tr_b16 v[30:31], v75 offset:18432
    s_waitcnt lgkmcnt(11)
    v_mfma_f32_16x16x32_bf16 v[164:167], v[132:135], v[152:155], 0
    v_mul_f32 v198, v198, v226
    v_mul_f32 v199, v199, v226
    ds_read_b64_tr_b16 v[32:33], v78 offset:16384
    ds_read_b64_tr_b16 v[34:35], v78 offset:18432
    ds_read_b64_tr_b16 v[36:37], v69 offset:20480
    s_waitcnt lgkmcnt(13)
    v_mfma_f32_16x16x32_bf16 v[168:171], v[136:139], v[152:155], 0
    v_mul_f32 v200, v200, v227
    v_mul_f32 v201, v201, v227
    ds_read_b64_tr_b16 v[38:39], v69 offset:22528
    ds_read_b64_tr_b16 v[40:41], v72 offset:20480
    ds_read_b64_tr_b16 v[42:43], v72 offset:22528
    s_waitcnt lgkmcnt(14)
    v_mfma_f32_16x16x32_bf16 v[172:175], v[140:143], v[156:159], 0
    v_mul_f32 v202, v202, v227
    v_mul_f32 v203, v203, v227
    ds_read_b64_tr_b16 v[44:45], v75 offset:20480
    ds_read_b64_tr_b16 v[46:47], v75 offset:22528
    ds_read_b64_tr_b16 v[48:49], v78 offset:20480
    s_waitcnt lgkmcnt(15)
    v_mfma_f32_16x16x32_bf16 v[176:179], v[144:147], v[156:159], 0
    v_cvt_pk_bf16_f32 v216, v184, v185
    v_cvt_pk_bf16_f32 v217, v186, v187
    ds_read_b64_tr_b16 v[50:51], v78 offset:22528
    v_mfma_f32_16x16x32_bf16 v[180:183], v[148:151], v[156:159], 0
    v_cvt_pk_bf16_f32 v218, v188, v189
    v_cvt_pk_bf16_f32 v219, v190, v191
    v_cvt_pk_bf16_f32 v220, v196, v197
    v_cvt_pk_bf16_f32 v221, v198, v199
    v_cvt_pk_bf16_f32 v222, v200, v201
    v_cvt_pk_bf16_f32 v223, v202, v203
    ds_read_b128 v[152:155], v58 offset:16384
    ds_read_b128 v[128:131], v62
    ds_read_b128 v[132:135], v63
    ds_read_b128 v[136:139], v64
    v_add_u32 v62, v62, v65
    v_add_u32 v63, v63, v66
    v_add_u32 v64, v64, v67
    ds_read_b128 v[156:159], v60 offset:16384
    ds_read_b128 v[140:143], v62
    ds_read_b128 v[144:147], v63
    ds_read_b128 v[148:151], v64
    v_add_u32 v62, v62, v65
    v_add_u32 v63, v63, v66
    v_add_u32 v64, v64, v67
    v_mfma_f32_16x16x32_bf16 v[80:83], v[96:99], v[216:219], v[80:83]
    v_add_f32 v224, s62, v168
    v_add_f32 v225, s62, v169
    v_mfma_f32_16x16x32_bf16 v[84:87], v[100:103], v[216:219], v[84:87]
    v_add_f32 v226, s62, v180
    v_add_f32 v227, s62, v181
    v_mfma_f32_16x16x32_bf16 v[88:91], v[104:107], v[216:219], v[88:91]
    v_rcp_f32 v224, v224
    v_rcp_f32 v225, v225
    v_mfma_f32_16x16x32_bf16 v[92:95], v[108:111], v[216:219], v[92:95]
    v_rcp_f32 v226, v226
    v_rcp_f32 v227, v227
    v_mfma_f32_16x16x32_bf16 v[80:83], v[112:115], v[220:223], v[80:83]
    v_mul_f32 v160, v160, v224
    v_mul_f32 v161, v161, v224
    v_mfma_f32_16x16x32_bf16 v[84:87], v[116:119], v[220:223], v[84:87]
    v_mul_f32 v162, v162, v224
    v_mul_f32 v163, v163, v224
    v_mfma_f32_16x16x32_bf16 v[88:91], v[120:123], v[220:223], v[88:91]
    v_mul_f32 v164, v164, v225
    v_mul_f32 v165, v165, v225
    v_mfma_f32_16x16x32_bf16 v[92:95], v[124:127], v[220:223], v[92:95]
    v_mul_f32 v166, v166, v225
    v_mul_f32 v167, v167, v225
    ds_read_b64_tr_b16 v[96:97], v69 offset:24576
    ds_read_b64_tr_b16 v[98:99], v69 offset:26624
    ds_read_b64_tr_b16 v[100:101], v72 offset:24576
    s_waitcnt lgkmcnt(9)
    v_mfma_f32_16x16x32_bf16 v[184:187], v[128:131], v[152:155], 0
    v_mul_f32 v172, v172, v226
    v_mul_f32 v173, v173, v226
    ds_read_b64_tr_b16 v[102:103], v72 offset:26624
    ds_read_b64_tr_b16 v[104:105], v75 offset:24576
    ds_read_b64_tr_b16 v[106:107], v75 offset:26624
    s_waitcnt lgkmcnt(11)
    v_mfma_f32_16x16x32_bf16 v[188:191], v[132:135], v[152:155], 0
    v_mul_f32 v174, v174, v226
    v_mul_f32 v175, v175, v226
    ds_read_b64_tr_b16 v[108:109], v78 offset:24576
    ds_read_b64_tr_b16 v[110:111], v78 offset:26624
    ds_read_b64_tr_b16 v[112:113], v69 offset:28672
    s_waitcnt lgkmcnt(13)
    v_mfma_f32_16x16x32_bf16 v[192:195], v[136:139], v[152:155], 0
    v_mul_f32 v176, v176, v227
    v_mul_f32 v177, v177, v227
    ds_read_b64_tr_b16 v[114:115], v69 offset:30720
    ds_read_b64_tr_b16 v[116:117], v72 offset:28672
    ds_read_b64_tr_b16 v[118:119], v72 offset:30720
    s_waitcnt lgkmcnt(14)
    v_mfma_f32_16x16x32_bf16 v[196:199], v[140:143], v[156:159], 0
    v_mul_f32 v178, v178, v227
    v_mul_f32 v179, v179, v227
    ds_read_b64_tr_b16 v[120:121], v75 offset:28672
    ds_read_b64_tr_b16 v[122:123], v75 offset:30720
    ds_read_b64_tr_b16 v[124:125], v78 offset:28672
    s_waitcnt lgkmcnt(15)
    v_mfma_f32_16x16x32_bf16 v[200:203], v[144:147], v[156:159], 0
    v_cvt_pk_bf16_f32 v208, v160, v161
    v_cvt_pk_bf16_f32 v209, v162, v163
    ds_read_b64_tr_b16 v[126:127], v78 offset:30720
    v_mfma_f32_16x16x32_bf16 v[204:207], v[148:151], v[156:159], 0
    v_cvt_pk_bf16_f32 v210, v164, v165
    v_cvt_pk_bf16_f32 v211, v166, v167
    v_cvt_pk_bf16_f32 v212, v172, v173
    v_cvt_pk_bf16_f32 v213, v174, v175
    v_cvt_pk_bf16_f32 v214, v176, v177
    v_cvt_pk_bf16_f32 v215, v178, v179
    s_waitcnt lgkmcnt(0)
    s_barrier
    ds_read_b128 v[152:155], v54 offset:32768
    ds_read_b128 v[128:131], v62
    ds_read_b128 v[132:135], v63
    ds_read_b128 v[136:139], v64
    v_add_u32 v62, v62, v65
    v_add_u32 v63, v63, v66
    v_add_u32 v64, v64, v67
    ds_read_b128 v[156:159], v56 offset:32768
    ds_read_b128 v[140:143], v62
    ds_read_b128 v[144:147], v63
    ds_read_b128 v[148:151], v64
    v_add_u32 v62, v62, v65
    v_add_u32 v63, v63, v66
    v_add_u32 v64, v64, v67
    v_mfma_f32_16x16x32_bf16 v[80:83], v[20:23], v[208:211], v[80:83]
    v_add_f32 v224, s62, v192
    v_add_f32 v225, s62, v193
    v_mfma_f32_16x16x32_bf16 v[84:87], v[24:27], v[208:211], v[84:87]
    v_add_f32 v226, s62, v204
    v_add_f32 v227, s62, v205
    v_mfma_f32_16x16x32_bf16 v[88:91], v[28:31], v[208:211], v[88:91]
    v_rcp_f32 v224, v224
    v_rcp_f32 v225, v225
    v_mfma_f32_16x16x32_bf16 v[92:95], v[32:35], v[208:211], v[92:95]
    v_rcp_f32 v226, v226
    v_rcp_f32 v227, v227
    v_mfma_f32_16x16x32_bf16 v[80:83], v[36:39], v[212:215], v[80:83]
    v_mul_f32 v184, v184, v224
    v_mul_f32 v185, v185, v224
    v_mfma_f32_16x16x32_bf16 v[84:87], v[40:43], v[212:215], v[84:87]
    v_mul_f32 v186, v186, v224
    v_mul_f32 v187, v187, v224
    v_mfma_f32_16x16x32_bf16 v[88:91], v[44:47], v[212:215], v[88:91]
    v_mul_f32 v188, v188, v225
    v_mul_f32 v189, v189, v225
    v_mfma_f32_16x16x32_bf16 v[92:95], v[48:51], v[212:215], v[92:95]
    v_mul_f32 v190, v190, v225
    v_mul_f32 v191, v191, v225
    ds_read_b64_tr_b16 v[20:21], v69 offset:32768
    ds_read_b64_tr_b16 v[22:23], v69 offset:34816
    ds_read_b64_tr_b16 v[24:25], v72 offset:32768
    s_waitcnt lgkmcnt(9)
    v_mfma_f32_16x16x32_bf16 v[160:163], v[128:131], v[152:155], 0
    v_mul_f32 v196, v196, v226
    v_mul_f32 v197, v197, v226
    ds_read_b64_tr_b16 v[26:27], v72 offset:34816
    ds_read_b64_tr_b16 v[28:29], v75 offset:32768
    ds_read_b64_tr_b16 v[30:31], v75 offset:34816
    s_waitcnt lgkmcnt(11)
    v_mfma_f32_16x16x32_bf16 v[164:167], v[132:135], v[152:155], 0
    v_mul_f32 v198, v198, v226
    v_mul_f32 v199, v199, v226
    ds_read_b64_tr_b16 v[32:33], v78 offset:32768
    ds_read_b64_tr_b16 v[34:35], v78 offset:34816
    ds_read_b64_tr_b16 v[36:37], v69 offset:36864
    s_waitcnt lgkmcnt(13)
    v_mfma_f32_16x16x32_bf16 v[168:171], v[136:139], v[152:155], 0
    v_mul_f32 v200, v200, v227
    v_mul_f32 v201, v201, v227
    ds_read_b64_tr_b16 v[38:39], v69 offset:38912
    ds_read_b64_tr_b16 v[40:41], v72 offset:36864
    ds_read_b64_tr_b16 v[42:43], v72 offset:38912
    s_waitcnt lgkmcnt(14)
    v_mfma_f32_16x16x32_bf16 v[172:175], v[140:143], v[156:159], 0
    v_mul_f32 v202, v202, v227
    v_mul_f32 v203, v203, v227
    ds_read_b64_tr_b16 v[44:45], v75 offset:36864
    ds_read_b64_tr_b16 v[46:47], v75 offset:38912
    ds_read_b64_tr_b16 v[48:49], v78 offset:36864
    s_waitcnt lgkmcnt(15)
    v_mfma_f32_16x16x32_bf16 v[176:179], v[144:147], v[156:159], 0
    v_cvt_pk_bf16_f32 v216, v184, v185
    v_cvt_pk_bf16_f32 v217, v186, v187
    ds_read_b64_tr_b16 v[50:51], v78 offset:38912
    v_mfma_f32_16x16x32_bf16 v[180:183], v[148:151], v[156:159], 0
    v_cvt_pk_bf16_f32 v218, v188, v189
    v_cvt_pk_bf16_f32 v219, v190, v191
    v_cvt_pk_bf16_f32 v220, v196, v197
    v_cvt_pk_bf16_f32 v221, v198, v199
    v_cvt_pk_bf16_f32 v222, v200, v201
    v_cvt_pk_bf16_f32 v223, v202, v203
    ds_read_b128 v[152:155], v58 offset:32768
    ds_read_b128 v[128:131], v62
    ds_read_b128 v[132:135], v63
    ds_read_b128 v[136:139], v64
    v_add_u32 v62, v62, v65
    v_add_u32 v63, v63, v66
    v_add_u32 v64, v64, v67
    ds_read_b128 v[156:159], v60 offset:32768
    ds_read_b128 v[140:143], v62
    ds_read_b128 v[144:147], v63
    ds_read_b128 v[148:151], v64
    v_add_u32 v62, v62, v65
    v_add_u32 v63, v63, v66
    v_add_u32 v64, v64, v67
    v_mfma_f32_16x16x32_bf16 v[80:83], v[96:99], v[216:219], v[80:83]
    v_add_f32 v224, s62, v168
    v_add_f32 v225, s62, v169
    v_mfma_f32_16x16x32_bf16 v[84:87], v[100:103], v[216:219], v[84:87]
    v_add_f32 v226, s62, v180
    v_add_f32 v227, s62, v181
    v_mfma_f32_16x16x32_bf16 v[88:91], v[104:107], v[216:219], v[88:91]
    v_rcp_f32 v224, v224
    v_rcp_f32 v225, v225
    v_mfma_f32_16x16x32_bf16 v[92:95], v[108:111], v[216:219], v[92:95]
    v_rcp_f32 v226, v226
    v_rcp_f32 v227, v227
    v_mfma_f32_16x16x32_bf16 v[80:83], v[112:115], v[220:223], v[80:83]
    v_mul_f32 v160, v160, v224
    v_mul_f32 v161, v161, v224
    v_mfma_f32_16x16x32_bf16 v[84:87], v[116:119], v[220:223], v[84:87]
    v_mul_f32 v162, v162, v224
    v_mul_f32 v163, v163, v224
    v_mfma_f32_16x16x32_bf16 v[88:91], v[120:123], v[220:223], v[88:91]
    v_mul_f32 v164, v164, v225
    v_mul_f32 v165, v165, v225
    v_mfma_f32_16x16x32_bf16 v[92:95], v[124:127], v[220:223], v[92:95]
    v_mul_f32 v166, v166, v225
    v_mul_f32 v167, v167, v225
    ds_read_b64_tr_b16 v[96:97], v69 offset:40960
    ds_read_b64_tr_b16 v[98:99], v69 offset:43008
    ds_read_b64_tr_b16 v[100:101], v72 offset:40960
    s_waitcnt lgkmcnt(9)
    v_mfma_f32_16x16x32_bf16 v[184:187], v[128:131], v[152:155], 0
    v_mul_f32 v172, v172, v226
    v_mul_f32 v173, v173, v226
    ds_read_b64_tr_b16 v[102:103], v72 offset:43008
    ds_read_b64_tr_b16 v[104:105], v75 offset:40960
    ds_read_b64_tr_b16 v[106:107], v75 offset:43008
    s_waitcnt lgkmcnt(11)
    v_mfma_f32_16x16x32_bf16 v[188:191], v[132:135], v[152:155], 0
    v_mul_f32 v174, v174, v226
    v_mul_f32 v175, v175, v226
    ds_read_b64_tr_b16 v[108:109], v78 offset:40960
    ds_read_b64_tr_b16 v[110:111], v78 offset:43008
    ds_read_b64_tr_b16 v[112:113], v69 offset:45056
    s_waitcnt lgkmcnt(13)
    v_mfma_f32_16x16x32_bf16 v[192:195], v[136:139], v[152:155], 0
    v_mul_f32 v176, v176, v227
    v_mul_f32 v177, v177, v227
    ds_read_b64_tr_b16 v[114:115], v69 offset:47104
    ds_read_b64_tr_b16 v[116:117], v72 offset:45056
    ds_read_b64_tr_b16 v[118:119], v72 offset:47104
    s_waitcnt lgkmcnt(14)
    v_mfma_f32_16x16x32_bf16 v[196:199], v[140:143], v[156:159], 0
    v_mul_f32 v178, v178, v227
    v_mul_f32 v179, v179, v227
    ds_read_b64_tr_b16 v[120:121], v75 offset:45056
    ds_read_b64_tr_b16 v[122:123], v75 offset:47104
    ds_read_b64_tr_b16 v[124:125], v78 offset:45056
    s_waitcnt lgkmcnt(15)
    v_mfma_f32_16x16x32_bf16 v[200:203], v[144:147], v[156:159], 0
    v_cvt_pk_bf16_f32 v208, v160, v161
    v_cvt_pk_bf16_f32 v209, v162, v163
    ds_read_b64_tr_b16 v[126:127], v78 offset:47104
    v_mfma_f32_16x16x32_bf16 v[204:207], v[148:151], v[156:159], 0
    v_cvt_pk_bf16_f32 v210, v164, v165
    v_cvt_pk_bf16_f32 v211, v166, v167
    v_cvt_pk_bf16_f32 v212, v172, v173
    v_cvt_pk_bf16_f32 v213, v174, v175
    v_cvt_pk_bf16_f32 v214, v176, v177
    v_cvt_pk_bf16_f32 v215, v178, v179
    s_waitcnt lgkmcnt(0)
    s_barrier
    ds_read_b128 v[152:155], v54 offset:49152
    ds_read_b128 v[128:131], v62
    ds_read_b128 v[132:135], v63
    ds_read_b128 v[136:139], v64
    v_add_u32 v62, v62, v65
    v_add_u32 v63, v63, v66
    v_add_u32 v64, v64, v67
    ds_read_b128 v[156:159], v56 offset:49152
    ds_read_b128 v[140:143], v62
    ds_read_b128 v[144:147], v63
    ds_read_b128 v[148:151], v64
    v_add_u32 v62, v62, v65
    v_add_u32 v63, v63, v66
    v_add_u32 v64, v64, v67
    v_mfma_f32_16x16x32_bf16 v[80:83], v[20:23], v[208:211], v[80:83]
    v_add_f32 v224, s62, v192
    v_add_f32 v225, s62, v193
    v_mfma_f32_16x16x32_bf16 v[84:87], v[24:27], v[208:211], v[84:87]
    v_add_f32 v226, s62, v204
    v_add_f32 v227, s62, v205
    v_mfma_f32_16x16x32_bf16 v[88:91], v[28:31], v[208:211], v[88:91]
    v_rcp_f32 v224, v224
    v_rcp_f32 v225, v225
    v_mfma_f32_16x16x32_bf16 v[92:95], v[32:35], v[208:211], v[92:95]
    v_rcp_f32 v226, v226
    v_rcp_f32 v227, v227
    v_mfma_f32_16x16x32_bf16 v[80:83], v[36:39], v[212:215], v[80:83]
    v_mul_f32 v184, v184, v224
    v_mul_f32 v185, v185, v224
    v_mfma_f32_16x16x32_bf16 v[84:87], v[40:43], v[212:215], v[84:87]
    v_mul_f32 v186, v186, v224
    v_mul_f32 v187, v187, v224
    v_mfma_f32_16x16x32_bf16 v[88:91], v[44:47], v[212:215], v[88:91]
    v_mul_f32 v188, v188, v225
    v_mul_f32 v189, v189, v225
    v_mfma_f32_16x16x32_bf16 v[92:95], v[48:51], v[212:215], v[92:95]
    v_mul_f32 v190, v190, v225
    v_mul_f32 v191, v191, v225
    ds_read_b64_tr_b16 v[20:21], v69 offset:49152
    ds_read_b64_tr_b16 v[22:23], v69 offset:51200
    ds_read_b64_tr_b16 v[24:25], v72 offset:49152
    s_waitcnt lgkmcnt(9)
    v_mfma_f32_16x16x32_bf16 v[160:163], v[128:131], v[152:155], 0
    v_mul_f32 v196, v196, v226
    v_mul_f32 v197, v197, v226
    ds_read_b64_tr_b16 v[26:27], v72 offset:51200
    ds_read_b64_tr_b16 v[28:29], v75 offset:49152
    ds_read_b64_tr_b16 v[30:31], v75 offset:51200
    s_waitcnt lgkmcnt(11)
    v_mfma_f32_16x16x32_bf16 v[164:167], v[132:135], v[152:155], 0
    v_mul_f32 v198, v198, v226
    v_mul_f32 v199, v199, v226
    ds_read_b64_tr_b16 v[32:33], v78 offset:49152
    ds_read_b64_tr_b16 v[34:35], v78 offset:51200
    ds_read_b64_tr_b16 v[36:37], v69 offset:53248
    s_waitcnt lgkmcnt(13)
    v_mfma_f32_16x16x32_bf16 v[168:171], v[136:139], v[152:155], 0
    v_mul_f32 v200, v200, v227
    v_mul_f32 v201, v201, v227
    ds_read_b64_tr_b16 v[38:39], v69 offset:55296
    ds_read_b64_tr_b16 v[40:41], v72 offset:53248
    ds_read_b64_tr_b16 v[42:43], v72 offset:55296
    s_waitcnt lgkmcnt(14)
    v_mfma_f32_16x16x32_bf16 v[172:175], v[140:143], v[156:159], 0
    v_mul_f32 v202, v202, v227
    v_mul_f32 v203, v203, v227
    ds_read_b64_tr_b16 v[44:45], v75 offset:53248
    ds_read_b64_tr_b16 v[46:47], v75 offset:55296
    ds_read_b64_tr_b16 v[48:49], v78 offset:53248
    s_waitcnt lgkmcnt(15)
    v_mfma_f32_16x16x32_bf16 v[176:179], v[144:147], v[156:159], 0
    v_cvt_pk_bf16_f32 v216, v184, v185
    v_cvt_pk_bf16_f32 v217, v186, v187
    ds_read_b64_tr_b16 v[50:51], v78 offset:55296
    v_mfma_f32_16x16x32_bf16 v[180:183], v[148:151], v[156:159], 0
    v_cvt_pk_bf16_f32 v218, v188, v189
    v_cvt_pk_bf16_f32 v219, v190, v191
    v_cvt_pk_bf16_f32 v220, v196, v197
    v_cvt_pk_bf16_f32 v221, v198, v199
    v_cvt_pk_bf16_f32 v222, v200, v201
    v_cvt_pk_bf16_f32 v223, v202, v203
    ds_read_b128 v[152:155], v58 offset:49152
    ds_read_b128 v[128:131], v62
    ds_read_b128 v[132:135], v63
    ds_read_b128 v[136:139], v64
    v_add_u32 v62, v62, v65
    v_add_u32 v63, v63, v66
    v_add_u32 v64, v64, v67
    ds_read_b128 v[156:159], v60 offset:49152
    ds_read_b128 v[140:143], v62
    ds_read_b128 v[144:147], v63
    ds_read_b128 v[148:151], v64
    v_add_u32 v62, v62, v65
    v_add_u32 v63, v63, v66
    v_add_u32 v64, v64, v67
    v_mfma_f32_16x16x32_bf16 v[80:83], v[96:99], v[216:219], v[80:83]
    v_add_f32 v224, s62, v168
    v_add_f32 v225, s62, v169
    v_mfma_f32_16x16x32_bf16 v[84:87], v[100:103], v[216:219], v[84:87]
    v_add_f32 v226, s62, v180
    v_add_f32 v227, s62, v181
    v_mfma_f32_16x16x32_bf16 v[88:91], v[104:107], v[216:219], v[88:91]
    v_rcp_f32 v224, v224
    v_rcp_f32 v225, v225
    v_mfma_f32_16x16x32_bf16 v[92:95], v[108:111], v[216:219], v[92:95]
    v_rcp_f32 v226, v226
    v_rcp_f32 v227, v227
    v_mfma_f32_16x16x32_bf16 v[80:83], v[112:115], v[220:223], v[80:83]
    v_mul_f32 v160, v160, v224
    v_mul_f32 v161, v161, v224
    v_mfma_f32_16x16x32_bf16 v[84:87], v[116:119], v[220:223], v[84:87]
    v_mul_f32 v162, v162, v224
    v_mul_f32 v163, v163, v224
    v_mfma_f32_16x16x32_bf16 v[88:91], v[120:123], v[220:223], v[88:91]
    v_mul_f32 v164, v164, v225
    v_mul_f32 v165, v165, v225
    v_mfma_f32_16x16x32_bf16 v[92:95], v[124:127], v[220:223], v[92:95]
    v_mul_f32 v166, v166, v225
    v_mul_f32 v167, v167, v225
    ds_read_b64_tr_b16 v[96:97], v69 offset:57344
    ds_read_b64_tr_b16 v[98:99], v69 offset:59392
    ds_read_b64_tr_b16 v[100:101], v72 offset:57344
    s_waitcnt lgkmcnt(9)
    v_mfma_f32_16x16x32_bf16 v[184:187], v[128:131], v[152:155], 0
    v_mul_f32 v172, v172, v226
    v_mul_f32 v173, v173, v226
    ds_read_b64_tr_b16 v[102:103], v72 offset:59392
    ds_read_b64_tr_b16 v[104:105], v75 offset:57344
    ds_read_b64_tr_b16 v[106:107], v75 offset:59392
    s_waitcnt lgkmcnt(11)
    v_mfma_f32_16x16x32_bf16 v[188:191], v[132:135], v[152:155], 0
    v_mul_f32 v174, v174, v226
    v_mul_f32 v175, v175, v226
    ds_read_b64_tr_b16 v[108:109], v78 offset:57344
    ds_read_b64_tr_b16 v[110:111], v78 offset:59392
    ds_read_b64_tr_b16 v[112:113], v69 offset:61440
    s_waitcnt lgkmcnt(13)
    v_mfma_f32_16x16x32_bf16 v[192:195], v[136:139], v[152:155], 0
    v_mul_f32 v176, v176, v227
    v_mul_f32 v177, v177, v227
    ds_read_b64_tr_b16 v[114:115], v69 offset:63488
    ds_read_b64_tr_b16 v[116:117], v72 offset:61440
    ds_read_b64_tr_b16 v[118:119], v72 offset:63488
    s_waitcnt lgkmcnt(14)
    v_mfma_f32_16x16x32_bf16 v[196:199], v[140:143], v[156:159], 0
    v_mul_f32 v178, v178, v227
    v_mul_f32 v179, v179, v227
    ds_read_b64_tr_b16 v[120:121], v75 offset:61440
    ds_read_b64_tr_b16 v[122:123], v75 offset:63488
    ds_read_b64_tr_b16 v[124:125], v78 offset:61440
    s_waitcnt lgkmcnt(15)
    v_mfma_f32_16x16x32_bf16 v[200:203], v[144:147], v[156:159], 0
    v_cvt_pk_bf16_f32 v208, v160, v161
    v_cvt_pk_bf16_f32 v209, v162, v163
    ds_read_b64_tr_b16 v[126:127], v78 offset:63488
    v_mfma_f32_16x16x32_bf16 v[204:207], v[148:151], v[156:159], 0
    v_cvt_pk_bf16_f32 v210, v164, v165
    v_cvt_pk_bf16_f32 v211, v166, v167
    v_cvt_pk_bf16_f32 v212, v172, v173
    v_cvt_pk_bf16_f32 v213, v174, v175
    v_cvt_pk_bf16_f32 v214, v176, v177
    v_cvt_pk_bf16_f32 v215, v178, v179
    v_mfma_f32_16x16x32_bf16 v[80:83], v[20:23], v[208:211], v[80:83]
    v_add_f32 v224, s62, v192
    v_add_f32 v225, s62, v193
    v_mfma_f32_16x16x32_bf16 v[84:87], v[24:27], v[208:211], v[84:87]
    v_add_f32 v226, s62, v204
    v_add_f32 v227, s62, v205
    v_mfma_f32_16x16x32_bf16 v[88:91], v[28:31], v[208:211], v[88:91]
    v_rcp_f32 v224, v224
    v_rcp_f32 v225, v225
    v_mfma_f32_16x16x32_bf16 v[92:95], v[32:35], v[208:211], v[92:95]
    v_rcp_f32 v226, v226
    v_rcp_f32 v227, v227
    v_mfma_f32_16x16x32_bf16 v[80:83], v[36:39], v[212:215], v[80:83]
    v_mul_f32 v184, v184, v224
    v_mul_f32 v185, v185, v224
    v_mfma_f32_16x16x32_bf16 v[84:87], v[40:43], v[212:215], v[84:87]
    v_mul_f32 v186, v186, v224
    v_mul_f32 v187, v187, v224
    v_mfma_f32_16x16x32_bf16 v[88:91], v[44:47], v[212:215], v[88:91]
    v_mul_f32 v188, v188, v225
    v_mul_f32 v189, v189, v225
    v_mfma_f32_16x16x32_bf16 v[92:95], v[48:51], v[212:215], v[92:95]
    v_mul_f32 v190, v190, v225
    v_mul_f32 v191, v191, v225
    v_mul_f32 v196, v196, v226
    v_mul_f32 v197, v197, v226
    v_mul_f32 v198, v198, v226
    v_mul_f32 v199, v199, v226
    v_mul_f32 v200, v200, v227
    v_mul_f32 v201, v201, v227
    v_mul_f32 v202, v202, v227
    v_mul_f32 v203, v203, v227
    v_cvt_pk_bf16_f32 v216, v184, v185
    v_cvt_pk_bf16_f32 v217, v186, v187
    v_cvt_pk_bf16_f32 v218, v188, v189
    v_cvt_pk_bf16_f32 v219, v190, v191
    v_cvt_pk_bf16_f32 v220, v196, v197
    v_cvt_pk_bf16_f32 v221, v198, v199
    v_cvt_pk_bf16_f32 v222, v200, v201
    v_cvt_pk_bf16_f32 v223, v202, v203
    s_waitcnt lgkmcnt(14)
    v_mfma_f32_16x16x32_bf16 v[80:83], v[96:99], v[216:219], v[80:83]
    s_waitcnt lgkmcnt(12)
    v_mfma_f32_16x16x32_bf16 v[84:87], v[100:103], v[216:219], v[84:87]
    s_waitcnt lgkmcnt(10)
    v_mfma_f32_16x16x32_bf16 v[88:91], v[104:107], v[216:219], v[88:91]
    s_waitcnt lgkmcnt(8)
    v_mfma_f32_16x16x32_bf16 v[92:95], v[108:111], v[216:219], v[92:95]
    s_waitcnt lgkmcnt(6)
    v_mfma_f32_16x16x32_bf16 v[80:83], v[112:115], v[220:223], v[80:83]
    s_waitcnt lgkmcnt(4)
    v_mfma_f32_16x16x32_bf16 v[84:87], v[116:119], v[220:223], v[84:87]
    s_waitcnt lgkmcnt(2)
    v_mfma_f32_16x16x32_bf16 v[88:91], v[120:123], v[220:223], v[88:91]
    s_waitcnt lgkmcnt(0)
    v_mfma_f32_16x16x32_bf16 v[92:95], v[124:127], v[220:223], v[92:95]
    s_barrier
    v_add_u32 v228, s52, v2
    v_mul_u32_u24 v228, 144, v228
    v_lshl_add_u32 v228, v3, 3, v228
    v_cvt_pk_bf16_f32 v80, v80, v81
    v_cvt_pk_bf16_f32 v81, v82, v83
    ds_write_b64 v228, v[80:81] offset:0
    v_cvt_pk_bf16_f32 v84, v84, v85
    v_cvt_pk_bf16_f32 v85, v86, v87
    ds_write_b64 v228, v[84:85] offset:32
    v_cvt_pk_bf16_f32 v88, v88, v89
    v_cvt_pk_bf16_f32 v89, v90, v91
    ds_write_b64 v228, v[88:89] offset:64
    v_cvt_pk_bf16_f32 v92, v92, v93
    v_cvt_pk_bf16_f32 v93, v94, v95
    ds_write_b64 v228, v[92:93] offset:96
    s_waitcnt lgkmcnt(0)
    s_add_u32 s40, s20, 2097152
    s_addc_u32 s41, s21, 0
    s_and_b32 s41, s41, 0xffff
    s_mov_b32 s42, 2097152
    s_mov_b32 s43, 0x20000
    s_add_u32 s44, s20, 15073280
    s_addc_u32 s45, s21, 0
    s_and_b32 s45, s45, 0xffff
    s_mov_b32 s46, 131072
    s_mov_b32 s47, 0x20000
    s_barrier
    v_lshrrev_b32 v42, 3, v0
    v_and_b32 v43, 7, v0
    v_mul_u32_u24 v32, 144, v42
    v_lshl_add_u32 v32, v43, 4, v32
    ds_read_b128 v[24:27], v32
    ds_read_b128 v[28:31], v32 offset:4608
    v_add_u32 v42, s50, v42
    v_lshlrev_b32 v33, 10, v42
    v_lshl_add_u32 v33, v43, 4, v33
    v_add_u32 v33, s54, v33
    v_mov_b32 v36, 0
    v_mov_b32 v37, 0
    v_mov_b32 v38, 0
    v_mov_b32 v39, 0
    s_mov_b32 s60, 0x3f803f80
    v_lshlrev_b32 v32, 6, v42
    s_lshr_b32 s61, s54, 4
    v_add_u32 v32, s61, v32
    s_waitcnt lgkmcnt(1)
    v_lshlrev_b32 v42, 16, v24
    v_and_b32 v43, 0xffff0000, v24
    s_waitcnt vmcnt(1)
    v_lshlrev_b32 v44, 16, v12
    v_and_b32 v45, 0xffff0000, v12
    v_add_f32 v42, v42, v44
    v_add_f32 v43, v43, v45
    v_cvt_pk_bf16_f32 v24, v42, v43
    v_dot2_f32_bf16 v36, v24, s60, v36
    v_dot2_f32_bf16 v37, v24, v24, v37
    v_lshlrev_b32 v42, 16, v25
    v_and_b32 v43, 0xffff0000, v25
    v_lshlrev_b32 v44, 16, v13
    v_and_b32 v45, 0xffff0000, v13
    v_add_f32 v42, v42, v44
    v_add_f32 v43, v43, v45
    v_cvt_pk_bf16_f32 v25, v42, v43
    v_dot2_f32_bf16 v36, v25, s60, v36
    v_dot2_f32_bf16 v37, v25, v25, v37
    v_lshlrev_b32 v42, 16, v26
    v_and_b32 v43, 0xffff0000, v26
    v_lshlrev_b32 v44, 16, v14
    v_and_b32 v45, 0xffff0000, v14
    v_add_f32 v42, v42, v44
    v_add_f32 v43, v43, v45
    v_cvt_pk_bf16_f32 v26, v42, v43
    v_dot2_f32_bf16 v36, v26, s60, v36
    v_dot2_f32_bf16 v37, v26, v26, v37
    v_lshlrev_b32 v42, 16, v27
    v_and_b32 v43, 0xffff0000, v27
    v_lshlrev_b32 v44, 16, v15
    v_and_b32 v45, 0xffff0000, v15
    v_add_f32 v42, v42, v44
    v_add_f32 v43, v43, v45
    v_cvt_pk_bf16_f32 v27, v42, v43
    v_dot2_f32_bf16 v36, v27, s60, v36
    v_dot2_f32_bf16 v37, v27, v27, v37
    s_waitcnt lgkmcnt(0)
    v_lshlrev_b32 v42, 16, v28
    v_and_b32 v43, 0xffff0000, v28
    s_waitcnt vmcnt(0)
    v_lshlrev_b32 v44, 16, v16
    v_and_b32 v45, 0xffff0000, v16
    v_add_f32 v42, v42, v44
    v_add_f32 v43, v43, v45
    v_cvt_pk_bf16_f32 v28, v42, v43
    v_dot2_f32_bf16 v38, v28, s60, v38
    v_dot2_f32_bf16 v39, v28, v28, v39
    v_lshlrev_b32 v42, 16, v29
    v_and_b32 v43, 0xffff0000, v29
    v_lshlrev_b32 v44, 16, v17
    v_and_b32 v45, 0xffff0000, v17
    v_add_f32 v42, v42, v44
    v_add_f32 v43, v43, v45
    v_cvt_pk_bf16_f32 v29, v42, v43
    v_dot2_f32_bf16 v38, v29, s60, v38
    v_dot2_f32_bf16 v39, v29, v29, v39
    v_lshlrev_b32 v42, 16, v30
    v_and_b32 v43, 0xffff0000, v30
    v_lshlrev_b32 v44, 16, v18
    v_and_b32 v45, 0xffff0000, v18
    v_add_f32 v42, v42, v44
    v_add_f32 v43, v43, v45
    v_cvt_pk_bf16_f32 v30, v42, v43
    v_dot2_f32_bf16 v38, v30, s60, v38
    v_dot2_f32_bf16 v39, v30, v30, v39
    v_lshlrev_b32 v42, 16, v31
    v_and_b32 v43, 0xffff0000, v31
    v_lshlrev_b32 v44, 16, v19
    v_and_b32 v45, 0xffff0000, v19
    v_add_f32 v42, v42, v44
    v_add_f32 v43, v43, v45
    v_cvt_pk_bf16_f32 v31, v42, v43
    v_dot2_f32_bf16 v38, v31, s60, v38
    v_dot2_f32_bf16 v39, v31, v31, v39
    v_add_f32_dpp v40, v36, v36 quad_perm:[1,0,3,2] row_mask:0xf bank_mask:0xf
    v_add_f32_dpp v41, v37, v37 quad_perm:[1,0,3,2] row_mask:0xf bank_mask:0xf
    v_mov_b32 v36, v40
    v_mov_b32 v37, v41
    v_add_f32_dpp v40, v38, v38 quad_perm:[1,0,3,2] row_mask:0xf bank_mask:0xf
    v_add_f32_dpp v41, v39, v39 quad_perm:[1,0,3,2] row_mask:0xf bank_mask:0xf
    v_mov_b32 v38, v40
    v_mov_b32 v39, v41
    v_add_f32_dpp v40, v36, v36 quad_perm:[2,3,0,1] row_mask:0xf bank_mask:0xf
    v_add_f32_dpp v41, v37, v37 quad_perm:[2,3,0,1] row_mask:0xf bank_mask:0xf
    v_mov_b32 v36, v40
    v_mov_b32 v37, v41
    v_add_f32_dpp v40, v38, v38 quad_perm:[2,3,0,1] row_mask:0xf bank_mask:0xf
    v_add_f32_dpp v41, v39, v39 quad_perm:[2,3,0,1] row_mask:0xf bank_mask:0xf
    v_mov_b32 v38, v40
    v_mov_b32 v39, v41
    v_add_f32_dpp v40, v36, v36 row_half_mirror row_mask:0xf bank_mask:0xf
    v_add_f32_dpp v41, v37, v37 row_half_mirror row_mask:0xf bank_mask:0xf
    v_mov_b32 v36, v40
    v_mov_b32 v37, v41
    v_add_f32_dpp v40, v38, v38 row_half_mirror row_mask:0xf bank_mask:0xf
    v_add_f32_dpp v41, v39, v39 row_half_mirror row_mask:0xf bank_mask:0xf
    v_mov_b32 v38, v40
    v_mov_b32 v39, v41
    s_mov_b32 s60, 32768
    v_mov_b32 v8, 148480
    ds_read_b32 v9, v8
    s_waitcnt lgkmcnt(0)
    v_readfirstlane_b32 s99, v9
    s_waitcnt vmcnt(0) lgkmcnt(0)
    s_nop 4
    s_cmp_eq_u32 s99, 1
    s_cbranch_scc0 kC_kernel_st0_slow
    buffer_store_dwordx4 v[24:27], v33, s[40:43], 0 offen
    buffer_store_dwordx4 v[28:31], v33, s[40:43], s60 offen
    buffer_store_dwordx2 v[36:37], v32, s[44:47], 0 offen
    buffer_store_dwordx2 v[38:39], v32, s[44:47], 0 offen offset:2048
    s_branch kC_kernel_st0_done
kC_kernel_st0_slow:
    buffer_store_dwordx4 v[24:27], v33, s[40:43], 0 offen sc0 sc1
    buffer_store_dwordx4 v[28:31], v33, s[40:43], s60 offen sc0 sc1
    buffer_store_dwordx2 v[36:37], v32, s[44:47], 0 offen sc0 sc1
    buffer_store_dwordx2 v[38:39], v32, s[44:47], 0 offen offset:2048 sc0 sc1
kC_kernel_st0_done:
    s_waitcnt vmcnt(0)
    s_barrier
    s_mov_b32 s22, s96
    s_mov_b32 s23, s97
    s_lshl_b32 s50, s22, 7
    s_mul_i32 s54, s23, 224
    s_lshl_b32 s52, s3, 5
    v_lshlrev_b32 v40, 4, v3
    v_add_u32 v40, 154624, v40
    v_add_u32 v5, s52, v2
    v_mul_u32_u24 v5, 128, v5
    v_bfe_u32 v6, v2, 1, 3
    v_xor_b32 v6, v6, v3
    v_xor_b32 v41, 0, v6
    v_lshl_add_u32 v41, v41, 4, v5
    v_xor_b32 v42, 4, v6
    v_lshl_add_u32 v42, v42, 4, v5
    v_bfe_u32 v5, v1, 2, 2
    v_and_b32 v6, 1, v3
    v_lshl_add_u32 v6, v6, 2, v5
    v_lshl_add_u32 v5, v3, 3, v5
    v_lshlrev_b32 v5, 8, v5
    v_and_b32 v7, 3, v1
    v_lshl_add_u32 v5, v7, 3, v5
    v_add_u32 v5, 65536, v5
    v_xor_b32 v7, 0, v6
    v_lshl_add_u32 v43, v7, 5, v5
    v_add_u32 v44, 65536, v43
    v_xor_b32 v7, 1, v6
    v_lshl_add_u32 v45, v7, 5, v5
    v_add_u32 v46, 65536, v45
    v_xor_b32 v7, 2, v6
    v_lshl_add_u32 v47, v7, 5, v5
    v_add_u32 v48, 65536, v47
    v_xor_b32 v7, 3, v6
    v_lshl_add_u32 v49, v7, 5, v5
    v_add_u32 v50, 65536, v49
    v_xor_b32 v7, 4, v6
    v_lshl_add_u32 v51, v7, 5, v5
    v_add_u32 v52, 65536, v51
    v_xor_b32 v7, 5, v6
    v_lshl_add_u32 v53, v7, 5, v5
    v_add_u32 v54, 65536, v53
    v_xor_b32 v7, 6, v6
    v_lshl_add_u32 v55, v7, 5, v5
    v_add_u32 v56, 65536, v55
    v_mov_b32 v60, 0
    v_mov_b32 v61, 0
    v_mov_b32 v62, 0
    v_mov_b32 v63, 0
    v_mov_b32 v64, 0
    v_mov_b32 v65, 0
    v_mov_b32 v66, 0
    v_mov_b32 v67, 0
    v_mov_b32 v68, 0
    v_mov_b32 v69, 0
    v_mov_b32 v70, 0
    v_mov_b32 v71, 0
    v_mov_b32 v72, 0
    v_mov_b32 v73, 0
    v_mov_b32 v74, 0
    v_mov_b32 v75, 0
    v_mov_b32 v76, 0
    v_mov_b32 v77, 0
    v_mov_b32 v78, 0
    v_mov_b32 v79, 0
    v_mov_b32 v80, 0
    v_mov_b32 v81, 0
    v_mov_b32 v82, 0
    v_mov_b32 v83, 0
    v_mov_b32 v84, 0
    v_mov_b32 v85, 0
    v_mov_b32 v86, 0
    v_mov_b32 v87, 0
    v_mov_b32 v88, 0
    v_mov_b32 v89, 0
    v_mov_b32 v90, 0
    v_mov_b32 v91, 0
    v_mov_b32 v92, 0
    v_mov_b32 v93, 0
    v_mov_b32 v94, 0
    v_mov_b32 v95, 0
    v_mov_b32 v96, 0
    v_mov_b32 v97, 0
    v_mov_b32 v98, 0
    v_mov_b32 v99, 0
    v_mov_b32 v100, 0
    v_mov_b32 v101, 0
    v_mov_b32 v102, 0
    v_mov_b32 v103, 0
    v_mov_b32 v104, 0
    v_mov_b32 v105, 0
    v_mov_b32 v106, 0
    v_mov_b32 v107, 0
    v_mov_b32 v108, 0
    v_mov_b32 v109, 0
    v_mov_b32 v110, 0
    v_mov_b32 v111, 0
    v_mov_b32 v112, 0
    v_mov_b32 v113, 0
    v_mov_b32 v114, 0
    v_mov_b32 v115, 0
    v_add_u32 v192, s52, v2
    v_lshlrev_b32 v192, 3, v192
    v_add_u32 v192, 147456, v192
    s_barrier
    ds_read_b128 v[116:119], v41 offset:0
    ds_read_b128 v[120:123], v41 offset:2048
    ds_read_b64_tr_b16 v[132:133], v43 offset:0
    ds_read_b64_tr_b16 v[134:135], v43 offset:1024
    ds_read_b64_tr_b16 v[136:137], v45 offset:0
    ds_read_b64_tr_b16 v[138:139], v45 offset:1024
    ds_read_b64_tr_b16 v[140:141], v47 offset:0
    ds_read_b64_tr_b16 v[142:143], v47 offset:1024
    ds_read_b64_tr_b16 v[144:145], v49 offset:0
    ds_read_b64_tr_b16 v[146:147], v49 offset:1024
    ds_read_b64_tr_b16 v[148:149], v51 offset:0
    ds_read_b64_tr_b16 v[150:151], v51 offset:1024
    ds_read_b64_tr_b16 v[152:153], v53 offset:0
    ds_read_b64_tr_b16 v[154:155], v53 offset:1024
    ds_read_b64_tr_b16 v[156:157], v55 offset:0
    ds_read_b64_tr_b16 v[158:159], v55 offset:1024
    ds_read_b128 v[124:127], v42 offset:0
    ds_read_b128 v[128:131], v42 offset:2048
    s_waitcnt lgkmcnt(14)
    v_mfma_f32_16x16x32_bf16 v[60:63], v[132:135], v[116:119], v[60:63]
    ds_read_b64_tr_b16 v[160:161], v43 offset:8192
    v_mfma_f32_16x16x32_bf16 v[88:91], v[132:135], v[120:123], v[88:91]
    ds_read_b64_tr_b16 v[162:163], v43 offset:9216
    s_waitcnt lgkmcnt(14)
    v_mfma_f32_16x16x32_bf16 v[64:67], v[136:139], v[116:119], v[64:67]
    ds_read_b64_tr_b16 v[164:165], v45 offset:8192
    v_mfma_f32_16x16x32_bf16 v[92:95], v[136:139], v[120:123], v[92:95]
    ds_read_b64_tr_b16 v[166:167], v45 offset:9216
    s_waitcnt lgkmcnt(14)
    v_mfma_f32_16x16x32_bf16 v[68:71], v[140:143], v[116:119], v[68:71]
    ds_read_b64_tr_b16 v[168:169], v47 offset:8192
    v_mfma_f32_16x16x32_bf16 v[96:99], v[140:143], v[120:123], v[96:99]
    ds_read_b64_tr_b16 v[170:171], v47 offset:9216
    s_waitcnt lgkmcnt(14)
    v_mfma_f32_16x16x32_bf16 v[72:75], v[144:147], v[116:119], v[72:75]
    ds_read_b64_tr_b16 v[172:173], v49 offset:8192
    v_mfma_f32_16x16x32_bf16 v[100:103], v[144:147], v[120:123], v[100:103]
    ds_read_b64_tr_b16 v[174:175], v49 offset:9216
    s_waitcnt lgkmcnt(14)
    v_mfma_f32_16x16x32_bf16 v[76:79], v[148:151], v[116:119], v[76:79]
    ds_read_b64_tr_b16 v[176:177], v51 offset:8192
    v_mfma_f32_16x16x32_bf16 v[104:107], v[148:151], v[120:123], v[104:107]
    ds_read_b64_tr_b16 v[178:179], v51 offset:9216
    s_waitcnt lgkmcnt(14)
    v_mfma_f32_16x16x32_bf16 v[80:83], v[152:155], v[116:119], v[80:83]
    ds_read_b64_tr_b16 v[180:181], v53 offset:8192
    v_mfma_f32_16x16x32_bf16 v[108:111], v[152:155], v[120:123], v[108:111]
    ds_read_b64_tr_b16 v[182:183], v53 offset:9216
    s_waitcnt lgkmcnt(14)
    v_mfma_f32_16x16x32_bf16 v[84:87], v[156:159], v[116:119], v[84:87]
    ds_read_b64_tr_b16 v[184:185], v55 offset:8192
    v_mfma_f32_16x16x32_bf16 v[112:115], v[156:159], v[120:123], v[112:115]
    ds_read_b64_tr_b16 v[186:187], v55 offset:9216
    s_waitcnt lgkmcnt(0)
    s_barrier
    ds_read_b128 v[116:119], v41 offset:16384
    ds_read_b128 v[120:123], v41 offset:18432
    v_mfma_f32_16x16x32_bf16 v[60:63], v[160:163], v[124:127], v[60:63]
    ds_read_b64_tr_b16 v[132:133], v43 offset:16384
    v_mfma_f32_16x16x32_bf16 v[88:91], v[160:163], v[128:131], v[88:91]
    ds_read_b64_tr_b16 v[134:135], v43 offset:17408
    v_mfma_f32_16x16x32_bf16 v[64:67], v[164:167], v[124:127], v[64:67]
    ds_read_b64_tr_b16 v[136:137], v45 offset:16384
    v_mfma_f32_16x16x32_bf16 v[92:95], v[164:167], v[128:131], v[92:95]
    ds_read_b64_tr_b16 v[138:139], v45 offset:17408
    v_mfma_f32_16x16x32_bf16 v[68:71], v[168:171], v[124:127], v[68:71]
    ds_read_b64_tr_b16 v[140:141], v47 offset:16384
    v_mfma_f32_16x16x32_bf16 v[96:99], v[168:171], v[128:131], v[96:99]
    ds_read_b64_tr_b16 v[142:143], v47 offset:17408
    v_mfma_f32_16x16x32_bf16 v[72:75], v[172:175], v[124:127], v[72:75]
    ds_read_b64_tr_b16 v[144:145], v49 offset:16384
    v_mfma_f32_16x16x32_bf16 v[100:103], v[172:175], v[128:131], v[100:103]
    ds_read_b64_tr_b16 v[146:147], v49 offset:17408
    v_mfma_f32_16x16x32_bf16 v[76:79], v[176:179], v[124:127], v[76:79]
    ds_read_b64_tr_b16 v[148:149], v51 offset:16384
    v_mfma_f32_16x16x32_bf16 v[104:107], v[176:179], v[128:131], v[104:107]
    ds_read_b64_tr_b16 v[150:151], v51 offset:17408
    v_mfma_f32_16x16x32_bf16 v[80:83], v[180:183], v[124:127], v[80:83]
    ds_read_b64_tr_b16 v[152:153], v53 offset:16384
    v_mfma_f32_16x16x32_bf16 v[108:111], v[180:183], v[128:131], v[108:111]
    ds_read_b64_tr_b16 v[154:155], v53 offset:17408
    v_mfma_f32_16x16x32_bf16 v[84:87], v[184:187], v[124:127], v[84:87]
    ds_read_b64_tr_b16 v[156:157], v55 offset:16384
    v_mfma_f32_16x16x32_bf16 v[112:115], v[184:187], v[128:131], v[112:115]
    ds_read_b64_tr_b16 v[158:159], v55 offset:17408
    ds_read_b128 v[124:127], v42 offset:16384
    ds_read_b128 v[128:131], v42 offset:18432
    s_waitcnt lgkmcnt(14)
    v_mfma_f32_16x16x32_bf16 v[60:63], v[132:135], v[116:119], v[60:63]
    ds_read_b64_tr_b16 v[160:161], v43 offset:24576
    v_mfma_f32_16x16x32_bf16 v[88:91], v[132:135], v[120:123], v[88:91]
    ds_read_b64_tr_b16 v[162:163], v43 offset:25600
    s_waitcnt lgkmcnt(14)
    v_mfma_f32_16x16x32_bf16 v[64:67], v[136:139], v[116:119], v[64:67]
    ds_read_b64_tr_b16 v[164:165], v45 offset:24576
    v_mfma_f32_16x16x32_bf16 v[92:95], v[136:139], v[120:123], v[92:95]
    ds_read_b64_tr_b16 v[166:167], v45 offset:25600
    s_waitcnt lgkmcnt(14)
    v_mfma_f32_16x16x32_bf16 v[68:71], v[140:143], v[116:119], v[68:71]
    ds_read_b64_tr_b16 v[168:169], v47 offset:24576
    v_mfma_f32_16x16x32_bf16 v[96:99], v[140:143], v[120:123], v[96:99]
    ds_read_b64_tr_b16 v[170:171], v47 offset:25600
    s_waitcnt lgkmcnt(14)
    v_mfma_f32_16x16x32_bf16 v[72:75], v[144:147], v[116:119], v[72:75]
    ds_read_b64_tr_b16 v[172:173], v49 offset:24576
    v_mfma_f32_16x16x32_bf16 v[100:103], v[144:147], v[120:123], v[100:103]
    ds_read_b64_tr_b16 v[174:175], v49 offset:25600
    s_waitcnt lgkmcnt(14)
    v_mfma_f32_16x16x32_bf16 v[76:79], v[148:151], v[116:119], v[76:79]
    ds_read_b64_tr_b16 v[176:177], v51 offset:24576
    v_mfma_f32_16x16x32_bf16 v[104:107], v[148:151], v[120:123], v[104:107]
    ds_read_b64_tr_b16 v[178:179], v51 offset:25600
    s_waitcnt lgkmcnt(14)
    v_mfma_f32_16x16x32_bf16 v[80:83], v[152:155], v[116:119], v[80:83]
    ds_read_b64_tr_b16 v[180:181], v53 offset:24576
    v_mfma_f32_16x16x32_bf16 v[108:111], v[152:155], v[120:123], v[108:111]
    ds_read_b64_tr_b16 v[182:183], v53 offset:25600
    s_waitcnt lgkmcnt(14)
    v_mfma_f32_16x16x32_bf16 v[84:87], v[156:159], v[116:119], v[84:87]
    ds_read_b64_tr_b16 v[184:185], v55 offset:24576
    v_mfma_f32_16x16x32_bf16 v[112:115], v[156:159], v[120:123], v[112:115]
    ds_read_b64_tr_b16 v[186:187], v55 offset:25600
    s_waitcnt lgkmcnt(0)
    s_barrier
    ds_read_b128 v[116:119], v41 offset:32768
    ds_read_b128 v[120:123], v41 offset:34816
    v_mfma_f32_16x16x32_bf16 v[60:63], v[160:163], v[124:127], v[60:63]
    ds_read_b64_tr_b16 v[132:133], v43 offset:32768
    v_mfma_f32_16x16x32_bf16 v[88:91], v[160:163], v[128:131], v[88:91]
    ds_read_b64_tr_b16 v[134:135], v43 offset:33792
    v_mfma_f32_16x16x32_bf16 v[64:67], v[164:167], v[124:127], v[64:67]
    ds_read_b64_tr_b16 v[136:137], v45 offset:32768
    v_mfma_f32_16x16x32_bf16 v[92:95], v[164:167], v[128:131], v[92:95]
    ds_read_b64_tr_b16 v[138:139], v45 offset:33792
    v_mfma_f32_16x16x32_bf16 v[68:71], v[168:171], v[124:127], v[68:71]
    ds_read_b64_tr_b16 v[140:141], v47 offset:32768
    v_mfma_f32_16x16x32_bf16 v[96:99], v[168:171], v[128:131], v[96:99]
    ds_read_b64_tr_b16 v[142:143], v47 offset:33792
    v_mfma_f32_16x16x32_bf16 v[72:75], v[172:175], v[124:127], v[72:75]
    ds_read_b64_tr_b16 v[144:145], v49 offset:32768
    v_mfma_f32_16x16x32_bf16 v[100:103], v[172:175], v[128:131], v[100:103]
    ds_read_b64_tr_b16 v[146:147], v49 offset:33792
    v_mfma_f32_16x16x32_bf16 v[76:79], v[176:179], v[124:127], v[76:79]
    ds_read_b64_tr_b16 v[148:149], v51 offset:32768
    v_mfma_f32_16x16x32_bf16 v[104:107], v[176:179], v[128:131], v[104:107]
    ds_read_b64_tr_b16 v[150:151], v51 offset:33792
    v_mfma_f32_16x16x32_bf16 v[80:83], v[180:183], v[124:127], v[80:83]
    ds_read_b64_tr_b16 v[152:153], v53 offset:32768
    v_mfma_f32_16x16x32_bf16 v[108:111], v[180:183], v[128:131], v[108:111]
    ds_read_b64_tr_b16 v[154:155], v53 offset:33792
    v_mfma_f32_16x16x32_bf16 v[84:87], v[184:187], v[124:127], v[84:87]
    ds_read_b64_tr_b16 v[156:157], v55 offset:32768
    v_mfma_f32_16x16x32_bf16 v[112:115], v[184:187], v[128:131], v[112:115]
    ds_read_b64_tr_b16 v[158:159], v55 offset:33792
    ds_read_b128 v[124:127], v42 offset:32768
    ds_read_b128 v[128:131], v42 offset:34816
    s_waitcnt lgkmcnt(14)
    v_mfma_f32_16x16x32_bf16 v[60:63], v[132:135], v[116:119], v[60:63]
    ds_read_b64_tr_b16 v[160:161], v43 offset:40960
    v_mfma_f32_16x16x32_bf16 v[88:91], v[132:135], v[120:123], v[88:91]
    ds_read_b64_tr_b16 v[162:163], v43 offset:41984
    s_waitcnt lgkmcnt(14)
    v_mfma_f32_16x16x32_bf16 v[64:67], v[136:139], v[116:119], v[64:67]
    ds_read_b64_tr_b16 v[164:165], v45 offset:40960
    v_mfma_f32_16x16x32_bf16 v[92:95], v[136:139], v[120:123], v[92:95]
    ds_read_b64_tr_b16 v[166:167], v45 offset:41984
    s_waitcnt lgkmcnt(14)
    v_mfma_f32_16x16x32_bf16 v[68:71], v[140:143], v[116:119], v[68:71]
    ds_read_b64_tr_b16 v[168:169], v47 offset:40960
    v_mfma_f32_16x16x32_bf16 v[96:99], v[140:143], v[120:123], v[96:99]
    ds_read_b64_tr_b16 v[170:171], v47 offset:41984
    s_waitcnt lgkmcnt(14)
    v_mfma_f32_16x16x32_bf16 v[72:75], v[144:147], v[116:119], v[72:75]
    ds_read_b64_tr_b16 v[172:173], v49 offset:40960
    v_mfma_f32_16x16x32_bf16 v[100:103], v[144:147], v[120:123], v[100:103]
    ds_read_b64_tr_b16 v[174:175], v49 offset:41984
    s_waitcnt lgkmcnt(14)
    v_mfma_f32_16x16x32_bf16 v[76:79], v[148:151], v[116:119], v[76:79]
    ds_read_b64_tr_b16 v[176:177], v51 offset:40960
    v_mfma_f32_16x16x32_bf16 v[104:107], v[148:151], v[120:123], v[104:107]
    ds_read_b64_tr_b16 v[178:179], v51 offset:41984
    s_waitcnt lgkmcnt(14)
    v_mfma_f32_16x16x32_bf16 v[80:83], v[152:155], v[116:119], v[80:83]
    ds_read_b64_tr_b16 v[180:181], v53 offset:40960
    v_mfma_f32_16x16x32_bf16 v[108:111], v[152:155], v[120:123], v[108:111]
    ds_read_b64_tr_b16 v[182:183], v53 offset:41984
    s_waitcnt lgkmcnt(14)
    v_mfma_f32_16x16x32_bf16 v[84:87], v[156:159], v[116:119], v[84:87]
    ds_read_b64_tr_b16 v[184:185], v55 offset:40960
    v_mfma_f32_16x16x32_bf16 v[112:115], v[156:159], v[120:123], v[112:115]
    ds_read_b64_tr_b16 v[186:187], v55 offset:41984
    s_waitcnt lgkmcnt(0)
    s_barrier
    ds_read_b128 v[116:119], v41 offset:49152
    ds_read_b128 v[120:123], v41 offset:51200
    v_mfma_f32_16x16x32_bf16 v[60:63], v[160:163], v[124:127], v[60:63]
    ds_read_b64_tr_b16 v[132:133], v43 offset:49152
    v_mfma_f32_16x16x32_bf16 v[88:91], v[160:163], v[128:131], v[88:91]
    ds_read_b64_tr_b16 v[134:135], v43 offset:50176
    v_mfma_f32_16x16x32_bf16 v[64:67], v[164:167], v[124:127], v[64:67]
    ds_read_b64_tr_b16 v[136:137], v45 offset:49152
    v_mfma_f32_16x16x32_bf16 v[92:95], v[164:167], v[128:131], v[92:95]
    ds_read_b64_tr_b16 v[138:139], v45 offset:50176
    v_mfma_f32_16x16x32_bf16 v[68:71], v[168:171], v[124:127], v[68:71]
    ds_read_b64_tr_b16 v[140:141], v47 offset:49152
    v_mfma_f32_16x16x32_bf16 v[96:99], v[168:171], v[128:131], v[96:99]
    ds_read_b64_tr_b16 v[142:143], v47 offset:50176
    v_mfma_f32_16x16x32_bf16 v[72:75], v[172:175], v[124:127], v[72:75]
    ds_read_b64_tr_b16 v[144:145], v49 offset:49152
    v_mfma_f32_16x16x32_bf16 v[100:103], v[172:175], v[128:131], v[100:103]
    ds_read_b64_tr_b16 v[146:147], v49 offset:50176
    v_mfma_f32_16x16x32_bf16 v[76:79], v[176:179], v[124:127], v[76:79]
    ds_read_b64_tr_b16 v[148:149], v51 offset:49152
    v_mfma_f32_16x16x32_bf16 v[104:107], v[176:179], v[128:131], v[104:107]
    ds_read_b64_tr_b16 v[150:151], v51 offset:50176
    v_mfma_f32_16x16x32_bf16 v[80:83], v[180:183], v[124:127], v[80:83]
    ds_read_b64_tr_b16 v[152:153], v53 offset:49152
    v_mfma_f32_16x16x32_bf16 v[108:111], v[180:183], v[128:131], v[108:111]
    ds_read_b64_tr_b16 v[154:155], v53 offset:50176
    v_mfma_f32_16x16x32_bf16 v[84:87], v[184:187], v[124:127], v[84:87]
    ds_read_b64_tr_b16 v[156:157], v55 offset:49152
    v_mfma_f32_16x16x32_bf16 v[112:115], v[184:187], v[128:131], v[112:115]
    ds_read_b64_tr_b16 v[158:159], v55 offset:50176
    ds_read_b128 v[124:127], v42 offset:49152
    ds_read_b128 v[128:131], v42 offset:51200
    s_waitcnt lgkmcnt(14)
    v_mfma_f32_16x16x32_bf16 v[60:63], v[132:135], v[116:119], v[60:63]
    ds_read_b64_tr_b16 v[160:161], v43 offset:57344
    v_mfma_f32_16x16x32_bf16 v[88:91], v[132:135], v[120:123], v[88:91]
    ds_read_b64_tr_b16 v[162:163], v43 offset:58368
    s_waitcnt lgkmcnt(14)
    v_mfma_f32_16x16x32_bf16 v[64:67], v[136:139], v[116:119], v[64:67]
    ds_read_b64_tr_b16 v[164:165], v45 offset:57344
    v_mfma_f32_16x16x32_bf16 v[92:95], v[136:139], v[120:123], v[92:95]
    ds_read_b64_tr_b16 v[166:167], v45 offset:58368
    s_waitcnt lgkmcnt(14)
    v_mfma_f32_16x16x32_bf16 v[68:71], v[140:143], v[116:119], v[68:71]
    ds_read_b64_tr_b16 v[168:169], v47 offset:57344
    v_mfma_f32_16x16x32_bf16 v[96:99], v[140:143], v[120:123], v[96:99]
    ds_read_b64_tr_b16 v[170:171], v47 offset:58368
    s_waitcnt lgkmcnt(14)
    v_mfma_f32_16x16x32_bf16 v[72:75], v[144:147], v[116:119], v[72:75]
    ds_read_b64_tr_b16 v[172:173], v49 offset:57344
    v_mfma_f32_16x16x32_bf16 v[100:103], v[144:147], v[120:123], v[100:103]
    ds_read_b64_tr_b16 v[174:175], v49 offset:58368
    s_waitcnt lgkmcnt(14)
    v_mfma_f32_16x16x32_bf16 v[76:79], v[148:151], v[116:119], v[76:79]
    ds_read_b64_tr_b16 v[176:177], v51 offset:57344
    v_mfma_f32_16x16x32_bf16 v[104:107], v[148:151], v[120:123], v[104:107]
    ds_read_b64_tr_b16 v[178:179], v51 offset:58368
    s_waitcnt lgkmcnt(14)
    v_mfma_f32_16x16x32_bf16 v[80:83], v[152:155], v[116:119], v[80:83]
    ds_read_b64_tr_b16 v[180:181], v53 offset:57344
    v_mfma_f32_16x16x32_bf16 v[108:111], v[152:155], v[120:123], v[108:111]
    ds_read_b64_tr_b16 v[182:183], v53 offset:58368
    s_waitcnt lgkmcnt(14)
    v_mfma_f32_16x16x32_bf16 v[84:87], v[156:159], v[116:119], v[84:87]
    ds_read_b64_tr_b16 v[184:185], v55 offset:57344
    v_mfma_f32_16x16x32_bf16 v[112:115], v[156:159], v[120:123], v[112:115]
    ds_read_b64_tr_b16 v[186:187], v55 offset:58368
    s_waitcnt lgkmcnt(0)
    s_barrier
    ds_read_b128 v[116:119], v41 offset:0
    ds_read_b128 v[120:123], v41 offset:2048
    v_mfma_f32_16x16x32_bf16 v[60:63], v[160:163], v[124:127], v[60:63]
    ds_read_b64_tr_b16 v[132:133], v44 offset:0
    v_mfma_f32_16x16x32_bf16 v[88:91], v[160:163], v[128:131], v[88:91]
    ds_read_b64_tr_b16 v[134:135], v44 offset:1024
    v_mfma_f32_16x16x32_bf16 v[64:67], v[164:167], v[124:127], v[64:67]
    ds_read_b64_tr_b16 v[136:137], v46 offset:0
    v_mfma_f32_16x16x32_bf16 v[92:95], v[164:167], v[128:131], v[92:95]
    ds_read_b64_tr_b16 v[138:139], v46 offset:1024
    v_mfma_f32_16x16x32_bf16 v[68:71], v[168:171], v[124:127], v[68:71]
    ds_read_b64_tr_b16 v[140:141], v48 offset:0
    v_mfma_f32_16x16x32_bf16 v[96:99], v[168:171], v[128:131], v[96:99]
    ds_read_b64_tr_b16 v[142:143], v48 offset:1024
    v_mfma_f32_16x16x32_bf16 v[72:75], v[172:175], v[124:127], v[72:75]
    ds_read_b64_tr_b16 v[144:145], v50 offset:0
    v_mfma_f32_16x16x32_bf16 v[100:103], v[172:175], v[128:131], v[100:103]
    ds_read_b64_tr_b16 v[146:147], v50 offset:1024
    v_mfma_f32_16x16x32_bf16 v[76:79], v[176:179], v[124:127], v[76:79]
    ds_read_b64_tr_b16 v[148:149], v52 offset:0
    v_mfma_f32_16x16x32_bf16 v[104:107], v[176:179], v[128:131], v[104:107]
    ds_read_b64_tr_b16 v[150:151], v52 offset:1024
    v_mfma_f32_16x16x32_bf16 v[80:83], v[180:183], v[124:127], v[80:83]
    ds_read_b64_tr_b16 v[152:153], v54 offset:0
    v_mfma_f32_16x16x32_bf16 v[108:111], v[180:183], v[128:131], v[108:111]
    ds_read_b64_tr_b16 v[154:155], v54 offset:1024
    v_mfma_f32_16x16x32_bf16 v[84:87], v[184:187], v[124:127], v[84:87]
    ds_read_b64_tr_b16 v[156:157], v56 offset:0
    v_mfma_f32_16x16x32_bf16 v[112:115], v[184:187], v[128:131], v[112:115]
    ds_read_b64_tr_b16 v[158:159], v56 offset:1024
    ds_read_b128 v[124:127], v42 offset:0
    ds_read_b128 v[128:131], v42 offset:2048
    s_waitcnt lgkmcnt(14)
    v_mfma_f32_16x16x32_bf16 v[60:63], v[132:135], v[116:119], v[60:63]
    ds_read_b64_tr_b16 v[160:161], v44 offset:8192
    v_mfma_f32_16x16x32_bf16 v[88:91], v[132:135], v[120:123], v[88:91]
    ds_read_b64_tr_b16 v[162:163], v44 offset:9216
    s_waitcnt lgkmcnt(14)
    v_mfma_f32_16x16x32_bf16 v[64:67], v[136:139], v[116:119], v[64:67]
    ds_read_b64_tr_b16 v[164:165], v46 offset:8192
    v_mfma_f32_16x16x32_bf16 v[92:95], v[136:139], v[120:123], v[92:95]
    ds_read_b64_tr_b16 v[166:167], v46 offset:9216
    s_waitcnt lgkmcnt(14)
    v_mfma_f32_16x16x32_bf16 v[68:71], v[140:143], v[116:119], v[68:71]
    ds_read_b64_tr_b16 v[168:169], v48 offset:8192
    v_mfma_f32_16x16x32_bf16 v[96:99], v[140:143], v[120:123], v[96:99]
    ds_read_b64_tr_b16 v[170:171], v48 offset:9216
    s_waitcnt lgkmcnt(14)
    v_mfma_f32_16x16x32_bf16 v[72:75], v[144:147], v[116:119], v[72:75]
    ds_read_b64_tr_b16 v[172:173], v50 offset:8192
    v_mfma_f32_16x16x32_bf16 v[100:103], v[144:147], v[120:123], v[100:103]
    ds_read_b64_tr_b16 v[174:175], v50 offset:9216
    s_waitcnt lgkmcnt(14)
    v_mfma_f32_16x16x32_bf16 v[76:79], v[148:151], v[116:119], v[76:79]
    ds_read_b64_tr_b16 v[176:177], v52 offset:8192
    v_mfma_f32_16x16x32_bf16 v[104:107], v[148:151], v[120:123], v[104:107]
    ds_read_b64_tr_b16 v[178:179], v52 offset:9216
    s_waitcnt lgkmcnt(14)
    v_mfma_f32_16x16x32_bf16 v[80:83], v[152:155], v[116:119], v[80:83]
    ds_read_b64_tr_b16 v[180:181], v54 offset:8192
    v_mfma_f32_16x16x32_bf16 v[108:111], v[152:155], v[120:123], v[108:111]
    ds_read_b64_tr_b16 v[182:183], v54 offset:9216
    s_waitcnt lgkmcnt(14)
    v_mfma_f32_16x16x32_bf16 v[84:87], v[156:159], v[116:119], v[84:87]
    ds_read_b64_tr_b16 v[184:185], v56 offset:8192
    v_mfma_f32_16x16x32_bf16 v[112:115], v[156:159], v[120:123], v[112:115]
    ds_read_b64_tr_b16 v[186:187], v56 offset:9216
    s_waitcnt lgkmcnt(0)
    s_barrier
    ds_read_b128 v[116:119], v41 offset:16384
    ds_read_b128 v[120:123], v41 offset:18432
    v_mfma_f32_16x16x32_bf16 v[60:63], v[160:163], v[124:127], v[60:63]
    ds_read_b64_tr_b16 v[132:133], v43 offset:0
    v_mfma_f32_16x16x32_bf16 v[88:91], v[160:163], v[128:131], v[88:91]
    ds_read_b64_tr_b16 v[134:135], v43 offset:1024
    v_mfma_f32_16x16x32_bf16 v[64:67], v[164:167], v[124:127], v[64:67]
    ds_read_b64_tr_b16 v[136:137], v45 offset:0
    v_mfma_f32_16x16x32_bf16 v[92:95], v[164:167], v[128:131], v[92:95]
    ds_read_b64_tr_b16 v[138:139], v45 offset:1024
    v_mfma_f32_16x16x32_bf16 v[68:71], v[168:171], v[124:127], v[68:71]
    ds_read_b64_tr_b16 v[140:141], v47 offset:0
    v_mfma_f32_16x16x32_bf16 v[96:99], v[168:171], v[128:131], v[96:99]
    ds_read_b64_tr_b16 v[142:143], v47 offset:1024
    v_mfma_f32_16x16x32_bf16 v[72:75], v[172:175], v[124:127], v[72:75]
    ds_read_b64_tr_b16 v[144:145], v49 offset:0
    v_mfma_f32_16x16x32_bf16 v[100:103], v[172:175], v[128:131], v[100:103]
    ds_read_b64_tr_b16 v[146:147], v49 offset:1024
    v_mfma_f32_16x16x32_bf16 v[76:79], v[176:179], v[124:127], v[76:79]
    ds_read_b64_tr_b16 v[148:149], v51 offset:0
    v_mfma_f32_16x16x32_bf16 v[104:107], v[176:179], v[128:131], v[104:107]
    ds_read_b64_tr_b16 v[150:151], v51 offset:1024
    v_mfma_f32_16x16x32_bf16 v[80:83], v[180:183], v[124:127], v[80:83]
    ds_read_b64_tr_b16 v[152:153], v53 offset:0
    v_mfma_f32_16x16x32_bf16 v[108:111], v[180:183], v[128:131], v[108:111]
    ds_read_b64_tr_b16 v[154:155], v53 offset:1024
    v_mfma_f32_16x16x32_bf16 v[84:87], v[184:187], v[124:127], v[84:87]
    ds_read_b64_tr_b16 v[156:157], v55 offset:0
    v_mfma_f32_16x16x32_bf16 v[112:115], v[184:187], v[128:131], v[112:115]
    ds_read_b64_tr_b16 v[158:159], v55 offset:1024
    ds_read_b128 v[124:127], v42 offset:16384
    ds_read_b128 v[128:131], v42 offset:18432
    s_waitcnt lgkmcnt(14)
    v_mfma_f32_16x16x32_bf16 v[60:63], v[132:135], v[116:119], v[60:63]
    ds_read_b64_tr_b16 v[160:161], v43 offset:8192
    v_mfma_f32_16x16x32_bf16 v[88:91], v[132:135], v[120:123], v[88:91]
    ds_read_b64_tr_b16 v[162:163], v43 offset:9216
    s_waitcnt lgkmcnt(14)
    v_mfma_f32_16x16x32_bf16 v[64:67], v[136:139], v[116:119], v[64:67]
    ds_read_b64_tr_b16 v[164:165], v45 offset:8192
    v_mfma_f32_16x16x32_bf16 v[92:95], v[136:139], v[120:123], v[92:95]
    ds_read_b64_tr_b16 v[166:167], v45 offset:9216
    s_waitcnt lgkmcnt(14)
    v_mfma_f32_16x16x32_bf16 v[68:71], v[140:143], v[116:119], v[68:71]
    ds_read_b64_tr_b16 v[168:169], v47 offset:8192
    v_mfma_f32_16x16x32_bf16 v[96:99], v[140:143], v[120:123], v[96:99]
    ds_read_b64_tr_b16 v[170:171], v47 offset:9216
    s_waitcnt lgkmcnt(14)
    v_mfma_f32_16x16x32_bf16 v[72:75], v[144:147], v[116:119], v[72:75]
    ds_read_b64_tr_b16 v[172:173], v49 offset:8192
    v_mfma_f32_16x16x32_bf16 v[100:103], v[144:147], v[120:123], v[100:103]
    ds_read_b64_tr_b16 v[174:175], v49 offset:9216
    s_waitcnt lgkmcnt(14)
    v_mfma_f32_16x16x32_bf16 v[76:79], v[148:151], v[116:119], v[76:79]
    ds_read_b64_tr_b16 v[176:177], v51 offset:8192
    v_mfma_f32_16x16x32_bf16 v[104:107], v[148:151], v[120:123], v[104:107]
    ds_read_b64_tr_b16 v[178:179], v51 offset:9216
    s_waitcnt lgkmcnt(14)
    v_mfma_f32_16x16x32_bf16 v[80:83], v[152:155], v[116:119], v[80:83]
    ds_read_b64_tr_b16 v[180:181], v53 offset:8192
    v_mfma_f32_16x16x32_bf16 v[108:111], v[152:155], v[120:123], v[108:111]
    ds_read_b64_tr_b16 v[182:183], v53 offset:9216
    s_waitcnt lgkmcnt(14)
    v_mfma_f32_16x16x32_bf16 v[84:87], v[156:159], v[116:119], v[84:87]
    ds_read_b64_tr_b16 v[184:185], v55 offset:8192
    v_mfma_f32_16x16x32_bf16 v[112:115], v[156:159], v[120:123], v[112:115]
    ds_read_b64_tr_b16 v[186:187], v55 offset:9216
    s_waitcnt lgkmcnt(0)
    s_barrier
    ds_read_b128 v[116:119], v41 offset:32768
    ds_read_b128 v[120:123], v41 offset:34816
    v_mfma_f32_16x16x32_bf16 v[60:63], v[160:163], v[124:127], v[60:63]
    ds_read_b64_tr_b16 v[132:133], v43 offset:16384
    v_mfma_f32_16x16x32_bf16 v[88:91], v[160:163], v[128:131], v[88:91]
    ds_read_b64_tr_b16 v[134:135], v43 offset:17408
    v_mfma_f32_16x16x32_bf16 v[64:67], v[164:167], v[124:127], v[64:67]
    ds_read_b64_tr_b16 v[136:137], v45 offset:16384
    v_mfma_f32_16x16x32_bf16 v[92:95], v[164:167], v[128:131], v[92:95]
    ds_read_b64_tr_b16 v[138:139], v45 offset:17408
    v_mfma_f32_16x16x32_bf16 v[68:71], v[168:171], v[124:127], v[68:71]
    ds_read_b64_tr_b16 v[140:141], v47 offset:16384
    v_mfma_f32_16x16x32_bf16 v[96:99], v[168:171], v[128:131], v[96:99]
    ds_read_b64_tr_b16 v[142:143], v47 offset:17408
    v_mfma_f32_16x16x32_bf16 v[72:75], v[172:175], v[124:127], v[72:75]
    ds_read_b64_tr_b16 v[144:145], v49 offset:16384
    v_mfma_f32_16x16x32_bf16 v[100:103], v[172:175], v[128:131], v[100:103]
    ds_read_b64_tr_b16 v[146:147], v49 offset:17408
    v_mfma_f32_16x16x32_bf16 v[76:79], v[176:179], v[124:127], v[76:79]
    ds_read_b64_tr_b16 v[148:149], v51 offset:16384
    v_mfma_f32_16x16x32_bf16 v[104:107], v[176:179], v[128:131], v[104:107]
    ds_read_b64_tr_b16 v[150:151], v51 offset:17408
    v_mfma_f32_16x16x32_bf16 v[80:83], v[180:183], v[124:127], v[80:83]
    ds_read_b64_tr_b16 v[152:153], v53 offset:16384
    v_mfma_f32_16x16x32_bf16 v[108:111], v[180:183], v[128:131], v[108:111]
    ds_read_b64_tr_b16 v[154:155], v53 offset:17408
    v_mfma_f32_16x16x32_bf16 v[84:87], v[184:187], v[124:127], v[84:87]
    ds_read_b64_tr_b16 v[156:157], v55 offset:16384
    v_mfma_f32_16x16x32_bf16 v[112:115], v[184:187], v[128:131], v[112:115]
    ds_read_b64_tr_b16 v[158:159], v55 offset:17408
    ds_read_b128 v[124:127], v42 offset:32768
    ds_read_b128 v[128:131], v42 offset:34816
    s_waitcnt lgkmcnt(14)
    v_mfma_f32_16x16x32_bf16 v[60:63], v[132:135], v[116:119], v[60:63]
    ds_read_b64_tr_b16 v[160:161], v43 offset:24576
    v_mfma_f32_16x16x32_bf16 v[88:91], v[132:135], v[120:123], v[88:91]
    ds_read_b64_tr_b16 v[162:163], v43 offset:25600
    s_waitcnt lgkmcnt(14)
    v_mfma_f32_16x16x32_bf16 v[64:67], v[136:139], v[116:119], v[64:67]
    ds_read_b64_tr_b16 v[164:165], v45 offset:24576
    v_mfma_f32_16x16x32_bf16 v[92:95], v[136:139], v[120:123], v[92:95]
    ds_read_b64_tr_b16 v[166:167], v45 offset:25600
    s_waitcnt lgkmcnt(14)
    v_mfma_f32_16x16x32_bf16 v[68:71], v[140:143], v[116:119], v[68:71]
    ds_read_b64_tr_b16 v[168:169], v47 offset:24576
    v_mfma_f32_16x16x32_bf16 v[96:99], v[140:143], v[120:123], v[96:99]
    ds_read_b64_tr_b16 v[170:171], v47 offset:25600
    s_waitcnt lgkmcnt(14)
    v_mfma_f32_16x16x32_bf16 v[72:75], v[144:147], v[116:119], v[72:75]
    ds_read_b64_tr_b16 v[172:173], v49 offset:24576
    v_mfma_f32_16x16x32_bf16 v[100:103], v[144:147], v[120:123], v[100:103]
    ds_read_b64_tr_b16 v[174:175], v49 offset:25600
    s_waitcnt lgkmcnt(14)
    v_mfma_f32_16x16x32_bf16 v[76:79], v[148:151], v[116:119], v[76:79]
    ds_read_b64_tr_b16 v[176:177], v51 offset:24576
    v_mfma_f32_16x16x32_bf16 v[104:107], v[148:151], v[120:123], v[104:107]
    ds_read_b64_tr_b16 v[178:179], v51 offset:25600
    s_waitcnt lgkmcnt(14)
    v_mfma_f32_16x16x32_bf16 v[80:83], v[152:155], v[116:119], v[80:83]
    ds_read_b64_tr_b16 v[180:181], v53 offset:24576
    v_mfma_f32_16x16x32_bf16 v[108:111], v[152:155], v[120:123], v[108:111]
    ds_read_b64_tr_b16 v[182:183], v53 offset:25600
    s_waitcnt lgkmcnt(14)
    v_mfma_f32_16x16x32_bf16 v[84:87], v[156:159], v[116:119], v[84:87]
    ds_read_b64_tr_b16 v[184:185], v55 offset:24576
    v_mfma_f32_16x16x32_bf16 v[112:115], v[156:159], v[120:123], v[112:115]
    ds_read_b64_tr_b16 v[186:187], v55 offset:25600
    s_waitcnt lgkmcnt(0)
    s_barrier
    ds_read_b128 v[116:119], v41 offset:49152
    ds_read_b128 v[120:123], v41 offset:51200
    v_mfma_f32_16x16x32_bf16 v[60:63], v[160:163], v[124:127], v[60:63]
    ds_read_b64_tr_b16 v[132:133], v43 offset:32768
    v_mfma_f32_16x16x32_bf16 v[88:91], v[160:163], v[128:131], v[88:91]
    ds_read_b64_tr_b16 v[134:135], v43 offset:33792
    v_mfma_f32_16x16x32_bf16 v[64:67], v[164:167], v[124:127], v[64:67]
    ds_read_b64_tr_b16 v[136:137], v45 offset:32768
    v_mfma_f32_16x16x32_bf16 v[92:95], v[164:167], v[128:131], v[92:95]
    ds_read_b64_tr_b16 v[138:139], v45 offset:33792
    v_mfma_f32_16x16x32_bf16 v[68:71], v[168:171], v[124:127], v[68:71]
    ds_read_b64_tr_b16 v[140:141], v47 offset:32768
    v_mfma_f32_16x16x32_bf16 v[96:99], v[168:171], v[128:131], v[96:99]
    ds_read_b64_tr_b16 v[142:143], v47 offset:33792
    v_mfma_f32_16x16x32_bf16 v[72:75], v[172:175], v[124:127], v[72:75]
    ds_read_b64_tr_b16 v[144:145], v49 offset:32768
    v_mfma_f32_16x16x32_bf16 v[100:103], v[172:175], v[128:131], v[100:103]
    ds_read_b64_tr_b16 v[146:147], v49 offset:33792
    v_mfma_f32_16x16x32_bf16 v[76:79], v[176:179], v[124:127], v[76:79]
    ds_read_b64_tr_b16 v[148:149], v51 offset:32768
    v_mfma_f32_16x16x32_bf16 v[104:107], v[176:179], v[128:131], v[104:107]
    ds_read_b64_tr_b16 v[150:151], v51 offset:33792
    v_mfma_f32_16x16x32_bf16 v[80:83], v[180:183], v[124:127], v[80:83]
    ds_read_b64_tr_b16 v[152:153], v53 offset:32768
    v_mfma_f32_16x16x32_bf16 v[108:111], v[180:183], v[128:131], v[108:111]
    ds_read_b64_tr_b16 v[154:155], v53 offset:33792
    v_mfma_f32_16x16x32_bf16 v[84:87], v[184:187], v[124:127], v[84:87]
    ds_read_b64_tr_b16 v[156:157], v55 offset:32768
    v_mfma_f32_16x16x32_bf16 v[112:115], v[184:187], v[128:131], v[112:115]
    ds_read_b64_tr_b16 v[158:159], v55 offset:33792
    ds_read_b128 v[124:127], v42 offset:49152
    ds_read_b128 v[128:131], v42 offset:51200
    s_waitcnt lgkmcnt(14)
    v_mfma_f32_16x16x32_bf16 v[60:63], v[132:135], v[116:119], v[60:63]
    ds_read_b64_tr_b16 v[160:161], v43 offset:40960
    v_mfma_f32_16x16x32_bf16 v[88:91], v[132:135], v[120:123], v[88:91]
    ds_read_b64_tr_b16 v[162:163], v43 offset:41984
    s_waitcnt lgkmcnt(14)
    v_mfma_f32_16x16x32_bf16 v[64:67], v[136:139], v[116:119], v[64:67]
    ds_read_b64_tr_b16 v[164:165], v45 offset:40960
    v_mfma_f32_16x16x32_bf16 v[92:95], v[136:139], v[120:123], v[92:95]
    ds_read_b64_tr_b16 v[166:167], v45 offset:41984
    s_waitcnt lgkmcnt(14)
    v_mfma_f32_16x16x32_bf16 v[68:71], v[140:143], v[116:119], v[68:71]
    ds_read_b64_tr_b16 v[168:169], v47 offset:40960
    v_mfma_f32_16x16x32_bf16 v[96:99], v[140:143], v[120:123], v[96:99]
    ds_read_b64_tr_b16 v[170:171], v47 offset:41984
    s_waitcnt lgkmcnt(14)
    v_mfma_f32_16x16x32_bf16 v[72:75], v[144:147], v[116:119], v[72:75]
    ds_read_b64_tr_b16 v[172:173], v49 offset:40960
    v_mfma_f32_16x16x32_bf16 v[100:103], v[144:147], v[120:123], v[100:103]
    ds_read_b64_tr_b16 v[174:175], v49 offset:41984
    s_waitcnt lgkmcnt(14)
    v_mfma_f32_16x16x32_bf16 v[76:79], v[148:151], v[116:119], v[76:79]
    ds_read_b64_tr_b16 v[176:177], v51 offset:40960
    v_mfma_f32_16x16x32_bf16 v[104:107], v[148:151], v[120:123], v[104:107]
    ds_read_b64_tr_b16 v[178:179], v51 offset:41984
    s_waitcnt lgkmcnt(14)
    v_mfma_f32_16x16x32_bf16 v[80:83], v[152:155], v[116:119], v[80:83]
    ds_read_b64_tr_b16 v[180:181], v53 offset:40960
    v_mfma_f32_16x16x32_bf16 v[108:111], v[152:155], v[120:123], v[108:111]
    ds_read_b64_tr_b16 v[182:183], v53 offset:41984
    s_waitcnt lgkmcnt(14)
    v_mfma_f32_16x16x32_bf16 v[84:87], v[156:159], v[116:119], v[84:87]
    ds_read_b64_tr_b16 v[184:185], v55 offset:40960
    v_mfma_f32_16x16x32_bf16 v[112:115], v[156:159], v[120:123], v[112:115]
    ds_read_b64_tr_b16 v[186:187], v55 offset:41984
    s_waitcnt lgkmcnt(12)
    v_mfma_f32_16x16x32_bf16 v[60:63], v[160:163], v[124:127], v[60:63]
    ds_read_b64 v[188:189], v192 offset:0
    v_mfma_f32_16x16x32_bf16 v[88:91], v[160:163], v[128:131], v[88:91]
    ds_read_b64 v[190:191], v192 offset:128
    s_waitcnt lgkmcnt(12)
    v_mfma_f32_16x16x32_bf16 v[64:67], v[164:167], v[124:127], v[64:67]
    ds_read_b128 v[12:15], v40 offset:0
    v_mfma_f32_16x16x32_bf16 v[92:95], v[164:167], v[128:131], v[92:95]
    ds_read_b128 v[16:19], v40 offset:64
    s_waitcnt lgkmcnt(12)
    v_mfma_f32_16x16x32_bf16 v[68:71], v[168:171], v[124:127], v[68:71]
    ds_read_b128 v[20:23], v40 offset:128
    v_mfma_f32_16x16x32_bf16 v[96:99], v[168:171], v[128:131], v[96:99]
    ds_read_b128 v[24:27], v40 offset:192
    s_waitcnt lgkmcnt(12)
    v_mfma_f32_16x16x32_bf16 v[72:75], v[172:175], v[124:127], v[72:75]
    ds_read_b128 v[28:31], v40 offset:256
    v_mfma_f32_16x16x32_bf16 v[100:103], v[172:175], v[128:131], v[100:103]
    ds_read_b128 v[32:35], v40 offset:320
    s_waitcnt lgkmcnt(12)
    v_mfma_f32_16x16x32_bf16 v[76:79], v[176:179], v[124:127], v[76:79]
    ds_read_b128 v[36:39], v40 offset:384
    v_mfma_f32_16x16x32_bf16 v[104:107], v[176:179], v[128:131], v[104:107]
    s_waitcnt lgkmcnt(11)
    v_mfma_f32_16x16x32_bf16 v[80:83], v[180:183], v[124:127], v[80:83]
    v_mfma_f32_16x16x32_bf16 v[108:111], v[180:183], v[128:131], v[108:111]
    s_waitcnt lgkmcnt(9)
    v_mfma_f32_16x16x32_bf16 v[84:87], v[184:187], v[124:127], v[84:87]
    v_mfma_f32_16x16x32_bf16 v[112:115], v[184:187], v[128:131], v[112:115]
    s_barrier
    v_add_u32 v193, s52, v2
    v_mul_u32_u24 v193, 240, v193
    v_lshl_add_u32 v193, v3, 3, v193
    s_mov_b32 s62, 0xbfb8aa3b
    s_mov_b32 s63, 0xbfb8aa3b
    s_mov_b32 s64, 1.0
    s_mov_b32 s65, 1.0
    s_waitcnt lgkmcnt(6)
    v_pk_mul_f32 v[196:197], v[12:13], v[188:189] op_sel:[0,1] op_sel_hi:[1,1]
    v_pk_mul_f32 v[198:199], v[14:15], v[188:189] op_sel:[0,1] op_sel_hi:[1,1]
    v_pk_fma_f32 v[60:61], v[60:61], v[188:189], v[196:197] op_sel:[0,0,0] op_sel_hi:[1,0,1]
    v_pk_fma_f32 v[62:63], v[62:63], v[188:189], v[198:199] op_sel:[0,0,0] op_sel_hi:[1,0,1]
    v_pk_mul_f32 v[196:197], v[60:61], s[62:63]
    v_pk_mul_f32 v[198:199], v[62:63], s[62:63]
    v_exp_f32 v196, v196
    v_exp_f32 v197, v197
    v_exp_f32 v198, v198
    v_exp_f32 v199, v199
    v_pk_add_f32 v[196:197], v[196:197], s[64:65]
    v_pk_add_f32 v[198:199], v[198:199], s[64:65]
    v_rcp_f32 v196, v196
    v_rcp_f32 v197, v197
    v_rcp_f32 v198, v198
    v_rcp_f32 v199, v199
    v_pk_mul_f32 v[60:61], v[60:61], v[196:197]
    v_pk_mul_f32 v[62:63], v[62:63], v[198:199]
    v_cvt_pk_bf16_f32 v60, v60, v61
    v_cvt_pk_bf16_f32 v61, v62, v63
    ds_write_b64 v193, v[60:61] offset:0
    s_waitcnt lgkmcnt(6)
    v_pk_mul_f32 v[200:201], v[16:17], v[188:189] op_sel:[0,1] op_sel_hi:[1,1]
    v_pk_mul_f32 v[202:203], v[18:19], v[188:189] op_sel:[0,1] op_sel_hi:[1,1]
    v_pk_fma_f32 v[64:65], v[64:65], v[188:189], v[200:201] op_sel:[0,0,0] op_sel_hi:[1,0,1]
    v_pk_fma_f32 v[66:67], v[66:67], v[188:189], v[202:203] op_sel:[0,0,0] op_sel_hi:[1,0,1]
    v_pk_mul_f32 v[200:201], v[64:65], s[62:63]
    v_pk_mul_f32 v[202:203], v[66:67], s[62:63]
    v_exp_f32 v200, v200
    v_exp_f32 v201, v201
    v_exp_f32 v202, v202
    v_exp_f32 v203, v203
    v_pk_add_f32 v[200:201], v[200:201], s[64:65]
    v_pk_add_f32 v[202:203], v[202:203], s[64:65]
    v_rcp_f32 v200, v200
    v_rcp_f32 v201, v201
    v_rcp_f32 v202, v202
    v_rcp_f32 v203, v203
    v_pk_mul_f32 v[64:65], v[64:65], v[200:201]
    v_pk_mul_f32 v[66:67], v[66:67], v[202:203]
    v_cvt_pk_bf16_f32 v64, v64, v65
    v_cvt_pk_bf16_f32 v65, v66, v67
    ds_write_b64 v193, v[64:65] offset:32
    s_waitcnt lgkmcnt(6)
    v_pk_mul_f32 v[196:197], v[20:21], v[188:189] op_sel:[0,1] op_sel_hi:[1,1]
    v_pk_mul_f32 v[198:199], v[22:23], v[188:189] op_sel:[0,1] op_sel_hi:[1,1]
    v_pk_fma_f32 v[68:69], v[68:69], v[188:189], v[196:197] op_sel:[0,0,0] op_sel_hi:[1,0,1]
    v_pk_fma_f32 v[70:71], v[70:71], v[188:189], v[198:199] op_sel:[0,0,0] op_sel_hi:[1,0,1]
    v_pk_mul_f32 v[196:197], v[68:69], s[62:63]
    v_pk_mul_f32 v[198:199], v[70:71], s[62:63]
    v_exp_f32 v196, v196
    v_exp_f32 v197, v197
    v_exp_f32 v198, v198
    v_exp_f32 v199, v199
    v_pk_add_f32 v[196:197], v[196:197], s[64:65]
    v_pk_add_f32 v[198:199], v[198:199], s[64:65]
    v_rcp_f32 v196, v196
    v_rcp_f32 v197, v197
    v_rcp_f32 v198, v198
    v_rcp_f32 v199, v199
    v_pk_mul_f32 v[68:69], v[68:69], v[196:197]
    v_pk_mul_f32 v[70:71], v[70:71], v[198:199]
    v_cvt_pk_bf16_f32 v68, v68, v69
    v_cvt_pk_bf16_f32 v69, v70, v71
    ds_write_b64 v193, v[68:69] offset:64
    s_waitcnt lgkmcnt(6)
    v_pk_mul_f32 v[200:201], v[24:25], v[188:189] op_sel:[0,1] op_sel_hi:[1,1]
    v_pk_mul_f32 v[202:203], v[26:27], v[188:189] op_sel:[0,1] op_sel_hi:[1,1]
    v_pk_fma_f32 v[72:73], v[72:73], v[188:189], v[200:201] op_sel:[0,0,0] op_sel_hi:[1,0,1]
    v_pk_fma_f32 v[74:75], v[74:75], v[188:189], v[202:203] op_sel:[0,0,0] op_sel_hi:[1,0,1]
    v_pk_mul_f32 v[200:201], v[72:73], s[62:63]
    v_pk_mul_f32 v[202:203], v[74:75], s[62:63]
    v_exp_f32 v200, v200
    v_exp_f32 v201, v201
    v_exp_f32 v202, v202
    v_exp_f32 v203, v203
    v_pk_add_f32 v[200:201], v[200:201], s[64:65]
    v_pk_add_f32 v[202:203], v[202:203], s[64:65]
    v_rcp_f32 v200, v200
    v_rcp_f32 v201, v201
    v_rcp_f32 v202, v202
    v_rcp_f32 v203, v203
    v_pk_mul_f32 v[72:73], v[72:73], v[200:201]
    v_pk_mul_f32 v[74:75], v[74:75], v[202:203]
    v_cvt_pk_bf16_f32 v72, v72, v73
    v_cvt_pk_bf16_f32 v73, v74, v75
    ds_write_b64 v193, v[72:73] offset:96
    s_waitcnt lgkmcnt(6)
    v_pk_mul_f32 v[196:197], v[28:29], v[188:189] op_sel:[0,1] op_sel_hi:[1,1]
    v_pk_mul_f32 v[198:199], v[30:31], v[188:189] op_sel:[0,1] op_sel_hi:[1,1]
    v_pk_fma_f32 v[76:77], v[76:77], v[188:189], v[196:197] op_sel:[0,0,0] op_sel_hi:[1,0,1]
    v_pk_fma_f32 v[78:79], v[78:79], v[188:189], v[198:199] op_sel:[0,0,0] op_sel_hi:[1,0,1]
    v_pk_mul_f32 v[196:197], v[76:77], s[62:63]
    v_pk_mul_f32 v[198:199], v[78:79], s[62:63]
    v_exp_f32 v196, v196
    v_exp_f32 v197, v197
    v_exp_f32 v198, v198
    v_exp_f32 v199, v199
    v_pk_add_f32 v[196:197], v[196:197], s[64:65]
    v_pk_add_f32 v[198:199], v[198:199], s[64:65]
    v_rcp_f32 v196, v196
    v_rcp_f32 v197, v197
    v_rcp_f32 v198, v198
    v_rcp_f32 v199, v199
    v_pk_mul_f32 v[76:77], v[76:77], v[196:197]
    v_pk_mul_f32 v[78:79], v[78:79], v[198:199]
    v_cvt_pk_bf16_f32 v76, v76, v77
    v_cvt_pk_bf16_f32 v77, v78, v79
    ds_write_b64 v193, v[76:77] offset:128
    s_waitcnt lgkmcnt(6)
    v_pk_mul_f32 v[200:201], v[32:33], v[188:189] op_sel:[0,1] op_sel_hi:[1,1]
    v_pk_mul_f32 v[202:203], v[34:35], v[188:189] op_sel:[0,1] op_sel_hi:[1,1]
    v_pk_fma_f32 v[80:81], v[80:81], v[188:189], v[200:201] op_sel:[0,0,0] op_sel_hi:[1,0,1]
    v_pk_fma_f32 v[82:83], v[82:83], v[188:189], v[202:203] op_sel:[0,0,0] op_sel_hi:[1,0,1]
    v_pk_mul_f32 v[200:201], v[80:81], s[62:63]
    v_pk_mul_f32 v[202:203], v[82:83], s[62:63]
    v_exp_f32 v200, v200
    v_exp_f32 v201, v201
    v_exp_f32 v202, v202
    v_exp_f32 v203, v203
    v_pk_add_f32 v[200:201], v[200:201], s[64:65]
    v_pk_add_f32 v[202:203], v[202:203], s[64:65]
    v_rcp_f32 v200, v200
    v_rcp_f32 v201, v201
    v_rcp_f32 v202, v202
    v_rcp_f32 v203, v203
    v_pk_mul_f32 v[80:81], v[80:81], v[200:201]
    v_pk_mul_f32 v[82:83], v[82:83], v[202:203]
    v_cvt_pk_bf16_f32 v80, v80, v81
    v_cvt_pk_bf16_f32 v81, v82, v83
    ds_write_b64 v193, v[80:81] offset:160
    s_waitcnt lgkmcnt(6)
    v_pk_mul_f32 v[196:197], v[36:37], v[188:189] op_sel:[0,1] op_sel_hi:[1,1]
    v_pk_mul_f32 v[198:199], v[38:39], v[188:189] op_sel:[0,1] op_sel_hi:[1,1]
    v_pk_fma_f32 v[84:85], v[84:85], v[188:189], v[196:197] op_sel:[0,0,0] op_sel_hi:[1,0,1]
    v_pk_fma_f32 v[86:87], v[86:87], v[188:189], v[198:199] op_sel:[0,0,0] op_sel_hi:[1,0,1]
    v_pk_mul_f32 v[196:197], v[84:85], s[62:63]
    v_pk_mul_f32 v[198:199], v[86:87], s[62:63]
    v_exp_f32 v196, v196
    v_exp_f32 v197, v197
    v_exp_f32 v198, v198
    v_exp_f32 v199, v199
    v_pk_add_f32 v[196:197], v[196:197], s[64:65]
    v_pk_add_f32 v[198:199], v[198:199], s[64:65]
    v_rcp_f32 v196, v196
    v_rcp_f32 v197, v197
    v_rcp_f32 v198, v198
    v_rcp_f32 v199, v199
    v_pk_mul_f32 v[84:85], v[84:85], v[196:197]
    v_pk_mul_f32 v[86:87], v[86:87], v[198:199]
    v_cvt_pk_bf16_f32 v84, v84, v85
    v_cvt_pk_bf16_f32 v85, v86, v87
    ds_write_b64 v193, v[84:85] offset:192
    v_pk_mul_f32 v[196:197], v[12:13], v[190:191] op_sel:[0,1] op_sel_hi:[1,1]
    v_pk_mul_f32 v[198:199], v[14:15], v[190:191] op_sel:[0,1] op_sel_hi:[1,1]
    v_pk_fma_f32 v[88:89], v[88:89], v[190:191], v[196:197] op_sel:[0,0,0] op_sel_hi:[1,0,1]
    v_pk_fma_f32 v[90:91], v[90:91], v[190:191], v[198:199] op_sel:[0,0,0] op_sel_hi:[1,0,1]
    v_pk_mul_f32 v[196:197], v[88:89], s[62:63]
    v_pk_mul_f32 v[198:199], v[90:91], s[62:63]
    v_exp_f32 v196, v196
    v_exp_f32 v197, v197
    v_exp_f32 v198, v198
    v_exp_f32 v199, v199
    v_pk_add_f32 v[196:197], v[196:197], s[64:65]
    v_pk_add_f32 v[198:199], v[198:199], s[64:65]
    v_rcp_f32 v196, v196
    v_rcp_f32 v197, v197
    v_rcp_f32 v198, v198
    v_rcp_f32 v199, v199
    v_pk_mul_f32 v[88:89], v[88:89], v[196:197]
    v_pk_mul_f32 v[90:91], v[90:91], v[198:199]
    v_cvt_pk_bf16_f32 v88, v88, v89
    v_cvt_pk_bf16_f32 v89, v90, v91
    ds_write_b64 v193, v[88:89] offset:3840
    v_pk_mul_f32 v[200:201], v[16:17], v[190:191] op_sel:[0,1] op_sel_hi:[1,1]
    v_pk_mul_f32 v[202:203], v[18:19], v[190:191] op_sel:[0,1] op_sel_hi:[1,1]
    v_pk_fma_f32 v[92:93], v[92:93], v[190:191], v[200:201] op_sel:[0,0,0] op_sel_hi:[1,0,1]
    v_pk_fma_f32 v[94:95], v[94:95], v[190:191], v[202:203] op_sel:[0,0,0] op_sel_hi:[1,0,1]
    v_pk_mul_f32 v[200:201], v[92:93], s[62:63]
    v_pk_mul_f32 v[202:203], v[94:95], s[62:63]
    v_exp_f32 v200, v200
    v_exp_f32 v201, v201
    v_exp_f32 v202, v202
    v_exp_f32 v203, v203
    v_pk_add_f32 v[200:201], v[200:201], s[64:65]
    v_pk_add_f32 v[202:203], v[202:203], s[64:65]
    v_rcp_f32 v200, v200
    v_rcp_f32 v201, v201
    v_rcp_f32 v202, v202
    v_rcp_f32 v203, v203
    v_pk_mul_f32 v[92:93], v[92:93], v[200:201]
    v_pk_mul_f32 v[94:95], v[94:95], v[202:203]
    v_cvt_pk_bf16_f32 v92, v92, v93
    v_cvt_pk_bf16_f32 v93, v94, v95
    ds_write_b64 v193, v[92:93] offset:3872
    v_pk_mul_f32 v[196:197], v[20:21], v[190:191] op_sel:[0,1] op_sel_hi:[1,1]
    v_pk_mul_f32 v[198:199], v[22:23], v[190:191] op_sel:[0,1] op_sel_hi:[1,1]
    v_pk_fma_f32 v[96:97], v[96:97], v[190:191], v[196:197] op_sel:[0,0,0] op_sel_hi:[1,0,1]
    v_pk_fma_f32 v[98:99], v[98:99], v[190:191], v[198:199] op_sel:[0,0,0] op_sel_hi:[1,0,1]
    v_pk_mul_f32 v[196:197], v[96:97], s[62:63]
    v_pk_mul_f32 v[198:199], v[98:99], s[62:63]
    v_exp_f32 v196, v196
    v_exp_f32 v197, v197
    v_exp_f32 v198, v198
    v_exp_f32 v199, v199
    v_pk_add_f32 v[196:197], v[196:197], s[64:65]
    v_pk_add_f32 v[198:199], v[198:199], s[64:65]
    v_rcp_f32 v196, v196
    v_rcp_f32 v197, v197
    v_rcp_f32 v198, v198
    v_rcp_f32 v199, v199
    v_pk_mul_f32 v[96:97], v[96:97], v[196:197]
    v_pk_mul_f32 v[98:99], v[98:99], v[198:199]
    v_cvt_pk_bf16_f32 v96, v96, v97
    v_cvt_pk_bf16_f32 v97, v98, v99
    ds_write_b64 v193, v[96:97] offset:3904
    v_pk_mul_f32 v[200:201], v[24:25], v[190:191] op_sel:[0,1] op_sel_hi:[1,1]
    v_pk_mul_f32 v[202:203], v[26:27], v[190:191] op_sel:[0,1] op_sel_hi:[1,1]
    v_pk_fma_f32 v[100:101], v[100:101], v[190:191], v[200:201] op_sel:[0,0,0] op_sel_hi:[1,0,1]
    v_pk_fma_f32 v[102:103], v[102:103], v[190:191], v[202:203] op_sel:[0,0,0] op_sel_hi:[1,0,1]
    v_pk_mul_f32 v[200:201], v[100:101], s[62:63]
    v_pk_mul_f32 v[202:203], v[102:103], s[62:63]
    v_exp_f32 v200, v200
    v_exp_f32 v201, v201
    v_exp_f32 v202, v202
    v_exp_f32 v203, v203
    v_pk_add_f32 v[200:201], v[200:201], s[64:65]
    v_pk_add_f32 v[202:203], v[202:203], s[64:65]
    v_rcp_f32 v200, v200
    v_rcp_f32 v201, v201
    v_rcp_f32 v202, v202
    v_rcp_f32 v203, v203
    v_pk_mul_f32 v[100:101], v[100:101], v[200:201]
    v_pk_mul_f32 v[102:103], v[102:103], v[202:203]
    v_cvt_pk_bf16_f32 v100, v100, v101
    v_cvt_pk_bf16_f32 v101, v102, v103
    ds_write_b64 v193, v[100:101] offset:3936
    v_pk_mul_f32 v[196:197], v[28:29], v[190:191] op_sel:[0,1] op_sel_hi:[1,1]
    v_pk_mul_f32 v[198:199], v[30:31], v[190:191] op_sel:[0,1] op_sel_hi:[1,1]
    v_pk_fma_f32 v[104:105], v[104:105], v[190:191], v[196:197] op_sel:[0,0,0] op_sel_hi:[1,0,1]
    v_pk_fma_f32 v[106:107], v[106:107], v[190:191], v[198:199] op_sel:[0,0,0] op_sel_hi:[1,0,1]
    v_pk_mul_f32 v[196:197], v[104:105], s[62:63]
    v_pk_mul_f32 v[198:199], v[106:107], s[62:63]
    v_exp_f32 v196, v196
    v_exp_f32 v197, v197
    v_exp_f32 v198, v198
    v_exp_f32 v199, v199
    v_pk_add_f32 v[196:197], v[196:197], s[64:65]
    v_pk_add_f32 v[198:199], v[198:199], s[64:65]
    v_rcp_f32 v196, v196
    v_rcp_f32 v197, v197
    v_rcp_f32 v198, v198
    v_rcp_f32 v199, v199
    v_pk_mul_f32 v[104:105], v[104:105], v[196:197]
    v_pk_mul_f32 v[106:107], v[106:107], v[198:199]
    v_cvt_pk_bf16_f32 v104, v104, v105
    v_cvt_pk_bf16_f32 v105, v106, v107
    ds_write_b64 v193, v[104:105] offset:3968
    v_pk_mul_f32 v[200:201], v[32:33], v[190:191] op_sel:[0,1] op_sel_hi:[1,1]
    v_pk_mul_f32 v[202:203], v[34:35], v[190:191] op_sel:[0,1] op_sel_hi:[1,1]
    v_pk_fma_f32 v[108:109], v[108:109], v[190:191], v[200:201] op_sel:[0,0,0] op_sel_hi:[1,0,1]
    v_pk_fma_f32 v[110:111], v[110:111], v[190:191], v[202:203] op_sel:[0,0,0] op_sel_hi:[1,0,1]
    v_pk_mul_f32 v[200:201], v[108:109], s[62:63]
    v_pk_mul_f32 v[202:203], v[110:111], s[62:63]
    v_exp_f32 v200, v200
    v_exp_f32 v201, v201
    v_exp_f32 v202, v202
    v_exp_f32 v203, v203
    v_pk_add_f32 v[200:201], v[200:201], s[64:65]
    v_pk_add_f32 v[202:203], v[202:203], s[64:65]
    v_rcp_f32 v200, v200
    v_rcp_f32 v201, v201
    v_rcp_f32 v202, v202
    v_rcp_f32 v203, v203
    v_pk_mul_f32 v[108:109], v[108:109], v[200:201]
    v_pk_mul_f32 v[110:111], v[110:111], v[202:203]
    v_cvt_pk_bf16_f32 v108, v108, v109
    v_cvt_pk_bf16_f32 v109, v110, v111
    ds_write_b64 v193, v[108:109] offset:4000
    v_pk_mul_f32 v[196:197], v[36:37], v[190:191] op_sel:[0,1] op_sel_hi:[1,1]
    v_pk_mul_f32 v[198:199], v[38:39], v[190:191] op_sel:[0,1] op_sel_hi:[1,1]
    v_pk_fma_f32 v[112:113], v[112:113], v[190:191], v[196:197] op_sel:[0,0,0] op_sel_hi:[1,0,1]
    v_pk_fma_f32 v[114:115], v[114:115], v[190:191], v[198:199] op_sel:[0,0,0] op_sel_hi:[1,0,1]
    v_pk_mul_f32 v[196:197], v[112:113], s[62:63]
    v_pk_mul_f32 v[198:199], v[114:115], s[62:63]
    v_exp_f32 v196, v196
    v_exp_f32 v197, v197
    v_exp_f32 v198, v198
    v_exp_f32 v199, v199
    v_pk_add_f32 v[196:197], v[196:197], s[64:65]
    v_pk_add_f32 v[198:199], v[198:199], s[64:65]
    v_rcp_f32 v196, v196
    v_rcp_f32 v197, v197
    v_rcp_f32 v198, v198
    v_rcp_f32 v199, v199
    v_pk_mul_f32 v[112:113], v[112:113], v[196:197]
    v_pk_mul_f32 v[114:115], v[114:115], v[198:199]
    v_cvt_pk_bf16_f32 v112, v112, v113
    v_cvt_pk_bf16_f32 v113, v114, v115
    ds_write_b64 v193, v[112:113] offset:4032
    s_waitcnt lgkmcnt(0)
    s_add_u32 s32, s20, 6291456
    s_addc_u32 s33, s21, 0
    s_and_b32 s33, s33, 0xffff
    s_mov_b32 s34, 7340032
    s_mov_b32 s35, 0x20000
    v_lshrrev_b32 v5, 4, v0
    v_and_b32 v6, 15, v0
    v_min_u32 v7, 13, v6
    v_mul_u32_u24 v56, 240, v5
    v_lshl_add_u32 v56, v7, 4, v56
    v_add_u32 v5, s50, v5
    v_mul_u32_u24 v57, 3584, v5
    v_lshl_add_u32 v57, v6, 4, v57
    v_add_u32 v57, s54, v57
    v_mov_b32 v7, 0x7f000000
    v_cmp_gt_u32 vcc, 14, v6
    s_nop 1
    v_cndmask_b32 v57, v7, v57, vcc
    s_barrier
    ds_read_b128 v[24:27], v56 offset:0
    ds_read_b128 v[28:31], v56 offset:3840
    ds_read_b128 v[32:35], v56 offset:7680
    ds_read_b128 v[36:39], v56 offset:11520
    ds_read_b128 v[40:43], v56 offset:15360
    ds_read_b128 v[44:47], v56 offset:19200
    ds_read_b128 v[48:51], v56 offset:23040
    ds_read_b128 v[52:55], v56 offset:26880
    s_waitcnt vmcnt(0) lgkmcnt(0)
    s_nop 4
    s_cmp_eq_u32 s99, 1
    s_cbranch_scc0 kC_kernel_st1_slow
    s_mov_b32 s56, 0
    buffer_store_dwordx4 v[24:27], v57, s[32:35], s56 offen
    s_mov_b32 s56, 57344
    buffer_store_dwordx4 v[28:31], v57, s[32:35], s56 offen
    s_mov_b32 s56, 114688
    buffer_store_dwordx4 v[32:35], v57, s[32:35], s56 offen
    s_mov_b32 s56, 172032
    buffer_store_dwordx4 v[36:39], v57, s[32:35], s56 offen
    s_mov_b32 s56, 229376
    buffer_store_dwordx4 v[40:43], v57, s[32:35], s56 offen
    s_mov_b32 s56, 286720
    buffer_store_dwordx4 v[44:47], v57, s[32:35], s56 offen
    s_mov_b32 s56, 344064
    buffer_store_dwordx4 v[48:51], v57, s[32:35], s56 offen
    s_mov_b32 s56, 401408
    buffer_store_dwordx4 v[52:55], v57, s[32:35], s56 offen
    s_branch kC_kernel_st1_done
kC_kernel_st1_slow:
    s_mov_b32 s56, 0
    buffer_store_dwordx4 v[24:27], v57, s[32:35], s56 offen sc0 sc1
    s_mov_b32 s56, 57344
    buffer_store_dwordx4 v[28:31], v57, s[32:35], s56 offen sc0 sc1
    s_mov_b32 s56, 114688
    buffer_store_dwordx4 v[32:35], v57, s[32:35], s56 offen sc0 sc1
    s_mov_b32 s56, 172032
    buffer_store_dwordx4 v[36:39], v57, s[32:35], s56 offen sc0 sc1
    s_mov_b32 s56, 229376
    buffer_store_dwordx4 v[40:43], v57, s[32:35], s56 offen sc0 sc1
    s_mov_b32 s56, 286720
    buffer_store_dwordx4 v[44:47], v57, s[32:35], s56 offen sc0 sc1
    s_mov_b32 s56, 344064
    buffer_store_dwordx4 v[48:51], v57, s[32:35], s56 offen sc0 sc1
    s_mov_b32 s56, 401408
    buffer_store_dwordx4 v[52:55], v57, s[32:35], s56 offen sc0 sc1
kC_kernel_st1_done:
    s_waitcnt vmcnt(0)
    s_barrier
    s_lshr_b32 s48, s97, 3
    s_lshl_b32 s22, s96, 1
    s_add_u32 s22, s22, s48
    s_and_b32 s23, s97, 7
    s_lshl_b32 s50, s22, 6
    s_lshl_b32 s54, s23, 7
    s_waitcnt lgkmcnt(0)
    s_add_u32 s24, s20, 2097152
    s_addc_u32 s25, s21, 0
    s_and_b32 s25, s25, 0xffff
    s_mov_b32 s26, 2097152
    s_mov_b32 s27, 0x20000
    v_lshrrev_b32 v5, 3, v0
    v_and_b32 v6, 7, v0
    v_add_u32 v5, s50, v5
    v_lshlrev_b32 v5, 10, v5
    v_lshl_add_u32 v5, v6, 4, v5
    v_add_u32 v5, s54, v5
    s_mov_b32 s60, 32768
    buffer_load_dwordx4 v[12:15], v5, s[24:27], 0 offen
    buffer_load_dwordx4 v[16:19], v5, s[24:27], s60 offen
    s_lshr_b32 s52, s3, 1
    s_lshl_b32 s52, s52, 5
    s_and_b32 s53, s3, 1
    v_add_u32 v5, s52, v2
    v_mul_u32_u24 v5, 256, v5
    v_mov_b32 v6, v2
    v_xor_b32 v6, v6, v3
    v_xor_b32 v20, 0, v6
    v_lshl_add_u32 v20, v20, 4, v5
    v_add_u32 v21, 65536, v20
    v_xor_b32 v22, 4, v6
    v_lshl_add_u32 v22, v22, 4, v5
    v_add_u32 v23, 65536, v22
    v_xor_b32 v24, 8, v6
    v_lshl_add_u32 v24, v24, 4, v5
    v_add_u32 v25, 65536, v24
    v_xor_b32 v26, 12, v6
    v_lshl_add_u32 v26, v26, 4, v5
    v_add_u32 v27, 65536, v26
    v_bfe_u32 v5, v1, 2, 2
    v_and_b32 v6, 1, v3
    v_lshlrev_b32 v6, 1, v6
    v_bfe_u32 v7, v1, 3, 1
    v_or_b32 v6, v6, v7
    s_lshl_b32 s57, s53, 1
    v_xor_b32 v6, s57, v6
    v_lshl_add_u32 v5, v3, 3, v5
    v_lshlrev_b32 v5, 7, v5
    v_and_b32 v7, 3, v1
    v_lshl_add_u32 v5, v7, 3, v5
    v_xor_b32 v7, 0, v6
    v_lshl_add_u32 v28, v7, 5, v5
    v_add_u32 v29, 65536, v28
    v_add_u32 v30, 131072, v28
    v_xor_b32 v7, 1, v6
    v_lshl_add_u32 v31, v7, 5, v5
    v_add_u32 v32, 65536, v31
    v_add_u32 v33, 131072, v31
    v_mov_b32 v36, 0
    v_mov_b32 v37, 0
    v_mov_b32 v38, 0
    v_mov_b32 v39, 0
    v_mov_b32 v40, 0
    v_mov_b32 v41, 0
    v_mov_b32 v42, 0
    v_mov_b32 v43, 0
    v_mov_b32 v44, 0
    v_mov_b32 v45, 0
    v_mov_b32 v46, 0
    v_mov_b32 v47, 0
    v_mov_b32 v48, 0
    v_mov_b32 v49, 0
    v_mov_b32 v50, 0
    v_mov_b32 v51, 0
    s_barrier
    ds_read_b128 v[52:55], v20 offset:0
    ds_read_b64_tr_b16 v[116:117], v29 offset:49152
    ds_read_b64_tr_b16 v[118:119], v29 offset:49664
    ds_read_b64_tr_b16 v[120:121], v32 offset:49152
    ds_read_b64_tr_b16 v[122:123], v32 offset:49664
    ds_read_b128 v[56:59], v20 offset:4096
    ds_read_b128 v[60:63], v22 offset:0
    ds_read_b64_tr_b16 v[124:125], v29 offset:53248
    ds_read_b64_tr_b16 v[126:127], v29 offset:53760
    ds_read_b64_tr_b16 v[128:129], v32 offset:53248
    ds_read_b64_tr_b16 v[130:131], v32 offset:53760
    ds_read_b128 v[64:67], v22 offset:4096
    ds_read_b128 v[68:71], v24 offset:0
    ds_read_b64_tr_b16 v[132:133], v29 offset:57344
    ds_read_b64_tr_b16 v[134:135], v29 offset:57856
    ds_read_b64_tr_b16 v[136:137], v32 offset:57344
    ds_read_b64_tr_b16 v[138:139], v32 offset:57856
    ds_read_b128 v[72:75], v24 offset:4096
    ds_read_b128 v[76:79], v26 offset:0
    ds_read_b64_tr_b16 v[140:141], v29 offset:61440
    ds_read_b64_tr_b16 v[142:143], v29 offset:61952
    ds_read_b64_tr_b16 v[144:145], v32 offset:61440
    ds_read_b64_tr_b16 v[146:147], v32 offset:61952
    ds_read_b128 v[80:83], v26 offset:4096
    s_waitcnt lgkmcnt(0)
    s_barrier
    ds_read_b128 v[84:87], v20 offset:16384
    ds_read_b64_tr_b16 v[148:149], v30 offset:0
    v_mfma_f32_16x16x32_bf16 v[36:39], v[116:119], v[52:55], v[36:39]
    ds_read_b64_tr_b16 v[150:151], v30 offset:512
    v_mfma_f32_16x16x32_bf16 v[40:43], v[120:123], v[52:55], v[40:43]
    ds_read_b64_tr_b16 v[152:153], v33 offset:0
    ds_read_b64_tr_b16 v[154:155], v33 offset:512
    v_mfma_f32_16x16x32_bf16 v[44:47], v[116:119], v[56:59], v[44:47]
    ds_read_b128 v[88:91], v20 offset:20480
    v_mfma_f32_16x16x32_bf16 v[48:51], v[120:123], v[56:59], v[48:51]
    ds_read_b128 v[92:95], v22 offset:16384
    ds_read_b64_tr_b16 v[156:157], v30 offset:4096
    v_mfma_f32_16x16x32_bf16 v[36:39], v[124:127], v[60:63], v[36:39]
    ds_read_b64_tr_b16 v[158:159], v30 offset:4608
    v_mfma_f32_16x16x32_bf16 v[40:43], v[128:131], v[60:63], v[40:43]
    ds_read_b64_tr_b16 v[160:161], v33 offset:4096
    ds_read_b64_tr_b16 v[162:163], v33 offset:4608
    v_mfma_f32_16x16x32_bf16 v[44:47], v[124:127], v[64:67], v[44:47]
    ds_read_b128 v[96:99], v22 offset:20480
    v_mfma_f32_16x16x32_bf16 v[48:51], v[128:131], v[64:67], v[48:51]
    ds_read_b128 v[100:103], v24 offset:16384
    ds_read_b64_tr_b16 v[164:165], v30 offset:8192
    v_mfma_f32_16x16x32_bf16 v[36:39], v[132:135], v[68:71], v[36:39]
    ds_read_b64_tr_b16 v[166:167], v30 offset:8704
    v_mfma_f32_16x16x32_bf16 v[40:43], v[136:139], v[68:71], v[40:43]
    ds_read_b64_tr_b16 v[168:169], v33 offset:8192
    ds_read_b64_tr_b16 v[170:171], v33 offset:8704
    v_mfma_f32_16x16x32_bf16 v[44:47], v[132:135], v[72:75], v[44:47]
    ds_read_b128 v[104:107], v24 offset:20480
    v_mfma_f32_16x16x32_bf16 v[48:51], v[136:139], v[72:75], v[48:51]
    ds_read_b128 v[108:111], v26 offset:16384
    ds_read_b64_tr_b16 v[172:173], v30 offset:12288
    v_mfma_f32_16x16x32_bf16 v[36:39], v[140:143], v[76:79], v[36:39]
    ds_read_b64_tr_b16 v[174:175], v30 offset:12800
    v_mfma_f32_16x16x32_bf16 v[40:43], v[144:147], v[76:79], v[40:43]
    ds_read_b64_tr_b16 v[176:177], v33 offset:12288
    ds_read_b64_tr_b16 v[178:179], v33 offset:12800
    v_mfma_f32_16x16x32_bf16 v[44:47], v[140:143], v[80:83], v[44:47]
    ds_read_b128 v[112:115], v26 offset:20480
    v_mfma_f32_16x16x32_bf16 v[48:51], v[144:147], v[80:83], v[48:51]
    s_waitcnt lgkmcnt(0)
    s_barrier
    ds_read_b128 v[52:55], v20 offset:32768
    ds_read_b64_tr_b16 v[116:117], v29 offset:0
    v_mfma_f32_16x16x32_bf16 v[36:39], v[148:151], v[84:87], v[36:39]
    ds_read_b64_tr_b16 v[118:119], v29 offset:512
    v_mfma_f32_16x16x32_bf16 v[40:43], v[152:155], v[84:87], v[40:43]
    ds_read_b64_tr_b16 v[120:121], v32 offset:0
    ds_read_b64_tr_b16 v[122:123], v32 offset:512
    v_mfma_f32_16x16x32_bf16 v[44:47], v[148:151], v[88:91], v[44:47]
    ds_read_b128 v[56:59], v20 offset:36864
    v_mfma_f32_16x16x32_bf16 v[48:51], v[152:155], v[88:91], v[48:51]
    ds_read_b128 v[60:63], v22 offset:32768
    ds_read_b64_tr_b16 v[124:125], v29 offset:4096
    v_mfma_f32_16x16x32_bf16 v[36:39], v[156:159], v[92:95], v[36:39]
    ds_read_b64_tr_b16 v[126:127], v29 offset:4608
    v_mfma_f32_16x16x32_bf16 v[40:43], v[160:163], v[92:95], v[40:43]
    ds_read_b64_tr_b16 v[128:129], v32 offset:4096
    ds_read_b64_tr_b16 v[130:131], v32 offset:4608
    v_mfma_f32_16x16x32_bf16 v[44:47], v[156:159], v[96:99], v[44:47]
    ds_read_b128 v[64:67], v22 offset:36864
    v_mfma_f32_16x16x32_bf16 v[48:51], v[160:163], v[96:99], v[48:51]
    ds_read_b128 v[68:71], v24 offset:32768
    ds_read_b64_tr_b16 v[132:133], v29 offset:8192
    v_mfma_f32_16x16x32_bf16 v[36:39], v[164:167], v[100:103], v[36:39]
    ds_read_b64_tr_b16 v[134:135], v29 offset:8704
    v_mfma_f32_16x16x32_bf16 v[40:43], v[168:171], v[100:103], v[40:43]
    ds_read_b64_tr_b16 v[136:137], v32 offset:8192
    ds_read_b64_tr_b16 v[138:139], v32 offset:8704
    v_mfma_f32_16x16x32_bf16 v[44:47], v[164:167], v[104:107], v[44:47]
    ds_read_b128 v[72:75], v24 offset:36864
    v_mfma_f32_16x16x32_bf16 v[48:51], v[168:171], v[104:107], v[48:51]
    ds_read_b128 v[76:79], v26 offset:32768
    ds_read_b64_tr_b16 v[140:141], v29 offset:12288
    v_mfma_f32_16x16x32_bf16 v[36:39], v[172:175], v[108:111], v[36:39]
    ds_read_b64_tr_b16 v[142:143], v29 offset:12800
    v_mfma_f32_16x16x32_bf16 v[40:43], v[176:179], v[108:111], v[40:43]
    ds_read_b64_tr_b16 v[144:145], v32 offset:12288
    ds_read_b64_tr_b16 v[146:147], v32 offset:12800
    v_mfma_f32_16x16x32_bf16 v[44:47], v[172:175], v[112:115], v[44:47]
    ds_read_b128 v[80:83], v26 offset:36864
    v_mfma_f32_16x16x32_bf16 v[48:51], v[176:179], v[112:115], v[48:51]
    s_waitcnt lgkmcnt(0)
    s_barrier
    ds_read_b128 v[84:87], v20 offset:49152
    ds_read_b64_tr_b16 v[148:149], v29 offset:16384
    v_mfma_f32_16x16x32_bf16 v[36:39], v[116:119], v[52:55], v[36:39]
    ds_read_b64_tr_b16 v[150:151], v29 offset:16896
    v_mfma_f32_16x16x32_bf16 v[40:43], v[120:123], v[52:55], v[40:43]
    ds_read_b64_tr_b16 v[152:153], v32 offset:16384
    ds_read_b64_tr_b16 v[154:155], v32 offset:16896
    v_mfma_f32_16x16x32_bf16 v[44:47], v[116:119], v[56:59], v[44:47]
    ds_read_b128 v[88:91], v20 offset:53248
    v_mfma_f32_16x16x32_bf16 v[48:51], v[120:123], v[56:59], v[48:51]
    ds_read_b128 v[92:95], v22 offset:49152
    ds_read_b64_tr_b16 v[156:157], v29 offset:20480
    v_mfma_f32_16x16x32_bf16 v[36:39], v[124:127], v[60:63], v[36:39]
    ds_read_b64_tr_b16 v[158:159], v29 offset:20992
    v_mfma_f32_16x16x32_bf16 v[40:43], v[128:131], v[60:63], v[40:43]
    ds_read_b64_tr_b16 v[160:161], v32 offset:20480
    ds_read_b64_tr_b16 v[162:163], v32 offset:20992
    v_mfma_f32_16x16x32_bf16 v[44:47], v[124:127], v[64:67], v[44:47]
    ds_read_b128 v[96:99], v22 offset:53248
    v_mfma_f32_16x16x32_bf16 v[48:51], v[128:131], v[64:67], v[48:51]
    ds_read_b128 v[100:103], v24 offset:49152
    ds_read_b64_tr_b16 v[164:165], v29 offset:24576
    v_mfma_f32_16x16x32_bf16 v[36:39], v[132:135], v[68:71], v[36:39]
    ds_read_b64_tr_b16 v[166:167], v29 offset:25088
    v_mfma_f32_16x16x32_bf16 v[40:43], v[136:139], v[68:71], v[40:43]
    ds_read_b64_tr_b16 v[168:169], v32 offset:24576
    ds_read_b64_tr_b16 v[170:171], v32 offset:25088
    v_mfma_f32_16x16x32_bf16 v[44:47], v[132:135], v[72:75], v[44:47]
    ds_read_b128 v[104:107], v24 offset:53248
    v_mfma_f32_16x16x32_bf16 v[48:51], v[136:139], v[72:75], v[48:51]
    ds_read_b128 v[108:111], v26 offset:49152
    ds_read_b64_tr_b16 v[172:173], v29 offset:28672
    v_mfma_f32_16x16x32_bf16 v[36:39], v[140:143], v[76:79], v[36:39]
    ds_read_b64_tr_b16 v[174:175], v29 offset:29184
    v_mfma_f32_16x16x32_bf16 v[40:43], v[144:147], v[76:79], v[40:43]
    ds_read_b64_tr_b16 v[176:177], v32 offset:28672
    ds_read_b64_tr_b16 v[178:179], v32 offset:29184
    v_mfma_f32_16x16x32_bf16 v[44:47], v[140:143], v[80:83], v[44:47]
    ds_read_b128 v[112:115], v26 offset:53248
    v_mfma_f32_16x16x32_bf16 v[48:51], v[144:147], v[80:83], v[48:51]
    s_waitcnt lgkmcnt(0)
    s_barrier
    ds_read_b128 v[52:55], v20 offset:0
    ds_read_b64_tr_b16 v[116:117], v29 offset:32768
    v_mfma_f32_16x16x32_bf16 v[36:39], v[148:151], v[84:87], v[36:39]
    ds_read_b64_tr_b16 v[118:119], v29 offset:33280
    v_mfma_f32_16x16x32_bf16 v[40:43], v[152:155], v[84:87], v[40:43]
    ds_read_b64_tr_b16 v[120:121], v32 offset:32768
    ds_read_b64_tr_b16 v[122:123], v32 offset:33280
    v_mfma_f32_16x16x32_bf16 v[44:47], v[148:151], v[88:91], v[44:47]
    ds_read_b128 v[56:59], v20 offset:4096
    v_mfma_f32_16x16x32_bf16 v[48:51], v[152:155], v[88:91], v[48:51]
    ds_read_b128 v[60:63], v22 offset:0
    ds_read_b64_tr_b16 v[124:125], v29 offset:36864
    v_mfma_f32_16x16x32_bf16 v[36:39], v[156:159], v[92:95], v[36:39]
    ds_read_b64_tr_b16 v[126:127], v29 offset:37376
    v_mfma_f32_16x16x32_bf16 v[40:43], v[160:163], v[92:95], v[40:43]
    ds_read_b64_tr_b16 v[128:129], v32 offset:36864
    ds_read_b64_tr_b16 v[130:131], v32 offset:37376
    v_mfma_f32_16x16x32_bf16 v[44:47], v[156:159], v[96:99], v[44:47]
    ds_read_b128 v[64:67], v22 offset:4096
    v_mfma_f32_16x16x32_bf16 v[48:51], v[160:163], v[96:99], v[48:51]
    ds_read_b128 v[68:71], v24 offset:0
    ds_read_b64_tr_b16 v[132:133], v29 offset:40960
    v_mfma_f32_16x16x32_bf16 v[36:39], v[164:167], v[100:103], v[36:39]
    ds_read_b64_tr_b16 v[134:135], v29 offset:41472
    v_mfma_f32_16x16x32_bf16 v[40:43], v[168:171], v[100:103], v[40:43]
    ds_read_b64_tr_b16 v[136:137], v32 offset:40960
    ds_read_b64_tr_b16 v[138:139], v32 offset:41472
    v_mfma_f32_16x16x32_bf16 v[44:47], v[164:167], v[104:107], v[44:47]
    ds_read_b128 v[72:75], v24 offset:4096
    v_mfma_f32_16x16x32_bf16 v[48:51], v[168:171], v[104:107], v[48:51]
    ds_read_b128 v[76:79], v26 offset:0
    ds_read_b64_tr_b16 v[140:141], v29 offset:45056
    v_mfma_f32_16x16x32_bf16 v[36:39], v[172:175], v[108:111], v[36:39]
    ds_read_b64_tr_b16 v[142:143], v29 offset:45568
    v_mfma_f32_16x16x32_bf16 v[40:43], v[176:179], v[108:111], v[40:43]
    ds_read_b64_tr_b16 v[144:145], v32 offset:45056
    ds_read_b64_tr_b16 v[146:147], v32 offset:45568
    v_mfma_f32_16x16x32_bf16 v[44:47], v[172:175], v[112:115], v[44:47]
    ds_read_b128 v[80:83], v26 offset:4096
    v_mfma_f32_16x16x32_bf16 v[48:51], v[176:179], v[112:115], v[48:51]
    s_waitcnt lgkmcnt(0)
    s_barrier
    ds_read_b128 v[84:87], v20 offset:16384
    ds_read_b64_tr_b16 v[148:149], v29 offset:49152
    v_mfma_f32_16x16x32_bf16 v[36:39], v[116:119], v[52:55], v[36:39]
    ds_read_b64_tr_b16 v[150:151], v29 offset:49664
    v_mfma_f32_16x16x32_bf16 v[40:43], v[120:123], v[52:55], v[40:43]
    ds_read_b64_tr_b16 v[152:153], v32 offset:49152
    ds_read_b64_tr_b16 v[154:155], v32 offset:49664
    v_mfma_f32_16x16x32_bf16 v[44:47], v[116:119], v[56:59], v[44:47]
    ds_read_b128 v[88:91], v20 offset:20480
    v_mfma_f32_16x16x32_bf16 v[48:51], v[120:123], v[56:59], v[48:51]
    ds_read_b128 v[92:95], v22 offset:16384
    ds_read_b64_tr_b16 v[156:157], v29 offset:53248
    v_mfma_f32_16x16x32_bf16 v[36:39], v[124:127], v[60:63], v[36:39]
    ds_read_b64_tr_b16 v[158:159], v29 offset:53760
    v_mfma_f32_16x16x32_bf16 v[40:43], v[128:131], v[60:63], v[40:43]
    ds_read_b64_tr_b16 v[160:161], v32 offset:53248
    ds_read_b64_tr_b16 v[162:163], v32 offset:53760
    v_mfma_f32_16x16x32_bf16 v[44:47], v[124:127], v[64:67], v[44:47]
    ds_read_b128 v[96:99], v22 offset:20480
    v_mfma_f32_16x16x32_bf16 v[48:51], v[128:131], v[64:67], v[48:51]
    ds_read_b128 v[100:103], v24 offset:16384
    ds_read_b64_tr_b16 v[164:165], v29 offset:57344
    v_mfma_f32_16x16x32_bf16 v[36:39], v[132:135], v[68:71], v[36:39]
    ds_read_b64_tr_b16 v[166:167], v29 offset:57856
    v_mfma_f32_16x16x32_bf16 v[40:43], v[136:139], v[68:71], v[40:43]
    ds_read_b64_tr_b16 v[168:169], v32 offset:57344
    ds_read_b64_tr_b16 v[170:171], v32 offset:57856
    v_mfma_f32_16x16x32_bf16 v[44:47], v[132:135], v[72:75], v[44:47]
    ds_read_b128 v[104:107], v24 offset:20480
    v_mfma_f32_16x16x32_bf16 v[48:51], v[136:139], v[72:75], v[48:51]
    ds_read_b128 v[108:111], v26 offset:16384
    ds_read_b64_tr_b16 v[172:173], v29 offset:61440
    v_mfma_f32_16x16x32_bf16 v[36:39], v[140:143], v[76:79], v[36:39]
    ds_read_b64_tr_b16 v[174:175], v29 offset:61952
    v_mfma_f32_16x16x32_bf16 v[40:43], v[144:147], v[76:79], v[40:43]
    ds_read_b64_tr_b16 v[176:177], v32 offset:61440
    ds_read_b64_tr_b16 v[178:179], v32 offset:61952
    v_mfma_f32_16x16x32_bf16 v[44:47], v[140:143], v[80:83], v[44:47]
    ds_read_b128 v[112:115], v26 offset:20480
    v_mfma_f32_16x16x32_bf16 v[48:51], v[144:147], v[80:83], v[48:51]
    s_waitcnt lgkmcnt(0)
    s_barrier
    ds_read_b128 v[52:55], v20 offset:32768
    ds_read_b64_tr_b16 v[116:117], v30 offset:0
    v_mfma_f32_16x16x32_bf16 v[36:39], v[148:151], v[84:87], v[36:39]
    ds_read_b64_tr_b16 v[118:119], v30 offset:512
    v_mfma_f32_16x16x32_bf16 v[40:43], v[152:155], v[84:87], v[40:43]
    ds_read_b64_tr_b16 v[120:121], v33 offset:0
    ds_read_b64_tr_b16 v[122:123], v33 offset:512
    v_mfma_f32_16x16x32_bf16 v[44:47], v[148:151], v[88:91], v[44:47]
    ds_read_b128 v[56:59], v20 offset:36864
    v_mfma_f32_16x16x32_bf16 v[48:51], v[152:155], v[88:91], v[48:51]
    ds_read_b128 v[60:63], v22 offset:32768
    ds_read_b64_tr_b16 v[124:125], v30 offset:4096
    v_mfma_f32_16x16x32_bf16 v[36:39], v[156:159], v[92:95], v[36:39]
    ds_read_b64_tr_b16 v[126:127], v30 offset:4608
    v_mfma_f32_16x16x32_bf16 v[40:43], v[160:163], v[92:95], v[40:43]
    ds_read_b64_tr_b16 v[128:129], v33 offset:4096
    ds_read_b64_tr_b16 v[130:131], v33 offset:4608
    v_mfma_f32_16x16x32_bf16 v[44:47], v[156:159], v[96:99], v[44:47]
    ds_read_b128 v[64:67], v22 offset:36864
    v_mfma_f32_16x16x32_bf16 v[48:51], v[160:163], v[96:99], v[48:51]
    ds_read_b128 v[68:71], v24 offset:32768
    ds_read_b64_tr_b16 v[132:133], v30 offset:8192
    v_mfma_f32_16x16x32_bf16 v[36:39], v[164:167], v[100:103], v[36:39]
    ds_read_b64_tr_b16 v[134:135], v30 offset:8704
    v_mfma_f32_16x16x32_bf16 v[40:43], v[168:171], v[100:103], v[40:43]
    ds_read_b64_tr_b16 v[136:137], v33 offset:8192
    ds_read_b64_tr_b16 v[138:139], v33 offset:8704
    v_mfma_f32_16x16x32_bf16 v[44:47], v[164:167], v[104:107], v[44:47]
    ds_read_b128 v[72:75], v24 offset:36864
    v_mfma_f32_16x16x32_bf16 v[48:51], v[168:171], v[104:107], v[48:51]
    ds_read_b128 v[76:79], v26 offset:32768
    ds_read_b64_tr_b16 v[140:141], v30 offset:12288
    v_mfma_f32_16x16x32_bf16 v[36:39], v[172:175], v[108:111], v[36:39]
    ds_read_b64_tr_b16 v[142:143], v30 offset:12800
    v_mfma_f32_16x16x32_bf16 v[40:43], v[176:179], v[108:111], v[40:43]
    ds_read_b64_tr_b16 v[144:145], v33 offset:12288
    ds_read_b64_tr_b16 v[146:147], v33 offset:12800
    v_mfma_f32_16x16x32_bf16 v[44:47], v[172:175], v[112:115], v[44:47]
    ds_read_b128 v[80:83], v26 offset:36864
    v_mfma_f32_16x16x32_bf16 v[48:51], v[176:179], v[112:115], v[48:51]
    s_waitcnt lgkmcnt(0)
    s_barrier
    ds_read_b128 v[84:87], v20 offset:49152
    ds_read_b64_tr_b16 v[148:149], v29 offset:0
    v_mfma_f32_16x16x32_bf16 v[36:39], v[116:119], v[52:55], v[36:39]
    ds_read_b64_tr_b16 v[150:151], v29 offset:512
    v_mfma_f32_16x16x32_bf16 v[40:43], v[120:123], v[52:55], v[40:43]
    ds_read_b64_tr_b16 v[152:153], v32 offset:0
    ds_read_b64_tr_b16 v[154:155], v32 offset:512
    v_mfma_f32_16x16x32_bf16 v[44:47], v[116:119], v[56:59], v[44:47]
    ds_read_b128 v[88:91], v20 offset:53248
    v_mfma_f32_16x16x32_bf16 v[48:51], v[120:123], v[56:59], v[48:51]
    ds_read_b128 v[92:95], v22 offset:49152
    ds_read_b64_tr_b16 v[156:157], v29 offset:4096
    v_mfma_f32_16x16x32_bf16 v[36:39], v[124:127], v[60:63], v[36:39]
    ds_read_b64_tr_b16 v[158:159], v29 offset:4608
    v_mfma_f32_16x16x32_bf16 v[40:43], v[128:131], v[60:63], v[40:43]
    ds_read_b64_tr_b16 v[160:161], v32 offset:4096
    ds_read_b64_tr_b16 v[162:163], v32 offset:4608
    v_mfma_f32_16x16x32_bf16 v[44:47], v[124:127], v[64:67], v[44:47]
    ds_read_b128 v[96:99], v22 offset:53248
    v_mfma_f32_16x16x32_bf16 v[48:51], v[128:131], v[64:67], v[48:51]
    ds_read_b128 v[100:103], v24 offset:49152
    ds_read_b64_tr_b16 v[164:165], v29 offset:8192
    v_mfma_f32_16x16x32_bf16 v[36:39], v[132:135], v[68:71], v[36:39]
    ds_read_b64_tr_b16 v[166:167], v29 offset:8704
    v_mfma_f32_16x16x32_bf16 v[40:43], v[136:139], v[68:71], v[40:43]
    ds_read_b64_tr_b16 v[168:169], v32 offset:8192
    ds_read_b64_tr_b16 v[170:171], v32 offset:8704
    v_mfma_f32_16x16x32_bf16 v[44:47], v[132:135], v[72:75], v[44:47]
    ds_read_b128 v[104:107], v24 offset:53248
    v_mfma_f32_16x16x32_bf16 v[48:51], v[136:139], v[72:75], v[48:51]
    ds_read_b128 v[108:111], v26 offset:49152
    ds_read_b64_tr_b16 v[172:173], v29 offset:12288
    v_mfma_f32_16x16x32_bf16 v[36:39], v[140:143], v[76:79], v[36:39]
    ds_read_b64_tr_b16 v[174:175], v29 offset:12800
    v_mfma_f32_16x16x32_bf16 v[40:43], v[144:147], v[76:79], v[40:43]
    ds_read_b64_tr_b16 v[176:177], v32 offset:12288
    ds_read_b64_tr_b16 v[178:179], v32 offset:12800
    v_mfma_f32_16x16x32_bf16 v[44:47], v[140:143], v[80:83], v[44:47]
    ds_read_b128 v[112:115], v26 offset:53248
    v_mfma_f32_16x16x32_bf16 v[48:51], v[144:147], v[80:83], v[48:51]
    s_waitcnt lgkmcnt(0)
    s_barrier
    ds_read_b128 v[52:55], v20 offset:0
    ds_read_b64_tr_b16 v[116:117], v29 offset:16384
    v_mfma_f32_16x16x32_bf16 v[36:39], v[148:151], v[84:87], v[36:39]
    ds_read_b64_tr_b16 v[118:119], v29 offset:16896
    v_mfma_f32_16x16x32_bf16 v[40:43], v[152:155], v[84:87], v[40:43]
    ds_read_b64_tr_b16 v[120:121], v32 offset:16384
    ds_read_b64_tr_b16 v[122:123], v32 offset:16896
    v_mfma_f32_16x16x32_bf16 v[44:47], v[148:151], v[88:91], v[44:47]
    ds_read_b128 v[56:59], v20 offset:4096
    v_mfma_f32_16x16x32_bf16 v[48:51], v[152:155], v[88:91], v[48:51]
    ds_read_b128 v[60:63], v22 offset:0
    ds_read_b64_tr_b16 v[124:125], v29 offset:20480
    v_mfma_f32_16x16x32_bf16 v[36:39], v[156:159], v[92:95], v[36:39]
    ds_read_b64_tr_b16 v[126:127], v29 offset:20992
    v_mfma_f32_16x16x32_bf16 v[40:43], v[160:163], v[92:95], v[40:43]
    ds_read_b64_tr_b16 v[128:129], v32 offset:20480
    ds_read_b64_tr_b16 v[130:131], v32 offset:20992
    v_mfma_f32_16x16x32_bf16 v[44:47], v[156:159], v[96:99], v[44:47]
    ds_read_b128 v[64:67], v22 offset:4096
    v_mfma_f32_16x16x32_bf16 v[48:51], v[160:163], v[96:99], v[48:51]
    ds_read_b128 v[68:71], v24 offset:0
    ds_read_b64_tr_b16 v[132:133], v29 offset:24576
    v_mfma_f32_16x16x32_bf16 v[36:39], v[164:167], v[100:103], v[36:39]
    ds_read_b64_tr_b16 v[134:135], v29 offset:25088
    v_mfma_f32_16x16x32_bf16 v[40:43], v[168:171], v[100:103], v[40:43]
    ds_read_b64_tr_b16 v[136:137], v32 offset:24576
    ds_read_b64_tr_b16 v[138:139], v32 offset:25088
    v_mfma_f32_16x16x32_bf16 v[44:47], v[164:167], v[104:107], v[44:47]
    ds_read_b128 v[72:75], v24 offset:4096
    v_mfma_f32_16x16x32_bf16 v[48:51], v[168:171], v[104:107], v[48:51]
    ds_read_b128 v[76:79], v26 offset:0
    ds_read_b64_tr_b16 v[140:141], v29 offset:28672
    v_mfma_f32_16x16x32_bf16 v[36:39], v[172:175], v[108:111], v[36:39]
    ds_read_b64_tr_b16 v[142:143], v29 offset:29184
    v_mfma_f32_16x16x32_bf16 v[40:43], v[176:179], v[108:111], v[40:43]
    ds_read_b64_tr_b16 v[144:145], v32 offset:28672
    ds_read_b64_tr_b16 v[146:147], v32 offset:29184
    v_mfma_f32_16x16x32_bf16 v[44:47], v[172:175], v[112:115], v[44:47]
    ds_read_b128 v[80:83], v26 offset:4096
    v_mfma_f32_16x16x32_bf16 v[48:51], v[176:179], v[112:115], v[48:51]
    s_waitcnt lgkmcnt(0)
    s_barrier
    ds_read_b128 v[84:87], v20 offset:16384
    ds_read_b64_tr_b16 v[148:149], v29 offset:32768
    v_mfma_f32_16x16x32_bf16 v[36:39], v[116:119], v[52:55], v[36:39]
    ds_read_b64_tr_b16 v[150:151], v29 offset:33280
    v_mfma_f32_16x16x32_bf16 v[40:43], v[120:123], v[52:55], v[40:43]
    ds_read_b64_tr_b16 v[152:153], v32 offset:32768
    ds_read_b64_tr_b16 v[154:155], v32 offset:33280
    v_mfma_f32_16x16x32_bf16 v[44:47], v[116:119], v[56:59], v[44:47]
    ds_read_b128 v[88:91], v20 offset:20480
    v_mfma_f32_16x16x32_bf16 v[48:51], v[120:123], v[56:59], v[48:51]
    ds_read_b128 v[92:95], v22 offset:16384
    ds_read_b64_tr_b16 v[156:157], v29 offset:36864
    v_mfma_f32_16x16x32_bf16 v[36:39], v[124:127], v[60:63], v[36:39]
    ds_read_b64_tr_b16 v[158:159], v29 offset:37376
    v_mfma_f32_16x16x32_bf16 v[40:43], v[128:131], v[60:63], v[40:43]
    ds_read_b64_tr_b16 v[160:161], v32 offset:36864
    ds_read_b64_tr_b16 v[162:163], v32 offset:37376
    v_mfma_f32_16x16x32_bf16 v[44:47], v[124:127], v[64:67], v[44:47]
    ds_read_b128 v[96:99], v22 offset:20480
    v_mfma_f32_16x16x32_bf16 v[48:51], v[128:131], v[64:67], v[48:51]
    ds_read_b128 v[100:103], v24 offset:16384
    ds_read_b64_tr_b16 v[164:165], v29 offset:40960
    v_mfma_f32_16x16x32_bf16 v[36:39], v[132:135], v[68:71], v[36:39]
    ds_read_b64_tr_b16 v[166:167], v29 offset:41472
    v_mfma_f32_16x16x32_bf16 v[40:43], v[136:139], v[68:71], v[40:43]
    ds_read_b64_tr_b16 v[168:169], v32 offset:40960
    ds_read_b64_tr_b16 v[170:171], v32 offset:41472
    v_mfma_f32_16x16x32_bf16 v[44:47], v[132:135], v[72:75], v[44:47]
    ds_read_b128 v[104:107], v24 offset:20480
    v_mfma_f32_16x16x32_bf16 v[48:51], v[136:139], v[72:75], v[48:51]
    ds_read_b128 v[108:111], v26 offset:16384
    ds_read_b64_tr_b16 v[172:173], v29 offset:45056
    v_mfma_f32_16x16x32_bf16 v[36:39], v[140:143], v[76:79], v[36:39]
    ds_read_b64_tr_b16 v[174:175], v29 offset:45568
    v_mfma_f32_16x16x32_bf16 v[40:43], v[144:147], v[76:79], v[40:43]
    ds_read_b64_tr_b16 v[176:177], v32 offset:45056
    ds_read_b64_tr_b16 v[178:179], v32 offset:45568
    v_mfma_f32_16x16x32_bf16 v[44:47], v[140:143], v[80:83], v[44:47]
    ds_read_b128 v[112:115], v26 offset:20480
    v_mfma_f32_16x16x32_bf16 v[48:51], v[144:147], v[80:83], v[48:51]
    s_waitcnt lgkmcnt(0)
    s_barrier
    ds_read_b128 v[52:55], v20 offset:32768
    ds_read_b64_tr_b16 v[116:117], v29 offset:49152
    v_mfma_f32_16x16x32_bf16 v[36:39], v[148:151], v[84:87], v[36:39]
    ds_read_b64_tr_b16 v[118:119], v29 offset:49664
    v_mfma_f32_16x16x32_bf16 v[40:43], v[152:155], v[84:87], v[40:43]
    ds_read_b64_tr_b16 v[120:121], v32 offset:49152
    ds_read_b64_tr_b16 v[122:123], v32 offset:49664
    v_mfma_f32_16x16x32_bf16 v[44:47], v[148:151], v[88:91], v[44:47]
    ds_read_b128 v[56:59], v20 offset:36864
    v_mfma_f32_16x16x32_bf16 v[48:51], v[152:155], v[88:91], v[48:51]
    ds_read_b128 v[60:63], v22 offset:32768
    ds_read_b64_tr_b16 v[124:125], v29 offset:53248
    v_mfma_f32_16x16x32_bf16 v[36:39], v[156:159], v[92:95], v[36:39]
    ds_read_b64_tr_b16 v[126:127], v29 offset:53760
    v_mfma_f32_16x16x32_bf16 v[40:43], v[160:163], v[92:95], v[40:43]
    ds_read_b64_tr_b16 v[128:129], v32 offset:53248
    ds_read_b64_tr_b16 v[130:131], v32 offset:53760
    v_mfma_f32_16x16x32_bf16 v[44:47], v[156:159], v[96:99], v[44:47]
    ds_read_b128 v[64:67], v22 offset:36864
    v_mfma_f32_16x16x32_bf16 v[48:51], v[160:163], v[96:99], v[48:51]
    ds_read_b128 v[68:71], v24 offset:32768
    ds_read_b64_tr_b16 v[132:133], v29 offset:57344
    v_mfma_f32_16x16x32_bf16 v[36:39], v[164:167], v[100:103], v[36:39]
    ds_read_b64_tr_b16 v[134:135], v29 offset:57856
    v_mfma_f32_16x16x32_bf16 v[40:43], v[168:171], v[100:103], v[40:43]
    ds_read_b64_tr_b16 v[136:137], v32 offset:57344
    ds_read_b64_tr_b16 v[138:139], v32 offset:57856
    v_mfma_f32_16x16x32_bf16 v[44:47], v[164:167], v[104:107], v[44:47]
    ds_read_b128 v[72:75], v24 offset:36864
    v_mfma_f32_16x16x32_bf16 v[48:51], v[168:171], v[104:107], v[48:51]
    ds_read_b128 v[76:79], v26 offset:32768
    ds_read_b64_tr_b16 v[140:141], v29 offset:61440
    v_mfma_f32_16x16x32_bf16 v[36:39], v[172:175], v[108:111], v[36:39]
    ds_read_b64_tr_b16 v[142:143], v29 offset:61952
    v_mfma_f32_16x16x32_bf16 v[40:43], v[176:179], v[108:111], v[40:43]
    ds_read_b64_tr_b16 v[144:145], v32 offset:61440
    ds_read_b64_tr_b16 v[146:147], v32 offset:61952
    v_mfma_f32_16x16x32_bf16 v[44:47], v[172:175], v[112:115], v[44:47]
    ds_read_b128 v[80:83], v26 offset:36864
    v_mfma_f32_16x16x32_bf16 v[48:51], v[176:179], v[112:115], v[48:51]
    s_waitcnt lgkmcnt(0)
    s_barrier
    ds_read_b128 v[84:87], v20 offset:49152
    ds_read_b64_tr_b16 v[148:149], v30 offset:0
    v_mfma_f32_16x16x32_bf16 v[36:39], v[116:119], v[52:55], v[36:39]
    ds_read_b64_tr_b16 v[150:151], v30 offset:512
    v_mfma_f32_16x16x32_bf16 v[40:43], v[120:123], v[52:55], v[40:43]
    ds_read_b64_tr_b16 v[152:153], v33 offset:0
    ds_read_b64_tr_b16 v[154:155], v33 offset:512
    v_mfma_f32_16x16x32_bf16 v[44:47], v[116:119], v[56:59], v[44:47]
    ds_read_b128 v[88:91], v20 offset:53248
    v_mfma_f32_16x16x32_bf16 v[48:51], v[120:123], v[56:59], v[48:51]
    ds_read_b128 v[92:95], v22 offset:49152
    ds_read_b64_tr_b16 v[156:157], v30 offset:4096
    v_mfma_f32_16x16x32_bf16 v[36:39], v[124:127], v[60:63], v[36:39]
    ds_read_b64_tr_b16 v[158:159], v30 offset:4608
    v_mfma_f32_16x16x32_bf16 v[40:43], v[128:131], v[60:63], v[40:43]
    ds_read_b64_tr_b16 v[160:161], v33 offset:4096
    ds_read_b64_tr_b16 v[162:163], v33 offset:4608
    v_mfma_f32_16x16x32_bf16 v[44:47], v[124:127], v[64:67], v[44:47]
    ds_read_b128 v[96:99], v22 offset:53248
    v_mfma_f32_16x16x32_bf16 v[48:51], v[128:131], v[64:67], v[48:51]
    ds_read_b128 v[100:103], v24 offset:49152
    ds_read_b64_tr_b16 v[164:165], v30 offset:8192
    v_mfma_f32_16x16x32_bf16 v[36:39], v[132:135], v[68:71], v[36:39]
    ds_read_b64_tr_b16 v[166:167], v30 offset:8704
    v_mfma_f32_16x16x32_bf16 v[40:43], v[136:139], v[68:71], v[40:43]
    ds_read_b64_tr_b16 v[168:169], v33 offset:8192
    ds_read_b64_tr_b16 v[170:171], v33 offset:8704
    v_mfma_f32_16x16x32_bf16 v[44:47], v[132:135], v[72:75], v[44:47]
    ds_read_b128 v[104:107], v24 offset:53248
    v_mfma_f32_16x16x32_bf16 v[48:51], v[136:139], v[72:75], v[48:51]
    ds_read_b128 v[108:111], v26 offset:49152
    ds_read_b64_tr_b16 v[172:173], v30 offset:12288
    v_mfma_f32_16x16x32_bf16 v[36:39], v[140:143], v[76:79], v[36:39]
    ds_read_b64_tr_b16 v[174:175], v30 offset:12800
    v_mfma_f32_16x16x32_bf16 v[40:43], v[144:147], v[76:79], v[40:43]
    ds_read_b64_tr_b16 v[176:177], v33 offset:12288
    ds_read_b64_tr_b16 v[178:179], v33 offset:12800
    v_mfma_f32_16x16x32_bf16 v[44:47], v[140:143], v[80:83], v[44:47]
    ds_read_b128 v[112:115], v26 offset:53248
    v_mfma_f32_16x16x32_bf16 v[48:51], v[144:147], v[80:83], v[48:51]
    s_waitcnt lgkmcnt(0)
    s_barrier
    ds_read_b128 v[52:55], v20 offset:0
    ds_read_b64_tr_b16 v[116:117], v29 offset:0
    v_mfma_f32_16x16x32_bf16 v[36:39], v[148:151], v[84:87], v[36:39]
    ds_read_b64_tr_b16 v[118:119], v29 offset:512
    v_mfma_f32_16x16x32_bf16 v[40:43], v[152:155], v[84:87], v[40:43]
    ds_read_b64_tr_b16 v[120:121], v32 offset:0
    ds_read_b64_tr_b16 v[122:123], v32 offset:512
    v_mfma_f32_16x16x32_bf16 v[44:47], v[148:151], v[88:91], v[44:47]
    ds_read_b128 v[56:59], v20 offset:4096
    v_mfma_f32_16x16x32_bf16 v[48:51], v[152:155], v[88:91], v[48:51]
    ds_read_b128 v[60:63], v22 offset:0
    ds_read_b64_tr_b16 v[124:125], v29 offset:4096
    v_mfma_f32_16x16x32_bf16 v[36:39], v[156:159], v[92:95], v[36:39]
    ds_read_b64_tr_b16 v[126:127], v29 offset:4608
    v_mfma_f32_16x16x32_bf16 v[40:43], v[160:163], v[92:95], v[40:43]
    ds_read_b64_tr_b16 v[128:129], v32 offset:4096
    ds_read_b64_tr_b16 v[130:131], v32 offset:4608
    v_mfma_f32_16x16x32_bf16 v[44:47], v[156:159], v[96:99], v[44:47]
    ds_read_b128 v[64:67], v22 offset:4096
    v_mfma_f32_16x16x32_bf16 v[48:51], v[160:163], v[96:99], v[48:51]
    ds_read_b128 v[68:71], v24 offset:0
    ds_read_b64_tr_b16 v[132:133], v29 offset:8192
    v_mfma_f32_16x16x32_bf16 v[36:39], v[164:167], v[100:103], v[36:39]
    ds_read_b64_tr_b16 v[134:135], v29 offset:8704
    v_mfma_f32_16x16x32_bf16 v[40:43], v[168:171], v[100:103], v[40:43]
    ds_read_b64_tr_b16 v[136:137], v32 offset:8192
    ds_read_b64_tr_b16 v[138:139], v32 offset:8704
    v_mfma_f32_16x16x32_bf16 v[44:47], v[164:167], v[104:107], v[44:47]
    ds_read_b128 v[72:75], v24 offset:4096
    v_mfma_f32_16x16x32_bf16 v[48:51], v[168:171], v[104:107], v[48:51]
    ds_read_b128 v[76:79], v26 offset:0
    ds_read_b64_tr_b16 v[140:141], v29 offset:12288
    v_mfma_f32_16x16x32_bf16 v[36:39], v[172:175], v[108:111], v[36:39]
    ds_read_b64_tr_b16 v[142:143], v29 offset:12800
    v_mfma_f32_16x16x32_bf16 v[40:43], v[176:179], v[108:111], v[40:43]
    ds_read_b64_tr_b16 v[144:145], v32 offset:12288
    ds_read_b64_tr_b16 v[146:147], v32 offset:12800
    v_mfma_f32_16x16x32_bf16 v[44:47], v[172:175], v[112:115], v[44:47]
    ds_read_b128 v[80:83], v26 offset:4096
    v_mfma_f32_16x16x32_bf16 v[48:51], v[176:179], v[112:115], v[48:51]
    s_waitcnt lgkmcnt(0)
    s_barrier
    ds_read_b128 v[84:87], v20 offset:16384
    ds_read_b64_tr_b16 v[148:149], v29 offset:16384
    v_mfma_f32_16x16x32_bf16 v[36:39], v[116:119], v[52:55], v[36:39]
    ds_read_b64_tr_b16 v[150:151], v29 offset:16896
    v_mfma_f32_16x16x32_bf16 v[40:43], v[120:123], v[52:55], v[40:43]
    ds_read_b64_tr_b16 v[152:153], v32 offset:16384
    ds_read_b64_tr_b16 v[154:155], v32 offset:16896
    v_mfma_f32_16x16x32_bf16 v[44:47], v[116:119], v[56:59], v[44:47]
    ds_read_b128 v[88:91], v20 offset:20480
    v_mfma_f32_16x16x32_bf16 v[48:51], v[120:123], v[56:59], v[48:51]
    ds_read_b128 v[92:95], v22 offset:16384
    ds_read_b64_tr_b16 v[156:157], v29 offset:20480
    v_mfma_f32_16x16x32_bf16 v[36:39], v[124:127], v[60:63], v[36:39]
    ds_read_b64_tr_b16 v[158:159], v29 offset:20992
    v_mfma_f32_16x16x32_bf16 v[40:43], v[128:131], v[60:63], v[40:43]
    ds_read_b64_tr_b16 v[160:161], v32 offset:20480
    ds_read_b64_tr_b16 v[162:163], v32 offset:20992
    v_mfma_f32_16x16x32_bf16 v[44:47], v[124:127], v[64:67], v[44:47]
    ds_read_b128 v[96:99], v22 offset:20480
    v_mfma_f32_16x16x32_bf16 v[48:51], v[128:131], v[64:67], v[48:51]
    ds_read_b128 v[100:103], v24 offset:16384
    ds_read_b64_tr_b16 v[164:165], v29 offset:24576
    v_mfma_f32_16x16x32_bf16 v[36:39], v[132:135], v[68:71], v[36:39]
    ds_read_b64_tr_b16 v[166:167], v29 offset:25088
    v_mfma_f32_16x16x32_bf16 v[40:43], v[136:139], v[68:71], v[40:43]
    ds_read_b64_tr_b16 v[168:169], v32 offset:24576
    ds_read_b64_tr_b16 v[170:171], v32 offset:25088
    v_mfma_f32_16x16x32_bf16 v[44:47], v[132:135], v[72:75], v[44:47]
    ds_read_b128 v[104:107], v24 offset:20480
    v_mfma_f32_16x16x32_bf16 v[48:51], v[136:139], v[72:75], v[48:51]
    ds_read_b128 v[108:111], v26 offset:16384
    ds_read_b64_tr_b16 v[172:173], v29 offset:28672
    v_mfma_f32_16x16x32_bf16 v[36:39], v[140:143], v[76:79], v[36:39]
    ds_read_b64_tr_b16 v[174:175], v29 offset:29184
    v_mfma_f32_16x16x32_bf16 v[40:43], v[144:147], v[76:79], v[40:43]
    ds_read_b64_tr_b16 v[176:177], v32 offset:28672
    ds_read_b64_tr_b16 v[178:179], v32 offset:29184
    v_mfma_f32_16x16x32_bf16 v[44:47], v[140:143], v[80:83], v[44:47]
    ds_read_b128 v[112:115], v26 offset:20480
    v_mfma_f32_16x16x32_bf16 v[48:51], v[144:147], v[80:83], v[48:51]
    s_waitcnt lgkmcnt(15)
    v_mfma_f32_16x16x32_bf16 v[36:39], v[148:151], v[84:87], v[36:39]
    v_mfma_f32_16x16x32_bf16 v[40:43], v[152:155], v[84:87], v[40:43]
    v_mfma_f32_16x16x32_bf16 v[44:47], v[148:151], v[88:91], v[44:47]
    v_mfma_f32_16x16x32_bf16 v[48:51], v[152:155], v[88:91], v[48:51]
    v_mfma_f32_16x16x32_bf16 v[36:39], v[156:159], v[92:95], v[36:39]
    s_waitcnt lgkmcnt(13)
    v_mfma_f32_16x16x32_bf16 v[40:43], v[160:163], v[92:95], v[40:43]
    s_waitcnt lgkmcnt(12)
    v_mfma_f32_16x16x32_bf16 v[44:47], v[156:159], v[96:99], v[44:47]
    v_mfma_f32_16x16x32_bf16 v[48:51], v[160:163], v[96:99], v[48:51]
    s_waitcnt lgkmcnt(9)
    v_mfma_f32_16x16x32_bf16 v[36:39], v[164:167], v[100:103], v[36:39]
    s_waitcnt lgkmcnt(7)
    v_mfma_f32_16x16x32_bf16 v[40:43], v[168:171], v[100:103], v[40:43]
    s_waitcnt lgkmcnt(6)
    v_mfma_f32_16x16x32_bf16 v[44:47], v[164:167], v[104:107], v[44:47]
    v_mfma_f32_16x16x32_bf16 v[48:51], v[168:171], v[104:107], v[48:51]
    s_waitcnt lgkmcnt(3)
    v_mfma_f32_16x16x32_bf16 v[36:39], v[172:175], v[108:111], v[36:39]
    s_waitcnt lgkmcnt(1)
    v_mfma_f32_16x16x32_bf16 v[40:43], v[176:179], v[108:111], v[40:43]
    s_waitcnt lgkmcnt(0)
    v_mfma_f32_16x16x32_bf16 v[44:47], v[172:175], v[112:115], v[44:47]
    v_mfma_f32_16x16x32_bf16 v[48:51], v[176:179], v[112:115], v[48:51]
    s_barrier
    v_add_u32 v180, s52, v2
    v_mul_u32_u24 v180, 144, v180
    v_lshl_add_u32 v180, v3, 3, v180
    s_lshl_b32 s57, s53, 6
    v_add_u32 v180, s57, v180
    v_cvt_pk_bf16_f32 v36, v36, v37
    v_cvt_pk_bf16_f32 v37, v38, v39
    ds_write_b64 v180, v[36:37] offset:0
    v_cvt_pk_bf16_f32 v40, v40, v41
    v_cvt_pk_bf16_f32 v41, v42, v43
    ds_write_b64 v180, v[40:41] offset:32
    v_cvt_pk_bf16_f32 v44, v44, v45
    v_cvt_pk_bf16_f32 v45, v46, v47
    ds_write_b64 v180, v[44:45] offset:2304
    v_cvt_pk_bf16_f32 v48, v48, v49
    v_cvt_pk_bf16_f32 v49, v50, v51
    ds_write_b64 v180, v[48:49] offset:2336
    s_waitcnt lgkmcnt(0)
    s_mov_b32 s40, s16
    s_and_b32 s41, s17, 0xffff
    s_mov_b32 s42, 2097152
    s_mov_b32 s43, 0x20000
    s_barrier
    v_lshrrev_b32 v42, 3, v0
    v_and_b32 v43, 7, v0
    v_mul_u32_u24 v32, 144, v42
    v_lshl_add_u32 v32, v43, 4, v32
    ds_read_b128 v[24:27], v32
    ds_read_b128 v[28:31], v32 offset:4608
    v_add_u32 v42, s50, v42
    v_lshlrev_b32 v33, 10, v42
    v_lshl_add_u32 v33, v43, 4, v33
    v_add_u32 v33, s54, v33
    s_waitcnt lgkmcnt(1)
    v_lshlrev_b32 v42, 16, v24
    v_and_b32 v43, 0xffff0000, v24
    s_waitcnt vmcnt(1)
    v_lshlrev_b32 v44, 16, v12
    v_and_b32 v45, 0xffff0000, v12
    v_add_f32 v42, v42, v44
    v_add_f32 v43, v43, v45
    v_cvt_pk_bf16_f32 v24, v42, v43
    v_lshlrev_b32 v42, 16, v25
    v_and_b32 v43, 0xffff0000, v25
    v_lshlrev_b32 v44, 16, v13
    v_and_b32 v45, 0xffff0000, v13
    v_add_f32 v42, v42, v44
    v_add_f32 v43, v43, v45
    v_cvt_pk_bf16_f32 v25, v42, v43
    v_lshlrev_b32 v42, 16, v26
    v_and_b32 v43, 0xffff0000, v26
    v_lshlrev_b32 v44, 16, v14
    v_and_b32 v45, 0xffff0000, v14
    v_add_f32 v42, v42, v44
    v_add_f32 v43, v43, v45
    v_cvt_pk_bf16_f32 v26, v42, v43
    v_lshlrev_b32 v42, 16, v27
    v_and_b32 v43, 0xffff0000, v27
    v_lshlrev_b32 v44, 16, v15
    v_and_b32 v45, 0xffff0000, v15
    v_add_f32 v42, v42, v44
    v_add_f32 v43, v43, v45
    v_cvt_pk_bf16_f32 v27, v42, v43
    s_waitcnt lgkmcnt(0)
    v_lshlrev_b32 v42, 16, v28
    v_and_b32 v43, 0xffff0000, v28
    s_waitcnt vmcnt(0)
    v_lshlrev_b32 v44, 16, v16
    v_and_b32 v45, 0xffff0000, v16
    v_add_f32 v42, v42, v44
    v_add_f32 v43, v43, v45
    v_cvt_pk_bf16_f32 v28, v42, v43
    v_lshlrev_b32 v42, 16, v29
    v_and_b32 v43, 0xffff0000, v29
    v_lshlrev_b32 v44, 16, v17
    v_and_b32 v45, 0xffff0000, v17
    v_add_f32 v42, v42, v44
    v_add_f32 v43, v43, v45
    v_cvt_pk_bf16_f32 v29, v42, v43
    v_lshlrev_b32 v42, 16, v30
    v_and_b32 v43, 0xffff0000, v30
    v_lshlrev_b32 v44, 16, v18
    v_and_b32 v45, 0xffff0000, v18
    v_add_f32 v42, v42, v44
    v_add_f32 v43, v43, v45
    v_cvt_pk_bf16_f32 v30, v42, v43
    v_lshlrev_b32 v42, 16, v31
    v_and_b32 v43, 0xffff0000, v31
    v_lshlrev_b32 v44, 16, v19
    v_and_b32 v45, 0xffff0000, v19
    v_add_f32 v42, v42, v44
    v_add_f32 v43, v43, v45
    v_cvt_pk_bf16_f32 v31, v42, v43
    s_mov_b32 s60, 32768
    buffer_store_dwordx4 v[24:27], v33, s[40:43], 0 offen
    buffer_store_dwordx4 v[28:31], v33, s[40:43], s60 offen
kC_kernel_end:
    s_endpgm
all_code_end:
.section .rodata,"a"
.p2align 6
.amdhsa_kernel kA_kernel
  .amdhsa_next_free_vgpr 256
  .amdhsa_next_free_sgpr 100
  .amdhsa_accum_offset 252
  .amdhsa_group_segment_fixed_size 0
  .amdhsa_kernarg_size 72
  .amdhsa_user_sgpr_count 2
  .amdhsa_user_sgpr_kernarg_segment_ptr 1
  .amdhsa_system_sgpr_workgroup_id_x 1
  .amdhsa_float_denorm_mode_32 3
.end_amdhsa_kernel
.p2align 6
.amdhsa_kernel kB_kernel
  .amdhsa_next_free_vgpr 232
  .amdhsa_next_free_sgpr 100
  .amdhsa_accum_offset 232
  .amdhsa_group_segment_fixed_size 0
  .amdhsa_kernarg_size 72
  .amdhsa_user_sgpr_count 2
  .amdhsa_user_sgpr_kernarg_segment_ptr 1
  .amdhsa_system_sgpr_workgroup_id_x 1
  .amdhsa_float_denorm_mode_32 3
.end_amdhsa_kernel
.p2align 6
.amdhsa_kernel kC_kernel
  .amdhsa_next_free_vgpr 232
  .amdhsa_next_free_sgpr 100
  .amdhsa_accum_offset 232
  .amdhsa_group_segment_fixed_size 0
  .amdhsa_kernarg_size 72
  .amdhsa_user_sgpr_count 2
  .amdhsa_user_sgpr_kernarg_segment_ptr 1
  .amdhsa_system_sgpr_workgroup_id_x 1
  .amdhsa_float_denorm_mode_32 3
.end_amdhsa_kernel
```
